```python
import torch

def _softmax(x, axis=-1):
    return torch.softmax(x, dim=axis)
def _gelu(x):
    return torch.nn.functional.gelu(x, approximate="tanh")
def _silu(x):
    return torch.nn.functional.silu(x)
def _sigmoid(x):
    return torch.sigmoid(x)
def _layernorm(x, axis=-1, eps=1e-5):
    m = x.mean(dim=axis, keepdim=True)
    v = x.var(dim=axis, keepdim=True, unbiased=False)
    return (x - m) / torch.sqrt(v + eps)
def _scatter_add(tgt, idx, src, axis=0):
    return tgt.clone().index_add_(axis, idx, src)
def _segment_sum(src, seg, n):
    out = torch.zeros((n,) + src.shape[1:], dtype=src.dtype)
    return out.index_add_(0, seg, src)
def _pad(x, pw):
    flat = tuple(v for pair in reversed(pw) for v in pair)
    return torch.nn.functional.pad(x, flat)

kernel_name = 'concat_heads__mha_block_cached__mha_block_cached__near_ridge'

def setup_inputs():

    _w = (lambda a: (lambda t: t.to(torch.bfloat16) if t.is_floating_point() else t)(torch.as_tensor(a)))
    def _A_setup():
        B, Sq, D = 16, 96, 512
        H, Sk, Dh = 32, 512, 128
        return {
            "x": _w((lambda *s: torch.randn(*s, dtype=torch.bfloat16) * 0.8)(B, Sq, D)),
            "k_cache": _w((lambda *s: torch.randn(*s, dtype=torch.bfloat16) * 0.8)(B, H, Sk, Dh)),
            "v_cache": _w((lambda *s: torch.randn(*s, dtype=torch.bfloat16) * 0.05)(B, H, Sk, Dh)),
            "wq": _w((lambda *s: torch.randn(*s, dtype=torch.bfloat16) * 0.8)(D, H * Dh) * (D ** -0.5)),
            "wo": _w((lambda *s: torch.randn(*s, dtype=torch.bfloat16) * 0.05)(H * Dh, D) * ((H * Dh) ** -0.5)),
        }
    _A_in = _A_setup()

    def _B_setup():
        B, Sq, D = 16, 96, 512
        H, Sk, Dh = 32, 512, 128
        return {
            "x": _w((lambda *s: torch.randn(*s, dtype=torch.bfloat16) * 0.8)(B, Sq, D)),
            "k_cache": _w((lambda *s: torch.randn(*s, dtype=torch.bfloat16) * 0.8)(B, H, Sk, Dh)),
            "v_cache": _w((lambda *s: torch.randn(*s, dtype=torch.bfloat16) * 0.05)(B, H, Sk, Dh)),
            "wq": _w((lambda *s: torch.randn(*s, dtype=torch.bfloat16) * 0.8)(D, H * Dh) * (D ** -0.5)),
            "wo": _w((lambda *s: torch.randn(*s, dtype=torch.bfloat16) * 0.05)(H * Dh, D) * ((H * Dh) ** -0.5)),
        }
    _B_in = _B_setup()

    return {
        "A_x": _A_in["x"],
        "A_k_cache": _A_in["k_cache"],
        "A_v_cache": _A_in["v_cache"],
        "A_wq": _A_in["wq"],
        "A_wo": _A_in["wo"],
        "B_x": _B_in["x"],
        "B_k_cache": _B_in["k_cache"],
        "B_v_cache": _B_in["v_cache"],
        "B_wq": _B_in["wq"],
        "B_wo": _B_in["wo"],
    }

def reference(A_x, A_k_cache, A_v_cache, A_wq, A_wo, B_x, B_k_cache, B_v_cache, B_wq, B_wo):
    def _A_ref(x, k_cache, v_cache, wq, wo):
        B, Sq, D = x.shape
        H, Dh = 32, 128
        q = (lambda x, *d: x.permute(*d))((x @ wq).reshape(B, Sq, H, Dh), 0, 2, 1, 3)
        scores = torch.einsum("bhqd,bhkd->bhqk", q, k_cache) * (Dh ** -0.5)
        p = _softmax(scores, axis=-1)
        o = torch.einsum("bhqk,bhkd->bhqd", p, v_cache)
        return (lambda x, *d: x.permute(*d))(o, 0, 2, 1, 3).reshape(B, Sq, H * Dh) @ wo

    def _B_ref(x, k_cache, v_cache, wq, wo):
        B, Sq, D = x.shape
        H, Dh = 32, 128
        q = (lambda x, *d: x.permute(*d))((x @ wq).reshape(B, Sq, H, Dh), 0, 2, 1, 3)
        scores = torch.einsum("bhqd,bhkd->bhqk", q, k_cache) * (Dh ** -0.5)
        p = _softmax(scores, axis=-1)
        o = torch.einsum("bhqk,bhkd->bhqd", p, v_cache)
        return (lambda x, *d: x.permute(*d))(o, 0, 2, 1, 3).reshape(B, Sq, H * Dh) @ wo

    a = _A_ref(A_x, A_k_cache, A_v_cache, A_wq, A_wo)
    b = _B_ref(B_x, B_k_cache, B_v_cache, B_wq, B_wo)
    return torch.concatenate([a, b], axis=-1)
```

```asm
; @launch grid=(256,1,1) block=(256,1,1) lds=163840
.amdgcn_target "amdgcn-amd-amdhsa--gfx950"
.text
.globl concat_heads__mha_block_cached__mha_block_cached__near_ridge_kernel
.p2align 8
.type concat_heads__mha_block_cached__mha_block_cached__near_ridge_kernel,@function
concat_heads__mha_block_cached__mha_block_cached__near_ridge_kernel:
s_cmp_ge_u32 s2, 256
s_cbranch_scc1 L_end
s_and_b32 s52, s2, 7
s_lshr_b32 s53, s2, 3
s_lshr_b32 s8, s52, 2
s_mul_i32 s54, s8, 40
s_add_u32 s4, s0, s54
s_addc_u32 s5, s1, 0
s_load_dwordx8 s[20:27], s[4:5], 0
s_load_dwordx2 s[28:29], s[4:5], 32
s_load_dwordx2 s[30:31], s[0:1], 96
s_and_b32 s7, s53, 15
s_lshr_b32 s55, s53, 4
s_and_b32 s52, s52, 3
s_lshl_b32 s9, s52, 1
s_add_u32 s9, s9, s55
s_mul_i32 s52, s52, 1
s_mul_i32 s55, s55, 0
s_add_u32 s71, s7, s52
s_add_u32 s71, s71, s55
s_lshr_b32 s55, s7, 2
s_and_b32 s55, s55, 3
s_add_u32 s54, s55, 0
s_and_b32 s54, s54, 3
s_lshl_b32 s92, s54, 6
s_lshl_b32 s96, s54, 18
s_add_u32 s54, s55, 1
s_and_b32 s54, s54, 3
s_lshl_b32 s93, s54, 6
s_lshl_b32 s97, s54, 18
s_add_u32 s54, s55, 2
s_and_b32 s54, s54, 3
s_lshl_b32 s94, s54, 6
s_lshl_b32 s98, s54, 18
s_add_u32 s54, s55, 3
s_and_b32 s54, s54, 3
s_lshl_b32 s95, s54, 6
s_lshl_b32 s99, s54, 18
v_lshrrev_b32 v244, 6, v0
v_and_b32 v1, 63, v0
v_lshrrev_b32 v250, 4, v1
v_and_b32 v251, 15, v1
v_lshlrev_b32 v148, 1, v250
v_xor_b32 v251, v251, v148
v_lshlrev_b32 v251, 4, v251
v_mul_u32_u24 v250, 1024, v250
v_add_u32 v148, v250, v251
v_xor_b32 v251, 0x80, v251
v_add_u32 v149, v250, v251
v_add_u32 v150, 6144, v148
v_add_u32 v151, 9216, v149
v_add_u32 v149, 3072, v149
v_lshrrev_b32 v250, 4, v1
v_and_b32 v251, 15, v1
v_lshlrev_b32 v240, 1, v250
v_xor_b32 v251, v251, v240
v_lshlrev_b32 v251, 4, v251
v_mul_u32_u24 v250, 8192, v250
v_add_u32 v240, v250, v251
v_xor_b32 v251, 0x80, v251
v_add_u32 v241, v250, v251
v_add_u32 v242, 129024, v240
v_add_u32 v243, 193536, v241
v_add_u32 v241, 64512, v241
s_waitcnt lgkmcnt(0)
v_readfirstlane_b32 s4, v244
s_mov_b32 s36, s20
s_and_b32 s37, s21, 0xffff
s_mov_b32 s38, 1572864
s_mov_b32 s39, 0x20000
s_mov_b32 s32, s26
s_and_b32 s33, s27, 0xffff
s_mov_b32 s34, 4194304
s_mov_b32 s35, 0x20000
s_lshr_b32 s5, s4, 1
s_and_b32 s6, s4, 1
s_add_u32 s52, s71, 0
s_and_b32 s52, s52, 3
s_mul_i32 s53, s52, 24576
s_mul_i32 s70, s4, 6144
s_add_u32 s70, s70, s53
s_lshl_b32 s52, s52, 8
s_mul_i32 s46, s7, 98304
s_add_u32 s46, s46, s52
s_mul_i32 s52, s4, 24576
s_add_u32 s46, s46, s52
s_add_u32 m0, s70, 65536
s_nop 0
buffer_load_dwordx4 v148, s[36:39], s46 offen lds
buffer_load_dwordx4 v149, s[36:39], s46 offen offset:1024 lds
buffer_load_dwordx4 v150, s[36:39], s46 offen offset:2048 lds
buffer_load_dwordx4 v151, s[36:39], s46 offen offset:3072 lds
s_add_u32 s46, s46, 16384
s_add_u32 m0, s70, 69632
s_nop 0
buffer_load_dwordx4 v148, s[36:39], s46 offen lds
buffer_load_dwordx4 v149, s[36:39], s46 offen offset:1024 lds
s_lshl_b32 s47, s4, 12
s_lshl_b32 s52, s9, 1
s_add_u32 s52, s52, s5
s_lshl_b32 s56, s52, 9
s_lshl_b32 s52, s6, 15
s_add_u32 s56, s56, s52
s_add_u32 s52, s71, 0
s_and_b32 s52, s52, 3
s_lshl_b32 s52, s52, 20
s_add_u32 s58, s52, s56
s_add_u32 s45, s58, s96
s_add_u32 m0, s47, 0
s_nop 0
buffer_load_dwordx4 v240, s[32:35], s45 offen lds
buffer_load_dwordx4 v241, s[32:35], s45 offen offset:1024 lds
buffer_load_dwordx4 v242, s[32:35], s45 offen offset:2048 lds
buffer_load_dwordx4 v243, s[32:35], s45 offen offset:3072 lds
s_add_u32 s45, s58, s97
s_add_u32 m0, s47, 16384
s_nop 0
buffer_load_dwordx4 v240, s[32:35], s45 offen lds
buffer_load_dwordx4 v241, s[32:35], s45 offen offset:1024 lds
buffer_load_dwordx4 v242, s[32:35], s45 offen offset:2048 lds
buffer_load_dwordx4 v243, s[32:35], s45 offen offset:3072 lds
s_getpc_b64 s[12:13]
L_pc1:
s_add_u32 s12, s12, L_q0-L_pc1
s_addc_u32 s13, s13, 0
s_and_b32 s13, s13, 0xffff
s_mov_b32 s14, L_codeend-L_q0
s_mov_b32 s15, 0x20000
s_and_b32 s52, s7, 7
s_lshl_b32 s52, s52, 2
s_add_u32 s52, s52, s4
s_lshl_b32 s52, s52, 11
v_and_b32 v249, 15, v1
v_lshlrev_b32 v249, 7, v249
buffer_load_dword v254, v249, s[12:15], s52 offen
s_mov_b32 s12, s22
s_and_b32 s13, s23, 0xffff
s_mov_b32 s14, 67108864
s_mov_b32 s15, 0x20000
s_mov_b32 s16, s24
s_and_b32 s17, s25, 0xffff
s_mov_b32 s18, 67108864
s_mov_b32 s19, 0x20000
s_mov_b32 s40, s30
s_and_b32 s41, s31, 0xffff
s_mov_b32 s42, 288358400
s_mov_b32 s43, 0x20000
s_load_dwordx2 s[20:21], s[0:1], 80
s_xor_b32 s10, s9, 7
s_lshl_b32 s49, s7, 22
s_lshl_b32 s57, s9, 19
s_add_u32 s49, s49, s57
s_lshl_b32 s52, s5, 18
s_add_u32 s49, s49, s52
s_lshl_b32 s52, s6, 12
s_add_u32 s49, s49, s52
s_lshl_b32 s52, s5, 9
s_add_u32 s57, s57, s52
s_lshl_b32 s52, s6, 15
s_add_u32 s54, s57, s52
s_add_u32 s54, s54, 131072
s_lshl_b32 s52, s5, 18
s_add_u32 s64, s54, s52
s_xor_b32 s52, s52, 262144
s_add_u32 s66, s54, s52
s_add_u32 s65, s64, 65536
s_add_u32 s67, s66, 65536
s_lshl_b32 s52, s6, 14
s_add_u32 s57, s57, s52
s_lshr_b32 s52, s10, 2
s_lshl_b32 s52, s52, 8
s_add_u32 s57, s57, s52
s_lshl_b32 s52, s52, 1
s_sub_u32 s30, 256, s52
s_lshr_b32 s52, s10, 1
s_lshl_b32 s31, s52, 7
s_and_b32 s52, s9, 1
s_mul_i32 s52, s52, 8
s_mul_i32 s54, s7, 1
s_add_u32 s52, s54, s52
s_and_b32 s52, s52, 15
s_lshl_b32 s11, s52, 13
s_mul_i32 s60, s6, 12288
s_add_u32 s60, s60, 65536
s_lshl_b32 s52, s8, 4
s_add_u32 s52, s52, s7
s_lshl_b32 s52, s52, 2
s_add_u32 s52, s52, s4
s_mul_i32 s53, s52, 196608
s_mul_i32 s54, s9, 3072
s_add_u32 s63, s53, s54
s_mul_i32 s54, s9, 24576
s_add_u32 s26, s53, s54
s_lshl_b32 s52, s52, 10
s_add_u32 s23, s52, 33554432
s_lshl_b32 s52, s9, 7
s_add_u32 s22, s23, s52
v_and_b32 v152, 7, v1
v_xor_b32 v152, s10, v152
v_lshlrev_b32 v152, 7, v152
buffer_load_dword v255, v152, s[40:43], s23 offen sc1
s_mul_i32 s52, s7, 96
s_mul_i32 s53, s6, 48
s_add_u32 s52, s52, s53
s_lshl_b32 s52, s52, 11
s_lshl_b32 s53, s8, 10
s_add_u32 s52, s52, s53
s_lshl_b32 s53, s5, 9
s_add_u32 s52, s52, s53
s_lshl_b32 s53, s9, 6
s_add_u32 s27, s52, s53
s_mul_hi_u32 s52, s7, 1073741825
s_mul_i32 s52, s52, 4
s_sub_u32 s52, s7, s52
s_lshl_b32 s61, 546, s52
s_mov_b32 s62, s11
v_and_b32 v248, 3, v1
v_lshlrev_b32 v248, 7, v248
v_and_b32 v153, 31, v1
v_lshrrev_b32 v154, 1, v153
v_lshlrev_b32 v154, 13, v154
v_and_b32 v244, 1, v1
v_lshl_add_u32 v154, v244, 7, v154
v_lshlrev_b32 v153, 7, v153
s_mov_b32 s88, s28
s_and_b32 s89, s29, 0xffff
s_mov_b32 s90, 4194304
s_mov_b32 s91, 0x20000
s_lshl_b32 s52, s7, 1
s_add_u32 s52, s52, s6
s_lshl_b32 s48, s52, 17
s_lshl_b32 s51, s52, 12
s_lshl_b32 s52, s9, 1
s_add_u32 s52, s52, s5
s_lshl_b32 s53, s52, 18
s_add_u32 s51, s51, s53
s_lshl_b32 s53, s52, 9
s_add_u32 s48, s48, s53
s_add_u32 s48, s48, 256
s_branch L_kvt_skip
L_kvt_u:
buffer_load_dword v254, v154, s[32:35], s48 offen
s_add_u32 s55, s62, s49
s_add_u32 s62, s62, 8192
s_and_b32 s62, s62, 0x1ffff
buffer_load_dword v254, v248, s[12:15], s55 offen
buffer_load_dword v254, v248, s[16:19], s55 offen
s_add_u32 s68, s68, 4
s_addc_u32 s69, s69, 0
s_setpc_b64 s[68:69]
L_kvt_v:
s_add_u32 s55, s51, 0
buffer_load_dword v254, v153, s[88:91], s55 offen
s_add_u32 s55, s62, s49
s_add_u32 s62, s62, 8192
s_and_b32 s62, s62, 0x1ffff
buffer_load_dword v254, v248, s[12:15], s55 offen
buffer_load_dword v254, v248, s[16:19], s55 offen
s_add_u32 s68, s68, 4
s_addc_u32 s69, s69, 0
s_setpc_b64 s[68:69]
L_kvt_w:
s_add_u32 s55, s51, 131072
buffer_load_dword v254, v153, s[88:91], s55 offen
s_add_u32 s55, s62, s49
s_add_u32 s62, s62, 8192
s_and_b32 s62, s62, 0x1ffff
buffer_load_dword v254, v248, s[12:15], s55 offen
buffer_load_dword v254, v248, s[16:19], s55 offen
s_add_u32 s68, s68, 4
s_addc_u32 s69, s69, 0
s_setpc_b64 s[68:69]
L_kvt_skip:
v_lshrrev_b32 v250, 4, v1
v_and_b32 v251, 15, v1
v_lshlrev_b32 v236, 1, v250
v_xor_b32 v251, v251, v236
v_lshlrev_b32 v251, 4, v251
v_mul_u32_u24 v250, 256, v250
v_add_u32 v236, v250, v251
v_xor_b32 v251, 0x80, v251
v_add_u32 v237, v250, v251
v_add_u32 v238, 0, v236
v_add_u32 v239, 0, v237
v_add_u32 v237, 0, v237
v_and_b32 v244, 15, v1
v_lshrrev_b32 v245, 4, v1
v_and_b32 v246, 7, v1
v_lshlrev_b32 v246, 1, v246
v_xor_b32 v246, v246, v245
v_lshlrev_b32 v246, 4, v246
v_lshl_add_u32 v2, v244, 8, v246
v_lshrrev_b32 v244, 2, v1
v_and_b32 v245, 7, v244
v_lshlrev_b32 v245, 5, v245
v_lshl_add_u32 v244, v244, 8, v245
v_and_b32 v245, 3, v1
v_lshl_add_u32 v244, v245, 3, v244
s_lshl_b32 s52, s5, 13
v_xor_b32 v224, 0, v244
v_add_u32 v224, s52, v224
v_xor_b32 v225, 32, v244
v_add_u32 v225, s52, v225
v_xor_b32 v226, 64, v244
v_add_u32 v226, s52, v226
v_xor_b32 v227, 96, v244
v_add_u32 v227, s52, v227
v_xor_b32 v228, 128, v244
v_add_u32 v228, s52, v228
v_xor_b32 v229, 160, v244
v_add_u32 v229, s52, v229
v_xor_b32 v230, 192, v244
v_add_u32 v230, s52, v230
v_xor_b32 v231, 224, v244
v_add_u32 v231, s52, v231
v_xor_b32 v232, 0, v2
v_add_u32 v232, s52, v232
v_xor_b32 v233, 64, v2
v_add_u32 v233, s52, v233
v_xor_b32 v234, 128, v2
v_add_u32 v234, s52, v234
v_xor_b32 v235, 192, v2
v_add_u32 v235, s52, v235
s_mul_i32 s52, s4, 12288
s_add_u32 s52, s52, 65536
v_lshlrev_b32 v253, 4, v1
v_add_u32 v252, s52, v253
v_mov_b32 v220, 0x3f803f80
v_mov_b32 v221, 0x3f803f80
v_mov_b32 v222, 0x3f803f80
v_mov_b32 v223, 0x3f803f80
s_mov_b32 s50, 0x41000000
L_q0:
s_waitcnt vmcnt(6) lgkmcnt(0)
s_barrier
s_add_u32 s53, s71, 0
s_and_b32 s53, s53, 3
s_mul_i32 s53, s53, 24576
s_add_u32 s59, s53, s60
v_xor_b32 v3, s92, v2
v_add_u32 v3, s59, v3
ds_read_b128 v[124:127], v3 offset:0
ds_read_b128 v[128:131], v3 offset:4096
ds_read_b128 v[132:135], v3 offset:8192
ds_read_b64_tr_b16 a[192:193], v224 offset:0
ds_read_b64_tr_b16 a[194:195], v224 offset:4096
ds_read_b64_tr_b16 a[196:197], v225 offset:0
ds_read_b64_tr_b16 a[198:199], v225 offset:4096
ds_read_b64_tr_b16 a[200:201], v226 offset:0
ds_read_b64_tr_b16 a[202:203], v226 offset:4096
ds_read_b64_tr_b16 a[204:205], v227 offset:0
ds_read_b64_tr_b16 a[206:207], v227 offset:4096
ds_read_b64_tr_b16 a[208:209], v228 offset:0
ds_read_b64_tr_b16 a[210:211], v228 offset:4096
ds_read_b64_tr_b16 a[212:213], v229 offset:0
ds_read_b64_tr_b16 a[214:215], v229 offset:4096
ds_read_b64_tr_b16 a[216:217], v230 offset:0
ds_read_b64_tr_b16 a[218:219], v230 offset:4096
ds_read_b64_tr_b16 a[220:221], v231 offset:0
ds_read_b64_tr_b16 a[222:223], v231 offset:4096
s_add_u32 s45, s58, s98
s_add_u32 m0, s47, 32768
s_nop 0
buffer_load_dwordx4 v240, s[32:35], s45 offen lds
buffer_load_dwordx4 v241, s[32:35], s45 offen offset:1024 lds
buffer_load_dwordx4 v242, s[32:35], s45 offen offset:2048 lds
buffer_load_dwordx4 v243, s[32:35], s45 offen offset:3072 lds
s_add_u32 s45, s58, s99
s_add_u32 m0, s47, 49152
s_nop 0
buffer_load_dwordx4 v240, s[32:35], s45 offen lds
buffer_load_dwordx4 v241, s[32:35], s45 offen offset:1024 lds
buffer_load_dwordx4 v242, s[32:35], s45 offen offset:2048 lds
buffer_load_dwordx4 v243, s[32:35], s45 offen offset:3072 lds
s_bitcmp1_b32 s61, 1
s_getpc_b64 s[68:69]
s_cbranch_scc1 L_kvt_u
s_waitcnt vmcnt(10) lgkmcnt(0)
s_barrier
v_mfma_f32_16x16x32_bf16 v[4:7], a[192:195], v[124:127], 0
ds_read_b64_tr_b16 a[224:225], v224 offset:16384
ds_read_b64_tr_b16 a[226:227], v224 offset:20480
s_add_u32 s52, s71, 1
v_mfma_f32_16x16x32_bf16 v[8:11], a[192:195], v[128:131], 0
ds_read_b64_tr_b16 a[228:229], v225 offset:16384
ds_read_b64_tr_b16 a[230:231], v225 offset:20480
s_and_b32 s52, s52, 3
v_mfma_f32_16x16x32_bf16 v[12:15], a[192:195], v[132:135], 0
ds_read_b64_tr_b16 a[232:233], v226 offset:16384
ds_read_b64_tr_b16 a[234:235], v226 offset:20480
s_lshl_b32 s52, s52, 20
v_mfma_f32_16x16x32_bf16 v[16:19], a[196:199], v[124:127], 0
s_add_u32 s58, s52, s56
s_add_u32 s45, s58, s96
s_add_u32 m0, s47, 0
s_nop 0
buffer_load_dwordx4 v240, s[32:35], s45 offen lds
v_mfma_f32_16x16x32_bf16 v[20:23], a[196:199], v[128:131], 0
ds_read_b64_tr_b16 a[236:237], v227 offset:16384
ds_read_b64_tr_b16 a[238:239], v227 offset:20480
v_xor_b32 v3, s93, v2
v_mfma_f32_16x16x32_bf16 v[24:27], a[196:199], v[132:135], 0
buffer_load_dwordx4 v241, s[32:35], s45 offen offset:1024 lds
v_mfma_f32_16x16x32_bf16 v[28:31], a[200:203], v[124:127], 0
ds_read_b64_tr_b16 a[240:241], v228 offset:16384
ds_read_b64_tr_b16 a[242:243], v228 offset:20480
v_add_u32 v3, s59, v3
v_mfma_f32_16x16x32_bf16 v[32:35], a[200:203], v[128:131], 0
buffer_load_dwordx4 v242, s[32:35], s45 offen offset:2048 lds
v_mfma_f32_16x16x32_bf16 v[36:39], a[200:203], v[132:135], 0
ds_read_b64_tr_b16 a[244:245], v229 offset:16384
ds_read_b64_tr_b16 a[246:247], v229 offset:20480
v_mfma_f32_16x16x32_bf16 v[40:43], a[204:207], v[124:127], 0
buffer_load_dwordx4 v243, s[32:35], s45 offen offset:3072 lds
v_mfma_f32_16x16x32_bf16 v[44:47], a[204:207], v[128:131], 0
ds_read_b64_tr_b16 a[248:249], v230 offset:16384
ds_read_b64_tr_b16 a[250:251], v230 offset:20480
s_add_u32 s52, s71, 1
v_mfma_f32_16x16x32_bf16 v[48:51], a[204:207], v[132:135], 0
s_and_b32 s52, s52, 3
s_mul_i32 s53, s52, 24576
s_mul_i32 s70, s4, 6144
s_add_u32 s70, s70, s53
s_lshl_b32 s52, s52, 8
s_mul_i32 s46, s7, 98304
s_add_u32 s46, s46, s52
s_mul_i32 s52, s4, 24576
s_add_u32 s46, s46, s52
s_add_u32 m0, s70, 65536
s_nop 0
buffer_load_dwordx4 v148, s[36:39], s46 offen lds
v_mfma_f32_16x16x32_bf16 v[52:55], a[208:211], v[124:127], 0
ds_read_b64_tr_b16 a[252:253], v231 offset:16384
v_mfma_f32_16x16x32_bf16 v[56:59], a[208:211], v[128:131], 0
ds_read_b64_tr_b16 a[254:255], v231 offset:20480
v_mfma_f32_16x16x32_bf16 v[60:63], a[208:211], v[132:135], 0
buffer_load_dwordx4 v149, s[36:39], s46 offen offset:1024 lds
v_mfma_f32_16x16x32_bf16 v[64:67], a[212:215], v[124:127], 0
ds_read_b128 v[136:139], v3 offset:0
v_mfma_f32_16x16x32_bf16 v[68:71], a[212:215], v[128:131], 0
buffer_load_dwordx4 v150, s[36:39], s46 offen offset:2048 lds
v_mfma_f32_16x16x32_bf16 v[72:75], a[212:215], v[132:135], 0
ds_read_b128 v[140:143], v3 offset:4096
v_mfma_f32_16x16x32_bf16 v[76:79], a[216:219], v[124:127], 0
buffer_load_dwordx4 v151, s[36:39], s46 offen offset:3072 lds
v_mfma_f32_16x16x32_bf16 v[80:83], a[216:219], v[128:131], 0
ds_read_b128 v[144:147], v3 offset:8192
s_add_u32 s46, s46, 16384
s_add_u32 m0, s70, 69632
v_mfma_f32_16x16x32_bf16 v[84:87], a[216:219], v[132:135], 0
buffer_load_dwordx4 v148, s[36:39], s46 offen lds
v_mfma_f32_16x16x32_bf16 v[88:91], a[220:223], v[124:127], 0
v_mfma_f32_16x16x32_bf16 v[92:95], a[220:223], v[128:131], 0
buffer_load_dwordx4 v149, s[36:39], s46 offen offset:1024 lds
v_mfma_f32_16x16x32_bf16 v[96:99], a[220:223], v[132:135], 0
s_bitcmp1_b32 s61, 2
s_getpc_b64 s[68:69]
s_cbranch_scc1 L_kvt_u
s_waitcnt vmcnt(14) lgkmcnt(0)
s_barrier
v_mfma_f32_16x16x32_bf16 v[4:7], a[224:227], v[136:139], v[4:7]
ds_read_b64_tr_b16 a[192:193], v224 offset:32768
ds_read_b64_tr_b16 a[194:195], v224 offset:36864
s_add_u32 s45, s58, s97
v_mfma_f32_16x16x32_bf16 v[8:11], a[224:227], v[140:143], v[8:11]
ds_read_b64_tr_b16 a[196:197], v225 offset:32768
ds_read_b64_tr_b16 a[198:199], v225 offset:36864
s_add_u32 m0, s47, 16384
v_mfma_f32_16x16x32_bf16 v[12:15], a[224:227], v[144:147], v[12:15]
ds_read_b64_tr_b16 a[200:201], v226 offset:32768
v_mfma_f32_16x16x32_bf16 v[16:19], a[228:231], v[136:139], v[16:19]
buffer_load_dwordx4 v240, s[32:35], s45 offen lds
v_mfma_f32_16x16x32_bf16 v[20:23], a[228:231], v[140:143], v[20:23]
ds_read_b64_tr_b16 a[202:203], v226 offset:36864
v_xor_b32 v3, s94, v2
v_mfma_f32_16x16x32_bf16 v[24:27], a[228:231], v[144:147], v[24:27]
ds_read_b64_tr_b16 a[204:205], v227 offset:32768
v_add_u32 v3, s59, v3
v_mfma_f32_16x16x32_bf16 v[28:31], a[232:235], v[136:139], v[28:31]
ds_read_b64_tr_b16 a[206:207], v227 offset:36864
v_mfma_f32_16x16x32_bf16 v[32:35], a[232:235], v[140:143], v[32:35]
ds_read_b64_tr_b16 a[208:209], v228 offset:32768
v_mfma_f32_16x16x32_bf16 v[36:39], a[232:235], v[144:147], v[36:39]
ds_read_b64_tr_b16 a[210:211], v228 offset:36864
v_mfma_f32_16x16x32_bf16 v[40:43], a[236:239], v[136:139], v[40:43]
buffer_load_dwordx4 v241, s[32:35], s45 offen offset:1024 lds
v_mfma_f32_16x16x32_bf16 v[44:47], a[236:239], v[140:143], v[44:47]
ds_read_b64_tr_b16 a[212:213], v229 offset:32768
v_mfma_f32_16x16x32_bf16 v[48:51], a[236:239], v[144:147], v[48:51]
ds_read_b64_tr_b16 a[214:215], v229 offset:36864
v_mfma_f32_16x16x32_bf16 v[52:55], a[240:243], v[136:139], v[52:55]
ds_read_b64_tr_b16 a[216:217], v230 offset:32768
v_mfma_f32_16x16x32_bf16 v[56:59], a[240:243], v[140:143], v[56:59]
ds_read_b64_tr_b16 a[218:219], v230 offset:36864
v_mfma_f32_16x16x32_bf16 v[60:63], a[240:243], v[144:147], v[60:63]
ds_read_b64_tr_b16 a[220:221], v231 offset:32768
v_mfma_f32_16x16x32_bf16 v[64:67], a[244:247], v[136:139], v[64:67]
ds_read_b64_tr_b16 a[222:223], v231 offset:36864
v_mfma_f32_16x16x32_bf16 v[68:71], a[244:247], v[140:143], v[68:71]
buffer_load_dwordx4 v242, s[32:35], s45 offen offset:2048 lds
v_mfma_f32_16x16x32_bf16 v[72:75], a[244:247], v[144:147], v[72:75]
ds_read_b128 v[124:127], v3 offset:0
v_mfma_f32_16x16x32_bf16 v[76:79], a[248:251], v[136:139], v[76:79]
ds_read_b128 v[128:131], v3 offset:4096
v_mfma_f32_16x16x32_bf16 v[80:83], a[248:251], v[140:143], v[80:83]
ds_read_b128 v[132:135], v3 offset:8192
v_mfma_f32_16x16x32_bf16 v[84:87], a[248:251], v[144:147], v[84:87]
v_mfma_f32_16x16x32_bf16 v[88:91], a[252:255], v[136:139], v[88:91]
v_mfma_f32_16x16x32_bf16 v[92:95], a[252:255], v[140:143], v[92:95]
buffer_load_dwordx4 v243, s[32:35], s45 offen offset:3072 lds
v_mfma_f32_16x16x32_bf16 v[96:99], a[252:255], v[144:147], v[96:99]
s_bitcmp1_b32 s61, 3
s_getpc_b64 s[68:69]
s_cbranch_scc1 L_kvt_u
s_waitcnt vmcnt(14) lgkmcnt(0)
s_barrier
v_mfma_f32_16x16x32_bf16 v[4:7], a[192:195], v[124:127], v[4:7]
ds_read_b64_tr_b16 a[224:225], v224 offset:49152
ds_read_b64_tr_b16 a[226:227], v224 offset:53248
s_add_u32 s45, s58, s98
v_mfma_f32_16x16x32_bf16 v[8:11], a[192:195], v[128:131], v[8:11]
ds_read_b64_tr_b16 a[228:229], v225 offset:49152
ds_read_b64_tr_b16 a[230:231], v225 offset:53248
s_add_u32 m0, s47, 32768
v_mfma_f32_16x16x32_bf16 v[12:15], a[192:195], v[132:135], v[12:15]
ds_read_b64_tr_b16 a[232:233], v226 offset:49152
v_mfma_f32_16x16x32_bf16 v[16:19], a[196:199], v[124:127], v[16:19]
buffer_load_dwordx4 v240, s[32:35], s45 offen lds
v_mfma_f32_16x16x32_bf16 v[20:23], a[196:199], v[128:131], v[20:23]
ds_read_b64_tr_b16 a[234:235], v226 offset:53248
v_xor_b32 v3, s95, v2
v_mfma_f32_16x16x32_bf16 v[24:27], a[196:199], v[132:135], v[24:27]
ds_read_b64_tr_b16 a[236:237], v227 offset:49152
v_add_u32 v3, s59, v3
v_mfma_f32_16x16x32_bf16 v[28:31], a[200:203], v[124:127], v[28:31]
ds_read_b64_tr_b16 a[238:239], v227 offset:53248
v_mfma_f32_16x16x32_bf16 v[32:35], a[200:203], v[128:131], v[32:35]
ds_read_b64_tr_b16 a[240:241], v228 offset:49152
v_mfma_f32_16x16x32_bf16 v[36:39], a[200:203], v[132:135], v[36:39]
ds_read_b64_tr_b16 a[242:243], v228 offset:53248
v_mfma_f32_16x16x32_bf16 v[40:43], a[204:207], v[124:127], v[40:43]
buffer_load_dwordx4 v241, s[32:35], s45 offen offset:1024 lds
v_mfma_f32_16x16x32_bf16 v[44:47], a[204:207], v[128:131], v[44:47]
ds_read_b64_tr_b16 a[244:245], v229 offset:49152
v_mfma_f32_16x16x32_bf16 v[48:51], a[204:207], v[132:135], v[48:51]
ds_read_b64_tr_b16 a[246:247], v229 offset:53248
v_mfma_f32_16x16x32_bf16 v[52:55], a[208:211], v[124:127], v[52:55]
ds_read_b64_tr_b16 a[248:249], v230 offset:49152
v_mfma_f32_16x16x32_bf16 v[56:59], a[208:211], v[128:131], v[56:59]
ds_read_b64_tr_b16 a[250:251], v230 offset:53248
v_mfma_f32_16x16x32_bf16 v[60:63], a[208:211], v[132:135], v[60:63]
ds_read_b64_tr_b16 a[252:253], v231 offset:49152
v_mfma_f32_16x16x32_bf16 v[64:67], a[212:215], v[124:127], v[64:67]
ds_read_b64_tr_b16 a[254:255], v231 offset:53248
v_mfma_f32_16x16x32_bf16 v[68:71], a[212:215], v[128:131], v[68:71]
buffer_load_dwordx4 v242, s[32:35], s45 offen offset:2048 lds
v_mfma_f32_16x16x32_bf16 v[72:75], a[212:215], v[132:135], v[72:75]
ds_read_b128 v[136:139], v3 offset:0
v_mfma_f32_16x16x32_bf16 v[76:79], a[216:219], v[124:127], v[76:79]
ds_read_b128 v[140:143], v3 offset:4096
v_mfma_f32_16x16x32_bf16 v[80:83], a[216:219], v[128:131], v[80:83]
ds_read_b128 v[144:147], v3 offset:8192
v_mfma_f32_16x16x32_bf16 v[84:87], a[216:219], v[132:135], v[84:87]
v_mfma_f32_16x16x32_bf16 v[88:91], a[220:223], v[124:127], v[88:91]
v_mfma_f32_16x16x32_bf16 v[92:95], a[220:223], v[128:131], v[92:95]
buffer_load_dwordx4 v243, s[32:35], s45 offen offset:3072 lds
v_mfma_f32_16x16x32_bf16 v[96:99], a[220:223], v[132:135], v[96:99]
s_bitcmp1_b32 s61, 4
s_getpc_b64 s[68:69]
s_cbranch_scc1 L_kvt_u
s_waitcnt vmcnt(8) lgkmcnt(0)
s_barrier
v_mfma_f32_16x16x32_bf16 v[4:7], a[224:227], v[136:139], v[4:7]
ds_read_b64_tr_b16 a[192:193], v224 offset:0
ds_read_b64_tr_b16 a[194:195], v224 offset:4096
s_add_u32 s53, s71, 1
v_mfma_f32_16x16x32_bf16 v[8:11], a[224:227], v[140:143], v[8:11]
ds_read_b64_tr_b16 a[196:197], v225 offset:0
ds_read_b64_tr_b16 a[198:199], v225 offset:4096
s_and_b32 s53, s53, 3
v_mfma_f32_16x16x32_bf16 v[12:15], a[224:227], v[144:147], v[12:15]
ds_read_b64_tr_b16 a[200:201], v226 offset:0
ds_read_b64_tr_b16 a[202:203], v226 offset:4096
s_mul_i32 s53, s53, 24576
v_mfma_f32_16x16x32_bf16 v[16:19], a[228:231], v[136:139], v[16:19]
s_add_u32 s59, s53, s60
s_add_u32 s45, s58, s99
s_add_u32 m0, s47, 49152
s_nop 0
buffer_load_dwordx4 v240, s[32:35], s45 offen lds
v_mfma_f32_16x16x32_bf16 v[20:23], a[228:231], v[140:143], v[20:23]
ds_read_b64_tr_b16 a[204:205], v227 offset:0
ds_read_b64_tr_b16 a[206:207], v227 offset:4096
v_xor_b32 v3, s92, v2
v_mfma_f32_16x16x32_bf16 v[24:27], a[228:231], v[144:147], v[24:27]
ds_read_b64_tr_b16 a[208:209], v228 offset:0
ds_read_b64_tr_b16 a[210:211], v228 offset:4096
v_add_u32 v3, s59, v3
v_mfma_f32_16x16x32_bf16 v[28:31], a[232:235], v[136:139], v[28:31]
buffer_load_dwordx4 v241, s[32:35], s45 offen offset:1024 lds
v_mfma_f32_16x16x32_bf16 v[32:35], a[232:235], v[140:143], v[32:35]
ds_read_b64_tr_b16 a[212:213], v229 offset:0
ds_read_b64_tr_b16 a[214:215], v229 offset:4096
v_mfma_f32_16x16x32_bf16 v[36:39], a[232:235], v[144:147], v[36:39]
buffer_load_dwordx4 v242, s[32:35], s45 offen offset:2048 lds
v_mfma_f32_16x16x32_bf16 v[40:43], a[236:239], v[136:139], v[40:43]
ds_read_b64_tr_b16 a[216:217], v230 offset:0
v_mfma_f32_16x16x32_bf16 v[44:47], a[236:239], v[140:143], v[44:47]
ds_read_b64_tr_b16 a[218:219], v230 offset:4096
v_mfma_f32_16x16x32_bf16 v[48:51], a[236:239], v[144:147], v[48:51]
buffer_load_dwordx4 v243, s[32:35], s45 offen offset:3072 lds
v_mfma_f32_16x16x32_bf16 v[52:55], a[240:243], v[136:139], v[52:55]
ds_read_b64_tr_b16 a[220:221], v231 offset:0
s_add_u32 s52, s71, 2
s_and_b32 s52, s52, 3
v_mfma_f32_16x16x32_bf16 v[56:59], a[240:243], v[140:143], v[56:59]
ds_read_b64_tr_b16 a[222:223], v231 offset:4096
s_mul_i32 s53, s52, 24576
s_mul_i32 s70, s4, 6144
v_mfma_f32_16x16x32_bf16 v[60:63], a[240:243], v[144:147], v[60:63]
s_add_u32 s70, s70, s53
s_lshl_b32 s52, s52, 8
s_mul_i32 s46, s7, 98304
s_add_u32 s46, s46, s52
s_mul_i32 s52, s4, 24576
s_add_u32 s46, s46, s52
s_add_u32 m0, s70, 65536
s_nop 0
buffer_load_dwordx4 v148, s[36:39], s46 offen lds
v_mfma_f32_16x16x32_bf16 v[64:67], a[244:247], v[136:139], v[64:67]
ds_read_b128 v[124:127], v3 offset:0
v_mfma_f32_16x16x32_bf16 v[68:71], a[244:247], v[140:143], v[68:71]
ds_read_b128 v[128:131], v3 offset:4096
v_mfma_f32_16x16x32_bf16 v[72:75], a[244:247], v[144:147], v[72:75]
buffer_load_dwordx4 v149, s[36:39], s46 offen offset:1024 lds
v_mfma_f32_16x16x32_bf16 v[76:79], a[248:251], v[136:139], v[76:79]
ds_read_b128 v[132:135], v3 offset:8192
v_mfma_f32_16x16x32_bf16 v[80:83], a[248:251], v[140:143], v[80:83]
buffer_load_dwordx4 v150, s[36:39], s46 offen offset:2048 lds
v_mfma_f32_16x16x32_bf16 v[84:87], a[248:251], v[144:147], v[84:87]
v_mfma_f32_16x16x32_bf16 v[88:91], a[252:255], v[136:139], v[88:91]
v_mfma_f32_16x16x32_bf16 v[92:95], a[252:255], v[140:143], v[92:95]
buffer_load_dwordx4 v151, s[36:39], s46 offen offset:3072 lds
v_mfma_f32_16x16x32_bf16 v[96:99], a[252:255], v[144:147], v[96:99]
s_bitcmp1_b32 s61, 5
s_getpc_b64 s[68:69]
s_cbranch_scc1 L_kvt_v
s_waitcnt vmcnt(12) lgkmcnt(0)
s_barrier
v_mfma_f32_16x16x32_bf16 v[4:7], a[192:195], v[124:127], v[4:7]
ds_read_b64_tr_b16 a[224:225], v224 offset:16384
ds_read_b64_tr_b16 a[226:227], v224 offset:20480
s_add_u32 s52, s71, 2
v_mfma_f32_16x16x32_bf16 v[8:11], a[192:195], v[128:131], v[8:11]
ds_read_b64_tr_b16 a[228:229], v225 offset:16384
ds_read_b64_tr_b16 a[230:231], v225 offset:20480
s_and_b32 s52, s52, 3
v_mfma_f32_16x16x32_bf16 v[12:15], a[192:195], v[132:135], v[12:15]
ds_read_b64_tr_b16 a[232:233], v226 offset:16384
ds_read_b64_tr_b16 a[234:235], v226 offset:20480
s_lshl_b32 s52, s52, 20
v_mfma_f32_16x16x32_bf16 v[16:19], a[196:199], v[124:127], v[16:19]
s_add_u32 s58, s52, s56
s_add_u32 s45, s58, s96
s_add_u32 m0, s47, 0
s_nop 0
buffer_load_dwordx4 v240, s[32:35], s45 offen lds
v_mfma_f32_16x16x32_bf16 v[20:23], a[196:199], v[128:131], v[20:23]
ds_read_b64_tr_b16 a[236:237], v227 offset:16384
ds_read_b64_tr_b16 a[238:239], v227 offset:20480
v_xor_b32 v3, s93, v2
v_mfma_f32_16x16x32_bf16 v[24:27], a[196:199], v[132:135], v[24:27]
ds_read_b64_tr_b16 a[240:241], v228 offset:16384
v_add_u32 v3, s59, v3
v_mfma_f32_16x16x32_bf16 v[28:31], a[200:203], v[124:127], v[28:31]
ds_read_b64_tr_b16 a[242:243], v228 offset:20480
v_mfma_f32_16x16x32_bf16 v[32:35], a[200:203], v[128:131], v[32:35]
buffer_load_dwordx4 v241, s[32:35], s45 offen offset:1024 lds
v_mfma_f32_16x16x32_bf16 v[36:39], a[200:203], v[132:135], v[36:39]
ds_read_b64_tr_b16 a[244:245], v229 offset:16384
v_mfma_f32_16x16x32_bf16 v[40:43], a[204:207], v[124:127], v[40:43]
ds_read_b64_tr_b16 a[246:247], v229 offset:20480
v_mfma_f32_16x16x32_bf16 v[44:47], a[204:207], v[128:131], v[44:47]
ds_read_b64_tr_b16 a[248:249], v230 offset:16384
v_mfma_f32_16x16x32_bf16 v[48:51], a[204:207], v[132:135], v[48:51]
buffer_load_dwordx4 v242, s[32:35], s45 offen offset:2048 lds
v_mfma_f32_16x16x32_bf16 v[52:55], a[208:211], v[124:127], v[52:55]
ds_read_b64_tr_b16 a[250:251], v230 offset:20480
v_mfma_f32_16x16x32_bf16 v[56:59], a[208:211], v[128:131], v[56:59]
ds_read_b64_tr_b16 a[252:253], v231 offset:16384
v_mfma_f32_16x16x32_bf16 v[60:63], a[208:211], v[132:135], v[60:63]
buffer_load_dwordx4 v243, s[32:35], s45 offen offset:3072 lds
v_mfma_f32_16x16x32_bf16 v[64:67], a[212:215], v[124:127], v[64:67]
ds_read_b64_tr_b16 a[254:255], v231 offset:20480
s_add_u32 s46, s46, 16384
s_add_u32 m0, s70, 69632
v_mfma_f32_16x16x32_bf16 v[68:71], a[212:215], v[128:131], v[68:71]
ds_read_b128 v[136:139], v3 offset:0
v_mfma_f32_16x16x32_bf16 v[72:75], a[212:215], v[132:135], v[72:75]
ds_read_b128 v[140:143], v3 offset:4096
v_mfma_f32_16x16x32_bf16 v[76:79], a[216:219], v[124:127], v[76:79]
buffer_load_dwordx4 v148, s[36:39], s46 offen lds
v_mfma_f32_16x16x32_bf16 v[80:83], a[216:219], v[128:131], v[80:83]
ds_read_b128 v[144:147], v3 offset:8192
v_mfma_f32_16x16x32_bf16 v[84:87], a[216:219], v[132:135], v[84:87]
v_mfma_f32_16x16x32_bf16 v[88:91], a[220:223], v[124:127], v[88:91]
v_mfma_f32_16x16x32_bf16 v[92:95], a[220:223], v[128:131], v[92:95]
buffer_load_dwordx4 v149, s[36:39], s46 offen offset:1024 lds
v_mfma_f32_16x16x32_bf16 v[96:99], a[220:223], v[132:135], v[96:99]
s_bitcmp1_b32 s61, 6
s_getpc_b64 s[68:69]
s_cbranch_scc1 L_kvt_v
s_waitcnt vmcnt(14) lgkmcnt(0)
s_barrier
v_mfma_f32_16x16x32_bf16 v[4:7], a[224:227], v[136:139], v[4:7]
ds_read_b64_tr_b16 a[192:193], v224 offset:32768
ds_read_b64_tr_b16 a[194:195], v224 offset:36864
s_add_u32 s45, s58, s97
v_mfma_f32_16x16x32_bf16 v[8:11], a[224:227], v[140:143], v[8:11]
ds_read_b64_tr_b16 a[196:197], v225 offset:32768
ds_read_b64_tr_b16 a[198:199], v225 offset:36864
s_add_u32 m0, s47, 16384
v_mfma_f32_16x16x32_bf16 v[12:15], a[224:227], v[144:147], v[12:15]
ds_read_b64_tr_b16 a[200:201], v226 offset:32768
v_mfma_f32_16x16x32_bf16 v[16:19], a[228:231], v[136:139], v[16:19]
buffer_load_dwordx4 v240, s[32:35], s45 offen lds
v_mfma_f32_16x16x32_bf16 v[20:23], a[228:231], v[140:143], v[20:23]
ds_read_b64_tr_b16 a[202:203], v226 offset:36864
v_xor_b32 v3, s94, v2
v_mfma_f32_16x16x32_bf16 v[24:27], a[228:231], v[144:147], v[24:27]
ds_read_b64_tr_b16 a[204:205], v227 offset:32768
v_add_u32 v3, s59, v3
v_mfma_f32_16x16x32_bf16 v[28:31], a[232:235], v[136:139], v[28:31]
ds_read_b64_tr_b16 a[206:207], v227 offset:36864
v_mfma_f32_16x16x32_bf16 v[32:35], a[232:235], v[140:143], v[32:35]
ds_read_b64_tr_b16 a[208:209], v228 offset:32768
v_mfma_f32_16x16x32_bf16 v[36:39], a[232:235], v[144:147], v[36:39]
ds_read_b64_tr_b16 a[210:211], v228 offset:36864
v_mfma_f32_16x16x32_bf16 v[40:43], a[236:239], v[136:139], v[40:43]
buffer_load_dwordx4 v241, s[32:35], s45 offen offset:1024 lds
v_mfma_f32_16x16x32_bf16 v[44:47], a[236:239], v[140:143], v[44:47]
ds_read_b64_tr_b16 a[212:213], v229 offset:32768
v_mfma_f32_16x16x32_bf16 v[48:51], a[236:239], v[144:147], v[48:51]
ds_read_b64_tr_b16 a[214:215], v229 offset:36864
v_mfma_f32_16x16x32_bf16 v[52:55], a[240:243], v[136:139], v[52:55]
ds_read_b64_tr_b16 a[216:217], v230 offset:32768
v_mfma_f32_16x16x32_bf16 v[56:59], a[240:243], v[140:143], v[56:59]
ds_read_b64_tr_b16 a[218:219], v230 offset:36864
v_mfma_f32_16x16x32_bf16 v[60:63], a[240:243], v[144:147], v[60:63]
ds_read_b64_tr_b16 a[220:221], v231 offset:32768
v_mfma_f32_16x16x32_bf16 v[64:67], a[244:247], v[136:139], v[64:67]
ds_read_b64_tr_b16 a[222:223], v231 offset:36864
v_mfma_f32_16x16x32_bf16 v[68:71], a[244:247], v[140:143], v[68:71]
buffer_load_dwordx4 v242, s[32:35], s45 offen offset:2048 lds
v_mfma_f32_16x16x32_bf16 v[72:75], a[244:247], v[144:147], v[72:75]
ds_read_b128 v[124:127], v3 offset:0
v_mfma_f32_16x16x32_bf16 v[76:79], a[248:251], v[136:139], v[76:79]
ds_read_b128 v[128:131], v3 offset:4096
v_mfma_f32_16x16x32_bf16 v[80:83], a[248:251], v[140:143], v[80:83]
ds_read_b128 v[132:135], v3 offset:8192
v_mfma_f32_16x16x32_bf16 v[84:87], a[248:251], v[144:147], v[84:87]
v_mfma_f32_16x16x32_bf16 v[88:91], a[252:255], v[136:139], v[88:91]
v_mfma_f32_16x16x32_bf16 v[92:95], a[252:255], v[140:143], v[92:95]
buffer_load_dwordx4 v243, s[32:35], s45 offen offset:3072 lds
v_mfma_f32_16x16x32_bf16 v[96:99], a[252:255], v[144:147], v[96:99]
s_bitcmp1_b32 s61, 7
s_getpc_b64 s[68:69]
s_cbranch_scc1 L_kvt_v
s_waitcnt vmcnt(14) lgkmcnt(0)
s_barrier
v_mfma_f32_16x16x32_bf16 v[4:7], a[192:195], v[124:127], v[4:7]
ds_read_b64_tr_b16 a[224:225], v224 offset:49152
ds_read_b64_tr_b16 a[226:227], v224 offset:53248
s_add_u32 s45, s58, s98
v_mfma_f32_16x16x32_bf16 v[8:11], a[192:195], v[128:131], v[8:11]
ds_read_b64_tr_b16 a[228:229], v225 offset:49152
ds_read_b64_tr_b16 a[230:231], v225 offset:53248
s_add_u32 m0, s47, 32768
v_mfma_f32_16x16x32_bf16 v[12:15], a[192:195], v[132:135], v[12:15]
ds_read_b64_tr_b16 a[232:233], v226 offset:49152
ds_read_b64_tr_b16 a[234:235], v226 offset:53248
v_mfma_f32_16x16x32_bf16 v[16:19], a[196:199], v[124:127], v[16:19]
buffer_load_dwordx4 v240, s[32:35], s45 offen lds
v_mfma_f32_16x16x32_bf16 v[20:23], a[196:199], v[128:131], v[20:23]
ds_read_b64_tr_b16 a[236:237], v227 offset:49152
ds_read_b64_tr_b16 a[238:239], v227 offset:53248
v_xor_b32 v3, s95, v2
v_mfma_f32_16x16x32_bf16 v[24:27], a[196:199], v[132:135], v[24:27]
ds_read_b64_tr_b16 a[240:241], v228 offset:49152
ds_read_b64_tr_b16 a[242:243], v228 offset:53248
v_add_u32 v3, s59, v3
v_mfma_f32_16x16x32_bf16 v[28:31], a[200:203], v[124:127], v[28:31]
buffer_load_dwordx4 v241, s[32:35], s45 offen offset:1024 lds
v_mfma_f32_16x16x32_bf16 v[32:35], a[200:203], v[128:131], v[32:35]
ds_read_b64_tr_b16 a[244:245], v229 offset:49152
ds_read_b64_tr_b16 a[246:247], v229 offset:53248
v_mfma_f32_16x16x32_bf16 v[36:39], a[200:203], v[132:135], v[36:39]
buffer_load_dwordx4 v242, s[32:35], s45 offen offset:2048 lds
v_mfma_f32_16x16x32_bf16 v[40:43], a[204:207], v[124:127], v[40:43]
ds_read_b64_tr_b16 a[248:249], v230 offset:49152
v_mfma_f32_16x16x32_bf16 v[44:47], a[204:207], v[128:131], v[44:47]
ds_read_b64_tr_b16 a[250:251], v230 offset:53248
v_mfma_f32_16x16x32_bf16 v[48:51], a[204:207], v[132:135], v[48:51]
buffer_load_dwordx4 v243, s[32:35], s45 offen offset:3072 lds
v_mfma_f32_16x16x32_bf16 v[52:55], a[208:211], v[124:127], v[52:55]
ds_read_b64_tr_b16 a[252:253], v231 offset:49152
s_add_u32 s52, s71, 3
s_and_b32 s52, s52, 3
v_mfma_f32_16x16x32_bf16 v[56:59], a[208:211], v[128:131], v[56:59]
ds_read_b64_tr_b16 a[254:255], v231 offset:53248
s_mul_i32 s53, s52, 24576
s_mul_i32 s70, s4, 6144
v_mfma_f32_16x16x32_bf16 v[60:63], a[208:211], v[132:135], v[60:63]
s_add_u32 s70, s70, s53
s_lshl_b32 s52, s52, 8
s_mul_i32 s46, s7, 98304
s_add_u32 s46, s46, s52
s_mul_i32 s52, s4, 24576
s_add_u32 s46, s46, s52
s_add_u32 m0, s70, 65536
s_nop 0
buffer_load_dwordx4 v148, s[36:39], s46 offen lds
v_mfma_f32_16x16x32_bf16 v[64:67], a[212:215], v[124:127], v[64:67]
ds_read_b128 v[136:139], v3 offset:0
v_mfma_f32_16x16x32_bf16 v[68:71], a[212:215], v[128:131], v[68:71]
ds_read_b128 v[140:143], v3 offset:4096
v_mfma_f32_16x16x32_bf16 v[72:75], a[212:215], v[132:135], v[72:75]
buffer_load_dwordx4 v149, s[36:39], s46 offen offset:1024 lds
v_mfma_f32_16x16x32_bf16 v[76:79], a[216:219], v[124:127], v[76:79]
ds_read_b128 v[144:147], v3 offset:8192
v_mfma_f32_16x16x32_bf16 v[80:83], a[216:219], v[128:131], v[80:83]
buffer_load_dwordx4 v150, s[36:39], s46 offen offset:2048 lds
v_mfma_f32_16x16x32_bf16 v[84:87], a[216:219], v[132:135], v[84:87]
v_mfma_f32_16x16x32_bf16 v[88:91], a[220:223], v[124:127], v[88:91]
v_mfma_f32_16x16x32_bf16 v[92:95], a[220:223], v[128:131], v[92:95]
buffer_load_dwordx4 v151, s[36:39], s46 offen offset:3072 lds
v_mfma_f32_16x16x32_bf16 v[96:99], a[220:223], v[132:135], v[96:99]
s_bitcmp1_b32 s61, 8
s_getpc_b64 s[68:69]
s_cbranch_scc1 L_kvt_v
s_waitcnt vmcnt(12) lgkmcnt(0)
s_barrier
v_mfma_f32_16x16x32_bf16 v[4:7], a[224:227], v[136:139], v[4:7]
ds_read_b64_tr_b16 a[192:193], v224 offset:0
ds_read_b64_tr_b16 a[194:195], v224 offset:4096
s_add_u32 s53, s71, 2
v_mfma_f32_16x16x32_bf16 v[8:11], a[224:227], v[140:143], v[8:11]
ds_read_b64_tr_b16 a[196:197], v225 offset:0
ds_read_b64_tr_b16 a[198:199], v225 offset:4096
s_and_b32 s53, s53, 3
v_mfma_f32_16x16x32_bf16 v[12:15], a[224:227], v[144:147], v[12:15]
ds_read_b64_tr_b16 a[200:201], v226 offset:0
ds_read_b64_tr_b16 a[202:203], v226 offset:4096
s_mul_i32 s53, s53, 24576
v_mfma_f32_16x16x32_bf16 v[16:19], a[228:231], v[136:139], v[16:19]
s_add_u32 s59, s53, s60
s_add_u32 s45, s58, s99
s_add_u32 m0, s47, 49152
s_nop 0
buffer_load_dwordx4 v240, s[32:35], s45 offen lds
v_mfma_f32_16x16x32_bf16 v[20:23], a[228:231], v[140:143], v[20:23]
ds_read_b64_tr_b16 a[204:205], v227 offset:0
ds_read_b64_tr_b16 a[206:207], v227 offset:4096
v_xor_b32 v3, s92, v2
v_mfma_f32_16x16x32_bf16 v[24:27], a[228:231], v[144:147], v[24:27]
ds_read_b64_tr_b16 a[208:209], v228 offset:0
v_add_u32 v3, s59, v3
v_mfma_f32_16x16x32_bf16 v[28:31], a[232:235], v[136:139], v[28:31]
ds_read_b64_tr_b16 a[210:211], v228 offset:4096
v_mfma_f32_16x16x32_bf16 v[32:35], a[232:235], v[140:143], v[32:35]
buffer_load_dwordx4 v241, s[32:35], s45 offen offset:1024 lds
v_mfma_f32_16x16x32_bf16 v[36:39], a[232:235], v[144:147], v[36:39]
ds_read_b64_tr_b16 a[212:213], v229 offset:0
v_mfma_f32_16x16x32_bf16 v[40:43], a[236:239], v[136:139], v[40:43]
ds_read_b64_tr_b16 a[214:215], v229 offset:4096
v_mfma_f32_16x16x32_bf16 v[44:47], a[236:239], v[140:143], v[44:47]
ds_read_b64_tr_b16 a[216:217], v230 offset:0
v_mfma_f32_16x16x32_bf16 v[48:51], a[236:239], v[144:147], v[48:51]
buffer_load_dwordx4 v242, s[32:35], s45 offen offset:2048 lds
v_mfma_f32_16x16x32_bf16 v[52:55], a[240:243], v[136:139], v[52:55]
ds_read_b64_tr_b16 a[218:219], v230 offset:4096
v_mfma_f32_16x16x32_bf16 v[56:59], a[240:243], v[140:143], v[56:59]
ds_read_b64_tr_b16 a[220:221], v231 offset:0
v_mfma_f32_16x16x32_bf16 v[60:63], a[240:243], v[144:147], v[60:63]
buffer_load_dwordx4 v243, s[32:35], s45 offen offset:3072 lds
v_mfma_f32_16x16x32_bf16 v[64:67], a[244:247], v[136:139], v[64:67]
ds_read_b64_tr_b16 a[222:223], v231 offset:4096
s_add_u32 s46, s46, 16384
s_add_u32 m0, s70, 69632
v_mfma_f32_16x16x32_bf16 v[68:71], a[244:247], v[140:143], v[68:71]
ds_read_b128 v[124:127], v3 offset:0
v_mfma_f32_16x16x32_bf16 v[72:75], a[244:247], v[144:147], v[72:75]
ds_read_b128 v[128:131], v3 offset:4096
v_mfma_f32_16x16x32_bf16 v[76:79], a[248:251], v[136:139], v[76:79]
buffer_load_dwordx4 v148, s[36:39], s46 offen lds
v_mfma_f32_16x16x32_bf16 v[80:83], a[248:251], v[140:143], v[80:83]
ds_read_b128 v[132:135], v3 offset:8192
v_mfma_f32_16x16x32_bf16 v[84:87], a[248:251], v[144:147], v[84:87]
v_mfma_f32_16x16x32_bf16 v[88:91], a[252:255], v[136:139], v[88:91]
v_mfma_f32_16x16x32_bf16 v[92:95], a[252:255], v[140:143], v[92:95]
buffer_load_dwordx4 v149, s[36:39], s46 offen offset:1024 lds
v_mfma_f32_16x16x32_bf16 v[96:99], a[252:255], v[144:147], v[96:99]
s_bitcmp1_b32 s61, 9
s_getpc_b64 s[68:69]
s_cbranch_scc1 L_kvt_w
s_waitcnt vmcnt(14) lgkmcnt(0)
s_barrier
v_mfma_f32_16x16x32_bf16 v[4:7], a[192:195], v[124:127], v[4:7]
ds_read_b64_tr_b16 a[224:225], v224 offset:16384
ds_read_b64_tr_b16 a[226:227], v224 offset:20480
s_add_u32 s52, s71, 3
v_mfma_f32_16x16x32_bf16 v[8:11], a[192:195], v[128:131], v[8:11]
ds_read_b64_tr_b16 a[228:229], v225 offset:16384
ds_read_b64_tr_b16 a[230:231], v225 offset:20480
s_and_b32 s52, s52, 3
v_mfma_f32_16x16x32_bf16 v[12:15], a[192:195], v[132:135], v[12:15]
ds_read_b64_tr_b16 a[232:233], v226 offset:16384
s_lshl_b32 s52, s52, 20
s_add_u32 s58, s52, s56
v_mfma_f32_16x16x32_bf16 v[16:19], a[196:199], v[124:127], v[16:19]
s_add_u32 s45, s58, s96
s_add_u32 m0, s47, 0
s_nop 0
buffer_load_dwordx4 v240, s[32:35], s45 offen lds
v_mfma_f32_16x16x32_bf16 v[20:23], a[196:199], v[128:131], v[20:23]
ds_read_b64_tr_b16 a[234:235], v226 offset:20480
v_xor_b32 v3, s93, v2
v_mfma_f32_16x16x32_bf16 v[24:27], a[196:199], v[132:135], v[24:27]
ds_read_b64_tr_b16 a[236:237], v227 offset:16384
v_add_u32 v3, s59, v3
v_mfma_f32_16x16x32_bf16 v[28:31], a[200:203], v[124:127], v[28:31]
ds_read_b64_tr_b16 a[238:239], v227 offset:20480
v_mfma_f32_16x16x32_bf16 v[32:35], a[200:203], v[128:131], v[32:35]
ds_read_b64_tr_b16 a[240:241], v228 offset:16384
v_mfma_f32_16x16x32_bf16 v[36:39], a[200:203], v[132:135], v[36:39]
ds_read_b64_tr_b16 a[242:243], v228 offset:20480
v_mfma_f32_16x16x32_bf16 v[40:43], a[204:207], v[124:127], v[40:43]
buffer_load_dwordx4 v241, s[32:35], s45 offen offset:1024 lds
v_mfma_f32_16x16x32_bf16 v[44:47], a[204:207], v[128:131], v[44:47]
ds_read_b64_tr_b16 a[244:245], v229 offset:16384
v_mfma_f32_16x16x32_bf16 v[48:51], a[204:207], v[132:135], v[48:51]
ds_read_b64_tr_b16 a[246:247], v229 offset:20480
v_mfma_f32_16x16x32_bf16 v[52:55], a[208:211], v[124:127], v[52:55]
ds_read_b64_tr_b16 a[248:249], v230 offset:16384
v_mfma_f32_16x16x32_bf16 v[56:59], a[208:211], v[128:131], v[56:59]
ds_read_b64_tr_b16 a[250:251], v230 offset:20480
v_mfma_f32_16x16x32_bf16 v[60:63], a[208:211], v[132:135], v[60:63]
ds_read_b64_tr_b16 a[252:253], v231 offset:16384
v_mfma_f32_16x16x32_bf16 v[64:67], a[212:215], v[124:127], v[64:67]
ds_read_b64_tr_b16 a[254:255], v231 offset:20480
v_mfma_f32_16x16x32_bf16 v[68:71], a[212:215], v[128:131], v[68:71]
buffer_load_dwordx4 v242, s[32:35], s45 offen offset:2048 lds
v_mfma_f32_16x16x32_bf16 v[72:75], a[212:215], v[132:135], v[72:75]
ds_read_b128 v[136:139], v3 offset:0
v_mfma_f32_16x16x32_bf16 v[76:79], a[216:219], v[124:127], v[76:79]
ds_read_b128 v[140:143], v3 offset:4096
v_mfma_f32_16x16x32_bf16 v[80:83], a[216:219], v[128:131], v[80:83]
ds_read_b128 v[144:147], v3 offset:8192
v_mfma_f32_16x16x32_bf16 v[84:87], a[216:219], v[132:135], v[84:87]
v_mfma_f32_16x16x32_bf16 v[88:91], a[220:223], v[124:127], v[88:91]
v_mfma_f32_16x16x32_bf16 v[92:95], a[220:223], v[128:131], v[92:95]
buffer_load_dwordx4 v243, s[32:35], s45 offen offset:3072 lds
v_mfma_f32_16x16x32_bf16 v[96:99], a[220:223], v[132:135], v[96:99]
s_bitcmp1_b32 s61, 10
s_getpc_b64 s[68:69]
s_cbranch_scc1 L_kvt_w
s_waitcnt vmcnt(14) lgkmcnt(0)
s_barrier
v_mfma_f32_16x16x32_bf16 v[4:7], a[224:227], v[136:139], v[4:7]
ds_read_b64_tr_b16 a[192:193], v224 offset:32768
ds_read_b64_tr_b16 a[194:195], v224 offset:36864
s_add_u32 s45, s58, s97
v_mfma_f32_16x16x32_bf16 v[8:11], a[224:227], v[140:143], v[8:11]
ds_read_b64_tr_b16 a[196:197], v225 offset:32768
ds_read_b64_tr_b16 a[198:199], v225 offset:36864
s_add_u32 m0, s47, 16384
v_mfma_f32_16x16x32_bf16 v[12:15], a[224:227], v[144:147], v[12:15]
ds_read_b64_tr_b16 a[200:201], v226 offset:32768
ds_read_b64_tr_b16 a[202:203], v226 offset:36864
v_mfma_f32_16x16x32_bf16 v[16:19], a[228:231], v[136:139], v[16:19]
buffer_load_dwordx4 v240, s[32:35], s45 offen lds
v_mfma_f32_16x16x32_bf16 v[20:23], a[228:231], v[140:143], v[20:23]
ds_read_b64_tr_b16 a[204:205], v227 offset:32768
v_xor_b32 v3, s94, v2
v_mfma_f32_16x16x32_bf16 v[24:27], a[228:231], v[144:147], v[24:27]
ds_read_b64_tr_b16 a[206:207], v227 offset:36864
v_add_u32 v3, s59, v3
v_mfma_f32_16x16x32_bf16 v[28:31], a[232:235], v[136:139], v[28:31]
ds_read_b64_tr_b16 a[208:209], v228 offset:32768
v_mfma_f32_16x16x32_bf16 v[32:35], a[232:235], v[140:143], v[32:35]
ds_read_b64_tr_b16 a[210:211], v228 offset:36864
v_mfma_f32_16x16x32_bf16 v[36:39], a[232:235], v[144:147], v[36:39]
buffer_load_dwordx4 v241, s[32:35], s45 offen offset:1024 lds
v_mfma_f32_16x16x32_bf16 v[40:43], a[236:239], v[136:139], v[40:43]
ds_read_b64_tr_b16 a[212:213], v229 offset:32768
v_mfma_f32_16x16x32_bf16 v[44:47], a[236:239], v[140:143], v[44:47]
ds_read_b64_tr_b16 a[214:215], v229 offset:36864
v_mfma_f32_16x16x32_bf16 v[48:51], a[236:239], v[144:147], v[48:51]
ds_read_b64_tr_b16 a[216:217], v230 offset:32768
v_mfma_f32_16x16x32_bf16 v[52:55], a[240:243], v[136:139], v[52:55]
ds_read_b64_tr_b16 a[218:219], v230 offset:36864
v_mfma_f32_16x16x32_bf16 v[56:59], a[240:243], v[140:143], v[56:59]
buffer_load_dwordx4 v242, s[32:35], s45 offen offset:2048 lds
v_mfma_f32_16x16x32_bf16 v[60:63], a[240:243], v[144:147], v[60:63]
ds_read_b64_tr_b16 a[220:221], v231 offset:32768
v_mfma_f32_16x16x32_bf16 v[64:67], a[244:247], v[136:139], v[64:67]
ds_read_b64_tr_b16 a[222:223], v231 offset:36864
v_mfma_f32_16x16x32_bf16 v[68:71], a[244:247], v[140:143], v[68:71]
ds_read_b128 v[124:127], v3 offset:0
v_mfma_f32_16x16x32_bf16 v[72:75], a[244:247], v[144:147], v[72:75]
buffer_load_dwordx4 v243, s[32:35], s45 offen offset:3072 lds
v_mfma_f32_16x16x32_bf16 v[76:79], a[248:251], v[136:139], v[76:79]
ds_read_b128 v[128:131], v3 offset:4096
s_getpc_b64 s[36:37]
L_pc2:
s_add_u32 s36, s36, L_q0end-L_pc2
v_mfma_f32_16x16x32_bf16 v[80:83], a[248:251], v[140:143], v[80:83]
ds_read_b128 v[132:135], v3 offset:8192
s_addc_u32 s37, s37, 0
s_and_b32 s37, s37, 0xffff
v_mfma_f32_16x16x32_bf16 v[84:87], a[248:251], v[144:147], v[84:87]
s_mov_b32 s38, L_codeend-L_q0end
s_mov_b32 s39, 0x20000
s_and_b32 s52, s7, 7
v_mfma_f32_16x16x32_bf16 v[88:91], a[252:255], v[136:139], v[88:91]
s_lshl_b32 s52, s52, 2
s_add_u32 s52, s52, s4
s_lshl_b32 s52, s52, 11
v_mfma_f32_16x16x32_bf16 v[92:95], a[252:255], v[140:143], v[92:95]
v_and_b32 v249, 15, v1
v_lshlrev_b32 v249, 7, v249
buffer_load_dword v254, v249, s[36:39], s52 offen
v_mfma_f32_16x16x32_bf16 v[96:99], a[252:255], v[144:147], v[96:99]
s_bitcmp1_b32 s61, 11
s_getpc_b64 s[68:69]
s_cbranch_scc1 L_kvt_w
s_waitcnt vmcnt(11) lgkmcnt(0)
s_barrier
v_mfma_f32_16x16x32_bf16 v[4:7], a[192:195], v[124:127], v[4:7]
ds_read_b64_tr_b16 a[224:225], v224 offset:49152
ds_read_b64_tr_b16 a[226:227], v224 offset:53248
s_add_u32 s45, s58, s98
v_mfma_f32_16x16x32_bf16 v[8:11], a[192:195], v[128:131], v[8:11]
ds_read_b64_tr_b16 a[228:229], v225 offset:49152
ds_read_b64_tr_b16 a[230:231], v225 offset:53248
s_add_u32 m0, s47, 32768
v_mfma_f32_16x16x32_bf16 v[12:15], a[192:195], v[132:135], v[12:15]
ds_read_b64_tr_b16 a[232:233], v226 offset:49152
v_mfma_f32_16x16x32_bf16 v[16:19], a[196:199], v[124:127], v[16:19]
buffer_load_dwordx4 v240, s[32:35], s45 offen lds
v_mfma_f32_16x16x32_bf16 v[20:23], a[196:199], v[128:131], v[20:23]
ds_read_b64_tr_b16 a[234:235], v226 offset:53248
v_xor_b32 v3, s95, v2
v_mfma_f32_16x16x32_bf16 v[24:27], a[196:199], v[132:135], v[24:27]
ds_read_b64_tr_b16 a[236:237], v227 offset:49152
v_add_u32 v3, s59, v3
v_mfma_f32_16x16x32_bf16 v[28:31], a[200:203], v[124:127], v[28:31]
ds_read_b64_tr_b16 a[238:239], v227 offset:53248
v_mfma_f32_16x16x32_bf16 v[32:35], a[200:203], v[128:131], v[32:35]
ds_read_b64_tr_b16 a[240:241], v228 offset:49152
v_mfma_f32_16x16x32_bf16 v[36:39], a[200:203], v[132:135], v[36:39]
ds_read_b64_tr_b16 a[242:243], v228 offset:53248
v_mfma_f32_16x16x32_bf16 v[40:43], a[204:207], v[124:127], v[40:43]
buffer_load_dwordx4 v241, s[32:35], s45 offen offset:1024 lds
v_mfma_f32_16x16x32_bf16 v[44:47], a[204:207], v[128:131], v[44:47]
ds_read_b64_tr_b16 a[244:245], v229 offset:49152
v_mfma_f32_16x16x32_bf16 v[48:51], a[204:207], v[132:135], v[48:51]
ds_read_b64_tr_b16 a[246:247], v229 offset:53248
v_mfma_f32_16x16x32_bf16 v[52:55], a[208:211], v[124:127], v[52:55]
ds_read_b64_tr_b16 a[248:249], v230 offset:49152
v_mfma_f32_16x16x32_bf16 v[56:59], a[208:211], v[128:131], v[56:59]
ds_read_b64_tr_b16 a[250:251], v230 offset:53248
v_mfma_f32_16x16x32_bf16 v[60:63], a[208:211], v[132:135], v[60:63]
ds_read_b64_tr_b16 a[252:253], v231 offset:49152
v_mfma_f32_16x16x32_bf16 v[64:67], a[212:215], v[124:127], v[64:67]
ds_read_b64_tr_b16 a[254:255], v231 offset:53248
v_mfma_f32_16x16x32_bf16 v[68:71], a[212:215], v[128:131], v[68:71]
buffer_load_dwordx4 v242, s[32:35], s45 offen offset:2048 lds
v_mfma_f32_16x16x32_bf16 v[72:75], a[212:215], v[132:135], v[72:75]
ds_read_b128 v[136:139], v3 offset:0
v_mfma_f32_16x16x32_bf16 v[76:79], a[216:219], v[124:127], v[76:79]
ds_read_b128 v[140:143], v3 offset:4096
v_mfma_f32_16x16x32_bf16 v[80:83], a[216:219], v[128:131], v[80:83]
ds_read_b128 v[144:147], v3 offset:8192
v_mfma_f32_16x16x32_bf16 v[84:87], a[216:219], v[132:135], v[84:87]
v_mfma_f32_16x16x32_bf16 v[88:91], a[220:223], v[124:127], v[88:91]
v_mfma_f32_16x16x32_bf16 v[92:95], a[220:223], v[128:131], v[92:95]
buffer_load_dwordx4 v243, s[32:35], s45 offen offset:3072 lds
v_mfma_f32_16x16x32_bf16 v[96:99], a[220:223], v[132:135], v[96:99]
s_bitcmp1_b32 s61, 12
s_getpc_b64 s[68:69]
s_cbranch_scc1 L_kvt_w
s_waitcnt vmcnt(9) lgkmcnt(0)
s_barrier
v_mfma_f32_16x16x32_bf16 v[4:7], a[224:227], v[136:139], v[4:7]
ds_read_b64_tr_b16 a[192:193], v224 offset:0
ds_read_b64_tr_b16 a[194:195], v224 offset:4096
s_add_u32 s53, s71, 3
v_mfma_f32_16x16x32_bf16 v[8:11], a[224:227], v[140:143], v[8:11]
ds_read_b64_tr_b16 a[196:197], v225 offset:0
ds_read_b64_tr_b16 a[198:199], v225 offset:4096
s_and_b32 s53, s53, 3
v_mfma_f32_16x16x32_bf16 v[12:15], a[224:227], v[144:147], v[12:15]
ds_read_b64_tr_b16 a[200:201], v226 offset:0
s_mul_i32 s53, s53, 24576
s_add_u32 s59, s53, s60
v_mfma_f32_16x16x32_bf16 v[16:19], a[228:231], v[136:139], v[16:19]
s_add_u32 s45, s58, s99
s_add_u32 m0, s47, 49152
s_nop 0
buffer_load_dwordx4 v240, s[32:35], s45 offen lds
v_mfma_f32_16x16x32_bf16 v[20:23], a[228:231], v[140:143], v[20:23]
ds_read_b64_tr_b16 a[202:203], v226 offset:4096
v_xor_b32 v3, s92, v2
v_mfma_f32_16x16x32_bf16 v[24:27], a[228:231], v[144:147], v[24:27]
ds_read_b64_tr_b16 a[204:205], v227 offset:0
v_add_u32 v3, s59, v3
v_mfma_f32_16x16x32_bf16 v[28:31], a[232:235], v[136:139], v[28:31]
ds_read_b64_tr_b16 a[206:207], v227 offset:4096
v_mfma_f32_16x16x32_bf16 v[32:35], a[232:235], v[140:143], v[32:35]
ds_read_b64_tr_b16 a[208:209], v228 offset:0
v_mfma_f32_16x16x32_bf16 v[36:39], a[232:235], v[144:147], v[36:39]
ds_read_b64_tr_b16 a[210:211], v228 offset:4096
v_mfma_f32_16x16x32_bf16 v[40:43], a[236:239], v[136:139], v[40:43]
buffer_load_dwordx4 v241, s[32:35], s45 offen offset:1024 lds
v_mfma_f32_16x16x32_bf16 v[44:47], a[236:239], v[140:143], v[44:47]
ds_read_b64_tr_b16 a[212:213], v229 offset:0
v_mfma_f32_16x16x32_bf16 v[48:51], a[236:239], v[144:147], v[48:51]
ds_read_b64_tr_b16 a[214:215], v229 offset:4096
v_mfma_f32_16x16x32_bf16 v[52:55], a[240:243], v[136:139], v[52:55]
ds_read_b64_tr_b16 a[216:217], v230 offset:0
v_mfma_f32_16x16x32_bf16 v[56:59], a[240:243], v[140:143], v[56:59]
ds_read_b64_tr_b16 a[218:219], v230 offset:4096
v_mfma_f32_16x16x32_bf16 v[60:63], a[240:243], v[144:147], v[60:63]
ds_read_b64_tr_b16 a[220:221], v231 offset:0
v_mfma_f32_16x16x32_bf16 v[64:67], a[244:247], v[136:139], v[64:67]
ds_read_b64_tr_b16 a[222:223], v231 offset:4096
v_mfma_f32_16x16x32_bf16 v[68:71], a[244:247], v[140:143], v[68:71]
buffer_load_dwordx4 v242, s[32:35], s45 offen offset:2048 lds
v_mfma_f32_16x16x32_bf16 v[72:75], a[244:247], v[144:147], v[72:75]
ds_read_b128 v[124:127], v3 offset:0
v_mfma_f32_16x16x32_bf16 v[76:79], a[248:251], v[136:139], v[76:79]
ds_read_b128 v[128:131], v3 offset:4096
v_mfma_f32_16x16x32_bf16 v[80:83], a[248:251], v[140:143], v[80:83]
ds_read_b128 v[132:135], v3 offset:8192
v_mfma_f32_16x16x32_bf16 v[84:87], a[248:251], v[144:147], v[84:87]
v_mfma_f32_16x16x32_bf16 v[88:91], a[252:255], v[136:139], v[88:91]
v_mfma_f32_16x16x32_bf16 v[92:95], a[252:255], v[140:143], v[92:95]
buffer_load_dwordx4 v243, s[32:35], s45 offen offset:3072 lds
v_mfma_f32_16x16x32_bf16 v[96:99], a[252:255], v[144:147], v[96:99]
s_waitcnt vmcnt(9) lgkmcnt(0)
s_barrier
v_mfma_f32_16x16x32_bf16 v[4:7], a[192:195], v[124:127], v[4:7]
ds_read_b64_tr_b16 a[224:225], v224 offset:16384
ds_read_b64_tr_b16 a[226:227], v224 offset:20480
s_add_u32 s44, s11, 0
v_mfma_f32_16x16x32_bf16 v[8:11], a[192:195], v[128:131], v[8:11]
ds_read_b64_tr_b16 a[228:229], v225 offset:16384
ds_read_b64_tr_b16 a[230:231], v225 offset:20480
s_and_b32 s44, s44, 0x1ffff
v_mfma_f32_16x16x32_bf16 v[12:15], a[192:195], v[132:135], v[12:15]
ds_read_b64_tr_b16 a[232:233], v226 offset:16384
s_add_u32 s44, s44, s49
s_add_u32 m0, s47, 0
v_mfma_f32_16x16x32_bf16 v[16:19], a[196:199], v[124:127], v[16:19]
buffer_load_dwordx4 v236, s[12:15], s44 offen nt lds
v_mfma_f32_16x16x32_bf16 v[20:23], a[196:199], v[128:131], v[20:23]
ds_read_b64_tr_b16 a[234:235], v226 offset:20480
v_xor_b32 v3, s93, v2
v_mfma_f32_16x16x32_bf16 v[24:27], a[196:199], v[132:135], v[24:27]
ds_read_b64_tr_b16 a[236:237], v227 offset:16384
v_add_u32 v3, s59, v3
v_mfma_f32_16x16x32_bf16 v[28:31], a[200:203], v[124:127], v[28:31]
ds_read_b64_tr_b16 a[238:239], v227 offset:20480
v_mfma_f32_16x16x32_bf16 v[32:35], a[200:203], v[128:131], v[32:35]
ds_read_b64_tr_b16 a[240:241], v228 offset:16384
v_mfma_f32_16x16x32_bf16 v[36:39], a[200:203], v[132:135], v[36:39]
ds_read_b64_tr_b16 a[242:243], v228 offset:20480
v_mfma_f32_16x16x32_bf16 v[40:43], a[204:207], v[124:127], v[40:43]
buffer_load_dwordx4 v237, s[12:15], s44 offen offset:1024 nt lds
v_mfma_f32_16x16x32_bf16 v[44:47], a[204:207], v[128:131], v[44:47]
ds_read_b64_tr_b16 a[244:245], v229 offset:16384
v_mfma_f32_16x16x32_bf16 v[48:51], a[204:207], v[132:135], v[48:51]
ds_read_b64_tr_b16 a[246:247], v229 offset:20480
v_mfma_f32_16x16x32_bf16 v[52:55], a[208:211], v[124:127], v[52:55]
ds_read_b64_tr_b16 a[248:249], v230 offset:16384
v_mfma_f32_16x16x32_bf16 v[56:59], a[208:211], v[128:131], v[56:59]
ds_read_b64_tr_b16 a[250:251], v230 offset:20480
v_mfma_f32_16x16x32_bf16 v[60:63], a[208:211], v[132:135], v[60:63]
ds_read_b64_tr_b16 a[252:253], v231 offset:16384
v_mfma_f32_16x16x32_bf16 v[64:67], a[212:215], v[124:127], v[64:67]
ds_read_b64_tr_b16 a[254:255], v231 offset:20480
v_mfma_f32_16x16x32_bf16 v[68:71], a[212:215], v[128:131], v[68:71]
buffer_load_dwordx4 v238, s[12:15], s44 offen offset:2048 nt lds
v_mfma_f32_16x16x32_bf16 v[72:75], a[212:215], v[132:135], v[72:75]
ds_read_b128 v[136:139], v3 offset:0
v_mfma_f32_16x16x32_bf16 v[76:79], a[216:219], v[124:127], v[76:79]
ds_read_b128 v[140:143], v3 offset:4096
v_mfma_f32_16x16x32_bf16 v[80:83], a[216:219], v[128:131], v[80:83]
ds_read_b128 v[144:147], v3 offset:8192
v_mfma_f32_16x16x32_bf16 v[84:87], a[216:219], v[132:135], v[84:87]
v_mfma_f32_16x16x32_bf16 v[88:91], a[220:223], v[124:127], v[88:91]
v_mfma_f32_16x16x32_bf16 v[92:95], a[220:223], v[128:131], v[92:95]
buffer_load_dwordx4 v239, s[12:15], s44 offen offset:3072 nt lds
v_mfma_f32_16x16x32_bf16 v[96:99], a[220:223], v[132:135], v[96:99]
s_waitcnt vmcnt(8) lgkmcnt(0)
s_barrier
v_mfma_f32_16x16x32_bf16 v[4:7], a[224:227], v[136:139], v[4:7]
ds_read_b64_tr_b16 a[192:193], v224 offset:32768
ds_read_b64_tr_b16 a[194:195], v224 offset:36864
s_add_u32 s56, s56, 256
v_mfma_f32_16x16x32_bf16 v[8:11], a[224:227], v[140:143], v[8:11]
ds_read_b64_tr_b16 a[196:197], v225 offset:32768
ds_read_b64_tr_b16 a[198:199], v225 offset:36864
s_add_u32 s52, s71, 0
v_mfma_f32_16x16x32_bf16 v[12:15], a[224:227], v[144:147], v[12:15]
ds_read_b64_tr_b16 a[200:201], v226 offset:32768
s_and_b32 s52, s52, 3
s_lshl_b32 s52, s52, 20
v_mfma_f32_16x16x32_bf16 v[16:19], a[228:231], v[136:139], v[16:19]
s_add_u32 s58, s52, s56
s_add_u32 s45, s58, s96
s_add_u32 m0, s47, 16384
s_nop 0
buffer_load_dwordx4 v240, s[32:35], s45 offen lds
v_mfma_f32_16x16x32_bf16 v[20:23], a[228:231], v[140:143], v[20:23]
ds_read_b64_tr_b16 a[202:203], v226 offset:36864
v_xor_b32 v3, s94, v2
v_mfma_f32_16x16x32_bf16 v[24:27], a[228:231], v[144:147], v[24:27]
ds_read_b64_tr_b16 a[204:205], v227 offset:32768
v_add_u32 v3, s59, v3
v_mfma_f32_16x16x32_bf16 v[28:31], a[232:235], v[136:139], v[28:31]
ds_read_b64_tr_b16 a[206:207], v227 offset:36864
v_mfma_f32_16x16x32_bf16 v[32:35], a[232:235], v[140:143], v[32:35]
ds_read_b64_tr_b16 a[208:209], v228 offset:32768
v_mfma_f32_16x16x32_bf16 v[36:39], a[232:235], v[144:147], v[36:39]
ds_read_b64_tr_b16 a[210:211], v228 offset:36864
v_mfma_f32_16x16x32_bf16 v[40:43], a[236:239], v[136:139], v[40:43]
buffer_load_dwordx4 v241, s[32:35], s45 offen offset:1024 lds
v_mfma_f32_16x16x32_bf16 v[44:47], a[236:239], v[140:143], v[44:47]
ds_read_b64_tr_b16 a[212:213], v229 offset:32768
v_mfma_f32_16x16x32_bf16 v[48:51], a[236:239], v[144:147], v[48:51]
ds_read_b64_tr_b16 a[214:215], v229 offset:36864
v_mfma_f32_16x16x32_bf16 v[52:55], a[240:243], v[136:139], v[52:55]
ds_read_b64_tr_b16 a[216:217], v230 offset:32768
v_mfma_f32_16x16x32_bf16 v[56:59], a[240:243], v[140:143], v[56:59]
ds_read_b64_tr_b16 a[218:219], v230 offset:36864
v_mfma_f32_16x16x32_bf16 v[60:63], a[240:243], v[144:147], v[60:63]
ds_read_b64_tr_b16 a[220:221], v231 offset:32768
v_mfma_f32_16x16x32_bf16 v[64:67], a[244:247], v[136:139], v[64:67]
ds_read_b64_tr_b16 a[222:223], v231 offset:36864
v_mfma_f32_16x16x32_bf16 v[68:71], a[244:247], v[140:143], v[68:71]
buffer_load_dwordx4 v242, s[32:35], s45 offen offset:2048 lds
v_mfma_f32_16x16x32_bf16 v[72:75], a[244:247], v[144:147], v[72:75]
ds_read_b128 v[124:127], v3 offset:0
v_mfma_f32_16x16x32_bf16 v[76:79], a[248:251], v[136:139], v[76:79]
ds_read_b128 v[128:131], v3 offset:4096
v_mfma_f32_16x16x32_bf16 v[80:83], a[248:251], v[140:143], v[80:83]
ds_read_b128 v[132:135], v3 offset:8192
v_mfma_f32_16x16x32_bf16 v[84:87], a[248:251], v[144:147], v[84:87]
v_mfma_f32_16x16x32_bf16 v[88:91], a[252:255], v[136:139], v[88:91]
v_mfma_f32_16x16x32_bf16 v[92:95], a[252:255], v[140:143], v[92:95]
buffer_load_dwordx4 v243, s[32:35], s45 offen offset:3072 lds
v_mfma_f32_16x16x32_bf16 v[96:99], a[252:255], v[144:147], v[96:99]
s_waitcnt vmcnt(8) lgkmcnt(0)
s_barrier
v_mfma_f32_16x16x32_bf16 v[4:7], a[192:195], v[124:127], v[4:7]
ds_read_b64_tr_b16 a[224:225], v224 offset:49152
ds_read_b64_tr_b16 a[226:227], v224 offset:53248
s_add_u32 s44, s11, 0
v_mfma_f32_16x16x32_bf16 v[8:11], a[192:195], v[128:131], v[8:11]
ds_read_b64_tr_b16 a[228:229], v225 offset:49152
ds_read_b64_tr_b16 a[230:231], v225 offset:53248
s_and_b32 s44, s44, 0x1ffff
v_mfma_f32_16x16x32_bf16 v[12:15], a[192:195], v[132:135], v[12:15]
ds_read_b64_tr_b16 a[232:233], v226 offset:49152
s_add_u32 s44, s44, s49
s_add_u32 m0, s47, 32768
v_mfma_f32_16x16x32_bf16 v[16:19], a[196:199], v[124:127], v[16:19]
buffer_load_dwordx4 v236, s[16:19], s44 offen nt lds
v_mfma_f32_16x16x32_bf16 v[20:23], a[196:199], v[128:131], v[20:23]
ds_read_b64_tr_b16 a[234:235], v226 offset:53248
v_xor_b32 v3, s95, v2
v_mfma_f32_16x16x32_bf16 v[24:27], a[196:199], v[132:135], v[24:27]
ds_read_b64_tr_b16 a[236:237], v227 offset:49152
v_add_u32 v3, s59, v3
v_mfma_f32_16x16x32_bf16 v[28:31], a[200:203], v[124:127], v[28:31]
ds_read_b64_tr_b16 a[238:239], v227 offset:53248
v_mfma_f32_16x16x32_bf16 v[32:35], a[200:203], v[128:131], v[32:35]
ds_read_b64_tr_b16 a[240:241], v228 offset:49152
v_mfma_f32_16x16x32_bf16 v[36:39], a[200:203], v[132:135], v[36:39]
ds_read_b64_tr_b16 a[242:243], v228 offset:53248
v_mfma_f32_16x16x32_bf16 v[40:43], a[204:207], v[124:127], v[40:43]
buffer_load_dwordx4 v237, s[16:19], s44 offen offset:1024 nt lds
v_mfma_f32_16x16x32_bf16 v[44:47], a[204:207], v[128:131], v[44:47]
ds_read_b64_tr_b16 a[244:245], v229 offset:49152
v_mfma_f32_16x16x32_bf16 v[48:51], a[204:207], v[132:135], v[48:51]
ds_read_b64_tr_b16 a[246:247], v229 offset:53248
v_mfma_f32_16x16x32_bf16 v[52:55], a[208:211], v[124:127], v[52:55]
ds_read_b64_tr_b16 a[248:249], v230 offset:49152
v_mfma_f32_16x16x32_bf16 v[56:59], a[208:211], v[128:131], v[56:59]
ds_read_b64_tr_b16 a[250:251], v230 offset:53248
v_mfma_f32_16x16x32_bf16 v[60:63], a[208:211], v[132:135], v[60:63]
ds_read_b64_tr_b16 a[252:253], v231 offset:49152
v_mfma_f32_16x16x32_bf16 v[64:67], a[212:215], v[124:127], v[64:67]
ds_read_b64_tr_b16 a[254:255], v231 offset:53248
v_mfma_f32_16x16x32_bf16 v[68:71], a[212:215], v[128:131], v[68:71]
buffer_load_dwordx4 v238, s[16:19], s44 offen offset:2048 nt lds
v_mfma_f32_16x16x32_bf16 v[72:75], a[212:215], v[132:135], v[72:75]
ds_read_b128 v[136:139], v3 offset:0
v_mfma_f32_16x16x32_bf16 v[76:79], a[216:219], v[124:127], v[76:79]
ds_read_b128 v[140:143], v3 offset:4096
v_mfma_f32_16x16x32_bf16 v[80:83], a[216:219], v[128:131], v[80:83]
ds_read_b128 v[144:147], v3 offset:8192
v_mfma_f32_16x16x32_bf16 v[84:87], a[216:219], v[132:135], v[84:87]
v_mfma_f32_16x16x32_bf16 v[88:91], a[220:223], v[124:127], v[88:91]
v_mfma_f32_16x16x32_bf16 v[92:95], a[220:223], v[128:131], v[92:95]
buffer_load_dwordx4 v239, s[16:19], s44 offen offset:3072 nt lds
v_mfma_f32_16x16x32_bf16 v[96:99], a[220:223], v[132:135], v[96:99]
s_waitcnt vmcnt(12) lgkmcnt(0)
s_barrier
v_mfma_f32_16x16x32_bf16 v[4:7], a[224:227], v[136:139], v[4:7]
v_mfma_f32_16x16x32_bf16 v[16:19], a[228:231], v[136:139], v[16:19]
v_mfma_f32_16x16x32_bf16 v[28:31], a[232:235], v[136:139], v[28:31]
v_mfma_f32_16x16x32_bf16 v[40:43], a[236:239], v[136:139], v[40:43]
v_mfma_f32_16x16x32_bf16 v[52:55], a[240:243], v[136:139], v[52:55]
v_mfma_f32_16x16x32_bf16 v[64:67], a[244:247], v[136:139], v[64:67]
v_mfma_f32_16x16x32_bf16 v[76:79], a[248:251], v[136:139], v[76:79]
v_mfma_f32_16x16x32_bf16 v[88:91], a[252:255], v[136:139], v[88:91]
v_mfma_f32_16x16x32_bf16 v[8:11], a[224:227], v[140:143], v[8:11]
v_mfma_f32_16x16x32_bf16 v[20:23], a[228:231], v[140:143], v[20:23]
v_mfma_f32_16x16x32_bf16 v[32:35], a[232:235], v[140:143], v[32:35]
s_mov_b32 s55, 0x3e0293ee
v_mul_f32 v4, s55, v4
v_mul_f32 v5, s55, v5
v_mfma_f32_16x16x32_bf16 v[44:47], a[236:239], v[140:143], v[44:47]
v_mul_f32 v6, s55, v6
v_mul_f32 v7, s55, v7
v_mul_f32 v16, s55, v16
v_mfma_f32_16x16x32_bf16 v[56:59], a[240:243], v[140:143], v[56:59]
v_mul_f32 v17, s55, v17
v_mul_f32 v18, s55, v18
v_mfma_f32_16x16x32_bf16 v[68:71], a[244:247], v[140:143], v[68:71]
v_mul_f32 v19, s55, v19
v_cvt_pk_bf16_f32 v160, v4, v5
v_mfma_f32_16x16x32_bf16 v[80:83], a[248:251], v[140:143], v[80:83]
v_cvt_pk_bf16_f32 v161, v6, v7
v_cvt_pk_bf16_f32 v162, v16, v17
v_mfma_f32_16x16x32_bf16 v[92:95], a[252:255], v[140:143], v[92:95]
v_cvt_pk_bf16_f32 v163, v18, v19
v_mul_f32 v28, s55, v28
v_mfma_f32_16x16x32_bf16 v[12:15], a[224:227], v[144:147], v[12:15]
v_mul_f32 v29, s55, v29
v_mul_f32 v30, s55, v30
v_mfma_f32_16x16x32_bf16 v[24:27], a[228:231], v[144:147], v[24:27]
v_mul_f32 v31, s55, v31
v_mul_f32 v40, s55, v40
v_mfma_f32_16x16x32_bf16 v[36:39], a[232:235], v[144:147], v[36:39]
v_mul_f32 v41, s55, v41
v_permlane32_swap_b32 v160, v162
v_mfma_f32_16x16x32_bf16 v[48:51], a[236:239], v[144:147], v[48:51]
v_permlane32_swap_b32 v161, v163
v_mul_f32 v42, s55, v42
v_mfma_f32_16x16x32_bf16 v[60:63], a[240:243], v[144:147], v[60:63]
v_mul_f32 v43, s55, v43
v_cvt_pk_bf16_f32 v172, v28, v29
v_mfma_f32_16x16x32_bf16 v[72:75], a[244:247], v[144:147], v[72:75]
v_cvt_pk_bf16_f32 v173, v30, v31
v_cvt_pk_bf16_f32 v174, v40, v41
v_mfma_f32_16x16x32_bf16 v[84:87], a[248:251], v[144:147], v[84:87]
v_cvt_pk_bf16_f32 v175, v42, v43
v_permlane16_swap_b32 v160, v162
v_mfma_f32_16x16x32_bf16 v[96:99], a[252:255], v[144:147], v[96:99]
v_permlane16_swap_b32 v161, v163
v_mul_f32 v52, s55, v52
L_q0end:
v_mul_f32 v53, s55, v53
v_mul_f32 v54, s55, v54
v_mul_f32 v55, s55, v55
v_mul_f32 v64, s55, v64
v_mul_f32 v65, s55, v65
v_permlane32_swap_b32 v172, v174
v_permlane32_swap_b32 v173, v175
v_mul_f32 v66, s55, v66
v_mul_f32 v67, s55, v67
v_cvt_pk_bf16_f32 v184, v52, v53
s_add_u32 s44, s11, 8192
v_cvt_pk_bf16_f32 v185, v54, v55
v_cvt_pk_bf16_f32 v186, v64, v65
v_cvt_pk_bf16_f32 v187, v66, v67
v_permlane16_swap_b32 v172, v174
v_permlane16_swap_b32 v173, v175
v_mul_f32 v76, s55, v76
v_mul_f32 v77, s55, v77
v_mul_f32 v78, s55, v78
v_mul_f32 v79, s55, v79
v_mul_f32 v88, s55, v88
s_and_b32 s44, s44, 0x1ffff
v_mul_f32 v89, s55, v89
v_permlane32_swap_b32 v184, v186
v_permlane32_swap_b32 v185, v187
v_mul_f32 v90, s55, v90
v_mul_f32 v91, s55, v91
v_cvt_pk_bf16_f32 v196, v76, v77
v_cvt_pk_bf16_f32 v197, v78, v79
v_cvt_pk_bf16_f32 v198, v88, v89
v_cvt_pk_bf16_f32 v199, v90, v91
v_permlane16_swap_b32 v184, v186
s_add_u32 s44, s44, s49
v_permlane16_swap_b32 v185, v187
v_mul_f32 v8, s55, v8
v_mul_f32 v9, s55, v9
v_mul_f32 v10, s55, v10
v_mul_f32 v11, s55, v11
v_mul_f32 v20, s55, v20
v_mul_f32 v21, s55, v21
v_permlane32_swap_b32 v196, v198
v_permlane32_swap_b32 v197, v199
v_mul_f32 v22, s55, v22
s_add_u32 m0, s47, 49152
v_mul_f32 v23, s55, v23
v_cvt_pk_bf16_f32 v164, v8, v9
v_cvt_pk_bf16_f32 v165, v10, v11
v_cvt_pk_bf16_f32 v166, v20, v21
v_cvt_pk_bf16_f32 v167, v22, v23
v_permlane16_swap_b32 v196, v198
v_permlane16_swap_b32 v197, v199
v_mul_f32 v32, s55, v32
v_mul_f32 v33, s55, v33
v_mul_f32 v34, s55, v34
buffer_load_dwordx4 v236, s[12:15], s44 offen nt lds
v_mul_f32 v35, s55, v35
v_mul_f32 v44, s55, v44
v_mul_f32 v45, s55, v45
v_permlane32_swap_b32 v164, v166
v_permlane32_swap_b32 v165, v167
v_mul_f32 v46, s55, v46
v_mul_f32 v47, s55, v47
v_cvt_pk_bf16_f32 v176, v32, v33
v_cvt_pk_bf16_f32 v177, v34, v35
v_cvt_pk_bf16_f32 v178, v44, v45
buffer_load_dwordx4 v237, s[12:15], s44 offen offset:1024 nt lds
v_cvt_pk_bf16_f32 v179, v46, v47
v_permlane16_swap_b32 v164, v166
v_permlane16_swap_b32 v165, v167
v_mul_f32 v56, s55, v56
v_mul_f32 v57, s55, v57
v_mul_f32 v58, s55, v58
v_mul_f32 v59, s55, v59
v_mul_f32 v68, s55, v68
v_mul_f32 v69, s55, v69
v_permlane32_swap_b32 v176, v178
buffer_load_dwordx4 v238, s[12:15], s44 offen offset:2048 nt lds
v_permlane32_swap_b32 v177, v179
v_mul_f32 v70, s55, v70
v_mul_f32 v71, s55, v71
v_cvt_pk_bf16_f32 v188, v56, v57
v_cvt_pk_bf16_f32 v189, v58, v59
v_cvt_pk_bf16_f32 v190, v68, v69
v_cvt_pk_bf16_f32 v191, v70, v71
v_permlane16_swap_b32 v176, v178
v_permlane16_swap_b32 v177, v179
v_mul_f32 v80, s55, v80
buffer_load_dwordx4 v239, s[12:15], s44 offen offset:3072 nt lds
v_mul_f32 v81, s55, v81
v_mul_f32 v82, s55, v82
v_mul_f32 v83, s55, v83
v_mul_f32 v92, s55, v92
v_mul_f32 v93, s55, v93
v_permlane32_swap_b32 v188, v190
v_permlane32_swap_b32 v189, v191
v_mul_f32 v94, s55, v94
v_mul_f32 v95, s55, v95
v_cvt_pk_bf16_f32 v200, v80, v81
s_waitcnt vmcnt(12) lgkmcnt(0)
s_barrier
v_cvt_pk_bf16_f32 v201, v82, v83
v_cvt_pk_bf16_f32 v202, v92, v93
v_cvt_pk_bf16_f32 v203, v94, v95
v_permlane16_swap_b32 v188, v190
v_permlane16_swap_b32 v189, v191
v_mul_f32 v12, s55, v12
v_mul_f32 v13, s55, v13
v_mul_f32 v14, s55, v14
v_mul_f32 v15, s55, v15
ds_read_b128 a[192:195], v232 offset:0
v_mul_f32 v24, s55, v24
v_mul_f32 v25, s55, v25
v_permlane32_swap_b32 v200, v202
v_permlane32_swap_b32 v201, v203
v_mul_f32 v26, s55, v26
v_mul_f32 v27, s55, v27
v_cvt_pk_bf16_f32 v168, v12, v13
v_cvt_pk_bf16_f32 v169, v14, v15
ds_read_b128 a[196:199], v233 offset:0
v_cvt_pk_bf16_f32 v170, v24, v25
v_cvt_pk_bf16_f32 v171, v26, v27
v_permlane16_swap_b32 v200, v202
v_permlane16_swap_b32 v201, v203
v_mul_f32 v36, s55, v36
v_mul_f32 v37, s55, v37
v_mul_f32 v38, s55, v38
v_mul_f32 v39, s55, v39
ds_read_b128 a[200:203], v234 offset:0
v_mul_f32 v48, s55, v48
v_mul_f32 v49, s55, v49
v_permlane32_swap_b32 v168, v170
v_permlane32_swap_b32 v169, v171
v_mul_f32 v50, s55, v50
v_mul_f32 v51, s55, v51
v_cvt_pk_bf16_f32 v180, v36, v37
v_cvt_pk_bf16_f32 v181, v38, v39
v_cvt_pk_bf16_f32 v182, v48, v49
ds_read_b128 a[204:207], v235 offset:0
v_cvt_pk_bf16_f32 v183, v50, v51
v_permlane16_swap_b32 v168, v170
v_permlane16_swap_b32 v169, v171
v_mul_f32 v60, s55, v60
v_mul_f32 v61, s55, v61
v_mul_f32 v62, s55, v62
v_mul_f32 v63, s55, v63
v_mul_f32 v72, s55, v72
ds_read_b128 a[208:211], v232 offset:4096
v_mul_f32 v73, s55, v73
v_permlane32_swap_b32 v180, v182
v_permlane32_swap_b32 v181, v183
v_mul_f32 v74, s55, v74
v_mul_f32 v75, s55, v75
v_cvt_pk_bf16_f32 v192, v60, v61
v_cvt_pk_bf16_f32 v193, v62, v63
v_cvt_pk_bf16_f32 v194, v72, v73
ds_read_b128 a[212:215], v233 offset:4096
v_cvt_pk_bf16_f32 v195, v74, v75
v_permlane16_swap_b32 v180, v182
v_permlane16_swap_b32 v181, v183
v_mul_f32 v84, s55, v84
v_mul_f32 v85, s55, v85
v_mul_f32 v86, s55, v86
v_mul_f32 v87, s55, v87
v_mul_f32 v96, s55, v96
v_mul_f32 v97, s55, v97
ds_read_b128 a[216:219], v234 offset:4096
v_permlane32_swap_b32 v192, v194
v_permlane32_swap_b32 v193, v195
v_mul_f32 v98, s55, v98
v_mul_f32 v99, s55, v99
v_cvt_pk_bf16_f32 v204, v84, v85
v_cvt_pk_bf16_f32 v205, v86, v87
v_cvt_pk_bf16_f32 v206, v96, v97
v_cvt_pk_bf16_f32 v207, v98, v99
ds_read_b128 a[220:223], v235 offset:4096
v_permlane16_swap_b32 v192, v194
v_permlane16_swap_b32 v193, v195
s_nop 1
v_permlane32_swap_b32 v204, v206
v_permlane32_swap_b32 v205, v207
s_nop 1
v_permlane16_swap_b32 v204, v206
v_permlane16_swap_b32 v205, v207
s_waitcnt vmcnt(8) lgkmcnt(0)
s_barrier
v_mfma_f32_16x16x32_bf16 v[124:127], a[192:195], v[160:163], 0
ds_read_b64_tr_b16 a[224:225], v224 offset:16384
s_add_u32 s53, s71, 0
s_and_b32 s53, s53, 3
v_mfma_f32_16x16x32_bf16 v[124:127], a[196:199], v[172:175], v[124:127]
ds_read_b64_tr_b16 a[226:227], v224 offset:20480
s_mul_i32 s53, s53, 24576
s_add_u32 s59, s53, s60
v_mfma_f32_16x16x32_bf16 v[124:127], a[200:203], v[184:187], v[124:127]
ds_read_b64_tr_b16 a[228:229], v225 offset:16384
s_add_u32 s45, s58, s97
s_add_u32 m0, s47, 0
v_mfma_f32_16x16x32_bf16 v[124:127], a[204:207], v[196:199], v[124:127]
ds_read_b64_tr_b16 a[230:231], v225 offset:20480
v_mfma_f32_16x16x32_bf16 v[136:139], a[208:211], v[160:163], 0
ds_read_b64_tr_b16 a[232:233], v226 offset:16384
ds_read_b64_tr_b16 a[234:235], v226 offset:20480
v_mfma_f32_16x16x32_bf16 v[136:139], a[212:215], v[172:175], v[136:139]
buffer_load_dwordx4 v240, s[32:35], s45 offen lds
v_mfma_f32_16x16x32_bf16 v[136:139], a[216:219], v[184:187], v[136:139]
ds_read_b64_tr_b16 a[236:237], v227 offset:16384
v_xor_b32 v3, s92, v2
v_mfma_f32_16x16x32_bf16 v[136:139], a[220:223], v[196:199], v[136:139]
ds_read_b64_tr_b16 a[238:239], v227 offset:20480
v_add_u32 v3, s59, v3
v_mfma_f32_16x16x32_bf16 v[128:131], a[192:195], v[164:167], 0
ds_read_b64_tr_b16 a[240:241], v228 offset:16384
v_mfma_f32_16x16x32_bf16 v[128:131], a[196:199], v[176:179], v[128:131]
ds_read_b64_tr_b16 a[242:243], v228 offset:20480
v_mfma_f32_16x16x32_bf16 v[128:131], a[200:203], v[188:191], v[128:131]
ds_read_b64_tr_b16 a[244:245], v229 offset:16384
ds_read_b64_tr_b16 a[246:247], v229 offset:20480
v_mfma_f32_16x16x32_bf16 v[128:131], a[204:207], v[200:203], v[128:131]
buffer_load_dwordx4 v241, s[32:35], s45 offen offset:1024 lds
v_mfma_f32_16x16x32_bf16 v[140:143], a[208:211], v[164:167], 0
ds_read_b64_tr_b16 a[248:249], v230 offset:16384
v_max3_f32 v244, v124, v125, v126
v_mfma_f32_16x16x32_bf16 v[140:143], a[212:215], v[176:179], v[140:143]
ds_read_b64_tr_b16 a[250:251], v230 offset:20480
v_max3_f32 v244, v244, v127, v136
v_mfma_f32_16x16x32_bf16 v[140:143], a[216:219], v[188:191], v[140:143]
ds_read_b64_tr_b16 a[252:253], v231 offset:16384
v_max3_f32 v244, v244, v137, v138
v_mfma_f32_16x16x32_bf16 v[140:143], a[220:223], v[200:203], v[140:143]
ds_read_b64_tr_b16 a[254:255], v231 offset:20480
ds_read_b128 v[208:211], v3 offset:0
v_max_f32 v244, v244, v139
v_mfma_f32_16x16x32_bf16 v[132:135], a[192:195], v[168:171], 0
buffer_load_dwordx4 v242, s[32:35], s45 offen offset:2048 lds
v_mfma_f32_16x16x32_bf16 v[132:135], a[196:199], v[180:183], v[132:135]
ds_read_b128 v[212:215], v3 offset:4096
v_mfma_f32_16x16x32_bf16 v[132:135], a[200:203], v[192:195], v[132:135]
ds_read_b128 v[216:219], v3 offset:8192
v_mfma_f32_16x16x32_bf16 v[132:135], a[204:207], v[204:207], v[132:135]
v_max3_f32 v245, v128, v129, v130
v_max3_f32 v245, v245, v131, v140
v_mfma_f32_16x16x32_bf16 v[144:147], a[208:211], v[168:171], 0
v_max3_f32 v245, v245, v141, v142
v_max_f32 v245, v245, v143
v_mfma_f32_16x16x32_bf16 v[144:147], a[212:215], v[180:183], v[144:147]
buffer_load_dwordx4 v243, s[32:35], s45 offen offset:3072 lds
v_mfma_f32_16x16x32_bf16 v[144:147], a[216:219], v[192:195], v[144:147]
v_mfma_f32_16x16x32_bf16 v[144:147], a[220:223], v[204:207], v[144:147]
s_waitcnt vmcnt(8) lgkmcnt(0)
s_barrier
v_mfma_f32_16x16x32_bf16 a[0:3], a[224:227], v[208:211], 0
ds_read_b64_tr_b16 a[192:193], v224 offset:32768
s_add_u32 s44, s11, 8192
s_and_b32 s44, s44, 0x1ffff
v_mfma_f32_16x16x32_bf16 a[4:7], a[224:227], v[212:215], 0
ds_read_b64_tr_b16 a[194:195], v224 offset:36864
ds_read_b64_tr_b16 a[196:197], v225 offset:32768
s_add_u32 s44, s44, s49
v_mfma_f32_16x16x32_bf16 a[8:11], a[224:227], v[216:219], 0
s_add_u32 m0, s47, 16384
s_nop 0
buffer_load_dwordx4 v236, s[16:19], s44 offen nt lds
v_mfma_f32_16x16x32_bf16 a[12:15], a[228:231], v[208:211], 0
ds_read_b64_tr_b16 a[198:199], v225 offset:36864
v_max3_f32 v246, v132, v133, v134
v_mfma_f32_16x16x32_bf16 a[16:19], a[228:231], v[212:215], 0
ds_read_b64_tr_b16 a[200:201], v226 offset:32768
v_max3_f32 v246, v246, v135, v144
v_mfma_f32_16x16x32_bf16 a[20:23], a[228:231], v[216:219], 0
v_max3_f32 v246, v246, v145, v146
v_max_f32 v246, v246, v147
v_mfma_f32_16x16x32_bf16 a[24:27], a[232:235], v[208:211], 0
v_mov_b32 v247, v244
v_mov_b32 v248, v245
v_mov_b32 v249, v246
v_mfma_f32_16x16x32_bf16 a[28:31], a[232:235], v[212:215], 0
s_nop 0
v_mfma_f32_16x16x32_bf16 a[32:35], a[232:235], v[216:219], 0
buffer_load_dwordx4 v237, s[16:19], s44 offen offset:1024 nt lds
v_mfma_f32_16x16x32_bf16 a[36:39], a[236:239], v[208:211], 0
ds_read_b64_tr_b16 a[202:203], v226 offset:36864
v_permlane32_swap_b32 v244, v247
v_mfma_f32_16x16x32_bf16 a[40:43], a[236:239], v[212:215], 0
ds_read_b64_tr_b16 a[204:205], v227 offset:32768
v_permlane32_swap_b32 v245, v248
v_mfma_f32_16x16x32_bf16 a[44:47], a[236:239], v[216:219], 0
ds_read_b64_tr_b16 a[206:207], v227 offset:36864
v_permlane32_swap_b32 v246, v249
v_mfma_f32_16x16x32_bf16 a[48:51], a[240:243], v[208:211], 0
ds_read_b64_tr_b16 a[208:209], v228 offset:32768
v_max_f32 v244, v244, v247
v_mfma_f32_16x16x32_bf16 a[52:55], a[240:243], v[212:215], 0
ds_read_b64_tr_b16 a[210:211], v228 offset:36864
v_max_f32 v245, v245, v248
v_mfma_f32_16x16x32_bf16 a[56:59], a[240:243], v[216:219], 0
buffer_load_dwordx4 v238, s[16:19], s44 offen offset:2048 nt lds
v_mfma_f32_16x16x32_bf16 a[60:63], a[244:247], v[208:211], 0
ds_read_b64_tr_b16 a[212:213], v229 offset:32768
v_max_f32 v246, v246, v249
v_mfma_f32_16x16x32_bf16 a[64:67], a[244:247], v[212:215], 0
ds_read_b64_tr_b16 a[214:215], v229 offset:36864
v_mov_b32 v247, v244
v_mfma_f32_16x16x32_bf16 a[68:71], a[244:247], v[216:219], 0
ds_read_b64_tr_b16 a[216:217], v230 offset:32768
v_mov_b32 v248, v245
v_mfma_f32_16x16x32_bf16 a[72:75], a[248:251], v[208:211], 0
ds_read_b64_tr_b16 a[218:219], v230 offset:36864
v_mov_b32 v249, v246
v_mfma_f32_16x16x32_bf16 a[76:79], a[248:251], v[212:215], 0
ds_read_b64_tr_b16 a[220:221], v231 offset:32768
ds_read_b64_tr_b16 a[222:223], v231 offset:36864
s_nop 0
v_mfma_f32_16x16x32_bf16 a[80:83], a[248:251], v[216:219], 0
buffer_load_dwordx4 v239, s[16:19], s44 offen offset:3072 nt lds
v_mfma_f32_16x16x32_bf16 a[84:87], a[252:255], v[208:211], 0
v_permlane16_swap_b32 v244, v247
v_permlane16_swap_b32 v245, v248
v_mfma_f32_16x16x32_bf16 a[88:91], a[252:255], v[212:215], 0
v_permlane16_swap_b32 v246, v249
v_max_f32 v244, v244, v247
v_mfma_f32_16x16x32_bf16 a[92:95], a[252:255], v[216:219], 0
v_max_f32 v245, v245, v248
v_max_f32 v246, v246, v249
v_sub_f32 v124, v124, v244
v_sub_f32 v125, v125, v244
v_sub_f32 v126, v126, v244
v_sub_f32 v127, v127, v244
v_sub_f32 v136, v136, v244
v_sub_f32 v137, v137, v244
v_sub_f32 v138, v138, v244
v_sub_f32 v139, v139, v244
v_sub_f32 v112, 0, v244
v_sub_f32 v113, 0, v244
v_sub_f32 v114, 0, v244
v_sub_f32 v115, 0, v244
v_sub_f32 v128, v128, v245
v_sub_f32 v129, v129, v245
v_sub_f32 v130, v130, v245
v_sub_f32 v131, v131, v245
v_sub_f32 v140, v140, v245
v_sub_f32 v141, v141, v245
v_sub_f32 v142, v142, v245
v_sub_f32 v143, v143, v245
v_sub_f32 v116, 0, v245
v_sub_f32 v117, 0, v245
v_sub_f32 v118, 0, v245
v_sub_f32 v119, 0, v245
v_sub_f32 v132, v132, v246
v_sub_f32 v133, v133, v246
v_sub_f32 v134, v134, v246
v_sub_f32 v135, v135, v246
v_sub_f32 v144, v144, v246
v_sub_f32 v145, v145, v246
v_sub_f32 v146, v146, v246
v_sub_f32 v147, v147, v246
v_sub_f32 v120, 0, v246
v_sub_f32 v121, 0, v246
v_sub_f32 v122, 0, v246
v_sub_f32 v123, 0, v246
v_exp_f32 v124, v124
v_exp_f32 v125, v125
v_exp_f32 v126, v126
v_exp_f32 v127, v127
v_exp_f32 v136, v136
v_exp_f32 v137, v137
v_exp_f32 v138, v138
v_exp_f32 v139, v139
v_cvt_pk_bf16_f32 v148, v124, v125
v_cvt_pk_bf16_f32 v149, v126, v127
v_cvt_pk_bf16_f32 v150, v136, v137
v_cvt_pk_bf16_f32 v151, v138, v139
v_exp_f32 v128, v128
v_exp_f32 v129, v129
v_exp_f32 v130, v130
v_exp_f32 v131, v131
s_waitcnt vmcnt(8) lgkmcnt(0)
s_barrier
v_mfma_f32_16x16x32_bf16 v[100:103], v[220:223], v[148:151], 0
s_add_u32 s44, s11, 16384
v_exp_f32 v140, v140
v_mfma_f32_16x16x32_bf16 v[4:7], a[192:195], v[148:151], 0
s_and_b32 s44, s44, 0x1ffff
v_exp_f32 v141, v141
v_mfma_f32_16x16x32_bf16 v[16:19], a[196:199], v[148:151], 0
s_add_u32 s44, s44, s49
v_exp_f32 v142, v142
v_mfma_f32_16x16x32_bf16 v[28:31], a[200:203], v[148:151], 0
s_add_u32 m0, s47, 32768
v_exp_f32 v143, v143
v_mfma_f32_16x16x32_bf16 v[40:43], a[204:207], v[148:151], 0
v_cvt_pk_bf16_f32 v152, v128, v129
v_cvt_pk_bf16_f32 v153, v130, v131
v_mfma_f32_16x16x32_bf16 v[52:55], a[208:211], v[148:151], 0
v_cvt_pk_bf16_f32 v154, v140, v141
v_cvt_pk_bf16_f32 v155, v142, v143
v_mfma_f32_16x16x32_bf16 v[64:67], a[212:215], v[148:151], 0
v_exp_f32 v132, v132
v_mfma_f32_16x16x32_bf16 v[76:79], a[216:219], v[148:151], 0
buffer_load_dwordx4 v236, s[12:15], s44 offen nt lds
v_mfma_f32_16x16x32_bf16 v[88:91], a[220:223], v[148:151], 0
v_exp_f32 v133, v133
v_mfma_f32_16x16x32_bf16 v[104:107], v[220:223], v[152:155], 0
v_exp_f32 v134, v134
v_mfma_f32_16x16x32_bf16 v[8:11], a[192:195], v[152:155], 0
v_exp_f32 v135, v135
v_mfma_f32_16x16x32_bf16 v[20:23], a[196:199], v[152:155], 0
v_exp_f32 v144, v144
v_mfma_f32_16x16x32_bf16 v[32:35], a[200:203], v[152:155], 0
buffer_load_dwordx4 v237, s[12:15], s44 offen offset:1024 nt lds
v_mfma_f32_16x16x32_bf16 v[44:47], a[204:207], v[152:155], 0
v_exp_f32 v145, v145
v_mfma_f32_16x16x32_bf16 v[56:59], a[208:211], v[152:155], 0
v_exp_f32 v146, v146
v_mfma_f32_16x16x32_bf16 v[68:71], a[212:215], v[152:155], 0
ds_read_b128 a[224:227], v232 offset:49152
v_exp_f32 v147, v147
v_mfma_f32_16x16x32_bf16 v[80:83], a[216:219], v[152:155], 0
ds_read_b128 a[228:231], v233 offset:49152
v_cvt_pk_bf16_f32 v156, v132, v133
v_cvt_pk_bf16_f32 v157, v134, v135
v_mfma_f32_16x16x32_bf16 v[92:95], a[220:223], v[152:155], 0
ds_read_b128 a[232:235], v234 offset:49152
v_cvt_pk_bf16_f32 v158, v144, v145
v_cvt_pk_bf16_f32 v159, v146, v147
s_nop 1
v_mfma_f32_16x16x32_bf16 v[108:111], v[220:223], v[156:159], 0
ds_read_b128 a[236:239], v235 offset:49152
ds_read_b128 a[240:243], v232 offset:53248
v_mfma_f32_16x16x32_bf16 v[12:15], a[192:195], v[156:159], 0
ds_read_b128 a[244:247], v233 offset:53248
v_mfma_f32_16x16x32_bf16 v[24:27], a[196:199], v[156:159], 0
buffer_load_dwordx4 v238, s[12:15], s44 offen offset:2048 nt lds
v_mfma_f32_16x16x32_bf16 v[36:39], a[200:203], v[156:159], 0
ds_read_b128 a[248:251], v234 offset:53248
ds_read_b128 a[252:255], v235 offset:53248
v_mfma_f32_16x16x32_bf16 v[48:51], a[204:207], v[156:159], 0
v_mfma_f32_16x16x32_bf16 v[60:63], a[208:211], v[156:159], 0
v_mfma_f32_16x16x32_bf16 v[72:75], a[212:215], v[156:159], 0
buffer_load_dwordx4 v239, s[12:15], s44 offen offset:3072 nt lds
v_mfma_f32_16x16x32_bf16 v[84:87], a[216:219], v[156:159], 0
v_mfma_f32_16x16x32_bf16 v[96:99], a[220:223], v[156:159], 0
s_waitcnt vmcnt(8) lgkmcnt(0)
s_barrier
v_mfma_f32_16x16x32_bf16 v[124:127], a[224:227], v[160:163], v[112:115]
ds_read_b64_tr_b16 a[192:193], v224 offset:0
s_add_u32 s45, s58, s98
s_add_u32 m0, s47, 49152
v_mfma_f32_16x16x32_bf16 v[124:127], a[228:231], v[172:175], v[124:127]
ds_read_b64_tr_b16 a[194:195], v224 offset:4096
v_mfma_f32_16x16x32_bf16 v[124:127], a[232:235], v[184:187], v[124:127]
ds_read_b64_tr_b16 a[196:197], v225 offset:0
v_mfma_f32_16x16x32_bf16 v[124:127], a[236:239], v[196:199], v[124:127]
ds_read_b64_tr_b16 a[198:199], v225 offset:4096
v_mfma_f32_16x16x32_bf16 v[136:139], a[240:243], v[160:163], v[112:115]
ds_read_b64_tr_b16 a[200:201], v226 offset:0
ds_read_b64_tr_b16 a[202:203], v226 offset:4096
v_mfma_f32_16x16x32_bf16 v[136:139], a[244:247], v[172:175], v[136:139]
buffer_load_dwordx4 v240, s[32:35], s45 offen lds
v_mfma_f32_16x16x32_bf16 v[136:139], a[248:251], v[184:187], v[136:139]
ds_read_b64_tr_b16 a[204:205], v227 offset:0
v_xor_b32 v3, s93, v2
v_mfma_f32_16x16x32_bf16 v[136:139], a[252:255], v[196:199], v[136:139]
ds_read_b64_tr_b16 a[206:207], v227 offset:4096
v_add_u32 v3, s59, v3
v_mfma_f32_16x16x32_bf16 v[128:131], a[224:227], v[164:167], v[116:119]
ds_read_b64_tr_b16 a[208:209], v228 offset:0
v_mfma_f32_16x16x32_bf16 v[128:131], a[228:231], v[176:179], v[128:131]
ds_read_b64_tr_b16 a[210:211], v228 offset:4096
v_mfma_f32_16x16x32_bf16 v[128:131], a[232:235], v[188:191], v[128:131]
ds_read_b64_tr_b16 a[212:213], v229 offset:0
ds_read_b64_tr_b16 a[214:215], v229 offset:4096
v_mfma_f32_16x16x32_bf16 v[128:131], a[236:239], v[200:203], v[128:131]
buffer_load_dwordx4 v241, s[32:35], s45 offen offset:1024 lds
v_mfma_f32_16x16x32_bf16 v[140:143], a[240:243], v[164:167], v[116:119]
ds_read_b64_tr_b16 a[216:217], v230 offset:0
v_max3_f32 v244, v124, v125, v126
v_mfma_f32_16x16x32_bf16 v[140:143], a[244:247], v[176:179], v[140:143]
ds_read_b64_tr_b16 a[218:219], v230 offset:4096
v_max3_f32 v244, v244, v127, v136
v_mfma_f32_16x16x32_bf16 v[140:143], a[248:251], v[188:191], v[140:143]
ds_read_b64_tr_b16 a[220:221], v231 offset:0
v_max3_f32 v244, v244, v137, v138
v_mfma_f32_16x16x32_bf16 v[140:143], a[252:255], v[200:203], v[140:143]
ds_read_b64_tr_b16 a[222:223], v231 offset:4096
ds_read_b128 v[208:211], v3 offset:0
v_max_f32 v244, v244, v139
v_mfma_f32_16x16x32_bf16 v[132:135], a[224:227], v[168:171], v[120:123]
buffer_load_dwordx4 v242, s[32:35], s45 offen offset:2048 lds
v_mfma_f32_16x16x32_bf16 v[132:135], a[228:231], v[180:183], v[132:135]
ds_read_b128 v[212:215], v3 offset:4096
v_mfma_f32_16x16x32_bf16 v[132:135], a[232:235], v[192:195], v[132:135]
ds_read_b128 v[216:219], v3 offset:8192
v_mfma_f32_16x16x32_bf16 v[132:135], a[236:239], v[204:207], v[132:135]
v_max3_f32 v245, v128, v129, v130
v_max3_f32 v245, v245, v131, v140
v_mfma_f32_16x16x32_bf16 v[144:147], a[240:243], v[168:171], v[120:123]
v_max3_f32 v245, v245, v141, v142
v_max_f32 v245, v245, v143
v_mfma_f32_16x16x32_bf16 v[144:147], a[244:247], v[180:183], v[144:147]
buffer_load_dwordx4 v243, s[32:35], s45 offen offset:3072 lds
v_mfma_f32_16x16x32_bf16 v[144:147], a[248:251], v[192:195], v[144:147]
v_mfma_f32_16x16x32_bf16 v[144:147], a[252:255], v[204:207], v[144:147]
s_waitcnt vmcnt(8) lgkmcnt(0)
s_barrier
v_mfma_f32_16x16x32_bf16 a[0:3], a[192:195], v[208:211], a[0:3]
ds_read_b64_tr_b16 a[224:225], v224 offset:16384
s_add_u32 s44, s11, 16384
s_and_b32 s44, s44, 0x1ffff
v_mfma_f32_16x16x32_bf16 a[4:7], a[192:195], v[212:215], a[4:7]
ds_read_b64_tr_b16 a[226:227], v224 offset:20480
ds_read_b64_tr_b16 a[228:229], v225 offset:16384
s_add_u32 s44, s44, s49
v_mfma_f32_16x16x32_bf16 a[8:11], a[192:195], v[216:219], a[8:11]
s_add_u32 m0, s47, 0
s_nop 0
buffer_load_dwordx4 v236, s[16:19], s44 offen nt lds
v_mfma_f32_16x16x32_bf16 a[12:15], a[196:199], v[208:211], a[12:15]
ds_read_b64_tr_b16 a[230:231], v225 offset:20480
v_max3_f32 v246, v132, v133, v134
v_mfma_f32_16x16x32_bf16 a[16:19], a[196:199], v[212:215], a[16:19]
ds_read_b64_tr_b16 a[232:233], v226 offset:16384
v_max3_f32 v246, v246, v135, v144
v_mfma_f32_16x16x32_bf16 a[20:23], a[196:199], v[216:219], a[20:23]
v_max3_f32 v246, v246, v145, v146
v_max_f32 v246, v246, v147
v_mfma_f32_16x16x32_bf16 a[24:27], a[200:203], v[208:211], a[24:27]
v_max3_f32 v247, v244, v245, v246
v_cmp_lt_f32 vcc, s50, v247
s_cbranch_vccnz L_rs3
L_rb3:
v_mfma_f32_16x16x32_bf16 a[28:31], a[200:203], v[212:215], a[28:31]
v_exp_f32 v124, v124
v_mfma_f32_16x16x32_bf16 a[32:35], a[200:203], v[216:219], a[32:35]
buffer_load_dwordx4 v237, s[16:19], s44 offen offset:1024 nt lds
v_mfma_f32_16x16x32_bf16 a[36:39], a[204:207], v[208:211], a[36:39]
ds_read_b64_tr_b16 a[234:235], v226 offset:20480
v_exp_f32 v125, v125
v_mfma_f32_16x16x32_bf16 a[40:43], a[204:207], v[212:215], a[40:43]
ds_read_b64_tr_b16 a[236:237], v227 offset:16384
v_exp_f32 v126, v126
v_mfma_f32_16x16x32_bf16 a[44:47], a[204:207], v[216:219], a[44:47]
ds_read_b64_tr_b16 a[238:239], v227 offset:20480
v_exp_f32 v127, v127
v_mfma_f32_16x16x32_bf16 a[48:51], a[208:211], v[208:211], a[48:51]
ds_read_b64_tr_b16 a[240:241], v228 offset:16384
v_exp_f32 v136, v136
v_mfma_f32_16x16x32_bf16 a[52:55], a[208:211], v[212:215], a[52:55]
ds_read_b64_tr_b16 a[242:243], v228 offset:20480
v_exp_f32 v137, v137
v_mfma_f32_16x16x32_bf16 a[56:59], a[208:211], v[216:219], a[56:59]
buffer_load_dwordx4 v238, s[16:19], s44 offen offset:2048 nt lds
v_mfma_f32_16x16x32_bf16 a[60:63], a[212:215], v[208:211], a[60:63]
ds_read_b64_tr_b16 a[244:245], v229 offset:16384
v_exp_f32 v138, v138
v_mfma_f32_16x16x32_bf16 a[64:67], a[212:215], v[212:215], a[64:67]
ds_read_b64_tr_b16 a[246:247], v229 offset:20480
v_exp_f32 v139, v139
v_mfma_f32_16x16x32_bf16 a[68:71], a[212:215], v[216:219], a[68:71]
ds_read_b64_tr_b16 a[248:249], v230 offset:16384
v_cvt_pk_bf16_f32 v148, v124, v125
v_mfma_f32_16x16x32_bf16 a[72:75], a[216:219], v[208:211], a[72:75]
ds_read_b64_tr_b16 a[250:251], v230 offset:20480
v_cvt_pk_bf16_f32 v149, v126, v127
v_mfma_f32_16x16x32_bf16 a[76:79], a[216:219], v[212:215], a[76:79]
ds_read_b64_tr_b16 a[252:253], v231 offset:16384
ds_read_b64_tr_b16 a[254:255], v231 offset:20480
v_cvt_pk_bf16_f32 v150, v136, v137
v_mfma_f32_16x16x32_bf16 a[80:83], a[216:219], v[216:219], a[80:83]
buffer_load_dwordx4 v239, s[16:19], s44 offen offset:3072 nt lds
v_mfma_f32_16x16x32_bf16 a[84:87], a[220:223], v[208:211], a[84:87]
v_cvt_pk_bf16_f32 v151, v138, v139
v_exp_f32 v128, v128
v_mfma_f32_16x16x32_bf16 a[88:91], a[220:223], v[212:215], a[88:91]
v_exp_f32 v129, v129
v_exp_f32 v130, v130
v_mfma_f32_16x16x32_bf16 a[92:95], a[220:223], v[216:219], a[92:95]
v_exp_f32 v131, v131
s_waitcnt vmcnt(8) lgkmcnt(0)
s_barrier
v_mfma_f32_16x16x32_bf16 v[100:103], v[220:223], v[148:151], v[100:103]
s_add_u32 s44, s11, 24576
v_exp_f32 v140, v140
v_mfma_f32_16x16x32_bf16 v[4:7], a[224:227], v[148:151], v[4:7]
s_and_b32 s44, s44, 0x1ffff
v_exp_f32 v141, v141
v_mfma_f32_16x16x32_bf16 v[16:19], a[228:231], v[148:151], v[16:19]
s_add_u32 s44, s44, s49
v_exp_f32 v142, v142
v_mfma_f32_16x16x32_bf16 v[28:31], a[232:235], v[148:151], v[28:31]
s_add_u32 m0, s47, 16384
v_exp_f32 v143, v143
v_mfma_f32_16x16x32_bf16 v[40:43], a[236:239], v[148:151], v[40:43]
v_cvt_pk_bf16_f32 v152, v128, v129
v_cvt_pk_bf16_f32 v153, v130, v131
v_mfma_f32_16x16x32_bf16 v[52:55], a[240:243], v[148:151], v[52:55]
v_cvt_pk_bf16_f32 v154, v140, v141
v_cvt_pk_bf16_f32 v155, v142, v143
v_mfma_f32_16x16x32_bf16 v[64:67], a[244:247], v[148:151], v[64:67]
v_exp_f32 v132, v132
v_mfma_f32_16x16x32_bf16 v[76:79], a[248:251], v[148:151], v[76:79]
buffer_load_dwordx4 v236, s[12:15], s44 offen nt lds
v_mfma_f32_16x16x32_bf16 v[88:91], a[252:255], v[148:151], v[88:91]
v_exp_f32 v133, v133
v_mfma_f32_16x16x32_bf16 v[104:107], v[220:223], v[152:155], v[104:107]
v_exp_f32 v134, v134
v_mfma_f32_16x16x32_bf16 v[8:11], a[224:227], v[152:155], v[8:11]
v_exp_f32 v135, v135
v_mfma_f32_16x16x32_bf16 v[20:23], a[228:231], v[152:155], v[20:23]
v_exp_f32 v144, v144
v_mfma_f32_16x16x32_bf16 v[32:35], a[232:235], v[152:155], v[32:35]
buffer_load_dwordx4 v237, s[12:15], s44 offen offset:1024 nt lds
v_mfma_f32_16x16x32_bf16 v[44:47], a[236:239], v[152:155], v[44:47]
v_exp_f32 v145, v145
v_mfma_f32_16x16x32_bf16 v[56:59], a[240:243], v[152:155], v[56:59]
v_exp_f32 v146, v146
v_mfma_f32_16x16x32_bf16 v[68:71], a[244:247], v[152:155], v[68:71]
ds_read_b128 a[192:195], v232 offset:32768
v_exp_f32 v147, v147
v_mfma_f32_16x16x32_bf16 v[80:83], a[248:251], v[152:155], v[80:83]
ds_read_b128 a[196:199], v233 offset:32768
v_cvt_pk_bf16_f32 v156, v132, v133
v_cvt_pk_bf16_f32 v157, v134, v135
v_mfma_f32_16x16x32_bf16 v[92:95], a[252:255], v[152:155], v[92:95]
ds_read_b128 a[200:203], v234 offset:32768
v_cvt_pk_bf16_f32 v158, v144, v145
v_cvt_pk_bf16_f32 v159, v146, v147
s_nop 1
v_mfma_f32_16x16x32_bf16 v[108:111], v[220:223], v[156:159], v[108:111]
ds_read_b128 a[204:207], v235 offset:32768
ds_read_b128 a[208:211], v232 offset:36864
v_mfma_f32_16x16x32_bf16 v[12:15], a[224:227], v[156:159], v[12:15]
ds_read_b128 a[212:215], v233 offset:36864
v_mfma_f32_16x16x32_bf16 v[24:27], a[228:231], v[156:159], v[24:27]
buffer_load_dwordx4 v238, s[12:15], s44 offen offset:2048 nt lds
v_mfma_f32_16x16x32_bf16 v[36:39], a[232:235], v[156:159], v[36:39]
ds_read_b128 a[216:219], v234 offset:36864
ds_read_b128 a[220:223], v235 offset:36864
v_mfma_f32_16x16x32_bf16 v[48:51], a[236:239], v[156:159], v[48:51]
v_mfma_f32_16x16x32_bf16 v[60:63], a[240:243], v[156:159], v[60:63]
v_mfma_f32_16x16x32_bf16 v[72:75], a[244:247], v[156:159], v[72:75]
buffer_load_dwordx4 v239, s[12:15], s44 offen offset:3072 nt lds
v_mfma_f32_16x16x32_bf16 v[84:87], a[248:251], v[156:159], v[84:87]
v_mfma_f32_16x16x32_bf16 v[96:99], a[252:255], v[156:159], v[96:99]
s_waitcnt vmcnt(8) lgkmcnt(0)
s_barrier
v_mfma_f32_16x16x32_bf16 v[124:127], a[192:195], v[160:163], v[112:115]
ds_read_b64_tr_b16 a[224:225], v224 offset:49152
s_add_u32 s45, s58, s99
s_add_u32 m0, s47, 32768
v_mfma_f32_16x16x32_bf16 v[124:127], a[196:199], v[172:175], v[124:127]
ds_read_b64_tr_b16 a[226:227], v224 offset:53248
v_mfma_f32_16x16x32_bf16 v[124:127], a[200:203], v[184:187], v[124:127]
ds_read_b64_tr_b16 a[228:229], v225 offset:49152
v_mfma_f32_16x16x32_bf16 v[124:127], a[204:207], v[196:199], v[124:127]
ds_read_b64_tr_b16 a[230:231], v225 offset:53248
v_mfma_f32_16x16x32_bf16 v[136:139], a[208:211], v[160:163], v[112:115]
ds_read_b64_tr_b16 a[232:233], v226 offset:49152
ds_read_b64_tr_b16 a[234:235], v226 offset:53248
v_mfma_f32_16x16x32_bf16 v[136:139], a[212:215], v[172:175], v[136:139]
buffer_load_dwordx4 v240, s[32:35], s45 offen lds
v_mfma_f32_16x16x32_bf16 v[136:139], a[216:219], v[184:187], v[136:139]
ds_read_b64_tr_b16 a[236:237], v227 offset:49152
v_xor_b32 v3, s94, v2
v_mfma_f32_16x16x32_bf16 v[136:139], a[220:223], v[196:199], v[136:139]
ds_read_b64_tr_b16 a[238:239], v227 offset:53248
v_add_u32 v3, s59, v3
v_mfma_f32_16x16x32_bf16 v[128:131], a[192:195], v[164:167], v[116:119]
ds_read_b64_tr_b16 a[240:241], v228 offset:49152
v_mfma_f32_16x16x32_bf16 v[128:131], a[196:199], v[176:179], v[128:131]
ds_read_b64_tr_b16 a[242:243], v228 offset:53248
v_mfma_f32_16x16x32_bf16 v[128:131], a[200:203], v[188:191], v[128:131]
ds_read_b64_tr_b16 a[244:245], v229 offset:49152
ds_read_b64_tr_b16 a[246:247], v229 offset:53248
v_mfma_f32_16x16x32_bf16 v[128:131], a[204:207], v[200:203], v[128:131]
buffer_load_dwordx4 v241, s[32:35], s45 offen offset:1024 lds
v_mfma_f32_16x16x32_bf16 v[140:143], a[208:211], v[164:167], v[116:119]
ds_read_b64_tr_b16 a[248:249], v230 offset:49152
v_max3_f32 v244, v124, v125, v126
v_mfma_f32_16x16x32_bf16 v[140:143], a[212:215], v[176:179], v[140:143]
ds_read_b64_tr_b16 a[250:251], v230 offset:53248
v_max3_f32 v244, v244, v127, v136
v_mfma_f32_16x16x32_bf16 v[140:143], a[216:219], v[188:191], v[140:143]
ds_read_b64_tr_b16 a[252:253], v231 offset:49152
v_max3_f32 v244, v244, v137, v138
v_mfma_f32_16x16x32_bf16 v[140:143], a[220:223], v[200:203], v[140:143]
ds_read_b64_tr_b16 a[254:255], v231 offset:53248
ds_read_b128 v[208:211], v3 offset:0
v_max_f32 v244, v244, v139
v_mfma_f32_16x16x32_bf16 v[132:135], a[192:195], v[168:171], v[120:123]
buffer_load_dwordx4 v242, s[32:35], s45 offen offset:2048 lds
v_mfma_f32_16x16x32_bf16 v[132:135], a[196:199], v[180:183], v[132:135]
ds_read_b128 v[212:215], v3 offset:4096
v_mfma_f32_16x16x32_bf16 v[132:135], a[200:203], v[192:195], v[132:135]
ds_read_b128 v[216:219], v3 offset:8192
v_mfma_f32_16x16x32_bf16 v[132:135], a[204:207], v[204:207], v[132:135]
v_max3_f32 v245, v128, v129, v130
v_max3_f32 v245, v245, v131, v140
v_mfma_f32_16x16x32_bf16 v[144:147], a[208:211], v[168:171], v[120:123]
v_max3_f32 v245, v245, v141, v142
v_max_f32 v245, v245, v143
v_mfma_f32_16x16x32_bf16 v[144:147], a[212:215], v[180:183], v[144:147]
buffer_load_dwordx4 v243, s[32:35], s45 offen offset:3072 lds
v_mfma_f32_16x16x32_bf16 v[144:147], a[216:219], v[192:195], v[144:147]
v_mfma_f32_16x16x32_bf16 v[144:147], a[220:223], v[204:207], v[144:147]
s_waitcnt vmcnt(8) lgkmcnt(0)
s_barrier
v_mfma_f32_16x16x32_bf16 a[0:3], a[224:227], v[208:211], a[0:3]
ds_read_b64_tr_b16 a[192:193], v224 offset:0
s_add_u32 s44, s11, 24576
s_and_b32 s44, s44, 0x1ffff
v_mfma_f32_16x16x32_bf16 a[4:7], a[224:227], v[212:215], a[4:7]
ds_read_b64_tr_b16 a[194:195], v224 offset:4096
ds_read_b64_tr_b16 a[196:197], v225 offset:0
s_add_u32 s44, s44, s49
v_mfma_f32_16x16x32_bf16 a[8:11], a[224:227], v[216:219], a[8:11]
s_add_u32 m0, s47, 49152
s_nop 0
buffer_load_dwordx4 v236, s[16:19], s44 offen nt lds
v_mfma_f32_16x16x32_bf16 a[12:15], a[228:231], v[208:211], a[12:15]
ds_read_b64_tr_b16 a[198:199], v225 offset:4096
v_max3_f32 v246, v132, v133, v134
v_mfma_f32_16x16x32_bf16 a[16:19], a[228:231], v[212:215], a[16:19]
ds_read_b64_tr_b16 a[200:201], v226 offset:0
v_max3_f32 v246, v246, v135, v144
v_mfma_f32_16x16x32_bf16 a[20:23], a[228:231], v[216:219], a[20:23]
v_max3_f32 v246, v246, v145, v146
v_max_f32 v246, v246, v147
v_mfma_f32_16x16x32_bf16 a[24:27], a[232:235], v[208:211], a[24:27]
v_max3_f32 v247, v244, v245, v246
v_cmp_lt_f32 vcc, s50, v247
s_cbranch_vccnz L_rs4
L_rb4:
v_mfma_f32_16x16x32_bf16 a[28:31], a[232:235], v[212:215], a[28:31]
v_exp_f32 v124, v124
v_mfma_f32_16x16x32_bf16 a[32:35], a[232:235], v[216:219], a[32:35]
buffer_load_dwordx4 v237, s[16:19], s44 offen offset:1024 nt lds
v_mfma_f32_16x16x32_bf16 a[36:39], a[236:239], v[208:211], a[36:39]
ds_read_b64_tr_b16 a[202:203], v226 offset:4096
v_exp_f32 v125, v125
v_mfma_f32_16x16x32_bf16 a[40:43], a[236:239], v[212:215], a[40:43]
ds_read_b64_tr_b16 a[204:205], v227 offset:0
v_exp_f32 v126, v126
v_mfma_f32_16x16x32_bf16 a[44:47], a[236:239], v[216:219], a[44:47]
ds_read_b64_tr_b16 a[206:207], v227 offset:4096
v_exp_f32 v127, v127
v_mfma_f32_16x16x32_bf16 a[48:51], a[240:243], v[208:211], a[48:51]
ds_read_b64_tr_b16 a[208:209], v228 offset:0
v_exp_f32 v136, v136
v_mfma_f32_16x16x32_bf16 a[52:55], a[240:243], v[212:215], a[52:55]
ds_read_b64_tr_b16 a[210:211], v228 offset:4096
v_exp_f32 v137, v137
v_mfma_f32_16x16x32_bf16 a[56:59], a[240:243], v[216:219], a[56:59]
buffer_load_dwordx4 v238, s[16:19], s44 offen offset:2048 nt lds
v_mfma_f32_16x16x32_bf16 a[60:63], a[244:247], v[208:211], a[60:63]
ds_read_b64_tr_b16 a[212:213], v229 offset:0
v_exp_f32 v138, v138
v_mfma_f32_16x16x32_bf16 a[64:67], a[244:247], v[212:215], a[64:67]
ds_read_b64_tr_b16 a[214:215], v229 offset:4096
v_exp_f32 v139, v139
v_mfma_f32_16x16x32_bf16 a[68:71], a[244:247], v[216:219], a[68:71]
ds_read_b64_tr_b16 a[216:217], v230 offset:0
v_cvt_pk_bf16_f32 v148, v124, v125
v_mfma_f32_16x16x32_bf16 a[72:75], a[248:251], v[208:211], a[72:75]
ds_read_b64_tr_b16 a[218:219], v230 offset:4096
v_cvt_pk_bf16_f32 v149, v126, v127
v_mfma_f32_16x16x32_bf16 a[76:79], a[248:251], v[212:215], a[76:79]
ds_read_b64_tr_b16 a[220:221], v231 offset:0
ds_read_b64_tr_b16 a[222:223], v231 offset:4096
v_cvt_pk_bf16_f32 v150, v136, v137
v_mfma_f32_16x16x32_bf16 a[80:83], a[248:251], v[216:219], a[80:83]
buffer_load_dwordx4 v239, s[16:19], s44 offen offset:3072 nt lds
v_mfma_f32_16x16x32_bf16 a[84:87], a[252:255], v[208:211], a[84:87]
v_cvt_pk_bf16_f32 v151, v138, v139
v_exp_f32 v128, v128
v_mfma_f32_16x16x32_bf16 a[88:91], a[252:255], v[212:215], a[88:91]
v_exp_f32 v129, v129
v_exp_f32 v130, v130
v_mfma_f32_16x16x32_bf16 a[92:95], a[252:255], v[216:219], a[92:95]
v_exp_f32 v131, v131
s_waitcnt vmcnt(8) lgkmcnt(0)
s_barrier
v_mfma_f32_16x16x32_bf16 v[100:103], v[220:223], v[148:151], v[100:103]
s_add_u32 s44, s11, 32768
v_exp_f32 v140, v140
v_mfma_f32_16x16x32_bf16 v[4:7], a[192:195], v[148:151], v[4:7]
s_and_b32 s44, s44, 0x1ffff
v_exp_f32 v141, v141
v_mfma_f32_16x16x32_bf16 v[16:19], a[196:199], v[148:151], v[16:19]
s_add_u32 s44, s44, s49
v_exp_f32 v142, v142
v_mfma_f32_16x16x32_bf16 v[28:31], a[200:203], v[148:151], v[28:31]
s_add_u32 m0, s47, 0
v_exp_f32 v143, v143
v_mfma_f32_16x16x32_bf16 v[40:43], a[204:207], v[148:151], v[40:43]
v_cvt_pk_bf16_f32 v152, v128, v129
v_cvt_pk_bf16_f32 v153, v130, v131
v_mfma_f32_16x16x32_bf16 v[52:55], a[208:211], v[148:151], v[52:55]
v_cvt_pk_bf16_f32 v154, v140, v141
v_cvt_pk_bf16_f32 v155, v142, v143
v_mfma_f32_16x16x32_bf16 v[64:67], a[212:215], v[148:151], v[64:67]
v_exp_f32 v132, v132
v_mfma_f32_16x16x32_bf16 v[76:79], a[216:219], v[148:151], v[76:79]
buffer_load_dwordx4 v236, s[12:15], s44 offen nt lds
v_mfma_f32_16x16x32_bf16 v[88:91], a[220:223], v[148:151], v[88:91]
v_exp_f32 v133, v133
v_mfma_f32_16x16x32_bf16 v[104:107], v[220:223], v[152:155], v[104:107]
v_exp_f32 v134, v134
v_mfma_f32_16x16x32_bf16 v[8:11], a[192:195], v[152:155], v[8:11]
v_exp_f32 v135, v135
v_mfma_f32_16x16x32_bf16 v[20:23], a[196:199], v[152:155], v[20:23]
v_exp_f32 v144, v144
v_mfma_f32_16x16x32_bf16 v[32:35], a[200:203], v[152:155], v[32:35]
buffer_load_dwordx4 v237, s[12:15], s44 offen offset:1024 nt lds
v_mfma_f32_16x16x32_bf16 v[44:47], a[204:207], v[152:155], v[44:47]
v_exp_f32 v145, v145
v_mfma_f32_16x16x32_bf16 v[56:59], a[208:211], v[152:155], v[56:59]
v_exp_f32 v146, v146
v_mfma_f32_16x16x32_bf16 v[68:71], a[212:215], v[152:155], v[68:71]
ds_read_b128 a[224:227], v232 offset:16384
v_exp_f32 v147, v147
v_mfma_f32_16x16x32_bf16 v[80:83], a[216:219], v[152:155], v[80:83]
ds_read_b128 a[228:231], v233 offset:16384
v_cvt_pk_bf16_f32 v156, v132, v133
v_cvt_pk_bf16_f32 v157, v134, v135
v_mfma_f32_16x16x32_bf16 v[92:95], a[220:223], v[152:155], v[92:95]
ds_read_b128 a[232:235], v234 offset:16384
v_cvt_pk_bf16_f32 v158, v144, v145
v_cvt_pk_bf16_f32 v159, v146, v147
s_nop 1
v_mfma_f32_16x16x32_bf16 v[108:111], v[220:223], v[156:159], v[108:111]
ds_read_b128 a[236:239], v235 offset:16384
ds_read_b128 a[240:243], v232 offset:20480
v_mfma_f32_16x16x32_bf16 v[12:15], a[192:195], v[156:159], v[12:15]
ds_read_b128 a[244:247], v233 offset:20480
v_mfma_f32_16x16x32_bf16 v[24:27], a[196:199], v[156:159], v[24:27]
buffer_load_dwordx4 v238, s[12:15], s44 offen offset:2048 nt lds
v_mfma_f32_16x16x32_bf16 v[36:39], a[200:203], v[156:159], v[36:39]
ds_read_b128 a[248:251], v234 offset:20480
ds_read_b128 a[252:255], v235 offset:20480
v_mfma_f32_16x16x32_bf16 v[48:51], a[204:207], v[156:159], v[48:51]
v_mfma_f32_16x16x32_bf16 v[60:63], a[208:211], v[156:159], v[60:63]
v_mfma_f32_16x16x32_bf16 v[72:75], a[212:215], v[156:159], v[72:75]
buffer_load_dwordx4 v239, s[12:15], s44 offen offset:3072 nt lds
v_mfma_f32_16x16x32_bf16 v[84:87], a[216:219], v[156:159], v[84:87]
L_here5:
s_getpc_b64 s[36:37]
L_pc6:
v_mfma_f32_16x16x32_bf16 v[96:99], a[220:223], v[156:159], v[96:99]
s_add_u32 s36, s36, L_here5-L_pc6
s_addc_u32 s37, s37, -1
s_and_b32 s37, s37, 0xffff
s_mov_b32 s38, L_codeend-L_here5
s_mov_b32 s39, 0x20000
s_and_b32 s52, s7, 7
s_lshl_b32 s52, s52, 2
s_add_u32 s52, s52, s4
s_lshl_b32 s52, s52, 11
v_and_b32 v248, 15, v1
v_lshlrev_b32 v248, 7, v248
buffer_load_dword v254, v248, s[36:39], s52 offen
s_waitcnt vmcnt(9) lgkmcnt(0)
s_barrier
v_mfma_f32_16x16x32_bf16 v[124:127], a[224:227], v[160:163], v[112:115]
ds_read_b64_tr_b16 a[192:193], v224 offset:32768
s_add_u32 s52, s71, 1
s_and_b32 s52, s52, 3
v_mfma_f32_16x16x32_bf16 v[124:127], a[228:231], v[172:175], v[124:127]
ds_read_b64_tr_b16 a[194:195], v224 offset:36864
s_lshl_b32 s52, s52, 20
s_add_u32 s58, s52, s56
v_mfma_f32_16x16x32_bf16 v[124:127], a[232:235], v[184:187], v[124:127]
ds_read_b64_tr_b16 a[196:197], v225 offset:32768
s_add_u32 s45, s58, s96
s_add_u32 m0, s47, 16384
v_mfma_f32_16x16x32_bf16 v[124:127], a[236:239], v[196:199], v[124:127]
ds_read_b64_tr_b16 a[198:199], v225 offset:36864
v_mfma_f32_16x16x32_bf16 v[136:139], a[240:243], v[160:163], v[112:115]
ds_read_b64_tr_b16 a[200:201], v226 offset:32768
ds_read_b64_tr_b16 a[202:203], v226 offset:36864
v_mfma_f32_16x16x32_bf16 v[136:139], a[244:247], v[172:175], v[136:139]
buffer_load_dwordx4 v240, s[32:35], s45 offen lds
v_mfma_f32_16x16x32_bf16 v[136:139], a[248:251], v[184:187], v[136:139]
ds_read_b64_tr_b16 a[204:205], v227 offset:32768
v_xor_b32 v3, s95, v2
v_mfma_f32_16x16x32_bf16 v[136:139], a[252:255], v[196:199], v[136:139]
ds_read_b64_tr_b16 a[206:207], v227 offset:36864
v_add_u32 v3, s59, v3
v_mfma_f32_16x16x32_bf16 v[128:131], a[224:227], v[164:167], v[116:119]
ds_read_b64_tr_b16 a[208:209], v228 offset:32768
v_mfma_f32_16x16x32_bf16 v[128:131], a[228:231], v[176:179], v[128:131]
ds_read_b64_tr_b16 a[210:211], v228 offset:36864
v_mfma_f32_16x16x32_bf16 v[128:131], a[232:235], v[188:191], v[128:131]
ds_read_b64_tr_b16 a[212:213], v229 offset:32768
ds_read_b64_tr_b16 a[214:215], v229 offset:36864
v_mfma_f32_16x16x32_bf16 v[128:131], a[236:239], v[200:203], v[128:131]
buffer_load_dwordx4 v241, s[32:35], s45 offen offset:1024 lds
v_mfma_f32_16x16x32_bf16 v[140:143], a[240:243], v[164:167], v[116:119]
ds_read_b64_tr_b16 a[216:217], v230 offset:32768
v_max3_f32 v244, v124, v125, v126
v_mfma_f32_16x16x32_bf16 v[140:143], a[244:247], v[176:179], v[140:143]
ds_read_b64_tr_b16 a[218:219], v230 offset:36864
v_max3_f32 v244, v244, v127, v136
v_mfma_f32_16x16x32_bf16 v[140:143], a[248:251], v[188:191], v[140:143]
ds_read_b64_tr_b16 a[220:221], v231 offset:32768
v_max3_f32 v244, v244, v137, v138
v_mfma_f32_16x16x32_bf16 v[140:143], a[252:255], v[200:203], v[140:143]
ds_read_b64_tr_b16 a[222:223], v231 offset:36864
ds_read_b128 v[208:211], v3 offset:0
v_max_f32 v244, v244, v139
v_mfma_f32_16x16x32_bf16 v[132:135], a[224:227], v[168:171], v[120:123]
buffer_load_dwordx4 v242, s[32:35], s45 offen offset:2048 lds
v_mfma_f32_16x16x32_bf16 v[132:135], a[228:231], v[180:183], v[132:135]
ds_read_b128 v[212:215], v3 offset:4096
v_mfma_f32_16x16x32_bf16 v[132:135], a[232:235], v[192:195], v[132:135]
ds_read_b128 v[216:219], v3 offset:8192
v_mfma_f32_16x16x32_bf16 v[132:135], a[236:239], v[204:207], v[132:135]
v_max3_f32 v245, v128, v129, v130
v_max3_f32 v245, v245, v131, v140
v_mfma_f32_16x16x32_bf16 v[144:147], a[240:243], v[168:171], v[120:123]
v_max3_f32 v245, v245, v141, v142
v_max_f32 v245, v245, v143
v_mfma_f32_16x16x32_bf16 v[144:147], a[244:247], v[180:183], v[144:147]
buffer_load_dwordx4 v243, s[32:35], s45 offen offset:3072 lds
v_mfma_f32_16x16x32_bf16 v[144:147], a[248:251], v[192:195], v[144:147]
v_mfma_f32_16x16x32_bf16 v[144:147], a[252:255], v[204:207], v[144:147]
s_waitcnt vmcnt(9) lgkmcnt(0)
s_barrier
v_mfma_f32_16x16x32_bf16 a[0:3], a[192:195], v[208:211], a[0:3]
ds_read_b64_tr_b16 a[224:225], v224 offset:49152
s_add_u32 s44, s11, 32768
s_and_b32 s44, s44, 0x1ffff
v_mfma_f32_16x16x32_bf16 a[4:7], a[192:195], v[212:215], a[4:7]
ds_read_b64_tr_b16 a[226:227], v224 offset:53248
ds_read_b64_tr_b16 a[228:229], v225 offset:49152
s_add_u32 s44, s44, s49
v_mfma_f32_16x16x32_bf16 a[8:11], a[192:195], v[216:219], a[8:11]
s_add_u32 m0, s47, 32768
s_nop 0
buffer_load_dwordx4 v236, s[16:19], s44 offen nt lds
v_mfma_f32_16x16x32_bf16 a[12:15], a[196:199], v[208:211], a[12:15]
ds_read_b64_tr_b16 a[230:231], v225 offset:53248
v_max3_f32 v246, v132, v133, v134
v_mfma_f32_16x16x32_bf16 a[16:19], a[196:199], v[212:215], a[16:19]
ds_read_b64_tr_b16 a[232:233], v226 offset:49152
v_max3_f32 v246, v246, v135, v144
v_mfma_f32_16x16x32_bf16 a[20:23], a[196:199], v[216:219], a[20:23]
v_max3_f32 v246, v246, v145, v146
v_max_f32 v246, v246, v147
v_mfma_f32_16x16x32_bf16 a[24:27], a[200:203], v[208:211], a[24:27]
v_max3_f32 v247, v244, v245, v246
v_cmp_lt_f32 vcc, s50, v247
s_cbranch_vccnz L_rs7
L_rb7:
v_mfma_f32_16x16x32_bf16 a[28:31], a[200:203], v[212:215], a[28:31]
v_exp_f32 v124, v124
v_mfma_f32_16x16x32_bf16 a[32:35], a[200:203], v[216:219], a[32:35]
buffer_load_dwordx4 v237, s[16:19], s44 offen offset:1024 nt lds
v_mfma_f32_16x16x32_bf16 a[36:39], a[204:207], v[208:211], a[36:39]
ds_read_b64_tr_b16 a[234:235], v226 offset:53248
v_exp_f32 v125, v125
v_mfma_f32_16x16x32_bf16 a[40:43], a[204:207], v[212:215], a[40:43]
ds_read_b64_tr_b16 a[236:237], v227 offset:49152
v_exp_f32 v126, v126
v_mfma_f32_16x16x32_bf16 a[44:47], a[204:207], v[216:219], a[44:47]
ds_read_b64_tr_b16 a[238:239], v227 offset:53248
v_exp_f32 v127, v127
v_mfma_f32_16x16x32_bf16 a[48:51], a[208:211], v[208:211], a[48:51]
ds_read_b64_tr_b16 a[240:241], v228 offset:49152
v_exp_f32 v136, v136
v_mfma_f32_16x16x32_bf16 a[52:55], a[208:211], v[212:215], a[52:55]
ds_read_b64_tr_b16 a[242:243], v228 offset:53248
v_exp_f32 v137, v137
v_mfma_f32_16x16x32_bf16 a[56:59], a[208:211], v[216:219], a[56:59]
buffer_load_dwordx4 v238, s[16:19], s44 offen offset:2048 nt lds
v_mfma_f32_16x16x32_bf16 a[60:63], a[212:215], v[208:211], a[60:63]
ds_read_b64_tr_b16 a[244:245], v229 offset:49152
v_exp_f32 v138, v138
v_mfma_f32_16x16x32_bf16 a[64:67], a[212:215], v[212:215], a[64:67]
ds_read_b64_tr_b16 a[246:247], v229 offset:53248
v_exp_f32 v139, v139
v_mfma_f32_16x16x32_bf16 a[68:71], a[212:215], v[216:219], a[68:71]
ds_read_b64_tr_b16 a[248:249], v230 offset:49152
v_cvt_pk_bf16_f32 v148, v124, v125
v_mfma_f32_16x16x32_bf16 a[72:75], a[216:219], v[208:211], a[72:75]
ds_read_b64_tr_b16 a[250:251], v230 offset:53248
v_cvt_pk_bf16_f32 v149, v126, v127
v_mfma_f32_16x16x32_bf16 a[76:79], a[216:219], v[212:215], a[76:79]
ds_read_b64_tr_b16 a[252:253], v231 offset:49152
ds_read_b64_tr_b16 a[254:255], v231 offset:53248
v_cvt_pk_bf16_f32 v150, v136, v137
v_mfma_f32_16x16x32_bf16 a[80:83], a[216:219], v[216:219], a[80:83]
buffer_load_dwordx4 v239, s[16:19], s44 offen offset:3072 nt lds
v_mfma_f32_16x16x32_bf16 a[84:87], a[220:223], v[208:211], a[84:87]
v_cvt_pk_bf16_f32 v151, v138, v139
v_exp_f32 v128, v128
v_mfma_f32_16x16x32_bf16 a[88:91], a[220:223], v[212:215], a[88:91]
v_exp_f32 v129, v129
v_exp_f32 v130, v130
v_mfma_f32_16x16x32_bf16 a[92:95], a[220:223], v[216:219], a[92:95]
v_exp_f32 v131, v131
s_waitcnt vmcnt(9) lgkmcnt(0)
s_barrier
v_mfma_f32_16x16x32_bf16 v[100:103], v[220:223], v[148:151], v[100:103]
s_add_u32 s44, s11, 40960
v_exp_f32 v140, v140
v_mfma_f32_16x16x32_bf16 v[4:7], a[224:227], v[148:151], v[4:7]
s_and_b32 s44, s44, 0x1ffff
v_exp_f32 v141, v141
v_mfma_f32_16x16x32_bf16 v[16:19], a[228:231], v[148:151], v[16:19]
s_add_u32 s44, s44, s49
v_exp_f32 v142, v142
v_mfma_f32_16x16x32_bf16 v[28:31], a[232:235], v[148:151], v[28:31]
s_add_u32 m0, s47, 49152
v_exp_f32 v143, v143
v_mfma_f32_16x16x32_bf16 v[40:43], a[236:239], v[148:151], v[40:43]
v_cvt_pk_bf16_f32 v152, v128, v129
v_cvt_pk_bf16_f32 v153, v130, v131
v_mfma_f32_16x16x32_bf16 v[52:55], a[240:243], v[148:151], v[52:55]
v_cvt_pk_bf16_f32 v154, v140, v141
v_cvt_pk_bf16_f32 v155, v142, v143
v_mfma_f32_16x16x32_bf16 v[64:67], a[244:247], v[148:151], v[64:67]
v_exp_f32 v132, v132
v_mfma_f32_16x16x32_bf16 v[76:79], a[248:251], v[148:151], v[76:79]
buffer_load_dwordx4 v236, s[12:15], s44 offen nt lds
v_mfma_f32_16x16x32_bf16 v[88:91], a[252:255], v[148:151], v[88:91]
v_exp_f32 v133, v133
v_mfma_f32_16x16x32_bf16 v[104:107], v[220:223], v[152:155], v[104:107]
v_exp_f32 v134, v134
v_mfma_f32_16x16x32_bf16 v[8:11], a[224:227], v[152:155], v[8:11]
v_exp_f32 v135, v135
v_mfma_f32_16x16x32_bf16 v[20:23], a[228:231], v[152:155], v[20:23]
v_exp_f32 v144, v144
v_mfma_f32_16x16x32_bf16 v[32:35], a[232:235], v[152:155], v[32:35]
buffer_load_dwordx4 v237, s[12:15], s44 offen offset:1024 nt lds
v_mfma_f32_16x16x32_bf16 v[44:47], a[236:239], v[152:155], v[44:47]
v_exp_f32 v145, v145
v_mfma_f32_16x16x32_bf16 v[56:59], a[240:243], v[152:155], v[56:59]
v_exp_f32 v146, v146
v_mfma_f32_16x16x32_bf16 v[68:71], a[244:247], v[152:155], v[68:71]
ds_read_b128 a[192:195], v232 offset:0
v_exp_f32 v147, v147
v_mfma_f32_16x16x32_bf16 v[80:83], a[248:251], v[152:155], v[80:83]
ds_read_b128 a[196:199], v233 offset:0
v_cvt_pk_bf16_f32 v156, v132, v133
v_cvt_pk_bf16_f32 v157, v134, v135
v_mfma_f32_16x16x32_bf16 v[92:95], a[252:255], v[152:155], v[92:95]
ds_read_b128 a[200:203], v234 offset:0
v_cvt_pk_bf16_f32 v158, v144, v145
v_cvt_pk_bf16_f32 v159, v146, v147
s_nop 1
v_mfma_f32_16x16x32_bf16 v[108:111], v[220:223], v[156:159], v[108:111]
ds_read_b128 a[204:207], v235 offset:0
ds_read_b128 a[208:211], v232 offset:4096
v_mfma_f32_16x16x32_bf16 v[12:15], a[224:227], v[156:159], v[12:15]
ds_read_b128 a[212:215], v233 offset:4096
v_mfma_f32_16x16x32_bf16 v[24:27], a[228:231], v[156:159], v[24:27]
buffer_load_dwordx4 v238, s[12:15], s44 offen offset:2048 nt lds
v_mfma_f32_16x16x32_bf16 v[36:39], a[232:235], v[156:159], v[36:39]
ds_read_b128 a[216:219], v234 offset:4096
ds_read_b128 a[220:223], v235 offset:4096
v_mfma_f32_16x16x32_bf16 v[48:51], a[236:239], v[156:159], v[48:51]
v_mfma_f32_16x16x32_bf16 v[60:63], a[240:243], v[156:159], v[60:63]
v_mfma_f32_16x16x32_bf16 v[72:75], a[244:247], v[156:159], v[72:75]
buffer_load_dwordx4 v239, s[12:15], s44 offen offset:3072 nt lds
v_mfma_f32_16x16x32_bf16 v[84:87], a[248:251], v[156:159], v[84:87]
v_mfma_f32_16x16x32_bf16 v[96:99], a[252:255], v[156:159], v[96:99]
s_waitcnt vmcnt(8) lgkmcnt(0)
s_barrier
v_mfma_f32_16x16x32_bf16 v[124:127], a[192:195], v[160:163], v[112:115]
ds_read_b64_tr_b16 a[224:225], v224 offset:16384
s_add_u32 s53, s71, 1
s_and_b32 s53, s53, 3
v_mfma_f32_16x16x32_bf16 v[124:127], a[196:199], v[172:175], v[124:127]
ds_read_b64_tr_b16 a[226:227], v224 offset:20480
s_mul_i32 s53, s53, 24576
s_add_u32 s59, s53, s60
v_mfma_f32_16x16x32_bf16 v[124:127], a[200:203], v[184:187], v[124:127]
ds_read_b64_tr_b16 a[228:229], v225 offset:16384
s_add_u32 s45, s58, s97
s_add_u32 m0, s47, 0
v_mfma_f32_16x16x32_bf16 v[124:127], a[204:207], v[196:199], v[124:127]
ds_read_b64_tr_b16 a[230:231], v225 offset:20480
v_mfma_f32_16x16x32_bf16 v[136:139], a[208:211], v[160:163], v[112:115]
ds_read_b64_tr_b16 a[232:233], v226 offset:16384
ds_read_b64_tr_b16 a[234:235], v226 offset:20480
v_mfma_f32_16x16x32_bf16 v[136:139], a[212:215], v[172:175], v[136:139]
buffer_load_dwordx4 v240, s[32:35], s45 offen lds
v_mfma_f32_16x16x32_bf16 v[136:139], a[216:219], v[184:187], v[136:139]
ds_read_b64_tr_b16 a[236:237], v227 offset:16384
v_xor_b32 v3, s92, v2
v_mfma_f32_16x16x32_bf16 v[136:139], a[220:223], v[196:199], v[136:139]
ds_read_b64_tr_b16 a[238:239], v227 offset:20480
v_add_u32 v3, s59, v3
v_mfma_f32_16x16x32_bf16 v[128:131], a[192:195], v[164:167], v[116:119]
ds_read_b64_tr_b16 a[240:241], v228 offset:16384
v_mfma_f32_16x16x32_bf16 v[128:131], a[196:199], v[176:179], v[128:131]
ds_read_b64_tr_b16 a[242:243], v228 offset:20480
v_mfma_f32_16x16x32_bf16 v[128:131], a[200:203], v[188:191], v[128:131]
ds_read_b64_tr_b16 a[244:245], v229 offset:16384
ds_read_b64_tr_b16 a[246:247], v229 offset:20480
v_mfma_f32_16x16x32_bf16 v[128:131], a[204:207], v[200:203], v[128:131]
buffer_load_dwordx4 v241, s[32:35], s45 offen offset:1024 lds
v_mfma_f32_16x16x32_bf16 v[140:143], a[208:211], v[164:167], v[116:119]
ds_read_b64_tr_b16 a[248:249], v230 offset:16384
v_max3_f32 v244, v124, v125, v126
v_mfma_f32_16x16x32_bf16 v[140:143], a[212:215], v[176:179], v[140:143]
ds_read_b64_tr_b16 a[250:251], v230 offset:20480
v_max3_f32 v244, v244, v127, v136
v_mfma_f32_16x16x32_bf16 v[140:143], a[216:219], v[188:191], v[140:143]
ds_read_b64_tr_b16 a[252:253], v231 offset:16384
v_max3_f32 v244, v244, v137, v138
v_mfma_f32_16x16x32_bf16 v[140:143], a[220:223], v[200:203], v[140:143]
ds_read_b64_tr_b16 a[254:255], v231 offset:20480
ds_read_b128 v[208:211], v3 offset:0
v_max_f32 v244, v244, v139
v_mfma_f32_16x16x32_bf16 v[132:135], a[192:195], v[168:171], v[120:123]
buffer_load_dwordx4 v242, s[32:35], s45 offen offset:2048 lds
v_mfma_f32_16x16x32_bf16 v[132:135], a[196:199], v[180:183], v[132:135]
ds_read_b128 v[212:215], v3 offset:4096
v_mfma_f32_16x16x32_bf16 v[132:135], a[200:203], v[192:195], v[132:135]
ds_read_b128 v[216:219], v3 offset:8192
v_mfma_f32_16x16x32_bf16 v[132:135], a[204:207], v[204:207], v[132:135]
v_max3_f32 v245, v128, v129, v130
v_max3_f32 v245, v245, v131, v140
v_mfma_f32_16x16x32_bf16 v[144:147], a[208:211], v[168:171], v[120:123]
v_max3_f32 v245, v245, v141, v142
v_max_f32 v245, v245, v143
v_mfma_f32_16x16x32_bf16 v[144:147], a[212:215], v[180:183], v[144:147]
buffer_load_dwordx4 v243, s[32:35], s45 offen offset:3072 lds
v_mfma_f32_16x16x32_bf16 v[144:147], a[216:219], v[192:195], v[144:147]
v_mfma_f32_16x16x32_bf16 v[144:147], a[220:223], v[204:207], v[144:147]
s_waitcnt vmcnt(8) lgkmcnt(0)
s_barrier
v_mfma_f32_16x16x32_bf16 a[0:3], a[224:227], v[208:211], a[0:3]
ds_read_b64_tr_b16 a[192:193], v224 offset:32768
s_add_u32 s44, s11, 40960
s_and_b32 s44, s44, 0x1ffff
v_mfma_f32_16x16x32_bf16 a[4:7], a[224:227], v[212:215], a[4:7]
ds_read_b64_tr_b16 a[194:195], v224 offset:36864
ds_read_b64_tr_b16 a[196:197], v225 offset:32768
s_add_u32 s44, s44, s49
v_mfma_f32_16x16x32_bf16 a[8:11], a[224:227], v[216:219], a[8:11]
s_add_u32 m0, s47, 16384
s_nop 0
buffer_load_dwordx4 v236, s[16:19], s44 offen nt lds
v_mfma_f32_16x16x32_bf16 a[12:15], a[228:231], v[208:211], a[12:15]
ds_read_b64_tr_b16 a[198:199], v225 offset:36864
v_max3_f32 v246, v132, v133, v134
v_mfma_f32_16x16x32_bf16 a[16:19], a[228:231], v[212:215], a[16:19]
ds_read_b64_tr_b16 a[200:201], v226 offset:32768
v_max3_f32 v246, v246, v135, v144
v_mfma_f32_16x16x32_bf16 a[20:23], a[228:231], v[216:219], a[20:23]
v_max3_f32 v246, v246, v145, v146
v_max_f32 v246, v246, v147
v_mfma_f32_16x16x32_bf16 a[24:27], a[232:235], v[208:211], a[24:27]
v_max3_f32 v247, v244, v245, v246
v_cmp_lt_f32 vcc, s50, v247
s_cbranch_vccnz L_rs8
L_rb8:
v_mfma_f32_16x16x32_bf16 a[28:31], a[232:235], v[212:215], a[28:31]
v_exp_f32 v124, v124
v_mfma_f32_16x16x32_bf16 a[32:35], a[232:235], v[216:219], a[32:35]
buffer_load_dwordx4 v237, s[16:19], s44 offen offset:1024 nt lds
v_mfma_f32_16x16x32_bf16 a[36:39], a[236:239], v[208:211], a[36:39]
ds_read_b64_tr_b16 a[202:203], v226 offset:36864
v_exp_f32 v125, v125
v_mfma_f32_16x16x32_bf16 a[40:43], a[236:239], v[212:215], a[40:43]
ds_read_b64_tr_b16 a[204:205], v227 offset:32768
v_exp_f32 v126, v126
v_mfma_f32_16x16x32_bf16 a[44:47], a[236:239], v[216:219], a[44:47]
ds_read_b64_tr_b16 a[206:207], v227 offset:36864
v_exp_f32 v127, v127
v_mfma_f32_16x16x32_bf16 a[48:51], a[240:243], v[208:211], a[48:51]
ds_read_b64_tr_b16 a[208:209], v228 offset:32768
v_exp_f32 v136, v136
v_mfma_f32_16x16x32_bf16 a[52:55], a[240:243], v[212:215], a[52:55]
ds_read_b64_tr_b16 a[210:211], v228 offset:36864
v_exp_f32 v137, v137
v_mfma_f32_16x16x32_bf16 a[56:59], a[240:243], v[216:219], a[56:59]
buffer_load_dwordx4 v238, s[16:19], s44 offen offset:2048 nt lds
v_mfma_f32_16x16x32_bf16 a[60:63], a[244:247], v[208:211], a[60:63]
ds_read_b64_tr_b16 a[212:213], v229 offset:32768
v_exp_f32 v138, v138
v_mfma_f32_16x16x32_bf16 a[64:67], a[244:247], v[212:215], a[64:67]
ds_read_b64_tr_b16 a[214:215], v229 offset:36864
v_exp_f32 v139, v139
v_mfma_f32_16x16x32_bf16 a[68:71], a[244:247], v[216:219], a[68:71]
ds_read_b64_tr_b16 a[216:217], v230 offset:32768
v_cvt_pk_bf16_f32 v148, v124, v125
v_mfma_f32_16x16x32_bf16 a[72:75], a[248:251], v[208:211], a[72:75]
ds_read_b64_tr_b16 a[218:219], v230 offset:36864
v_cvt_pk_bf16_f32 v149, v126, v127
v_mfma_f32_16x16x32_bf16 a[76:79], a[248:251], v[212:215], a[76:79]
ds_read_b64_tr_b16 a[220:221], v231 offset:32768
ds_read_b64_tr_b16 a[222:223], v231 offset:36864
v_cvt_pk_bf16_f32 v150, v136, v137
v_mfma_f32_16x16x32_bf16 a[80:83], a[248:251], v[216:219], a[80:83]
buffer_load_dwordx4 v239, s[16:19], s44 offen offset:3072 nt lds
v_mfma_f32_16x16x32_bf16 a[84:87], a[252:255], v[208:211], a[84:87]
v_cvt_pk_bf16_f32 v151, v138, v139
v_exp_f32 v128, v128
v_mfma_f32_16x16x32_bf16 a[88:91], a[252:255], v[212:215], a[88:91]
v_exp_f32 v129, v129
v_exp_f32 v130, v130
v_mfma_f32_16x16x32_bf16 a[92:95], a[252:255], v[216:219], a[92:95]
v_exp_f32 v131, v131
s_waitcnt vmcnt(8) lgkmcnt(0)
s_barrier
v_mfma_f32_16x16x32_bf16 v[100:103], v[220:223], v[148:151], v[100:103]
s_add_u32 s44, s11, 49152
v_exp_f32 v140, v140
v_mfma_f32_16x16x32_bf16 v[4:7], a[192:195], v[148:151], v[4:7]
s_and_b32 s44, s44, 0x1ffff
v_exp_f32 v141, v141
v_mfma_f32_16x16x32_bf16 v[16:19], a[196:199], v[148:151], v[16:19]
s_add_u32 s44, s44, s49
v_exp_f32 v142, v142
v_mfma_f32_16x16x32_bf16 v[28:31], a[200:203], v[148:151], v[28:31]
s_add_u32 m0, s47, 32768
v_exp_f32 v143, v143
v_mfma_f32_16x16x32_bf16 v[40:43], a[204:207], v[148:151], v[40:43]
v_cvt_pk_bf16_f32 v152, v128, v129
v_cvt_pk_bf16_f32 v153, v130, v131
v_mfma_f32_16x16x32_bf16 v[52:55], a[208:211], v[148:151], v[52:55]
v_cvt_pk_bf16_f32 v154, v140, v141
v_cvt_pk_bf16_f32 v155, v142, v143
v_mfma_f32_16x16x32_bf16 v[64:67], a[212:215], v[148:151], v[64:67]
v_exp_f32 v132, v132
v_mfma_f32_16x16x32_bf16 v[76:79], a[216:219], v[148:151], v[76:79]
buffer_load_dwordx4 v236, s[12:15], s44 offen nt lds
v_mfma_f32_16x16x32_bf16 v[88:91], a[220:223], v[148:151], v[88:91]
v_exp_f32 v133, v133
v_mfma_f32_16x16x32_bf16 v[104:107], v[220:223], v[152:155], v[104:107]
v_exp_f32 v134, v134
v_mfma_f32_16x16x32_bf16 v[8:11], a[192:195], v[152:155], v[8:11]
v_exp_f32 v135, v135
v_mfma_f32_16x16x32_bf16 v[20:23], a[196:199], v[152:155], v[20:23]
v_exp_f32 v144, v144
v_mfma_f32_16x16x32_bf16 v[32:35], a[200:203], v[152:155], v[32:35]
buffer_load_dwordx4 v237, s[12:15], s44 offen offset:1024 nt lds
v_mfma_f32_16x16x32_bf16 v[44:47], a[204:207], v[152:155], v[44:47]
v_exp_f32 v145, v145
v_mfma_f32_16x16x32_bf16 v[56:59], a[208:211], v[152:155], v[56:59]
v_exp_f32 v146, v146
v_mfma_f32_16x16x32_bf16 v[68:71], a[212:215], v[152:155], v[68:71]
ds_read_b128 a[224:227], v232 offset:49152
v_exp_f32 v147, v147
v_mfma_f32_16x16x32_bf16 v[80:83], a[216:219], v[152:155], v[80:83]
ds_read_b128 a[228:231], v233 offset:49152
v_cvt_pk_bf16_f32 v156, v132, v133
v_cvt_pk_bf16_f32 v157, v134, v135
v_mfma_f32_16x16x32_bf16 v[92:95], a[220:223], v[152:155], v[92:95]
ds_read_b128 a[232:235], v234 offset:49152
v_cvt_pk_bf16_f32 v158, v144, v145
v_cvt_pk_bf16_f32 v159, v146, v147
s_nop 1
v_mfma_f32_16x16x32_bf16 v[108:111], v[220:223], v[156:159], v[108:111]
ds_read_b128 a[236:239], v235 offset:49152
ds_read_b128 a[240:243], v232 offset:53248
v_mfma_f32_16x16x32_bf16 v[12:15], a[192:195], v[156:159], v[12:15]
ds_read_b128 a[244:247], v233 offset:53248
v_mfma_f32_16x16x32_bf16 v[24:27], a[196:199], v[156:159], v[24:27]
buffer_load_dwordx4 v238, s[12:15], s44 offen offset:2048 nt lds
v_mfma_f32_16x16x32_bf16 v[36:39], a[200:203], v[156:159], v[36:39]
ds_read_b128 a[248:251], v234 offset:53248
ds_read_b128 a[252:255], v235 offset:53248
v_mfma_f32_16x16x32_bf16 v[48:51], a[204:207], v[156:159], v[48:51]
v_mfma_f32_16x16x32_bf16 v[60:63], a[208:211], v[156:159], v[60:63]
v_mfma_f32_16x16x32_bf16 v[72:75], a[212:215], v[156:159], v[72:75]
buffer_load_dwordx4 v239, s[12:15], s44 offen offset:3072 nt lds
v_mfma_f32_16x16x32_bf16 v[84:87], a[216:219], v[156:159], v[84:87]
v_mfma_f32_16x16x32_bf16 v[96:99], a[220:223], v[156:159], v[96:99]
s_waitcnt vmcnt(8) lgkmcnt(0)
s_barrier
v_mfma_f32_16x16x32_bf16 v[124:127], a[224:227], v[160:163], v[112:115]
ds_read_b64_tr_b16 a[192:193], v224 offset:0
s_add_u32 s45, s58, s98
s_add_u32 m0, s47, 49152
v_mfma_f32_16x16x32_bf16 v[124:127], a[228:231], v[172:175], v[124:127]
ds_read_b64_tr_b16 a[194:195], v224 offset:4096
v_mfma_f32_16x16x32_bf16 v[124:127], a[232:235], v[184:187], v[124:127]
ds_read_b64_tr_b16 a[196:197], v225 offset:0
v_mfma_f32_16x16x32_bf16 v[124:127], a[236:239], v[196:199], v[124:127]
ds_read_b64_tr_b16 a[198:199], v225 offset:4096
v_mfma_f32_16x16x32_bf16 v[136:139], a[240:243], v[160:163], v[112:115]
ds_read_b64_tr_b16 a[200:201], v226 offset:0
ds_read_b64_tr_b16 a[202:203], v226 offset:4096
v_mfma_f32_16x16x32_bf16 v[136:139], a[244:247], v[172:175], v[136:139]
buffer_load_dwordx4 v240, s[32:35], s45 offen lds
v_mfma_f32_16x16x32_bf16 v[136:139], a[248:251], v[184:187], v[136:139]
ds_read_b64_tr_b16 a[204:205], v227 offset:0
v_xor_b32 v3, s93, v2
v_mfma_f32_16x16x32_bf16 v[136:139], a[252:255], v[196:199], v[136:139]
ds_read_b64_tr_b16 a[206:207], v227 offset:4096
v_add_u32 v3, s59, v3
v_mfma_f32_16x16x32_bf16 v[128:131], a[224:227], v[164:167], v[116:119]
ds_read_b64_tr_b16 a[208:209], v228 offset:0
v_mfma_f32_16x16x32_bf16 v[128:131], a[228:231], v[176:179], v[128:131]
ds_read_b64_tr_b16 a[210:211], v228 offset:4096
v_mfma_f32_16x16x32_bf16 v[128:131], a[232:235], v[188:191], v[128:131]
ds_read_b64_tr_b16 a[212:213], v229 offset:0
ds_read_b64_tr_b16 a[214:215], v229 offset:4096
v_mfma_f32_16x16x32_bf16 v[128:131], a[236:239], v[200:203], v[128:131]
buffer_load_dwordx4 v241, s[32:35], s45 offen offset:1024 lds
v_mfma_f32_16x16x32_bf16 v[140:143], a[240:243], v[164:167], v[116:119]
ds_read_b64_tr_b16 a[216:217], v230 offset:0
v_max3_f32 v244, v124, v125, v126
v_mfma_f32_16x16x32_bf16 v[140:143], a[244:247], v[176:179], v[140:143]
ds_read_b64_tr_b16 a[218:219], v230 offset:4096
v_max3_f32 v244, v244, v127, v136
v_mfma_f32_16x16x32_bf16 v[140:143], a[248:251], v[188:191], v[140:143]
ds_read_b64_tr_b16 a[220:221], v231 offset:0
v_max3_f32 v244, v244, v137, v138
v_mfma_f32_16x16x32_bf16 v[140:143], a[252:255], v[200:203], v[140:143]
ds_read_b64_tr_b16 a[222:223], v231 offset:4096
ds_read_b128 v[208:211], v3 offset:0
v_max_f32 v244, v244, v139
v_mfma_f32_16x16x32_bf16 v[132:135], a[224:227], v[168:171], v[120:123]
buffer_load_dwordx4 v242, s[32:35], s45 offen offset:2048 lds
v_mfma_f32_16x16x32_bf16 v[132:135], a[228:231], v[180:183], v[132:135]
ds_read_b128 v[212:215], v3 offset:4096
v_mfma_f32_16x16x32_bf16 v[132:135], a[232:235], v[192:195], v[132:135]
ds_read_b128 v[216:219], v3 offset:8192
v_mfma_f32_16x16x32_bf16 v[132:135], a[236:239], v[204:207], v[132:135]
v_max3_f32 v245, v128, v129, v130
v_max3_f32 v245, v245, v131, v140
v_mfma_f32_16x16x32_bf16 v[144:147], a[240:243], v[168:171], v[120:123]
v_max3_f32 v245, v245, v141, v142
v_max_f32 v245, v245, v143
v_mfma_f32_16x16x32_bf16 v[144:147], a[244:247], v[180:183], v[144:147]
buffer_load_dwordx4 v243, s[32:35], s45 offen offset:3072 lds
v_mfma_f32_16x16x32_bf16 v[144:147], a[248:251], v[192:195], v[144:147]
v_mfma_f32_16x16x32_bf16 v[144:147], a[252:255], v[204:207], v[144:147]
s_waitcnt vmcnt(8) lgkmcnt(0)
s_barrier
v_mfma_f32_16x16x32_bf16 a[0:3], a[192:195], v[208:211], a[0:3]
ds_read_b64_tr_b16 a[224:225], v224 offset:16384
s_add_u32 s44, s11, 49152
s_and_b32 s44, s44, 0x1ffff
v_mfma_f32_16x16x32_bf16 a[4:7], a[192:195], v[212:215], a[4:7]
ds_read_b64_tr_b16 a[226:227], v224 offset:20480
ds_read_b64_tr_b16 a[228:229], v225 offset:16384
s_add_u32 s44, s44, s49
v_mfma_f32_16x16x32_bf16 a[8:11], a[192:195], v[216:219], a[8:11]
s_add_u32 m0, s47, 0
s_nop 0
buffer_load_dwordx4 v236, s[16:19], s44 offen nt lds
v_mfma_f32_16x16x32_bf16 a[12:15], a[196:199], v[208:211], a[12:15]
ds_read_b64_tr_b16 a[230:231], v225 offset:20480
v_max3_f32 v246, v132, v133, v134
v_mfma_f32_16x16x32_bf16 a[16:19], a[196:199], v[212:215], a[16:19]
ds_read_b64_tr_b16 a[232:233], v226 offset:16384
v_max3_f32 v246, v246, v135, v144
v_mfma_f32_16x16x32_bf16 a[20:23], a[196:199], v[216:219], a[20:23]
v_max3_f32 v246, v246, v145, v146
v_max_f32 v246, v246, v147
v_mfma_f32_16x16x32_bf16 a[24:27], a[200:203], v[208:211], a[24:27]
v_max3_f32 v247, v244, v245, v246
v_cmp_lt_f32 vcc, s50, v247
s_cbranch_vccnz L_rs9
L_rb9:
v_mfma_f32_16x16x32_bf16 a[28:31], a[200:203], v[212:215], a[28:31]
v_exp_f32 v124, v124
v_mfma_f32_16x16x32_bf16 a[32:35], a[200:203], v[216:219], a[32:35]
buffer_load_dwordx4 v237, s[16:19], s44 offen offset:1024 nt lds
v_mfma_f32_16x16x32_bf16 a[36:39], a[204:207], v[208:211], a[36:39]
ds_read_b64_tr_b16 a[234:235], v226 offset:20480
v_exp_f32 v125, v125
v_mfma_f32_16x16x32_bf16 a[40:43], a[204:207], v[212:215], a[40:43]
ds_read_b64_tr_b16 a[236:237], v227 offset:16384
v_exp_f32 v126, v126
v_mfma_f32_16x16x32_bf16 a[44:47], a[204:207], v[216:219], a[44:47]
ds_read_b64_tr_b16 a[238:239], v227 offset:20480
v_exp_f32 v127, v127
v_mfma_f32_16x16x32_bf16 a[48:51], a[208:211], v[208:211], a[48:51]
ds_read_b64_tr_b16 a[240:241], v228 offset:16384
v_exp_f32 v136, v136
v_mfma_f32_16x16x32_bf16 a[52:55], a[208:211], v[212:215], a[52:55]
ds_read_b64_tr_b16 a[242:243], v228 offset:20480
v_exp_f32 v137, v137
v_mfma_f32_16x16x32_bf16 a[56:59], a[208:211], v[216:219], a[56:59]
buffer_load_dwordx4 v238, s[16:19], s44 offen offset:2048 nt lds
v_mfma_f32_16x16x32_bf16 a[60:63], a[212:215], v[208:211], a[60:63]
ds_read_b64_tr_b16 a[244:245], v229 offset:16384
v_exp_f32 v138, v138
v_mfma_f32_16x16x32_bf16 a[64:67], a[212:215], v[212:215], a[64:67]
ds_read_b64_tr_b16 a[246:247], v229 offset:20480
v_exp_f32 v139, v139
v_mfma_f32_16x16x32_bf16 a[68:71], a[212:215], v[216:219], a[68:71]
ds_read_b64_tr_b16 a[248:249], v230 offset:16384
v_cvt_pk_bf16_f32 v148, v124, v125
v_mfma_f32_16x16x32_bf16 a[72:75], a[216:219], v[208:211], a[72:75]
ds_read_b64_tr_b16 a[250:251], v230 offset:20480
v_cvt_pk_bf16_f32 v149, v126, v127
v_mfma_f32_16x16x32_bf16 a[76:79], a[216:219], v[212:215], a[76:79]
ds_read_b64_tr_b16 a[252:253], v231 offset:16384
ds_read_b64_tr_b16 a[254:255], v231 offset:20480
v_cvt_pk_bf16_f32 v150, v136, v137
v_mfma_f32_16x16x32_bf16 a[80:83], a[216:219], v[216:219], a[80:83]
buffer_load_dwordx4 v239, s[16:19], s44 offen offset:3072 nt lds
v_mfma_f32_16x16x32_bf16 a[84:87], a[220:223], v[208:211], a[84:87]
v_cvt_pk_bf16_f32 v151, v138, v139
v_exp_f32 v128, v128
v_mfma_f32_16x16x32_bf16 a[88:91], a[220:223], v[212:215], a[88:91]
v_exp_f32 v129, v129
v_exp_f32 v130, v130
v_mfma_f32_16x16x32_bf16 a[92:95], a[220:223], v[216:219], a[92:95]
v_exp_f32 v131, v131
s_waitcnt vmcnt(8) lgkmcnt(0)
s_barrier
v_mfma_f32_16x16x32_bf16 v[100:103], v[220:223], v[148:151], v[100:103]
s_add_u32 s44, s11, 57344
v_exp_f32 v140, v140
v_mfma_f32_16x16x32_bf16 v[4:7], a[224:227], v[148:151], v[4:7]
s_and_b32 s44, s44, 0x1ffff
v_exp_f32 v141, v141
v_mfma_f32_16x16x32_bf16 v[16:19], a[228:231], v[148:151], v[16:19]
s_add_u32 s44, s44, s49
v_exp_f32 v142, v142
v_mfma_f32_16x16x32_bf16 v[28:31], a[232:235], v[148:151], v[28:31]
s_add_u32 m0, s47, 16384
v_exp_f32 v143, v143
v_mfma_f32_16x16x32_bf16 v[40:43], a[236:239], v[148:151], v[40:43]
v_cvt_pk_bf16_f32 v152, v128, v129
v_cvt_pk_bf16_f32 v153, v130, v131
v_mfma_f32_16x16x32_bf16 v[52:55], a[240:243], v[148:151], v[52:55]
v_cvt_pk_bf16_f32 v154, v140, v141
v_cvt_pk_bf16_f32 v155, v142, v143
v_mfma_f32_16x16x32_bf16 v[64:67], a[244:247], v[148:151], v[64:67]
v_exp_f32 v132, v132
v_mfma_f32_16x16x32_bf16 v[76:79], a[248:251], v[148:151], v[76:79]
buffer_load_dwordx4 v236, s[12:15], s44 offen nt lds
v_mfma_f32_16x16x32_bf16 v[88:91], a[252:255], v[148:151], v[88:91]
v_exp_f32 v133, v133
v_mfma_f32_16x16x32_bf16 v[104:107], v[220:223], v[152:155], v[104:107]
v_exp_f32 v134, v134
v_mfma_f32_16x16x32_bf16 v[8:11], a[224:227], v[152:155], v[8:11]
v_exp_f32 v135, v135
v_mfma_f32_16x16x32_bf16 v[20:23], a[228:231], v[152:155], v[20:23]
v_exp_f32 v144, v144
v_mfma_f32_16x16x32_bf16 v[32:35], a[232:235], v[152:155], v[32:35]
buffer_load_dwordx4 v237, s[12:15], s44 offen offset:1024 nt lds
v_mfma_f32_16x16x32_bf16 v[44:47], a[236:239], v[152:155], v[44:47]
v_exp_f32 v145, v145
v_mfma_f32_16x16x32_bf16 v[56:59], a[240:243], v[152:155], v[56:59]
v_exp_f32 v146, v146
v_mfma_f32_16x16x32_bf16 v[68:71], a[244:247], v[152:155], v[68:71]
ds_read_b128 a[192:195], v232 offset:32768
v_exp_f32 v147, v147
v_mfma_f32_16x16x32_bf16 v[80:83], a[248:251], v[152:155], v[80:83]
ds_read_b128 a[196:199], v233 offset:32768
v_cvt_pk_bf16_f32 v156, v132, v133
v_cvt_pk_bf16_f32 v157, v134, v135
v_mfma_f32_16x16x32_bf16 v[92:95], a[252:255], v[152:155], v[92:95]
ds_read_b128 a[200:203], v234 offset:32768
v_cvt_pk_bf16_f32 v158, v144, v145
v_cvt_pk_bf16_f32 v159, v146, v147
s_nop 1
v_mfma_f32_16x16x32_bf16 v[108:111], v[220:223], v[156:159], v[108:111]
ds_read_b128 a[204:207], v235 offset:32768
ds_read_b128 a[208:211], v232 offset:36864
v_mfma_f32_16x16x32_bf16 v[12:15], a[224:227], v[156:159], v[12:15]
ds_read_b128 a[212:215], v233 offset:36864
v_mfma_f32_16x16x32_bf16 v[24:27], a[228:231], v[156:159], v[24:27]
buffer_load_dwordx4 v238, s[12:15], s44 offen offset:2048 nt lds
v_mfma_f32_16x16x32_bf16 v[36:39], a[232:235], v[156:159], v[36:39]
ds_read_b128 a[216:219], v234 offset:36864
ds_read_b128 a[220:223], v235 offset:36864
v_mfma_f32_16x16x32_bf16 v[48:51], a[236:239], v[156:159], v[48:51]
v_mfma_f32_16x16x32_bf16 v[60:63], a[240:243], v[156:159], v[60:63]
v_mfma_f32_16x16x32_bf16 v[72:75], a[244:247], v[156:159], v[72:75]
buffer_load_dwordx4 v239, s[12:15], s44 offen offset:3072 nt lds
v_mfma_f32_16x16x32_bf16 v[84:87], a[248:251], v[156:159], v[84:87]
v_mfma_f32_16x16x32_bf16 v[96:99], a[252:255], v[156:159], v[96:99]
s_waitcnt vmcnt(8) lgkmcnt(0)
s_barrier
v_mfma_f32_16x16x32_bf16 v[124:127], a[192:195], v[160:163], v[112:115]
ds_read_b64_tr_b16 a[224:225], v224 offset:49152
s_add_u32 s45, s58, s99
s_add_u32 m0, s47, 32768
v_mfma_f32_16x16x32_bf16 v[124:127], a[196:199], v[172:175], v[124:127]
ds_read_b64_tr_b16 a[226:227], v224 offset:53248
v_mfma_f32_16x16x32_bf16 v[124:127], a[200:203], v[184:187], v[124:127]
ds_read_b64_tr_b16 a[228:229], v225 offset:49152
v_mfma_f32_16x16x32_bf16 v[124:127], a[204:207], v[196:199], v[124:127]
ds_read_b64_tr_b16 a[230:231], v225 offset:53248
v_mfma_f32_16x16x32_bf16 v[136:139], a[208:211], v[160:163], v[112:115]
ds_read_b64_tr_b16 a[232:233], v226 offset:49152
ds_read_b64_tr_b16 a[234:235], v226 offset:53248
v_mfma_f32_16x16x32_bf16 v[136:139], a[212:215], v[172:175], v[136:139]
buffer_load_dwordx4 v240, s[32:35], s45 offen lds
v_mfma_f32_16x16x32_bf16 v[136:139], a[216:219], v[184:187], v[136:139]
ds_read_b64_tr_b16 a[236:237], v227 offset:49152
v_xor_b32 v3, s94, v2
v_mfma_f32_16x16x32_bf16 v[136:139], a[220:223], v[196:199], v[136:139]
ds_read_b64_tr_b16 a[238:239], v227 offset:53248
v_add_u32 v3, s59, v3
v_mfma_f32_16x16x32_bf16 v[128:131], a[192:195], v[164:167], v[116:119]
ds_read_b64_tr_b16 a[240:241], v228 offset:49152
v_mfma_f32_16x16x32_bf16 v[128:131], a[196:199], v[176:179], v[128:131]
ds_read_b64_tr_b16 a[242:243], v228 offset:53248
v_mfma_f32_16x16x32_bf16 v[128:131], a[200:203], v[188:191], v[128:131]
ds_read_b64_tr_b16 a[244:245], v229 offset:49152
ds_read_b64_tr_b16 a[246:247], v229 offset:53248
v_mfma_f32_16x16x32_bf16 v[128:131], a[204:207], v[200:203], v[128:131]
buffer_load_dwordx4 v241, s[32:35], s45 offen offset:1024 lds
v_mfma_f32_16x16x32_bf16 v[140:143], a[208:211], v[164:167], v[116:119]
ds_read_b64_tr_b16 a[248:249], v230 offset:49152
v_max3_f32 v244, v124, v125, v126
v_mfma_f32_16x16x32_bf16 v[140:143], a[212:215], v[176:179], v[140:143]
ds_read_b64_tr_b16 a[250:251], v230 offset:53248
v_max3_f32 v244, v244, v127, v136
v_mfma_f32_16x16x32_bf16 v[140:143], a[216:219], v[188:191], v[140:143]
ds_read_b64_tr_b16 a[252:253], v231 offset:49152
v_max3_f32 v244, v244, v137, v138
v_mfma_f32_16x16x32_bf16 v[140:143], a[220:223], v[200:203], v[140:143]
ds_read_b64_tr_b16 a[254:255], v231 offset:53248
ds_read_b128 v[208:211], v3 offset:0
v_max_f32 v244, v244, v139
v_mfma_f32_16x16x32_bf16 v[132:135], a[192:195], v[168:171], v[120:123]
buffer_load_dwordx4 v242, s[32:35], s45 offen offset:2048 lds
v_mfma_f32_16x16x32_bf16 v[132:135], a[196:199], v[180:183], v[132:135]
ds_read_b128 v[212:215], v3 offset:4096
v_mfma_f32_16x16x32_bf16 v[132:135], a[200:203], v[192:195], v[132:135]
ds_read_b128 v[216:219], v3 offset:8192
v_mfma_f32_16x16x32_bf16 v[132:135], a[204:207], v[204:207], v[132:135]
v_max3_f32 v245, v128, v129, v130
v_max3_f32 v245, v245, v131, v140
v_mfma_f32_16x16x32_bf16 v[144:147], a[208:211], v[168:171], v[120:123]
v_max3_f32 v245, v245, v141, v142
v_max_f32 v245, v245, v143
v_mfma_f32_16x16x32_bf16 v[144:147], a[212:215], v[180:183], v[144:147]
buffer_load_dwordx4 v243, s[32:35], s45 offen offset:3072 lds
v_mfma_f32_16x16x32_bf16 v[144:147], a[216:219], v[192:195], v[144:147]
v_mfma_f32_16x16x32_bf16 v[144:147], a[220:223], v[204:207], v[144:147]
s_waitcnt vmcnt(8) lgkmcnt(0)
s_barrier
v_mfma_f32_16x16x32_bf16 a[0:3], a[224:227], v[208:211], a[0:3]
ds_read_b64_tr_b16 a[192:193], v224 offset:0
s_add_u32 s44, s11, 57344
s_and_b32 s44, s44, 0x1ffff
v_mfma_f32_16x16x32_bf16 a[4:7], a[224:227], v[212:215], a[4:7]
ds_read_b64_tr_b16 a[194:195], v224 offset:4096
ds_read_b64_tr_b16 a[196:197], v225 offset:0
s_add_u32 s44, s44, s49
v_mfma_f32_16x16x32_bf16 a[8:11], a[224:227], v[216:219], a[8:11]
s_add_u32 m0, s47, 49152
s_nop 0
buffer_load_dwordx4 v236, s[16:19], s44 offen nt lds
v_mfma_f32_16x16x32_bf16 a[12:15], a[228:231], v[208:211], a[12:15]
ds_read_b64_tr_b16 a[198:199], v225 offset:4096
v_max3_f32 v246, v132, v133, v134
v_mfma_f32_16x16x32_bf16 a[16:19], a[228:231], v[212:215], a[16:19]
ds_read_b64_tr_b16 a[200:201], v226 offset:0
v_max3_f32 v246, v246, v135, v144
v_mfma_f32_16x16x32_bf16 a[20:23], a[228:231], v[216:219], a[20:23]
v_max3_f32 v246, v246, v145, v146
v_max_f32 v246, v246, v147
v_mfma_f32_16x16x32_bf16 a[24:27], a[232:235], v[208:211], a[24:27]
v_max3_f32 v247, v244, v245, v246
v_cmp_lt_f32 vcc, s50, v247
s_cbranch_vccnz L_rs10
L_rb10:
v_mfma_f32_16x16x32_bf16 a[28:31], a[232:235], v[212:215], a[28:31]
v_exp_f32 v124, v124
v_mfma_f32_16x16x32_bf16 a[32:35], a[232:235], v[216:219], a[32:35]
buffer_load_dwordx4 v237, s[16:19], s44 offen offset:1024 nt lds
v_mfma_f32_16x16x32_bf16 a[36:39], a[236:239], v[208:211], a[36:39]
ds_read_b64_tr_b16 a[202:203], v226 offset:4096
v_exp_f32 v125, v125
v_mfma_f32_16x16x32_bf16 a[40:43], a[236:239], v[212:215], a[40:43]
ds_read_b64_tr_b16 a[204:205], v227 offset:0
v_exp_f32 v126, v126
v_mfma_f32_16x16x32_bf16 a[44:47], a[236:239], v[216:219], a[44:47]
ds_read_b64_tr_b16 a[206:207], v227 offset:4096
v_exp_f32 v127, v127
v_mfma_f32_16x16x32_bf16 a[48:51], a[240:243], v[208:211], a[48:51]
ds_read_b64_tr_b16 a[208:209], v228 offset:0
v_exp_f32 v136, v136
v_mfma_f32_16x16x32_bf16 a[52:55], a[240:243], v[212:215], a[52:55]
ds_read_b64_tr_b16 a[210:211], v228 offset:4096
v_exp_f32 v137, v137
v_mfma_f32_16x16x32_bf16 a[56:59], a[240:243], v[216:219], a[56:59]
buffer_load_dwordx4 v238, s[16:19], s44 offen offset:2048 nt lds
v_mfma_f32_16x16x32_bf16 a[60:63], a[244:247], v[208:211], a[60:63]
ds_read_b64_tr_b16 a[212:213], v229 offset:0
v_exp_f32 v138, v138
v_mfma_f32_16x16x32_bf16 a[64:67], a[244:247], v[212:215], a[64:67]
ds_read_b64_tr_b16 a[214:215], v229 offset:4096
v_exp_f32 v139, v139
v_mfma_f32_16x16x32_bf16 a[68:71], a[244:247], v[216:219], a[68:71]
ds_read_b64_tr_b16 a[216:217], v230 offset:0
v_cvt_pk_bf16_f32 v148, v124, v125
v_mfma_f32_16x16x32_bf16 a[72:75], a[248:251], v[208:211], a[72:75]
ds_read_b64_tr_b16 a[218:219], v230 offset:4096
v_cvt_pk_bf16_f32 v149, v126, v127
v_mfma_f32_16x16x32_bf16 a[76:79], a[248:251], v[212:215], a[76:79]
ds_read_b64_tr_b16 a[220:221], v231 offset:0
ds_read_b64_tr_b16 a[222:223], v231 offset:4096
v_cvt_pk_bf16_f32 v150, v136, v137
v_mfma_f32_16x16x32_bf16 a[80:83], a[248:251], v[216:219], a[80:83]
buffer_load_dwordx4 v239, s[16:19], s44 offen offset:3072 nt lds
v_mfma_f32_16x16x32_bf16 a[84:87], a[252:255], v[208:211], a[84:87]
v_cvt_pk_bf16_f32 v151, v138, v139
v_exp_f32 v128, v128
v_mfma_f32_16x16x32_bf16 a[88:91], a[252:255], v[212:215], a[88:91]
v_exp_f32 v129, v129
v_exp_f32 v130, v130
v_mfma_f32_16x16x32_bf16 a[92:95], a[252:255], v[216:219], a[92:95]
v_exp_f32 v131, v131
s_waitcnt vmcnt(8) lgkmcnt(0)
s_barrier
v_mfma_f32_16x16x32_bf16 v[100:103], v[220:223], v[148:151], v[100:103]
s_add_u32 s44, s11, 65536
v_exp_f32 v140, v140
v_mfma_f32_16x16x32_bf16 v[4:7], a[192:195], v[148:151], v[4:7]
s_and_b32 s44, s44, 0x1ffff
v_exp_f32 v141, v141
v_mfma_f32_16x16x32_bf16 v[16:19], a[196:199], v[148:151], v[16:19]
s_add_u32 s44, s44, s49
v_exp_f32 v142, v142
v_mfma_f32_16x16x32_bf16 v[28:31], a[200:203], v[148:151], v[28:31]
s_add_u32 m0, s47, 0
v_exp_f32 v143, v143
v_mfma_f32_16x16x32_bf16 v[40:43], a[204:207], v[148:151], v[40:43]
v_cvt_pk_bf16_f32 v152, v128, v129
v_cvt_pk_bf16_f32 v153, v130, v131
v_mfma_f32_16x16x32_bf16 v[52:55], a[208:211], v[148:151], v[52:55]
v_cvt_pk_bf16_f32 v154, v140, v141
v_cvt_pk_bf16_f32 v155, v142, v143
v_mfma_f32_16x16x32_bf16 v[64:67], a[212:215], v[148:151], v[64:67]
v_exp_f32 v132, v132
v_mfma_f32_16x16x32_bf16 v[76:79], a[216:219], v[148:151], v[76:79]
buffer_load_dwordx4 v236, s[12:15], s44 offen nt lds
v_mfma_f32_16x16x32_bf16 v[88:91], a[220:223], v[148:151], v[88:91]
v_exp_f32 v133, v133
v_mfma_f32_16x16x32_bf16 v[104:107], v[220:223], v[152:155], v[104:107]
v_exp_f32 v134, v134
v_mfma_f32_16x16x32_bf16 v[8:11], a[192:195], v[152:155], v[8:11]
v_exp_f32 v135, v135
v_mfma_f32_16x16x32_bf16 v[20:23], a[196:199], v[152:155], v[20:23]
v_exp_f32 v144, v144
v_mfma_f32_16x16x32_bf16 v[32:35], a[200:203], v[152:155], v[32:35]
buffer_load_dwordx4 v237, s[12:15], s44 offen offset:1024 nt lds
v_mfma_f32_16x16x32_bf16 v[44:47], a[204:207], v[152:155], v[44:47]
v_exp_f32 v145, v145
v_mfma_f32_16x16x32_bf16 v[56:59], a[208:211], v[152:155], v[56:59]
v_exp_f32 v146, v146
v_mfma_f32_16x16x32_bf16 v[68:71], a[212:215], v[152:155], v[68:71]
ds_read_b128 a[224:227], v232 offset:16384
v_exp_f32 v147, v147
v_mfma_f32_16x16x32_bf16 v[80:83], a[216:219], v[152:155], v[80:83]
ds_read_b128 a[228:231], v233 offset:16384
v_cvt_pk_bf16_f32 v156, v132, v133
v_cvt_pk_bf16_f32 v157, v134, v135
v_mfma_f32_16x16x32_bf16 v[92:95], a[220:223], v[152:155], v[92:95]
ds_read_b128 a[232:235], v234 offset:16384
v_cvt_pk_bf16_f32 v158, v144, v145
v_cvt_pk_bf16_f32 v159, v146, v147
s_nop 1
v_mfma_f32_16x16x32_bf16 v[108:111], v[220:223], v[156:159], v[108:111]
ds_read_b128 a[236:239], v235 offset:16384
ds_read_b128 a[240:243], v232 offset:20480
v_mfma_f32_16x16x32_bf16 v[12:15], a[192:195], v[156:159], v[12:15]
ds_read_b128 a[244:247], v233 offset:20480
v_mfma_f32_16x16x32_bf16 v[24:27], a[196:199], v[156:159], v[24:27]
buffer_load_dwordx4 v238, s[12:15], s44 offen offset:2048 nt lds
v_mfma_f32_16x16x32_bf16 v[36:39], a[200:203], v[156:159], v[36:39]
ds_read_b128 a[248:251], v234 offset:20480
ds_read_b128 a[252:255], v235 offset:20480
v_mfma_f32_16x16x32_bf16 v[48:51], a[204:207], v[156:159], v[48:51]
v_mfma_f32_16x16x32_bf16 v[60:63], a[208:211], v[156:159], v[60:63]
v_mfma_f32_16x16x32_bf16 v[72:75], a[212:215], v[156:159], v[72:75]
buffer_load_dwordx4 v239, s[12:15], s44 offen offset:3072 nt lds
v_mfma_f32_16x16x32_bf16 v[84:87], a[216:219], v[156:159], v[84:87]
v_mfma_f32_16x16x32_bf16 v[96:99], a[220:223], v[156:159], v[96:99]
s_waitcnt vmcnt(8) lgkmcnt(0)
s_barrier
v_mfma_f32_16x16x32_bf16 v[124:127], a[224:227], v[160:163], v[112:115]
ds_read_b64_tr_b16 a[192:193], v224 offset:32768
s_add_u32 s52, s71, 2
s_and_b32 s52, s52, 3
v_mfma_f32_16x16x32_bf16 v[124:127], a[228:231], v[172:175], v[124:127]
ds_read_b64_tr_b16 a[194:195], v224 offset:36864
s_lshl_b32 s52, s52, 20
s_add_u32 s58, s52, s56
v_mfma_f32_16x16x32_bf16 v[124:127], a[232:235], v[184:187], v[124:127]
ds_read_b64_tr_b16 a[196:197], v225 offset:32768
s_add_u32 s45, s58, s96
s_add_u32 m0, s47, 16384
v_mfma_f32_16x16x32_bf16 v[124:127], a[236:239], v[196:199], v[124:127]
ds_read_b64_tr_b16 a[198:199], v225 offset:36864
v_mfma_f32_16x16x32_bf16 v[136:139], a[240:243], v[160:163], v[112:115]
ds_read_b64_tr_b16 a[200:201], v226 offset:32768
ds_read_b64_tr_b16 a[202:203], v226 offset:36864
v_mfma_f32_16x16x32_bf16 v[136:139], a[244:247], v[172:175], v[136:139]
buffer_load_dwordx4 v240, s[32:35], s45 offen lds
v_mfma_f32_16x16x32_bf16 v[136:139], a[248:251], v[184:187], v[136:139]
ds_read_b64_tr_b16 a[204:205], v227 offset:32768
v_xor_b32 v3, s95, v2
v_mfma_f32_16x16x32_bf16 v[136:139], a[252:255], v[196:199], v[136:139]
ds_read_b64_tr_b16 a[206:207], v227 offset:36864
v_add_u32 v3, s59, v3
v_mfma_f32_16x16x32_bf16 v[128:131], a[224:227], v[164:167], v[116:119]
ds_read_b64_tr_b16 a[208:209], v228 offset:32768
v_mfma_f32_16x16x32_bf16 v[128:131], a[228:231], v[176:179], v[128:131]
ds_read_b64_tr_b16 a[210:211], v228 offset:36864
v_mfma_f32_16x16x32_bf16 v[128:131], a[232:235], v[188:191], v[128:131]
ds_read_b64_tr_b16 a[212:213], v229 offset:32768
ds_read_b64_tr_b16 a[214:215], v229 offset:36864
v_mfma_f32_16x16x32_bf16 v[128:131], a[236:239], v[200:203], v[128:131]
buffer_load_dwordx4 v241, s[32:35], s45 offen offset:1024 lds
v_mfma_f32_16x16x32_bf16 v[140:143], a[240:243], v[164:167], v[116:119]
ds_read_b64_tr_b16 a[216:217], v230 offset:32768
v_max3_f32 v244, v124, v125, v126
v_mfma_f32_16x16x32_bf16 v[140:143], a[244:247], v[176:179], v[140:143]
ds_read_b64_tr_b16 a[218:219], v230 offset:36864
v_max3_f32 v244, v244, v127, v136
v_mfma_f32_16x16x32_bf16 v[140:143], a[248:251], v[188:191], v[140:143]
ds_read_b64_tr_b16 a[220:221], v231 offset:32768
v_max3_f32 v244, v244, v137, v138
v_mfma_f32_16x16x32_bf16 v[140:143], a[252:255], v[200:203], v[140:143]
ds_read_b64_tr_b16 a[222:223], v231 offset:36864
ds_read_b128 v[208:211], v3 offset:0
v_max_f32 v244, v244, v139
v_mfma_f32_16x16x32_bf16 v[132:135], a[224:227], v[168:171], v[120:123]
buffer_load_dwordx4 v242, s[32:35], s45 offen offset:2048 lds
v_mfma_f32_16x16x32_bf16 v[132:135], a[228:231], v[180:183], v[132:135]
ds_read_b128 v[212:215], v3 offset:4096
v_mfma_f32_16x16x32_bf16 v[132:135], a[232:235], v[192:195], v[132:135]
ds_read_b128 v[216:219], v3 offset:8192
v_mfma_f32_16x16x32_bf16 v[132:135], a[236:239], v[204:207], v[132:135]
v_max3_f32 v245, v128, v129, v130
v_max3_f32 v245, v245, v131, v140
v_mfma_f32_16x16x32_bf16 v[144:147], a[240:243], v[168:171], v[120:123]
v_max3_f32 v245, v245, v141, v142
v_max_f32 v245, v245, v143
v_mfma_f32_16x16x32_bf16 v[144:147], a[244:247], v[180:183], v[144:147]
buffer_load_dwordx4 v243, s[32:35], s45 offen offset:3072 lds
v_mfma_f32_16x16x32_bf16 v[144:147], a[248:251], v[192:195], v[144:147]
v_mfma_f32_16x16x32_bf16 v[144:147], a[252:255], v[204:207], v[144:147]
s_waitcnt vmcnt(8) lgkmcnt(0)
s_barrier
v_mfma_f32_16x16x32_bf16 a[0:3], a[192:195], v[208:211], a[0:3]
ds_read_b64_tr_b16 a[224:225], v224 offset:49152
s_add_u32 s44, s11, 65536
s_and_b32 s44, s44, 0x1ffff
v_mfma_f32_16x16x32_bf16 a[4:7], a[192:195], v[212:215], a[4:7]
ds_read_b64_tr_b16 a[226:227], v224 offset:53248
ds_read_b64_tr_b16 a[228:229], v225 offset:49152
s_add_u32 s44, s44, s49
v_mfma_f32_16x16x32_bf16 a[8:11], a[192:195], v[216:219], a[8:11]
s_add_u32 m0, s47, 32768
s_nop 0
buffer_load_dwordx4 v236, s[16:19], s44 offen nt lds
v_mfma_f32_16x16x32_bf16 a[12:15], a[196:199], v[208:211], a[12:15]
ds_read_b64_tr_b16 a[230:231], v225 offset:53248
v_max3_f32 v246, v132, v133, v134
v_mfma_f32_16x16x32_bf16 a[16:19], a[196:199], v[212:215], a[16:19]
ds_read_b64_tr_b16 a[232:233], v226 offset:49152
v_max3_f32 v246, v246, v135, v144
v_mfma_f32_16x16x32_bf16 a[20:23], a[196:199], v[216:219], a[20:23]
v_max3_f32 v246, v246, v145, v146
v_max_f32 v246, v246, v147
v_mfma_f32_16x16x32_bf16 a[24:27], a[200:203], v[208:211], a[24:27]
v_max3_f32 v247, v244, v245, v246
v_cmp_lt_f32 vcc, s50, v247
s_cbranch_vccnz L_rs11
L_rb11:
v_mfma_f32_16x16x32_bf16 a[28:31], a[200:203], v[212:215], a[28:31]
v_exp_f32 v124, v124
v_mfma_f32_16x16x32_bf16 a[32:35], a[200:203], v[216:219], a[32:35]
buffer_load_dwordx4 v237, s[16:19], s44 offen offset:1024 nt lds
v_mfma_f32_16x16x32_bf16 a[36:39], a[204:207], v[208:211], a[36:39]
ds_read_b64_tr_b16 a[234:235], v226 offset:53248
v_exp_f32 v125, v125
v_mfma_f32_16x16x32_bf16 a[40:43], a[204:207], v[212:215], a[40:43]
ds_read_b64_tr_b16 a[236:237], v227 offset:49152
v_exp_f32 v126, v126
v_mfma_f32_16x16x32_bf16 a[44:47], a[204:207], v[216:219], a[44:47]
ds_read_b64_tr_b16 a[238:239], v227 offset:53248
v_exp_f32 v127, v127
v_mfma_f32_16x16x32_bf16 a[48:51], a[208:211], v[208:211], a[48:51]
ds_read_b64_tr_b16 a[240:241], v228 offset:49152
v_exp_f32 v136, v136
v_mfma_f32_16x16x32_bf16 a[52:55], a[208:211], v[212:215], a[52:55]
ds_read_b64_tr_b16 a[242:243], v228 offset:53248
v_exp_f32 v137, v137
v_mfma_f32_16x16x32_bf16 a[56:59], a[208:211], v[216:219], a[56:59]
buffer_load_dwordx4 v238, s[16:19], s44 offen offset:2048 nt lds
v_mfma_f32_16x16x32_bf16 a[60:63], a[212:215], v[208:211], a[60:63]
ds_read_b64_tr_b16 a[244:245], v229 offset:49152
v_exp_f32 v138, v138
v_mfma_f32_16x16x32_bf16 a[64:67], a[212:215], v[212:215], a[64:67]
ds_read_b64_tr_b16 a[246:247], v229 offset:53248
v_exp_f32 v139, v139
v_mfma_f32_16x16x32_bf16 a[68:71], a[212:215], v[216:219], a[68:71]
ds_read_b64_tr_b16 a[248:249], v230 offset:49152
v_cvt_pk_bf16_f32 v148, v124, v125
v_mfma_f32_16x16x32_bf16 a[72:75], a[216:219], v[208:211], a[72:75]
ds_read_b64_tr_b16 a[250:251], v230 offset:53248
v_cvt_pk_bf16_f32 v149, v126, v127
v_mfma_f32_16x16x32_bf16 a[76:79], a[216:219], v[212:215], a[76:79]
ds_read_b64_tr_b16 a[252:253], v231 offset:49152
ds_read_b64_tr_b16 a[254:255], v231 offset:53248
v_cvt_pk_bf16_f32 v150, v136, v137
v_mfma_f32_16x16x32_bf16 a[80:83], a[216:219], v[216:219], a[80:83]
buffer_load_dwordx4 v239, s[16:19], s44 offen offset:3072 nt lds
v_mfma_f32_16x16x32_bf16 a[84:87], a[220:223], v[208:211], a[84:87]
v_cvt_pk_bf16_f32 v151, v138, v139
v_exp_f32 v128, v128
v_mfma_f32_16x16x32_bf16 a[88:91], a[220:223], v[212:215], a[88:91]
v_exp_f32 v129, v129
v_exp_f32 v130, v130
v_mfma_f32_16x16x32_bf16 a[92:95], a[220:223], v[216:219], a[92:95]
v_exp_f32 v131, v131
s_waitcnt vmcnt(8) lgkmcnt(0)
s_barrier
v_mfma_f32_16x16x32_bf16 v[100:103], v[220:223], v[148:151], v[100:103]
s_add_u32 s44, s11, 73728
v_exp_f32 v140, v140
v_mfma_f32_16x16x32_bf16 v[4:7], a[224:227], v[148:151], v[4:7]
s_and_b32 s44, s44, 0x1ffff
v_exp_f32 v141, v141
v_mfma_f32_16x16x32_bf16 v[16:19], a[228:231], v[148:151], v[16:19]
s_add_u32 s44, s44, s49
v_exp_f32 v142, v142
v_mfma_f32_16x16x32_bf16 v[28:31], a[232:235], v[148:151], v[28:31]
s_add_u32 m0, s47, 49152
v_exp_f32 v143, v143
v_mfma_f32_16x16x32_bf16 v[40:43], a[236:239], v[148:151], v[40:43]
v_cvt_pk_bf16_f32 v152, v128, v129
v_cvt_pk_bf16_f32 v153, v130, v131
v_mfma_f32_16x16x32_bf16 v[52:55], a[240:243], v[148:151], v[52:55]
v_cvt_pk_bf16_f32 v154, v140, v141
v_cvt_pk_bf16_f32 v155, v142, v143
v_mfma_f32_16x16x32_bf16 v[64:67], a[244:247], v[148:151], v[64:67]
v_exp_f32 v132, v132
v_mfma_f32_16x16x32_bf16 v[76:79], a[248:251], v[148:151], v[76:79]
buffer_load_dwordx4 v236, s[12:15], s44 offen nt lds
v_mfma_f32_16x16x32_bf16 v[88:91], a[252:255], v[148:151], v[88:91]
v_exp_f32 v133, v133
v_mfma_f32_16x16x32_bf16 v[104:107], v[220:223], v[152:155], v[104:107]
v_exp_f32 v134, v134
v_mfma_f32_16x16x32_bf16 v[8:11], a[224:227], v[152:155], v[8:11]
v_exp_f32 v135, v135
v_mfma_f32_16x16x32_bf16 v[20:23], a[228:231], v[152:155], v[20:23]
v_exp_f32 v144, v144
v_mfma_f32_16x16x32_bf16 v[32:35], a[232:235], v[152:155], v[32:35]
buffer_load_dwordx4 v237, s[12:15], s44 offen offset:1024 nt lds
v_mfma_f32_16x16x32_bf16 v[44:47], a[236:239], v[152:155], v[44:47]
v_exp_f32 v145, v145
v_mfma_f32_16x16x32_bf16 v[56:59], a[240:243], v[152:155], v[56:59]
v_exp_f32 v146, v146
v_mfma_f32_16x16x32_bf16 v[68:71], a[244:247], v[152:155], v[68:71]
ds_read_b128 a[192:195], v232 offset:0
v_exp_f32 v147, v147
v_mfma_f32_16x16x32_bf16 v[80:83], a[248:251], v[152:155], v[80:83]
ds_read_b128 a[196:199], v233 offset:0
v_cvt_pk_bf16_f32 v156, v132, v133
v_cvt_pk_bf16_f32 v157, v134, v135
v_mfma_f32_16x16x32_bf16 v[92:95], a[252:255], v[152:155], v[92:95]
ds_read_b128 a[200:203], v234 offset:0
v_cvt_pk_bf16_f32 v158, v144, v145
v_cvt_pk_bf16_f32 v159, v146, v147
s_nop 1
v_mfma_f32_16x16x32_bf16 v[108:111], v[220:223], v[156:159], v[108:111]
ds_read_b128 a[204:207], v235 offset:0
ds_read_b128 a[208:211], v232 offset:4096
v_mfma_f32_16x16x32_bf16 v[12:15], a[224:227], v[156:159], v[12:15]
ds_read_b128 a[212:215], v233 offset:4096
v_mfma_f32_16x16x32_bf16 v[24:27], a[228:231], v[156:159], v[24:27]
buffer_load_dwordx4 v238, s[12:15], s44 offen offset:2048 nt lds
v_mfma_f32_16x16x32_bf16 v[36:39], a[232:235], v[156:159], v[36:39]
ds_read_b128 a[216:219], v234 offset:4096
ds_read_b128 a[220:223], v235 offset:4096
v_mfma_f32_16x16x32_bf16 v[48:51], a[236:239], v[156:159], v[48:51]
v_mfma_f32_16x16x32_bf16 v[60:63], a[240:243], v[156:159], v[60:63]
v_mfma_f32_16x16x32_bf16 v[72:75], a[244:247], v[156:159], v[72:75]
buffer_load_dwordx4 v239, s[12:15], s44 offen offset:3072 nt lds
v_mfma_f32_16x16x32_bf16 v[84:87], a[248:251], v[156:159], v[84:87]
v_mfma_f32_16x16x32_bf16 v[96:99], a[252:255], v[156:159], v[96:99]
s_waitcnt vmcnt(8) lgkmcnt(0)
s_barrier
v_mfma_f32_16x16x32_bf16 v[124:127], a[192:195], v[160:163], v[112:115]
ds_read_b64_tr_b16 a[224:225], v224 offset:16384
s_add_u32 s53, s71, 2
s_and_b32 s53, s53, 3
v_mfma_f32_16x16x32_bf16 v[124:127], a[196:199], v[172:175], v[124:127]
ds_read_b64_tr_b16 a[226:227], v224 offset:20480
s_mul_i32 s53, s53, 24576
s_add_u32 s59, s53, s60
v_mfma_f32_16x16x32_bf16 v[124:127], a[200:203], v[184:187], v[124:127]
ds_read_b64_tr_b16 a[228:229], v225 offset:16384
s_add_u32 s45, s58, s97
s_add_u32 m0, s47, 0
v_mfma_f32_16x16x32_bf16 v[124:127], a[204:207], v[196:199], v[124:127]
ds_read_b64_tr_b16 a[230:231], v225 offset:20480
v_mfma_f32_16x16x32_bf16 v[136:139], a[208:211], v[160:163], v[112:115]
ds_read_b64_tr_b16 a[232:233], v226 offset:16384
ds_read_b64_tr_b16 a[234:235], v226 offset:20480
v_mfma_f32_16x16x32_bf16 v[136:139], a[212:215], v[172:175], v[136:139]
buffer_load_dwordx4 v240, s[32:35], s45 offen lds
v_mfma_f32_16x16x32_bf16 v[136:139], a[216:219], v[184:187], v[136:139]
ds_read_b64_tr_b16 a[236:237], v227 offset:16384
v_xor_b32 v3, s92, v2
v_mfma_f32_16x16x32_bf16 v[136:139], a[220:223], v[196:199], v[136:139]
ds_read_b64_tr_b16 a[238:239], v227 offset:20480
v_add_u32 v3, s59, v3
v_mfma_f32_16x16x32_bf16 v[128:131], a[192:195], v[164:167], v[116:119]
ds_read_b64_tr_b16 a[240:241], v228 offset:16384
v_mfma_f32_16x16x32_bf16 v[128:131], a[196:199], v[176:179], v[128:131]
ds_read_b64_tr_b16 a[242:243], v228 offset:20480
v_mfma_f32_16x16x32_bf16 v[128:131], a[200:203], v[188:191], v[128:131]
ds_read_b64_tr_b16 a[244:245], v229 offset:16384
ds_read_b64_tr_b16 a[246:247], v229 offset:20480
v_mfma_f32_16x16x32_bf16 v[128:131], a[204:207], v[200:203], v[128:131]
buffer_load_dwordx4 v241, s[32:35], s45 offen offset:1024 lds
v_mfma_f32_16x16x32_bf16 v[140:143], a[208:211], v[164:167], v[116:119]
ds_read_b64_tr_b16 a[248:249], v230 offset:16384
v_max3_f32 v244, v124, v125, v126
v_mfma_f32_16x16x32_bf16 v[140:143], a[212:215], v[176:179], v[140:143]
ds_read_b64_tr_b16 a[250:251], v230 offset:20480
v_max3_f32 v244, v244, v127, v136
v_mfma_f32_16x16x32_bf16 v[140:143], a[216:219], v[188:191], v[140:143]
ds_read_b64_tr_b16 a[252:253], v231 offset:16384
v_max3_f32 v244, v244, v137, v138
v_mfma_f32_16x16x32_bf16 v[140:143], a[220:223], v[200:203], v[140:143]
ds_read_b64_tr_b16 a[254:255], v231 offset:20480
ds_read_b128 v[208:211], v3 offset:0
v_max_f32 v244, v244, v139
v_mfma_f32_16x16x32_bf16 v[132:135], a[192:195], v[168:171], v[120:123]
buffer_load_dwordx4 v242, s[32:35], s45 offen offset:2048 lds
v_mfma_f32_16x16x32_bf16 v[132:135], a[196:199], v[180:183], v[132:135]
ds_read_b128 v[212:215], v3 offset:4096
v_mfma_f32_16x16x32_bf16 v[132:135], a[200:203], v[192:195], v[132:135]
ds_read_b128 v[216:219], v3 offset:8192
v_mfma_f32_16x16x32_bf16 v[132:135], a[204:207], v[204:207], v[132:135]
v_max3_f32 v245, v128, v129, v130
v_max3_f32 v245, v245, v131, v140
v_mfma_f32_16x16x32_bf16 v[144:147], a[208:211], v[168:171], v[120:123]
v_max3_f32 v245, v245, v141, v142
v_max_f32 v245, v245, v143
v_mfma_f32_16x16x32_bf16 v[144:147], a[212:215], v[180:183], v[144:147]
buffer_load_dwordx4 v243, s[32:35], s45 offen offset:3072 lds
v_mfma_f32_16x16x32_bf16 v[144:147], a[216:219], v[192:195], v[144:147]
v_mfma_f32_16x16x32_bf16 v[144:147], a[220:223], v[204:207], v[144:147]
s_waitcnt vmcnt(8) lgkmcnt(0)
s_barrier
v_mfma_f32_16x16x32_bf16 a[0:3], a[224:227], v[208:211], a[0:3]
ds_read_b64_tr_b16 a[192:193], v224 offset:32768
s_add_u32 s44, s11, 73728
s_and_b32 s44, s44, 0x1ffff
v_mfma_f32_16x16x32_bf16 a[4:7], a[224:227], v[212:215], a[4:7]
ds_read_b64_tr_b16 a[194:195], v224 offset:36864
ds_read_b64_tr_b16 a[196:197], v225 offset:32768
s_add_u32 s44, s44, s49
v_mfma_f32_16x16x32_bf16 a[8:11], a[224:227], v[216:219], a[8:11]
s_add_u32 m0, s47, 16384
s_nop 0
buffer_load_dwordx4 v236, s[16:19], s44 offen nt lds
v_mfma_f32_16x16x32_bf16 a[12:15], a[228:231], v[208:211], a[12:15]
ds_read_b64_tr_b16 a[198:199], v225 offset:36864
v_max3_f32 v246, v132, v133, v134
v_mfma_f32_16x16x32_bf16 a[16:19], a[228:231], v[212:215], a[16:19]
ds_read_b64_tr_b16 a[200:201], v226 offset:32768
v_max3_f32 v246, v246, v135, v144
v_mfma_f32_16x16x32_bf16 a[20:23], a[228:231], v[216:219], a[20:23]
v_max3_f32 v246, v246, v145, v146
v_max_f32 v246, v246, v147
v_mfma_f32_16x16x32_bf16 a[24:27], a[232:235], v[208:211], a[24:27]
v_max3_f32 v247, v244, v245, v246
v_cmp_lt_f32 vcc, s50, v247
s_cbranch_vccnz L_rs12
L_rb12:
v_mfma_f32_16x16x32_bf16 a[28:31], a[232:235], v[212:215], a[28:31]
v_exp_f32 v124, v124
v_mfma_f32_16x16x32_bf16 a[32:35], a[232:235], v[216:219], a[32:35]
buffer_load_dwordx4 v237, s[16:19], s44 offen offset:1024 nt lds
v_mfma_f32_16x16x32_bf16 a[36:39], a[236:239], v[208:211], a[36:39]
ds_read_b64_tr_b16 a[202:203], v226 offset:36864
v_exp_f32 v125, v125
v_mfma_f32_16x16x32_bf16 a[40:43], a[236:239], v[212:215], a[40:43]
ds_read_b64_tr_b16 a[204:205], v227 offset:32768
v_exp_f32 v126, v126
v_mfma_f32_16x16x32_bf16 a[44:47], a[236:239], v[216:219], a[44:47]
ds_read_b64_tr_b16 a[206:207], v227 offset:36864
v_exp_f32 v127, v127
v_mfma_f32_16x16x32_bf16 a[48:51], a[240:243], v[208:211], a[48:51]
ds_read_b64_tr_b16 a[208:209], v228 offset:32768
v_exp_f32 v136, v136
v_mfma_f32_16x16x32_bf16 a[52:55], a[240:243], v[212:215], a[52:55]
ds_read_b64_tr_b16 a[210:211], v228 offset:36864
v_exp_f32 v137, v137
v_mfma_f32_16x16x32_bf16 a[56:59], a[240:243], v[216:219], a[56:59]
buffer_load_dwordx4 v238, s[16:19], s44 offen offset:2048 nt lds
v_mfma_f32_16x16x32_bf16 a[60:63], a[244:247], v[208:211], a[60:63]
ds_read_b64_tr_b16 a[212:213], v229 offset:32768
v_exp_f32 v138, v138
v_mfma_f32_16x16x32_bf16 a[64:67], a[244:247], v[212:215], a[64:67]
ds_read_b64_tr_b16 a[214:215], v229 offset:36864
v_exp_f32 v139, v139
v_mfma_f32_16x16x32_bf16 a[68:71], a[244:247], v[216:219], a[68:71]
ds_read_b64_tr_b16 a[216:217], v230 offset:32768
v_cvt_pk_bf16_f32 v148, v124, v125
v_mfma_f32_16x16x32_bf16 a[72:75], a[248:251], v[208:211], a[72:75]
ds_read_b64_tr_b16 a[218:219], v230 offset:36864
v_cvt_pk_bf16_f32 v149, v126, v127
v_mfma_f32_16x16x32_bf16 a[76:79], a[248:251], v[212:215], a[76:79]
ds_read_b64_tr_b16 a[220:221], v231 offset:32768
ds_read_b64_tr_b16 a[222:223], v231 offset:36864
v_cvt_pk_bf16_f32 v150, v136, v137
v_mfma_f32_16x16x32_bf16 a[80:83], a[248:251], v[216:219], a[80:83]
buffer_load_dwordx4 v239, s[16:19], s44 offen offset:3072 nt lds
v_mfma_f32_16x16x32_bf16 a[84:87], a[252:255], v[208:211], a[84:87]
v_cvt_pk_bf16_f32 v151, v138, v139
v_exp_f32 v128, v128
v_mfma_f32_16x16x32_bf16 a[88:91], a[252:255], v[212:215], a[88:91]
v_exp_f32 v129, v129
v_exp_f32 v130, v130
v_mfma_f32_16x16x32_bf16 a[92:95], a[252:255], v[216:219], a[92:95]
v_exp_f32 v131, v131
s_waitcnt vmcnt(8) lgkmcnt(0)
s_barrier
v_mfma_f32_16x16x32_bf16 v[100:103], v[220:223], v[148:151], v[100:103]
s_add_u32 s44, s11, 81920
v_exp_f32 v140, v140
v_mfma_f32_16x16x32_bf16 v[4:7], a[192:195], v[148:151], v[4:7]
s_and_b32 s44, s44, 0x1ffff
v_exp_f32 v141, v141
v_mfma_f32_16x16x32_bf16 v[16:19], a[196:199], v[148:151], v[16:19]
s_add_u32 s44, s44, s49
v_exp_f32 v142, v142
v_mfma_f32_16x16x32_bf16 v[28:31], a[200:203], v[148:151], v[28:31]
s_add_u32 m0, s47, 32768
v_exp_f32 v143, v143
v_mfma_f32_16x16x32_bf16 v[40:43], a[204:207], v[148:151], v[40:43]
v_cvt_pk_bf16_f32 v152, v128, v129
v_cvt_pk_bf16_f32 v153, v130, v131
v_mfma_f32_16x16x32_bf16 v[52:55], a[208:211], v[148:151], v[52:55]
v_cvt_pk_bf16_f32 v154, v140, v141
v_cvt_pk_bf16_f32 v155, v142, v143
v_mfma_f32_16x16x32_bf16 v[64:67], a[212:215], v[148:151], v[64:67]
v_exp_f32 v132, v132
v_mfma_f32_16x16x32_bf16 v[76:79], a[216:219], v[148:151], v[76:79]
buffer_load_dwordx4 v236, s[12:15], s44 offen nt lds
v_mfma_f32_16x16x32_bf16 v[88:91], a[220:223], v[148:151], v[88:91]
v_exp_f32 v133, v133
v_mfma_f32_16x16x32_bf16 v[104:107], v[220:223], v[152:155], v[104:107]
v_exp_f32 v134, v134
v_mfma_f32_16x16x32_bf16 v[8:11], a[192:195], v[152:155], v[8:11]
v_exp_f32 v135, v135
v_mfma_f32_16x16x32_bf16 v[20:23], a[196:199], v[152:155], v[20:23]
v_exp_f32 v144, v144
v_mfma_f32_16x16x32_bf16 v[32:35], a[200:203], v[152:155], v[32:35]
buffer_load_dwordx4 v237, s[12:15], s44 offen offset:1024 nt lds
v_mfma_f32_16x16x32_bf16 v[44:47], a[204:207], v[152:155], v[44:47]
v_exp_f32 v145, v145
v_mfma_f32_16x16x32_bf16 v[56:59], a[208:211], v[152:155], v[56:59]
v_exp_f32 v146, v146
v_mfma_f32_16x16x32_bf16 v[68:71], a[212:215], v[152:155], v[68:71]
ds_read_b128 a[224:227], v232 offset:49152
v_exp_f32 v147, v147
v_mfma_f32_16x16x32_bf16 v[80:83], a[216:219], v[152:155], v[80:83]
ds_read_b128 a[228:231], v233 offset:49152
v_cvt_pk_bf16_f32 v156, v132, v133
v_cvt_pk_bf16_f32 v157, v134, v135
v_mfma_f32_16x16x32_bf16 v[92:95], a[220:223], v[152:155], v[92:95]
ds_read_b128 a[232:235], v234 offset:49152
v_cvt_pk_bf16_f32 v158, v144, v145
v_cvt_pk_bf16_f32 v159, v146, v147
s_nop 1
v_mfma_f32_16x16x32_bf16 v[108:111], v[220:223], v[156:159], v[108:111]
ds_read_b128 a[236:239], v235 offset:49152
ds_read_b128 a[240:243], v232 offset:53248
v_mfma_f32_16x16x32_bf16 v[12:15], a[192:195], v[156:159], v[12:15]
ds_read_b128 a[244:247], v233 offset:53248
v_mfma_f32_16x16x32_bf16 v[24:27], a[196:199], v[156:159], v[24:27]
buffer_load_dwordx4 v238, s[12:15], s44 offen offset:2048 nt lds
v_mfma_f32_16x16x32_bf16 v[36:39], a[200:203], v[156:159], v[36:39]
ds_read_b128 a[248:251], v234 offset:53248
ds_read_b128 a[252:255], v235 offset:53248
v_mfma_f32_16x16x32_bf16 v[48:51], a[204:207], v[156:159], v[48:51]
v_mfma_f32_16x16x32_bf16 v[60:63], a[208:211], v[156:159], v[60:63]
v_mfma_f32_16x16x32_bf16 v[72:75], a[212:215], v[156:159], v[72:75]
buffer_load_dwordx4 v239, s[12:15], s44 offen offset:3072 nt lds
v_mfma_f32_16x16x32_bf16 v[84:87], a[216:219], v[156:159], v[84:87]
v_mfma_f32_16x16x32_bf16 v[96:99], a[220:223], v[156:159], v[96:99]
s_waitcnt vmcnt(8) lgkmcnt(0)
s_barrier
v_mfma_f32_16x16x32_bf16 v[124:127], a[224:227], v[160:163], v[112:115]
ds_read_b64_tr_b16 a[192:193], v224 offset:0
s_add_u32 s45, s58, s98
s_add_u32 m0, s47, 49152
v_mfma_f32_16x16x32_bf16 v[124:127], a[228:231], v[172:175], v[124:127]
ds_read_b64_tr_b16 a[194:195], v224 offset:4096
v_mfma_f32_16x16x32_bf16 v[124:127], a[232:235], v[184:187], v[124:127]
ds_read_b64_tr_b16 a[196:197], v225 offset:0
v_mfma_f32_16x16x32_bf16 v[124:127], a[236:239], v[196:199], v[124:127]
ds_read_b64_tr_b16 a[198:199], v225 offset:4096
v_mfma_f32_16x16x32_bf16 v[136:139], a[240:243], v[160:163], v[112:115]
ds_read_b64_tr_b16 a[200:201], v226 offset:0
ds_read_b64_tr_b16 a[202:203], v226 offset:4096
v_mfma_f32_16x16x32_bf16 v[136:139], a[244:247], v[172:175], v[136:139]
buffer_load_dwordx4 v240, s[32:35], s45 offen lds
v_mfma_f32_16x16x32_bf16 v[136:139], a[248:251], v[184:187], v[136:139]
ds_read_b64_tr_b16 a[204:205], v227 offset:0
v_xor_b32 v3, s93, v2
v_mfma_f32_16x16x32_bf16 v[136:139], a[252:255], v[196:199], v[136:139]
ds_read_b64_tr_b16 a[206:207], v227 offset:4096
v_add_u32 v3, s59, v3
v_mfma_f32_16x16x32_bf16 v[128:131], a[224:227], v[164:167], v[116:119]
ds_read_b64_tr_b16 a[208:209], v228 offset:0
v_mfma_f32_16x16x32_bf16 v[128:131], a[228:231], v[176:179], v[128:131]
ds_read_b64_tr_b16 a[210:211], v228 offset:4096
v_mfma_f32_16x16x32_bf16 v[128:131], a[232:235], v[188:191], v[128:131]
ds_read_b64_tr_b16 a[212:213], v229 offset:0
ds_read_b64_tr_b16 a[214:215], v229 offset:4096
v_mfma_f32_16x16x32_bf16 v[128:131], a[236:239], v[200:203], v[128:131]
buffer_load_dwordx4 v241, s[32:35], s45 offen offset:1024 lds
v_mfma_f32_16x16x32_bf16 v[140:143], a[240:243], v[164:167], v[116:119]
ds_read_b64_tr_b16 a[216:217], v230 offset:0
v_max3_f32 v244, v124, v125, v126
v_mfma_f32_16x16x32_bf16 v[140:143], a[244:247], v[176:179], v[140:143]
ds_read_b64_tr_b16 a[218:219], v230 offset:4096
v_max3_f32 v244, v244, v127, v136
v_mfma_f32_16x16x32_bf16 v[140:143], a[248:251], v[188:191], v[140:143]
ds_read_b64_tr_b16 a[220:221], v231 offset:0
v_max3_f32 v244, v244, v137, v138
v_mfma_f32_16x16x32_bf16 v[140:143], a[252:255], v[200:203], v[140:143]
ds_read_b64_tr_b16 a[222:223], v231 offset:4096
ds_read_b128 v[208:211], v3 offset:0
v_max_f32 v244, v244, v139
v_mfma_f32_16x16x32_bf16 v[132:135], a[224:227], v[168:171], v[120:123]
buffer_load_dwordx4 v242, s[32:35], s45 offen offset:2048 lds
v_mfma_f32_16x16x32_bf16 v[132:135], a[228:231], v[180:183], v[132:135]
ds_read_b128 v[212:215], v3 offset:4096
v_mfma_f32_16x16x32_bf16 v[132:135], a[232:235], v[192:195], v[132:135]
ds_read_b128 v[216:219], v3 offset:8192
v_mfma_f32_16x16x32_bf16 v[132:135], a[236:239], v[204:207], v[132:135]
v_max3_f32 v245, v128, v129, v130
v_max3_f32 v245, v245, v131, v140
v_mfma_f32_16x16x32_bf16 v[144:147], a[240:243], v[168:171], v[120:123]
v_max3_f32 v245, v245, v141, v142
v_max_f32 v245, v245, v143
v_mfma_f32_16x16x32_bf16 v[144:147], a[244:247], v[180:183], v[144:147]
buffer_load_dwordx4 v243, s[32:35], s45 offen offset:3072 lds
v_mfma_f32_16x16x32_bf16 v[144:147], a[248:251], v[192:195], v[144:147]
v_mfma_f32_16x16x32_bf16 v[144:147], a[252:255], v[204:207], v[144:147]
s_waitcnt vmcnt(8) lgkmcnt(0)
s_barrier
v_mfma_f32_16x16x32_bf16 a[0:3], a[192:195], v[208:211], a[0:3]
ds_read_b64_tr_b16 a[224:225], v224 offset:16384
s_add_u32 s44, s11, 81920
s_and_b32 s44, s44, 0x1ffff
v_mfma_f32_16x16x32_bf16 a[4:7], a[192:195], v[212:215], a[4:7]
ds_read_b64_tr_b16 a[226:227], v224 offset:20480
ds_read_b64_tr_b16 a[228:229], v225 offset:16384
s_add_u32 s44, s44, s49
v_mfma_f32_16x16x32_bf16 a[8:11], a[192:195], v[216:219], a[8:11]
s_add_u32 m0, s47, 0
s_nop 0
buffer_load_dwordx4 v236, s[16:19], s44 offen nt lds
v_mfma_f32_16x16x32_bf16 a[12:15], a[196:199], v[208:211], a[12:15]
ds_read_b64_tr_b16 a[230:231], v225 offset:20480
v_max3_f32 v246, v132, v133, v134
v_mfma_f32_16x16x32_bf16 a[16:19], a[196:199], v[212:215], a[16:19]
ds_read_b64_tr_b16 a[232:233], v226 offset:16384
v_max3_f32 v246, v246, v135, v144
v_mfma_f32_16x16x32_bf16 a[20:23], a[196:199], v[216:219], a[20:23]
v_max3_f32 v246, v246, v145, v146
v_max_f32 v246, v246, v147
v_mfma_f32_16x16x32_bf16 a[24:27], a[200:203], v[208:211], a[24:27]
v_max3_f32 v247, v244, v245, v246
v_cmp_lt_f32 vcc, s50, v247
s_cbranch_vccnz L_rs13
L_rb13:
v_mfma_f32_16x16x32_bf16 a[28:31], a[200:203], v[212:215], a[28:31]
v_exp_f32 v124, v124
v_mfma_f32_16x16x32_bf16 a[32:35], a[200:203], v[216:219], a[32:35]
buffer_load_dwordx4 v237, s[16:19], s44 offen offset:1024 nt lds
v_mfma_f32_16x16x32_bf16 a[36:39], a[204:207], v[208:211], a[36:39]
ds_read_b64_tr_b16 a[234:235], v226 offset:20480
v_exp_f32 v125, v125
v_mfma_f32_16x16x32_bf16 a[40:43], a[204:207], v[212:215], a[40:43]
ds_read_b64_tr_b16 a[236:237], v227 offset:16384
v_exp_f32 v126, v126
v_mfma_f32_16x16x32_bf16 a[44:47], a[204:207], v[216:219], a[44:47]
ds_read_b64_tr_b16 a[238:239], v227 offset:20480
v_exp_f32 v127, v127
v_mfma_f32_16x16x32_bf16 a[48:51], a[208:211], v[208:211], a[48:51]
ds_read_b64_tr_b16 a[240:241], v228 offset:16384
v_exp_f32 v136, v136
v_mfma_f32_16x16x32_bf16 a[52:55], a[208:211], v[212:215], a[52:55]
ds_read_b64_tr_b16 a[242:243], v228 offset:20480
v_exp_f32 v137, v137
v_mfma_f32_16x16x32_bf16 a[56:59], a[208:211], v[216:219], a[56:59]
buffer_load_dwordx4 v238, s[16:19], s44 offen offset:2048 nt lds
v_mfma_f32_16x16x32_bf16 a[60:63], a[212:215], v[208:211], a[60:63]
ds_read_b64_tr_b16 a[244:245], v229 offset:16384
v_exp_f32 v138, v138
v_mfma_f32_16x16x32_bf16 a[64:67], a[212:215], v[212:215], a[64:67]
ds_read_b64_tr_b16 a[246:247], v229 offset:20480
v_exp_f32 v139, v139
v_mfma_f32_16x16x32_bf16 a[68:71], a[212:215], v[216:219], a[68:71]
ds_read_b64_tr_b16 a[248:249], v230 offset:16384
v_cvt_pk_bf16_f32 v148, v124, v125
v_mfma_f32_16x16x32_bf16 a[72:75], a[216:219], v[208:211], a[72:75]
ds_read_b64_tr_b16 a[250:251], v230 offset:20480
v_cvt_pk_bf16_f32 v149, v126, v127
v_mfma_f32_16x16x32_bf16 a[76:79], a[216:219], v[212:215], a[76:79]
ds_read_b64_tr_b16 a[252:253], v231 offset:16384
ds_read_b64_tr_b16 a[254:255], v231 offset:20480
v_cvt_pk_bf16_f32 v150, v136, v137
v_mfma_f32_16x16x32_bf16 a[80:83], a[216:219], v[216:219], a[80:83]
buffer_load_dwordx4 v239, s[16:19], s44 offen offset:3072 nt lds
v_mfma_f32_16x16x32_bf16 a[84:87], a[220:223], v[208:211], a[84:87]
v_cvt_pk_bf16_f32 v151, v138, v139
v_exp_f32 v128, v128
v_mfma_f32_16x16x32_bf16 a[88:91], a[220:223], v[212:215], a[88:91]
v_exp_f32 v129, v129
v_exp_f32 v130, v130
v_mfma_f32_16x16x32_bf16 a[92:95], a[220:223], v[216:219], a[92:95]
v_exp_f32 v131, v131
s_waitcnt vmcnt(8) lgkmcnt(0)
s_barrier
v_mfma_f32_16x16x32_bf16 v[100:103], v[220:223], v[148:151], v[100:103]
s_add_u32 s44, s11, 90112
v_exp_f32 v140, v140
v_mfma_f32_16x16x32_bf16 v[4:7], a[224:227], v[148:151], v[4:7]
s_and_b32 s44, s44, 0x1ffff
v_exp_f32 v141, v141
v_mfma_f32_16x16x32_bf16 v[16:19], a[228:231], v[148:151], v[16:19]
s_add_u32 s44, s44, s49
v_exp_f32 v142, v142
v_mfma_f32_16x16x32_bf16 v[28:31], a[232:235], v[148:151], v[28:31]
s_add_u32 m0, s47, 16384
v_exp_f32 v143, v143
v_mfma_f32_16x16x32_bf16 v[40:43], a[236:239], v[148:151], v[40:43]
v_cvt_pk_bf16_f32 v152, v128, v129
v_cvt_pk_bf16_f32 v153, v130, v131
v_mfma_f32_16x16x32_bf16 v[52:55], a[240:243], v[148:151], v[52:55]
v_cvt_pk_bf16_f32 v154, v140, v141
v_cvt_pk_bf16_f32 v155, v142, v143
v_mfma_f32_16x16x32_bf16 v[64:67], a[244:247], v[148:151], v[64:67]
v_exp_f32 v132, v132
v_mfma_f32_16x16x32_bf16 v[76:79], a[248:251], v[148:151], v[76:79]
buffer_load_dwordx4 v236, s[12:15], s44 offen nt lds
v_mfma_f32_16x16x32_bf16 v[88:91], a[252:255], v[148:151], v[88:91]
v_exp_f32 v133, v133
v_mfma_f32_16x16x32_bf16 v[104:107], v[220:223], v[152:155], v[104:107]
v_exp_f32 v134, v134
v_mfma_f32_16x16x32_bf16 v[8:11], a[224:227], v[152:155], v[8:11]
v_exp_f32 v135, v135
v_mfma_f32_16x16x32_bf16 v[20:23], a[228:231], v[152:155], v[20:23]
v_exp_f32 v144, v144
v_mfma_f32_16x16x32_bf16 v[32:35], a[232:235], v[152:155], v[32:35]
buffer_load_dwordx4 v237, s[12:15], s44 offen offset:1024 nt lds
v_mfma_f32_16x16x32_bf16 v[44:47], a[236:239], v[152:155], v[44:47]
v_exp_f32 v145, v145
v_mfma_f32_16x16x32_bf16 v[56:59], a[240:243], v[152:155], v[56:59]
v_exp_f32 v146, v146
v_mfma_f32_16x16x32_bf16 v[68:71], a[244:247], v[152:155], v[68:71]
ds_read_b128 a[192:195], v232 offset:32768
v_exp_f32 v147, v147
v_mfma_f32_16x16x32_bf16 v[80:83], a[248:251], v[152:155], v[80:83]
ds_read_b128 a[196:199], v233 offset:32768
v_cvt_pk_bf16_f32 v156, v132, v133
v_cvt_pk_bf16_f32 v157, v134, v135
v_mfma_f32_16x16x32_bf16 v[92:95], a[252:255], v[152:155], v[92:95]
ds_read_b128 a[200:203], v234 offset:32768
v_cvt_pk_bf16_f32 v158, v144, v145
v_cvt_pk_bf16_f32 v159, v146, v147
s_nop 1
v_mfma_f32_16x16x32_bf16 v[108:111], v[220:223], v[156:159], v[108:111]
ds_read_b128 a[204:207], v235 offset:32768
ds_read_b128 a[208:211], v232 offset:36864
v_mfma_f32_16x16x32_bf16 v[12:15], a[224:227], v[156:159], v[12:15]
ds_read_b128 a[212:215], v233 offset:36864
v_mfma_f32_16x16x32_bf16 v[24:27], a[228:231], v[156:159], v[24:27]
buffer_load_dwordx4 v238, s[12:15], s44 offen offset:2048 nt lds
v_mfma_f32_16x16x32_bf16 v[36:39], a[232:235], v[156:159], v[36:39]
ds_read_b128 a[216:219], v234 offset:36864
ds_read_b128 a[220:223], v235 offset:36864
v_mfma_f32_16x16x32_bf16 v[48:51], a[236:239], v[156:159], v[48:51]
v_mfma_f32_16x16x32_bf16 v[60:63], a[240:243], v[156:159], v[60:63]
v_mfma_f32_16x16x32_bf16 v[72:75], a[244:247], v[156:159], v[72:75]
buffer_load_dwordx4 v239, s[12:15], s44 offen offset:3072 nt lds
v_mfma_f32_16x16x32_bf16 v[84:87], a[248:251], v[156:159], v[84:87]
v_mfma_f32_16x16x32_bf16 v[96:99], a[252:255], v[156:159], v[96:99]
s_waitcnt vmcnt(8) lgkmcnt(0)
s_barrier
v_mfma_f32_16x16x32_bf16 v[124:127], a[192:195], v[160:163], v[112:115]
ds_read_b64_tr_b16 a[224:225], v224 offset:49152
s_add_u32 s45, s58, s99
s_add_u32 m0, s47, 32768
v_mfma_f32_16x16x32_bf16 v[124:127], a[196:199], v[172:175], v[124:127]
ds_read_b64_tr_b16 a[226:227], v224 offset:53248
v_mfma_f32_16x16x32_bf16 v[124:127], a[200:203], v[184:187], v[124:127]
ds_read_b64_tr_b16 a[228:229], v225 offset:49152
v_mfma_f32_16x16x32_bf16 v[124:127], a[204:207], v[196:199], v[124:127]
ds_read_b64_tr_b16 a[230:231], v225 offset:53248
v_mfma_f32_16x16x32_bf16 v[136:139], a[208:211], v[160:163], v[112:115]
ds_read_b64_tr_b16 a[232:233], v226 offset:49152
ds_read_b64_tr_b16 a[234:235], v226 offset:53248
v_mfma_f32_16x16x32_bf16 v[136:139], a[212:215], v[172:175], v[136:139]
buffer_load_dwordx4 v240, s[32:35], s45 offen lds
v_mfma_f32_16x16x32_bf16 v[136:139], a[216:219], v[184:187], v[136:139]
ds_read_b64_tr_b16 a[236:237], v227 offset:49152
v_xor_b32 v3, s94, v2
v_mfma_f32_16x16x32_bf16 v[136:139], a[220:223], v[196:199], v[136:139]
ds_read_b64_tr_b16 a[238:239], v227 offset:53248
v_add_u32 v3, s59, v3
v_mfma_f32_16x16x32_bf16 v[128:131], a[192:195], v[164:167], v[116:119]
ds_read_b64_tr_b16 a[240:241], v228 offset:49152
v_mfma_f32_16x16x32_bf16 v[128:131], a[196:199], v[176:179], v[128:131]
ds_read_b64_tr_b16 a[242:243], v228 offset:53248
v_mfma_f32_16x16x32_bf16 v[128:131], a[200:203], v[188:191], v[128:131]
ds_read_b64_tr_b16 a[244:245], v229 offset:49152
ds_read_b64_tr_b16 a[246:247], v229 offset:53248
v_mfma_f32_16x16x32_bf16 v[128:131], a[204:207], v[200:203], v[128:131]
buffer_load_dwordx4 v241, s[32:35], s45 offen offset:1024 lds
v_mfma_f32_16x16x32_bf16 v[140:143], a[208:211], v[164:167], v[116:119]
ds_read_b64_tr_b16 a[248:249], v230 offset:49152
v_max3_f32 v244, v124, v125, v126
v_mfma_f32_16x16x32_bf16 v[140:143], a[212:215], v[176:179], v[140:143]
ds_read_b64_tr_b16 a[250:251], v230 offset:53248
v_max3_f32 v244, v244, v127, v136
v_mfma_f32_16x16x32_bf16 v[140:143], a[216:219], v[188:191], v[140:143]
ds_read_b64_tr_b16 a[252:253], v231 offset:49152
v_max3_f32 v244, v244, v137, v138
v_mfma_f32_16x16x32_bf16 v[140:143], a[220:223], v[200:203], v[140:143]
ds_read_b64_tr_b16 a[254:255], v231 offset:53248
ds_read_b128 v[208:211], v3 offset:0
v_max_f32 v244, v244, v139
v_mfma_f32_16x16x32_bf16 v[132:135], a[192:195], v[168:171], v[120:123]
buffer_load_dwordx4 v242, s[32:35], s45 offen offset:2048 lds
v_mfma_f32_16x16x32_bf16 v[132:135], a[196:199], v[180:183], v[132:135]
ds_read_b128 v[212:215], v3 offset:4096
v_mfma_f32_16x16x32_bf16 v[132:135], a[200:203], v[192:195], v[132:135]
ds_read_b128 v[216:219], v3 offset:8192
v_mfma_f32_16x16x32_bf16 v[132:135], a[204:207], v[204:207], v[132:135]
v_max3_f32 v245, v128, v129, v130
v_max3_f32 v245, v245, v131, v140
v_mfma_f32_16x16x32_bf16 v[144:147], a[208:211], v[168:171], v[120:123]
v_max3_f32 v245, v245, v141, v142
v_max_f32 v245, v245, v143
v_mfma_f32_16x16x32_bf16 v[144:147], a[212:215], v[180:183], v[144:147]
buffer_load_dwordx4 v243, s[32:35], s45 offen offset:3072 lds
v_mfma_f32_16x16x32_bf16 v[144:147], a[216:219], v[192:195], v[144:147]
v_mfma_f32_16x16x32_bf16 v[144:147], a[220:223], v[204:207], v[144:147]
s_waitcnt vmcnt(8) lgkmcnt(0)
s_barrier
v_mfma_f32_16x16x32_bf16 a[0:3], a[224:227], v[208:211], a[0:3]
ds_read_b64_tr_b16 a[192:193], v224 offset:0
s_add_u32 s44, s11, 90112
s_and_b32 s44, s44, 0x1ffff
v_mfma_f32_16x16x32_bf16 a[4:7], a[224:227], v[212:215], a[4:7]
ds_read_b64_tr_b16 a[194:195], v224 offset:4096
ds_read_b64_tr_b16 a[196:197], v225 offset:0
s_add_u32 s44, s44, s49
v_mfma_f32_16x16x32_bf16 a[8:11], a[224:227], v[216:219], a[8:11]
s_add_u32 m0, s47, 49152
s_nop 0
buffer_load_dwordx4 v236, s[16:19], s44 offen nt lds
v_mfma_f32_16x16x32_bf16 a[12:15], a[228:231], v[208:211], a[12:15]
ds_read_b64_tr_b16 a[198:199], v225 offset:4096
v_max3_f32 v246, v132, v133, v134
v_mfma_f32_16x16x32_bf16 a[16:19], a[228:231], v[212:215], a[16:19]
ds_read_b64_tr_b16 a[200:201], v226 offset:0
v_max3_f32 v246, v246, v135, v144
v_mfma_f32_16x16x32_bf16 a[20:23], a[228:231], v[216:219], a[20:23]
v_max3_f32 v246, v246, v145, v146
v_max_f32 v246, v246, v147
v_mfma_f32_16x16x32_bf16 a[24:27], a[232:235], v[208:211], a[24:27]
v_max3_f32 v247, v244, v245, v246
v_cmp_lt_f32 vcc, s50, v247
s_cbranch_vccnz L_rs14
L_rb14:
v_mfma_f32_16x16x32_bf16 a[28:31], a[232:235], v[212:215], a[28:31]
v_exp_f32 v124, v124
v_mfma_f32_16x16x32_bf16 a[32:35], a[232:235], v[216:219], a[32:35]
buffer_load_dwordx4 v237, s[16:19], s44 offen offset:1024 nt lds
v_mfma_f32_16x16x32_bf16 a[36:39], a[236:239], v[208:211], a[36:39]
ds_read_b64_tr_b16 a[202:203], v226 offset:4096
v_exp_f32 v125, v125
v_mfma_f32_16x16x32_bf16 a[40:43], a[236:239], v[212:215], a[40:43]
ds_read_b64_tr_b16 a[204:205], v227 offset:0
v_exp_f32 v126, v126
v_mfma_f32_16x16x32_bf16 a[44:47], a[236:239], v[216:219], a[44:47]
ds_read_b64_tr_b16 a[206:207], v227 offset:4096
v_exp_f32 v127, v127
v_mfma_f32_16x16x32_bf16 a[48:51], a[240:243], v[208:211], a[48:51]
ds_read_b64_tr_b16 a[208:209], v228 offset:0
v_exp_f32 v136, v136
v_mfma_f32_16x16x32_bf16 a[52:55], a[240:243], v[212:215], a[52:55]
ds_read_b64_tr_b16 a[210:211], v228 offset:4096
v_exp_f32 v137, v137
v_mfma_f32_16x16x32_bf16 a[56:59], a[240:243], v[216:219], a[56:59]
buffer_load_dwordx4 v238, s[16:19], s44 offen offset:2048 nt lds
v_mfma_f32_16x16x32_bf16 a[60:63], a[244:247], v[208:211], a[60:63]
ds_read_b64_tr_b16 a[212:213], v229 offset:0
v_exp_f32 v138, v138
v_mfma_f32_16x16x32_bf16 a[64:67], a[244:247], v[212:215], a[64:67]
ds_read_b64_tr_b16 a[214:215], v229 offset:4096
v_exp_f32 v139, v139
v_mfma_f32_16x16x32_bf16 a[68:71], a[244:247], v[216:219], a[68:71]
ds_read_b64_tr_b16 a[216:217], v230 offset:0
v_cvt_pk_bf16_f32 v148, v124, v125
v_mfma_f32_16x16x32_bf16 a[72:75], a[248:251], v[208:211], a[72:75]
ds_read_b64_tr_b16 a[218:219], v230 offset:4096
v_cvt_pk_bf16_f32 v149, v126, v127
v_mfma_f32_16x16x32_bf16 a[76:79], a[248:251], v[212:215], a[76:79]
ds_read_b64_tr_b16 a[220:221], v231 offset:0
ds_read_b64_tr_b16 a[222:223], v231 offset:4096
v_cvt_pk_bf16_f32 v150, v136, v137
v_mfma_f32_16x16x32_bf16 a[80:83], a[248:251], v[216:219], a[80:83]
buffer_load_dwordx4 v239, s[16:19], s44 offen offset:3072 nt lds
v_mfma_f32_16x16x32_bf16 a[84:87], a[252:255], v[208:211], a[84:87]
v_cvt_pk_bf16_f32 v151, v138, v139
v_exp_f32 v128, v128
v_mfma_f32_16x16x32_bf16 a[88:91], a[252:255], v[212:215], a[88:91]
v_exp_f32 v129, v129
v_exp_f32 v130, v130
v_mfma_f32_16x16x32_bf16 a[92:95], a[252:255], v[216:219], a[92:95]
v_exp_f32 v131, v131
s_waitcnt vmcnt(8) lgkmcnt(0)
s_barrier
v_mfma_f32_16x16x32_bf16 v[100:103], v[220:223], v[148:151], v[100:103]
s_add_u32 s44, s11, 98304
v_exp_f32 v140, v140
v_mfma_f32_16x16x32_bf16 v[4:7], a[192:195], v[148:151], v[4:7]
s_and_b32 s44, s44, 0x1ffff
v_exp_f32 v141, v141
v_mfma_f32_16x16x32_bf16 v[16:19], a[196:199], v[148:151], v[16:19]
s_add_u32 s44, s44, s49
v_exp_f32 v142, v142
v_mfma_f32_16x16x32_bf16 v[28:31], a[200:203], v[148:151], v[28:31]
s_add_u32 m0, s47, 0
v_exp_f32 v143, v143
v_mfma_f32_16x16x32_bf16 v[40:43], a[204:207], v[148:151], v[40:43]
v_cvt_pk_bf16_f32 v152, v128, v129
v_cvt_pk_bf16_f32 v153, v130, v131
v_mfma_f32_16x16x32_bf16 v[52:55], a[208:211], v[148:151], v[52:55]
v_cvt_pk_bf16_f32 v154, v140, v141
v_cvt_pk_bf16_f32 v155, v142, v143
v_mfma_f32_16x16x32_bf16 v[64:67], a[212:215], v[148:151], v[64:67]
v_exp_f32 v132, v132
v_mfma_f32_16x16x32_bf16 v[76:79], a[216:219], v[148:151], v[76:79]
buffer_load_dwordx4 v236, s[12:15], s44 offen nt lds
v_mfma_f32_16x16x32_bf16 v[88:91], a[220:223], v[148:151], v[88:91]
v_exp_f32 v133, v133
v_mfma_f32_16x16x32_bf16 v[104:107], v[220:223], v[152:155], v[104:107]
v_exp_f32 v134, v134
v_mfma_f32_16x16x32_bf16 v[8:11], a[192:195], v[152:155], v[8:11]
v_exp_f32 v135, v135
v_mfma_f32_16x16x32_bf16 v[20:23], a[196:199], v[152:155], v[20:23]
v_exp_f32 v144, v144
v_mfma_f32_16x16x32_bf16 v[32:35], a[200:203], v[152:155], v[32:35]
buffer_load_dwordx4 v237, s[12:15], s44 offen offset:1024 nt lds
v_mfma_f32_16x16x32_bf16 v[44:47], a[204:207], v[152:155], v[44:47]
v_exp_f32 v145, v145
v_mfma_f32_16x16x32_bf16 v[56:59], a[208:211], v[152:155], v[56:59]
v_exp_f32 v146, v146
v_mfma_f32_16x16x32_bf16 v[68:71], a[212:215], v[152:155], v[68:71]
ds_read_b128 a[224:227], v232 offset:16384
v_exp_f32 v147, v147
v_mfma_f32_16x16x32_bf16 v[80:83], a[216:219], v[152:155], v[80:83]
ds_read_b128 a[228:231], v233 offset:16384
v_cvt_pk_bf16_f32 v156, v132, v133
v_cvt_pk_bf16_f32 v157, v134, v135
v_mfma_f32_16x16x32_bf16 v[92:95], a[220:223], v[152:155], v[92:95]
ds_read_b128 a[232:235], v234 offset:16384
v_cvt_pk_bf16_f32 v158, v144, v145
v_cvt_pk_bf16_f32 v159, v146, v147
s_nop 1
v_mfma_f32_16x16x32_bf16 v[108:111], v[220:223], v[156:159], v[108:111]
ds_read_b128 a[236:239], v235 offset:16384
ds_read_b128 a[240:243], v232 offset:20480
v_mfma_f32_16x16x32_bf16 v[12:15], a[192:195], v[156:159], v[12:15]
ds_read_b128 a[244:247], v233 offset:20480
v_mfma_f32_16x16x32_bf16 v[24:27], a[196:199], v[156:159], v[24:27]
buffer_load_dwordx4 v238, s[12:15], s44 offen offset:2048 nt lds
v_mfma_f32_16x16x32_bf16 v[36:39], a[200:203], v[156:159], v[36:39]
ds_read_b128 a[248:251], v234 offset:20480
ds_read_b128 a[252:255], v235 offset:20480
v_mfma_f32_16x16x32_bf16 v[48:51], a[204:207], v[156:159], v[48:51]
v_mfma_f32_16x16x32_bf16 v[60:63], a[208:211], v[156:159], v[60:63]
v_mfma_f32_16x16x32_bf16 v[72:75], a[212:215], v[156:159], v[72:75]
buffer_load_dwordx4 v239, s[12:15], s44 offen offset:3072 nt lds
v_mfma_f32_16x16x32_bf16 v[84:87], a[216:219], v[156:159], v[84:87]
L_here15:
s_getpc_b64 s[36:37]
L_pc16:
v_mfma_f32_16x16x32_bf16 v[96:99], a[220:223], v[156:159], v[96:99]
s_add_u32 s36, s36, L_here15-L_pc16
s_addc_u32 s37, s37, -1
s_and_b32 s37, s37, 0xffff
s_mov_b32 s38, L_codeend-L_here15
s_mov_b32 s39, 0x20000
s_and_b32 s52, s7, 7
s_lshl_b32 s52, s52, 2
s_add_u32 s52, s52, s4
s_lshl_b32 s52, s52, 11
v_and_b32 v248, 15, v1
v_lshlrev_b32 v248, 7, v248
buffer_load_dword v254, v248, s[36:39], s52 offen
s_waitcnt vmcnt(9) lgkmcnt(0)
s_barrier
v_mfma_f32_16x16x32_bf16 v[124:127], a[224:227], v[160:163], v[112:115]
ds_read_b64_tr_b16 a[192:193], v224 offset:32768
s_add_u32 s52, s71, 3
s_and_b32 s52, s52, 3
v_mfma_f32_16x16x32_bf16 v[124:127], a[228:231], v[172:175], v[124:127]
ds_read_b64_tr_b16 a[194:195], v224 offset:36864
s_lshl_b32 s52, s52, 20
s_add_u32 s58, s52, s56
v_mfma_f32_16x16x32_bf16 v[124:127], a[232:235], v[184:187], v[124:127]
ds_read_b64_tr_b16 a[196:197], v225 offset:32768
s_add_u32 s45, s58, s96
s_add_u32 m0, s47, 16384
v_mfma_f32_16x16x32_bf16 v[124:127], a[236:239], v[196:199], v[124:127]
ds_read_b64_tr_b16 a[198:199], v225 offset:36864
v_mfma_f32_16x16x32_bf16 v[136:139], a[240:243], v[160:163], v[112:115]
ds_read_b64_tr_b16 a[200:201], v226 offset:32768
ds_read_b64_tr_b16 a[202:203], v226 offset:36864
v_mfma_f32_16x16x32_bf16 v[136:139], a[244:247], v[172:175], v[136:139]
buffer_load_dwordx4 v240, s[32:35], s45 offen lds
v_mfma_f32_16x16x32_bf16 v[136:139], a[248:251], v[184:187], v[136:139]
ds_read_b64_tr_b16 a[204:205], v227 offset:32768
v_xor_b32 v3, s95, v2
v_mfma_f32_16x16x32_bf16 v[136:139], a[252:255], v[196:199], v[136:139]
ds_read_b64_tr_b16 a[206:207], v227 offset:36864
v_add_u32 v3, s59, v3
v_mfma_f32_16x16x32_bf16 v[128:131], a[224:227], v[164:167], v[116:119]
ds_read_b64_tr_b16 a[208:209], v228 offset:32768
v_mfma_f32_16x16x32_bf16 v[128:131], a[228:231], v[176:179], v[128:131]
ds_read_b64_tr_b16 a[210:211], v228 offset:36864
v_mfma_f32_16x16x32_bf16 v[128:131], a[232:235], v[188:191], v[128:131]
ds_read_b64_tr_b16 a[212:213], v229 offset:32768
ds_read_b64_tr_b16 a[214:215], v229 offset:36864
v_mfma_f32_16x16x32_bf16 v[128:131], a[236:239], v[200:203], v[128:131]
buffer_load_dwordx4 v241, s[32:35], s45 offen offset:1024 lds
v_mfma_f32_16x16x32_bf16 v[140:143], a[240:243], v[164:167], v[116:119]
ds_read_b64_tr_b16 a[216:217], v230 offset:32768
v_max3_f32 v244, v124, v125, v126
v_mfma_f32_16x16x32_bf16 v[140:143], a[244:247], v[176:179], v[140:143]
ds_read_b64_tr_b16 a[218:219], v230 offset:36864
v_max3_f32 v244, v244, v127, v136
v_mfma_f32_16x16x32_bf16 v[140:143], a[248:251], v[188:191], v[140:143]
ds_read_b64_tr_b16 a[220:221], v231 offset:32768
v_max3_f32 v244, v244, v137, v138
v_mfma_f32_16x16x32_bf16 v[140:143], a[252:255], v[200:203], v[140:143]
ds_read_b64_tr_b16 a[222:223], v231 offset:36864
ds_read_b128 v[208:211], v3 offset:0
v_max_f32 v244, v244, v139
v_mfma_f32_16x16x32_bf16 v[132:135], a[224:227], v[168:171], v[120:123]
buffer_load_dwordx4 v242, s[32:35], s45 offen offset:2048 lds
v_mfma_f32_16x16x32_bf16 v[132:135], a[228:231], v[180:183], v[132:135]
ds_read_b128 v[212:215], v3 offset:4096
v_mfma_f32_16x16x32_bf16 v[132:135], a[232:235], v[192:195], v[132:135]
ds_read_b128 v[216:219], v3 offset:8192
v_mfma_f32_16x16x32_bf16 v[132:135], a[236:239], v[204:207], v[132:135]
v_max3_f32 v245, v128, v129, v130
v_max3_f32 v245, v245, v131, v140
v_mfma_f32_16x16x32_bf16 v[144:147], a[240:243], v[168:171], v[120:123]
v_max3_f32 v245, v245, v141, v142
v_max_f32 v245, v245, v143
v_mfma_f32_16x16x32_bf16 v[144:147], a[244:247], v[180:183], v[144:147]
buffer_load_dwordx4 v243, s[32:35], s45 offen offset:3072 lds
v_mfma_f32_16x16x32_bf16 v[144:147], a[248:251], v[192:195], v[144:147]
v_mfma_f32_16x16x32_bf16 v[144:147], a[252:255], v[204:207], v[144:147]
s_waitcnt vmcnt(9) lgkmcnt(0)
s_barrier
v_mfma_f32_16x16x32_bf16 a[0:3], a[192:195], v[208:211], a[0:3]
ds_read_b64_tr_b16 a[224:225], v224 offset:49152
s_add_u32 s44, s11, 98304
s_and_b32 s44, s44, 0x1ffff
v_mfma_f32_16x16x32_bf16 a[4:7], a[192:195], v[212:215], a[4:7]
ds_read_b64_tr_b16 a[226:227], v224 offset:53248
ds_read_b64_tr_b16 a[228:229], v225 offset:49152
s_add_u32 s44, s44, s49
v_mfma_f32_16x16x32_bf16 a[8:11], a[192:195], v[216:219], a[8:11]
s_add_u32 m0, s47, 32768
s_nop 0
buffer_load_dwordx4 v236, s[16:19], s44 offen nt lds
v_mfma_f32_16x16x32_bf16 a[12:15], a[196:199], v[208:211], a[12:15]
ds_read_b64_tr_b16 a[230:231], v225 offset:53248
v_max3_f32 v246, v132, v133, v134
v_mfma_f32_16x16x32_bf16 a[16:19], a[196:199], v[212:215], a[16:19]
ds_read_b64_tr_b16 a[232:233], v226 offset:49152
v_max3_f32 v246, v246, v135, v144
v_mfma_f32_16x16x32_bf16 a[20:23], a[196:199], v[216:219], a[20:23]
v_max3_f32 v246, v246, v145, v146
v_max_f32 v246, v246, v147
v_mfma_f32_16x16x32_bf16 a[24:27], a[200:203], v[208:211], a[24:27]
v_max3_f32 v247, v244, v245, v246
v_cmp_lt_f32 vcc, s50, v247
s_cbranch_vccnz L_rs17
L_rb17:
v_mfma_f32_16x16x32_bf16 a[28:31], a[200:203], v[212:215], a[28:31]
v_exp_f32 v124, v124
v_mfma_f32_16x16x32_bf16 a[32:35], a[200:203], v[216:219], a[32:35]
buffer_load_dwordx4 v237, s[16:19], s44 offen offset:1024 nt lds
v_mfma_f32_16x16x32_bf16 a[36:39], a[204:207], v[208:211], a[36:39]
ds_read_b64_tr_b16 a[234:235], v226 offset:53248
v_exp_f32 v125, v125
v_mfma_f32_16x16x32_bf16 a[40:43], a[204:207], v[212:215], a[40:43]
ds_read_b64_tr_b16 a[236:237], v227 offset:49152
v_exp_f32 v126, v126
v_mfma_f32_16x16x32_bf16 a[44:47], a[204:207], v[216:219], a[44:47]
ds_read_b64_tr_b16 a[238:239], v227 offset:53248
v_exp_f32 v127, v127
v_mfma_f32_16x16x32_bf16 a[48:51], a[208:211], v[208:211], a[48:51]
ds_read_b64_tr_b16 a[240:241], v228 offset:49152
v_exp_f32 v136, v136
v_mfma_f32_16x16x32_bf16 a[52:55], a[208:211], v[212:215], a[52:55]
ds_read_b64_tr_b16 a[242:243], v228 offset:53248
v_exp_f32 v137, v137
v_mfma_f32_16x16x32_bf16 a[56:59], a[208:211], v[216:219], a[56:59]
buffer_load_dwordx4 v238, s[16:19], s44 offen offset:2048 nt lds
v_mfma_f32_16x16x32_bf16 a[60:63], a[212:215], v[208:211], a[60:63]
ds_read_b64_tr_b16 a[244:245], v229 offset:49152
v_exp_f32 v138, v138
v_mfma_f32_16x16x32_bf16 a[64:67], a[212:215], v[212:215], a[64:67]
ds_read_b64_tr_b16 a[246:247], v229 offset:53248
v_exp_f32 v139, v139
v_mfma_f32_16x16x32_bf16 a[68:71], a[212:215], v[216:219], a[68:71]
ds_read_b64_tr_b16 a[248:249], v230 offset:49152
v_cvt_pk_bf16_f32 v148, v124, v125
v_mfma_f32_16x16x32_bf16 a[72:75], a[216:219], v[208:211], a[72:75]
ds_read_b64_tr_b16 a[250:251], v230 offset:53248
v_cvt_pk_bf16_f32 v149, v126, v127
v_mfma_f32_16x16x32_bf16 a[76:79], a[216:219], v[212:215], a[76:79]
ds_read_b64_tr_b16 a[252:253], v231 offset:49152
ds_read_b64_tr_b16 a[254:255], v231 offset:53248
v_cvt_pk_bf16_f32 v150, v136, v137
v_mfma_f32_16x16x32_bf16 a[80:83], a[216:219], v[216:219], a[80:83]
buffer_load_dwordx4 v239, s[16:19], s44 offen offset:3072 nt lds
v_mfma_f32_16x16x32_bf16 a[84:87], a[220:223], v[208:211], a[84:87]
v_cvt_pk_bf16_f32 v151, v138, v139
v_exp_f32 v128, v128
v_mfma_f32_16x16x32_bf16 a[88:91], a[220:223], v[212:215], a[88:91]
v_exp_f32 v129, v129
v_exp_f32 v130, v130
v_mfma_f32_16x16x32_bf16 a[92:95], a[220:223], v[216:219], a[92:95]
v_exp_f32 v131, v131
s_waitcnt vmcnt(9) lgkmcnt(0)
s_barrier
v_mfma_f32_16x16x32_bf16 v[100:103], v[220:223], v[148:151], v[100:103]
s_add_u32 s44, s11, 106496
v_exp_f32 v140, v140
v_mfma_f32_16x16x32_bf16 v[4:7], a[224:227], v[148:151], v[4:7]
s_and_b32 s44, s44, 0x1ffff
v_exp_f32 v141, v141
v_mfma_f32_16x16x32_bf16 v[16:19], a[228:231], v[148:151], v[16:19]
s_add_u32 s44, s44, s49
v_exp_f32 v142, v142
v_mfma_f32_16x16x32_bf16 v[28:31], a[232:235], v[148:151], v[28:31]
s_add_u32 m0, s47, 49152
v_exp_f32 v143, v143
v_mfma_f32_16x16x32_bf16 v[40:43], a[236:239], v[148:151], v[40:43]
v_cvt_pk_bf16_f32 v152, v128, v129
v_cvt_pk_bf16_f32 v153, v130, v131
v_mfma_f32_16x16x32_bf16 v[52:55], a[240:243], v[148:151], v[52:55]
v_cvt_pk_bf16_f32 v154, v140, v141
v_cvt_pk_bf16_f32 v155, v142, v143
v_mfma_f32_16x16x32_bf16 v[64:67], a[244:247], v[148:151], v[64:67]
v_exp_f32 v132, v132
v_mfma_f32_16x16x32_bf16 v[76:79], a[248:251], v[148:151], v[76:79]
buffer_load_dwordx4 v236, s[12:15], s44 offen nt lds
v_mfma_f32_16x16x32_bf16 v[88:91], a[252:255], v[148:151], v[88:91]
v_exp_f32 v133, v133
v_mfma_f32_16x16x32_bf16 v[104:107], v[220:223], v[152:155], v[104:107]
v_exp_f32 v134, v134
v_mfma_f32_16x16x32_bf16 v[8:11], a[224:227], v[152:155], v[8:11]
v_exp_f32 v135, v135
v_mfma_f32_16x16x32_bf16 v[20:23], a[228:231], v[152:155], v[20:23]
v_exp_f32 v144, v144
v_mfma_f32_16x16x32_bf16 v[32:35], a[232:235], v[152:155], v[32:35]
buffer_load_dwordx4 v237, s[12:15], s44 offen offset:1024 nt lds
v_mfma_f32_16x16x32_bf16 v[44:47], a[236:239], v[152:155], v[44:47]
v_exp_f32 v145, v145
v_mfma_f32_16x16x32_bf16 v[56:59], a[240:243], v[152:155], v[56:59]
v_exp_f32 v146, v146
v_mfma_f32_16x16x32_bf16 v[68:71], a[244:247], v[152:155], v[68:71]
ds_read_b128 a[192:195], v232 offset:0
v_exp_f32 v147, v147
v_mfma_f32_16x16x32_bf16 v[80:83], a[248:251], v[152:155], v[80:83]
ds_read_b128 a[196:199], v233 offset:0
v_cvt_pk_bf16_f32 v156, v132, v133
v_cvt_pk_bf16_f32 v157, v134, v135
v_mfma_f32_16x16x32_bf16 v[92:95], a[252:255], v[152:155], v[92:95]
ds_read_b128 a[200:203], v234 offset:0
v_cvt_pk_bf16_f32 v158, v144, v145
v_cvt_pk_bf16_f32 v159, v146, v147
s_nop 1
v_mfma_f32_16x16x32_bf16 v[108:111], v[220:223], v[156:159], v[108:111]
ds_read_b128 a[204:207], v235 offset:0
ds_read_b128 a[208:211], v232 offset:4096
v_mfma_f32_16x16x32_bf16 v[12:15], a[224:227], v[156:159], v[12:15]
ds_read_b128 a[212:215], v233 offset:4096
v_mfma_f32_16x16x32_bf16 v[24:27], a[228:231], v[156:159], v[24:27]
buffer_load_dwordx4 v238, s[12:15], s44 offen offset:2048 nt lds
v_mfma_f32_16x16x32_bf16 v[36:39], a[232:235], v[156:159], v[36:39]
ds_read_b128 a[216:219], v234 offset:4096
ds_read_b128 a[220:223], v235 offset:4096
v_mfma_f32_16x16x32_bf16 v[48:51], a[236:239], v[156:159], v[48:51]
v_mfma_f32_16x16x32_bf16 v[60:63], a[240:243], v[156:159], v[60:63]
v_mfma_f32_16x16x32_bf16 v[72:75], a[244:247], v[156:159], v[72:75]
buffer_load_dwordx4 v239, s[12:15], s44 offen offset:3072 nt lds
v_mfma_f32_16x16x32_bf16 v[84:87], a[248:251], v[156:159], v[84:87]
v_mfma_f32_16x16x32_bf16 v[96:99], a[252:255], v[156:159], v[96:99]
s_waitcnt vmcnt(8) lgkmcnt(0)
s_barrier
v_mfma_f32_16x16x32_bf16 v[124:127], a[192:195], v[160:163], v[112:115]
ds_read_b64_tr_b16 a[224:225], v224 offset:16384
s_add_u32 s53, s71, 3
s_and_b32 s53, s53, 3
v_mfma_f32_16x16x32_bf16 v[124:127], a[196:199], v[172:175], v[124:127]
ds_read_b64_tr_b16 a[226:227], v224 offset:20480
s_mul_i32 s53, s53, 24576
s_add_u32 s59, s53, s60
v_mfma_f32_16x16x32_bf16 v[124:127], a[200:203], v[184:187], v[124:127]
ds_read_b64_tr_b16 a[228:229], v225 offset:16384
s_add_u32 s45, s58, s97
s_add_u32 m0, s47, 0
v_mfma_f32_16x16x32_bf16 v[124:127], a[204:207], v[196:199], v[124:127]
ds_read_b64_tr_b16 a[230:231], v225 offset:20480
v_mfma_f32_16x16x32_bf16 v[136:139], a[208:211], v[160:163], v[112:115]
ds_read_b64_tr_b16 a[232:233], v226 offset:16384
ds_read_b64_tr_b16 a[234:235], v226 offset:20480
v_mfma_f32_16x16x32_bf16 v[136:139], a[212:215], v[172:175], v[136:139]
buffer_load_dwordx4 v240, s[32:35], s45 offen lds
v_mfma_f32_16x16x32_bf16 v[136:139], a[216:219], v[184:187], v[136:139]
ds_read_b64_tr_b16 a[236:237], v227 offset:16384
v_xor_b32 v3, s92, v2
v_mfma_f32_16x16x32_bf16 v[136:139], a[220:223], v[196:199], v[136:139]
ds_read_b64_tr_b16 a[238:239], v227 offset:20480
v_add_u32 v3, s59, v3
v_mfma_f32_16x16x32_bf16 v[128:131], a[192:195], v[164:167], v[116:119]
ds_read_b64_tr_b16 a[240:241], v228 offset:16384
v_mfma_f32_16x16x32_bf16 v[128:131], a[196:199], v[176:179], v[128:131]
ds_read_b64_tr_b16 a[242:243], v228 offset:20480
v_mfma_f32_16x16x32_bf16 v[128:131], a[200:203], v[188:191], v[128:131]
ds_read_b64_tr_b16 a[244:245], v229 offset:16384
ds_read_b64_tr_b16 a[246:247], v229 offset:20480
v_mfma_f32_16x16x32_bf16 v[128:131], a[204:207], v[200:203], v[128:131]
buffer_load_dwordx4 v241, s[32:35], s45 offen offset:1024 lds
v_mfma_f32_16x16x32_bf16 v[140:143], a[208:211], v[164:167], v[116:119]
ds_read_b64_tr_b16 a[248:249], v230 offset:16384
v_max3_f32 v244, v124, v125, v126
v_mfma_f32_16x16x32_bf16 v[140:143], a[212:215], v[176:179], v[140:143]
ds_read_b64_tr_b16 a[250:251], v230 offset:20480
v_max3_f32 v244, v244, v127, v136
v_mfma_f32_16x16x32_bf16 v[140:143], a[216:219], v[188:191], v[140:143]
ds_read_b64_tr_b16 a[252:253], v231 offset:16384
v_max3_f32 v244, v244, v137, v138
v_mfma_f32_16x16x32_bf16 v[140:143], a[220:223], v[200:203], v[140:143]
ds_read_b64_tr_b16 a[254:255], v231 offset:20480
ds_read_b128 v[208:211], v3 offset:0
v_max_f32 v244, v244, v139
v_mfma_f32_16x16x32_bf16 v[132:135], a[192:195], v[168:171], v[120:123]
buffer_load_dwordx4 v242, s[32:35], s45 offen offset:2048 lds
v_mfma_f32_16x16x32_bf16 v[132:135], a[196:199], v[180:183], v[132:135]
ds_read_b128 v[212:215], v3 offset:4096
v_mfma_f32_16x16x32_bf16 v[132:135], a[200:203], v[192:195], v[132:135]
ds_read_b128 v[216:219], v3 offset:8192
v_mfma_f32_16x16x32_bf16 v[132:135], a[204:207], v[204:207], v[132:135]
v_max3_f32 v245, v128, v129, v130
v_max3_f32 v245, v245, v131, v140
v_mfma_f32_16x16x32_bf16 v[144:147], a[208:211], v[168:171], v[120:123]
v_max3_f32 v245, v245, v141, v142
v_max_f32 v245, v245, v143
v_mfma_f32_16x16x32_bf16 v[144:147], a[212:215], v[180:183], v[144:147]
buffer_load_dwordx4 v243, s[32:35], s45 offen offset:3072 lds
v_mfma_f32_16x16x32_bf16 v[144:147], a[216:219], v[192:195], v[144:147]
v_mfma_f32_16x16x32_bf16 v[144:147], a[220:223], v[204:207], v[144:147]
s_waitcnt vmcnt(8) lgkmcnt(0)
s_barrier
v_mfma_f32_16x16x32_bf16 a[0:3], a[224:227], v[208:211], a[0:3]
ds_read_b64_tr_b16 a[192:193], v224 offset:32768
s_add_u32 s44, s11, 106496
s_and_b32 s44, s44, 0x1ffff
v_mfma_f32_16x16x32_bf16 a[4:7], a[224:227], v[212:215], a[4:7]
ds_read_b64_tr_b16 a[194:195], v224 offset:36864
ds_read_b64_tr_b16 a[196:197], v225 offset:32768
s_add_u32 s44, s44, s49
v_mfma_f32_16x16x32_bf16 a[8:11], a[224:227], v[216:219], a[8:11]
s_add_u32 m0, s47, 16384
s_nop 0
buffer_load_dwordx4 v236, s[16:19], s44 offen nt lds
v_mfma_f32_16x16x32_bf16 a[12:15], a[228:231], v[208:211], a[12:15]
ds_read_b64_tr_b16 a[198:199], v225 offset:36864
v_max3_f32 v246, v132, v133, v134
v_mfma_f32_16x16x32_bf16 a[16:19], a[228:231], v[212:215], a[16:19]
ds_read_b64_tr_b16 a[200:201], v226 offset:32768
v_max3_f32 v246, v246, v135, v144
v_mfma_f32_16x16x32_bf16 a[20:23], a[228:231], v[216:219], a[20:23]
v_max3_f32 v246, v246, v145, v146
v_max_f32 v246, v246, v147
v_mfma_f32_16x16x32_bf16 a[24:27], a[232:235], v[208:211], a[24:27]
v_max3_f32 v247, v244, v245, v246
v_cmp_lt_f32 vcc, s50, v247
s_cbranch_vccnz L_rs18
L_rb18:
v_mfma_f32_16x16x32_bf16 a[28:31], a[232:235], v[212:215], a[28:31]
v_exp_f32 v124, v124
v_mfma_f32_16x16x32_bf16 a[32:35], a[232:235], v[216:219], a[32:35]
buffer_load_dwordx4 v237, s[16:19], s44 offen offset:1024 nt lds
v_mfma_f32_16x16x32_bf16 a[36:39], a[236:239], v[208:211], a[36:39]
ds_read_b64_tr_b16 a[202:203], v226 offset:36864
v_exp_f32 v125, v125
v_mfma_f32_16x16x32_bf16 a[40:43], a[236:239], v[212:215], a[40:43]
ds_read_b64_tr_b16 a[204:205], v227 offset:32768
v_exp_f32 v126, v126
v_mfma_f32_16x16x32_bf16 a[44:47], a[236:239], v[216:219], a[44:47]
ds_read_b64_tr_b16 a[206:207], v227 offset:36864
v_exp_f32 v127, v127
v_mfma_f32_16x16x32_bf16 a[48:51], a[240:243], v[208:211], a[48:51]
ds_read_b64_tr_b16 a[208:209], v228 offset:32768
v_exp_f32 v136, v136
v_mfma_f32_16x16x32_bf16 a[52:55], a[240:243], v[212:215], a[52:55]
ds_read_b64_tr_b16 a[210:211], v228 offset:36864
v_exp_f32 v137, v137
v_mfma_f32_16x16x32_bf16 a[56:59], a[240:243], v[216:219], a[56:59]
buffer_load_dwordx4 v238, s[16:19], s44 offen offset:2048 nt lds
v_mfma_f32_16x16x32_bf16 a[60:63], a[244:247], v[208:211], a[60:63]
ds_read_b64_tr_b16 a[212:213], v229 offset:32768
v_exp_f32 v138, v138
v_mfma_f32_16x16x32_bf16 a[64:67], a[244:247], v[212:215], a[64:67]
ds_read_b64_tr_b16 a[214:215], v229 offset:36864
v_exp_f32 v139, v139
v_mfma_f32_16x16x32_bf16 a[68:71], a[244:247], v[216:219], a[68:71]
ds_read_b64_tr_b16 a[216:217], v230 offset:32768
v_cvt_pk_bf16_f32 v148, v124, v125
v_mfma_f32_16x16x32_bf16 a[72:75], a[248:251], v[208:211], a[72:75]
ds_read_b64_tr_b16 a[218:219], v230 offset:36864
v_cvt_pk_bf16_f32 v149, v126, v127
v_mfma_f32_16x16x32_bf16 a[76:79], a[248:251], v[212:215], a[76:79]
ds_read_b64_tr_b16 a[220:221], v231 offset:32768
ds_read_b64_tr_b16 a[222:223], v231 offset:36864
v_cvt_pk_bf16_f32 v150, v136, v137
v_mfma_f32_16x16x32_bf16 a[80:83], a[248:251], v[216:219], a[80:83]
buffer_load_dwordx4 v239, s[16:19], s44 offen offset:3072 nt lds
v_mfma_f32_16x16x32_bf16 a[84:87], a[252:255], v[208:211], a[84:87]
v_cvt_pk_bf16_f32 v151, v138, v139
v_exp_f32 v128, v128
v_mfma_f32_16x16x32_bf16 a[88:91], a[252:255], v[212:215], a[88:91]
v_exp_f32 v129, v129
v_exp_f32 v130, v130
v_mfma_f32_16x16x32_bf16 a[92:95], a[252:255], v[216:219], a[92:95]
v_exp_f32 v131, v131
s_waitcnt vmcnt(8) lgkmcnt(0)
s_barrier
v_mfma_f32_16x16x32_bf16 v[100:103], v[220:223], v[148:151], v[100:103]
s_add_u32 s44, s11, 114688
v_exp_f32 v140, v140
v_mfma_f32_16x16x32_bf16 v[4:7], a[192:195], v[148:151], v[4:7]
s_and_b32 s44, s44, 0x1ffff
v_exp_f32 v141, v141
v_mfma_f32_16x16x32_bf16 v[16:19], a[196:199], v[148:151], v[16:19]
s_add_u32 s44, s44, s49
v_exp_f32 v142, v142
v_mfma_f32_16x16x32_bf16 v[28:31], a[200:203], v[148:151], v[28:31]
s_add_u32 m0, s47, 32768
v_exp_f32 v143, v143
v_mfma_f32_16x16x32_bf16 v[40:43], a[204:207], v[148:151], v[40:43]
v_cvt_pk_bf16_f32 v152, v128, v129
v_cvt_pk_bf16_f32 v153, v130, v131
v_mfma_f32_16x16x32_bf16 v[52:55], a[208:211], v[148:151], v[52:55]
v_cvt_pk_bf16_f32 v154, v140, v141
v_cvt_pk_bf16_f32 v155, v142, v143
v_mfma_f32_16x16x32_bf16 v[64:67], a[212:215], v[148:151], v[64:67]
v_exp_f32 v132, v132
v_mfma_f32_16x16x32_bf16 v[76:79], a[216:219], v[148:151], v[76:79]
buffer_load_dwordx4 v236, s[12:15], s44 offen nt lds
v_mfma_f32_16x16x32_bf16 v[88:91], a[220:223], v[148:151], v[88:91]
v_exp_f32 v133, v133
v_mfma_f32_16x16x32_bf16 v[104:107], v[220:223], v[152:155], v[104:107]
v_exp_f32 v134, v134
v_mfma_f32_16x16x32_bf16 v[8:11], a[192:195], v[152:155], v[8:11]
v_exp_f32 v135, v135
v_mfma_f32_16x16x32_bf16 v[20:23], a[196:199], v[152:155], v[20:23]
v_exp_f32 v144, v144
v_mfma_f32_16x16x32_bf16 v[32:35], a[200:203], v[152:155], v[32:35]
buffer_load_dwordx4 v237, s[12:15], s44 offen offset:1024 nt lds
v_mfma_f32_16x16x32_bf16 v[44:47], a[204:207], v[152:155], v[44:47]
v_exp_f32 v145, v145
v_mfma_f32_16x16x32_bf16 v[56:59], a[208:211], v[152:155], v[56:59]
v_exp_f32 v146, v146
v_mfma_f32_16x16x32_bf16 v[68:71], a[212:215], v[152:155], v[68:71]
ds_read_b128 a[224:227], v232 offset:49152
v_exp_f32 v147, v147
v_mfma_f32_16x16x32_bf16 v[80:83], a[216:219], v[152:155], v[80:83]
ds_read_b128 a[228:231], v233 offset:49152
v_cvt_pk_bf16_f32 v156, v132, v133
v_cvt_pk_bf16_f32 v157, v134, v135
v_mfma_f32_16x16x32_bf16 v[92:95], a[220:223], v[152:155], v[92:95]
ds_read_b128 a[232:235], v234 offset:49152
v_cvt_pk_bf16_f32 v158, v144, v145
v_cvt_pk_bf16_f32 v159, v146, v147
s_nop 1
v_mfma_f32_16x16x32_bf16 v[108:111], v[220:223], v[156:159], v[108:111]
ds_read_b128 a[236:239], v235 offset:49152
ds_read_b128 a[240:243], v232 offset:53248
v_mfma_f32_16x16x32_bf16 v[12:15], a[192:195], v[156:159], v[12:15]
ds_read_b128 a[244:247], v233 offset:53248
v_mfma_f32_16x16x32_bf16 v[24:27], a[196:199], v[156:159], v[24:27]
buffer_load_dwordx4 v238, s[12:15], s44 offen offset:2048 nt lds
v_mfma_f32_16x16x32_bf16 v[36:39], a[200:203], v[156:159], v[36:39]
ds_read_b128 a[248:251], v234 offset:53248
ds_read_b128 a[252:255], v235 offset:53248
v_mfma_f32_16x16x32_bf16 v[48:51], a[204:207], v[156:159], v[48:51]
v_mfma_f32_16x16x32_bf16 v[60:63], a[208:211], v[156:159], v[60:63]
v_mfma_f32_16x16x32_bf16 v[72:75], a[212:215], v[156:159], v[72:75]
buffer_load_dwordx4 v239, s[12:15], s44 offen offset:3072 nt lds
v_mfma_f32_16x16x32_bf16 v[84:87], a[216:219], v[156:159], v[84:87]
v_mfma_f32_16x16x32_bf16 v[96:99], a[220:223], v[156:159], v[96:99]
s_waitcnt vmcnt(8) lgkmcnt(0)
s_barrier
v_mfma_f32_16x16x32_bf16 v[124:127], a[224:227], v[160:163], v[112:115]
ds_read_b64_tr_b16 a[192:193], v224 offset:0
s_add_u32 s45, s58, s98
s_add_u32 m0, s47, 49152
v_mfma_f32_16x16x32_bf16 v[124:127], a[228:231], v[172:175], v[124:127]
ds_read_b64_tr_b16 a[194:195], v224 offset:4096
v_mfma_f32_16x16x32_bf16 v[124:127], a[232:235], v[184:187], v[124:127]
ds_read_b64_tr_b16 a[196:197], v225 offset:0
v_mfma_f32_16x16x32_bf16 v[124:127], a[236:239], v[196:199], v[124:127]
ds_read_b64_tr_b16 a[198:199], v225 offset:4096
v_mfma_f32_16x16x32_bf16 v[136:139], a[240:243], v[160:163], v[112:115]
ds_read_b64_tr_b16 a[200:201], v226 offset:0
ds_read_b64_tr_b16 a[202:203], v226 offset:4096
v_mfma_f32_16x16x32_bf16 v[136:139], a[244:247], v[172:175], v[136:139]
buffer_load_dwordx4 v240, s[32:35], s45 offen lds
v_mfma_f32_16x16x32_bf16 v[136:139], a[248:251], v[184:187], v[136:139]
ds_read_b64_tr_b16 a[204:205], v227 offset:0
v_xor_b32 v3, s93, v2
v_mfma_f32_16x16x32_bf16 v[136:139], a[252:255], v[196:199], v[136:139]
ds_read_b64_tr_b16 a[206:207], v227 offset:4096
v_add_u32 v3, s59, v3
v_mfma_f32_16x16x32_bf16 v[128:131], a[224:227], v[164:167], v[116:119]
ds_read_b64_tr_b16 a[208:209], v228 offset:0
v_mfma_f32_16x16x32_bf16 v[128:131], a[228:231], v[176:179], v[128:131]
ds_read_b64_tr_b16 a[210:211], v228 offset:4096
v_mfma_f32_16x16x32_bf16 v[128:131], a[232:235], v[188:191], v[128:131]
ds_read_b64_tr_b16 a[212:213], v229 offset:0
ds_read_b64_tr_b16 a[214:215], v229 offset:4096
v_mfma_f32_16x16x32_bf16 v[128:131], a[236:239], v[200:203], v[128:131]
buffer_load_dwordx4 v241, s[32:35], s45 offen offset:1024 lds
v_mfma_f32_16x16x32_bf16 v[140:143], a[240:243], v[164:167], v[116:119]
ds_read_b64_tr_b16 a[216:217], v230 offset:0
v_max3_f32 v244, v124, v125, v126
v_mfma_f32_16x16x32_bf16 v[140:143], a[244:247], v[176:179], v[140:143]
ds_read_b64_tr_b16 a[218:219], v230 offset:4096
v_max3_f32 v244, v244, v127, v136
v_mfma_f32_16x16x32_bf16 v[140:143], a[248:251], v[188:191], v[140:143]
ds_read_b64_tr_b16 a[220:221], v231 offset:0
v_max3_f32 v244, v244, v137, v138
v_mfma_f32_16x16x32_bf16 v[140:143], a[252:255], v[200:203], v[140:143]
ds_read_b64_tr_b16 a[222:223], v231 offset:4096
ds_read_b128 v[208:211], v3 offset:0
v_max_f32 v244, v244, v139
v_mfma_f32_16x16x32_bf16 v[132:135], a[224:227], v[168:171], v[120:123]
buffer_load_dwordx4 v242, s[32:35], s45 offen offset:2048 lds
v_mfma_f32_16x16x32_bf16 v[132:135], a[228:231], v[180:183], v[132:135]
ds_read_b128 v[212:215], v3 offset:4096
v_mfma_f32_16x16x32_bf16 v[132:135], a[232:235], v[192:195], v[132:135]
ds_read_b128 v[216:219], v3 offset:8192
v_mfma_f32_16x16x32_bf16 v[132:135], a[236:239], v[204:207], v[132:135]
v_max3_f32 v245, v128, v129, v130
v_max3_f32 v245, v245, v131, v140
v_mfma_f32_16x16x32_bf16 v[144:147], a[240:243], v[168:171], v[120:123]
v_max3_f32 v245, v245, v141, v142
v_max_f32 v245, v245, v143
v_mfma_f32_16x16x32_bf16 v[144:147], a[244:247], v[180:183], v[144:147]
buffer_load_dwordx4 v243, s[32:35], s45 offen offset:3072 lds
v_mfma_f32_16x16x32_bf16 v[144:147], a[248:251], v[192:195], v[144:147]
v_mfma_f32_16x16x32_bf16 v[144:147], a[252:255], v[204:207], v[144:147]
s_waitcnt vmcnt(8) lgkmcnt(0)
s_barrier
v_mfma_f32_16x16x32_bf16 a[0:3], a[192:195], v[208:211], a[0:3]
ds_read_b64_tr_b16 a[224:225], v224 offset:16384
s_add_u32 s44, s11, 114688
s_and_b32 s44, s44, 0x1ffff
v_mfma_f32_16x16x32_bf16 a[4:7], a[192:195], v[212:215], a[4:7]
ds_read_b64_tr_b16 a[226:227], v224 offset:20480
ds_read_b64_tr_b16 a[228:229], v225 offset:16384
s_add_u32 s44, s44, s49
v_mfma_f32_16x16x32_bf16 a[8:11], a[192:195], v[216:219], a[8:11]
s_add_u32 m0, s47, 0
s_nop 0
buffer_load_dwordx4 v236, s[16:19], s44 offen nt lds
v_mfma_f32_16x16x32_bf16 a[12:15], a[196:199], v[208:211], a[12:15]
ds_read_b64_tr_b16 a[230:231], v225 offset:20480
v_max3_f32 v246, v132, v133, v134
v_mfma_f32_16x16x32_bf16 a[16:19], a[196:199], v[212:215], a[16:19]
ds_read_b64_tr_b16 a[232:233], v226 offset:16384
v_max3_f32 v246, v246, v135, v144
v_mfma_f32_16x16x32_bf16 a[20:23], a[196:199], v[216:219], a[20:23]
v_max3_f32 v246, v246, v145, v146
v_max_f32 v246, v246, v147
v_mfma_f32_16x16x32_bf16 a[24:27], a[200:203], v[208:211], a[24:27]
v_max3_f32 v247, v244, v245, v246
v_cmp_lt_f32 vcc, s50, v247
s_cbranch_vccnz L_rs19
L_rb19:
v_mfma_f32_16x16x32_bf16 a[28:31], a[200:203], v[212:215], a[28:31]
v_exp_f32 v124, v124
v_mfma_f32_16x16x32_bf16 a[32:35], a[200:203], v[216:219], a[32:35]
buffer_load_dwordx4 v237, s[16:19], s44 offen offset:1024 nt lds
v_mfma_f32_16x16x32_bf16 a[36:39], a[204:207], v[208:211], a[36:39]
ds_read_b64_tr_b16 a[234:235], v226 offset:20480
v_exp_f32 v125, v125
v_mfma_f32_16x16x32_bf16 a[40:43], a[204:207], v[212:215], a[40:43]
ds_read_b64_tr_b16 a[236:237], v227 offset:16384
v_exp_f32 v126, v126
v_mfma_f32_16x16x32_bf16 a[44:47], a[204:207], v[216:219], a[44:47]
ds_read_b64_tr_b16 a[238:239], v227 offset:20480
v_exp_f32 v127, v127
v_mfma_f32_16x16x32_bf16 a[48:51], a[208:211], v[208:211], a[48:51]
ds_read_b64_tr_b16 a[240:241], v228 offset:16384
v_exp_f32 v136, v136
v_mfma_f32_16x16x32_bf16 a[52:55], a[208:211], v[212:215], a[52:55]
ds_read_b64_tr_b16 a[242:243], v228 offset:20480
v_exp_f32 v137, v137
v_mfma_f32_16x16x32_bf16 a[56:59], a[208:211], v[216:219], a[56:59]
buffer_load_dwordx4 v238, s[16:19], s44 offen offset:2048 nt lds
v_mfma_f32_16x16x32_bf16 a[60:63], a[212:215], v[208:211], a[60:63]
ds_read_b64_tr_b16 a[244:245], v229 offset:16384
v_exp_f32 v138, v138
v_mfma_f32_16x16x32_bf16 a[64:67], a[212:215], v[212:215], a[64:67]
ds_read_b64_tr_b16 a[246:247], v229 offset:20480
v_exp_f32 v139, v139
v_mfma_f32_16x16x32_bf16 a[68:71], a[212:215], v[216:219], a[68:71]
ds_read_b64_tr_b16 a[248:249], v230 offset:16384
v_cvt_pk_bf16_f32 v148, v124, v125
v_mfma_f32_16x16x32_bf16 a[72:75], a[216:219], v[208:211], a[72:75]
ds_read_b64_tr_b16 a[250:251], v230 offset:20480
v_cvt_pk_bf16_f32 v149, v126, v127
v_mfma_f32_16x16x32_bf16 a[76:79], a[216:219], v[212:215], a[76:79]
ds_read_b64_tr_b16 a[252:253], v231 offset:16384
ds_read_b64_tr_b16 a[254:255], v231 offset:20480
v_cvt_pk_bf16_f32 v150, v136, v137
v_mfma_f32_16x16x32_bf16 a[80:83], a[216:219], v[216:219], a[80:83]
buffer_load_dwordx4 v239, s[16:19], s44 offen offset:3072 nt lds
v_mfma_f32_16x16x32_bf16 a[84:87], a[220:223], v[208:211], a[84:87]
v_cvt_pk_bf16_f32 v151, v138, v139
v_exp_f32 v128, v128
v_mfma_f32_16x16x32_bf16 a[88:91], a[220:223], v[212:215], a[88:91]
v_exp_f32 v129, v129
v_exp_f32 v130, v130
v_mfma_f32_16x16x32_bf16 a[92:95], a[220:223], v[216:219], a[92:95]
v_exp_f32 v131, v131
s_waitcnt vmcnt(8) lgkmcnt(0)
s_barrier
v_mfma_f32_16x16x32_bf16 v[100:103], v[220:223], v[148:151], v[100:103]
s_add_u32 s44, s11, 122880
v_exp_f32 v140, v140
v_mfma_f32_16x16x32_bf16 v[4:7], a[224:227], v[148:151], v[4:7]
s_and_b32 s44, s44, 0x1ffff
v_exp_f32 v141, v141
v_mfma_f32_16x16x32_bf16 v[16:19], a[228:231], v[148:151], v[16:19]
s_add_u32 s44, s44, s49
v_exp_f32 v142, v142
v_mfma_f32_16x16x32_bf16 v[28:31], a[232:235], v[148:151], v[28:31]
s_add_u32 m0, s47, 16384
v_exp_f32 v143, v143
v_mfma_f32_16x16x32_bf16 v[40:43], a[236:239], v[148:151], v[40:43]
v_cvt_pk_bf16_f32 v152, v128, v129
v_cvt_pk_bf16_f32 v153, v130, v131
v_mfma_f32_16x16x32_bf16 v[52:55], a[240:243], v[148:151], v[52:55]
v_cvt_pk_bf16_f32 v154, v140, v141
v_cvt_pk_bf16_f32 v155, v142, v143
v_mfma_f32_16x16x32_bf16 v[64:67], a[244:247], v[148:151], v[64:67]
v_exp_f32 v132, v132
v_mfma_f32_16x16x32_bf16 v[76:79], a[248:251], v[148:151], v[76:79]
buffer_load_dwordx4 v236, s[12:15], s44 offen nt lds
v_mfma_f32_16x16x32_bf16 v[88:91], a[252:255], v[148:151], v[88:91]
v_exp_f32 v133, v133
v_mfma_f32_16x16x32_bf16 v[104:107], v[220:223], v[152:155], v[104:107]
v_exp_f32 v134, v134
v_mfma_f32_16x16x32_bf16 v[8:11], a[224:227], v[152:155], v[8:11]
v_exp_f32 v135, v135
v_mfma_f32_16x16x32_bf16 v[20:23], a[228:231], v[152:155], v[20:23]
v_exp_f32 v144, v144
v_mfma_f32_16x16x32_bf16 v[32:35], a[232:235], v[152:155], v[32:35]
buffer_load_dwordx4 v237, s[12:15], s44 offen offset:1024 nt lds
v_mfma_f32_16x16x32_bf16 v[44:47], a[236:239], v[152:155], v[44:47]
v_exp_f32 v145, v145
v_mfma_f32_16x16x32_bf16 v[56:59], a[240:243], v[152:155], v[56:59]
v_exp_f32 v146, v146
v_mfma_f32_16x16x32_bf16 v[68:71], a[244:247], v[152:155], v[68:71]
ds_read_b128 a[192:195], v232 offset:32768
v_exp_f32 v147, v147
v_mfma_f32_16x16x32_bf16 v[80:83], a[248:251], v[152:155], v[80:83]
ds_read_b128 a[196:199], v233 offset:32768
v_cvt_pk_bf16_f32 v156, v132, v133
v_cvt_pk_bf16_f32 v157, v134, v135
v_mfma_f32_16x16x32_bf16 v[92:95], a[252:255], v[152:155], v[92:95]
ds_read_b128 a[200:203], v234 offset:32768
v_cvt_pk_bf16_f32 v158, v144, v145
v_cvt_pk_bf16_f32 v159, v146, v147
s_nop 1
v_mfma_f32_16x16x32_bf16 v[108:111], v[220:223], v[156:159], v[108:111]
ds_read_b128 a[204:207], v235 offset:32768
ds_read_b128 a[208:211], v232 offset:36864
v_mfma_f32_16x16x32_bf16 v[12:15], a[224:227], v[156:159], v[12:15]
ds_read_b128 a[212:215], v233 offset:36864
v_mfma_f32_16x16x32_bf16 v[24:27], a[228:231], v[156:159], v[24:27]
buffer_load_dwordx4 v238, s[12:15], s44 offen offset:2048 nt lds
v_mfma_f32_16x16x32_bf16 v[36:39], a[232:235], v[156:159], v[36:39]
ds_read_b128 a[216:219], v234 offset:36864
ds_read_b128 a[220:223], v235 offset:36864
v_mfma_f32_16x16x32_bf16 v[48:51], a[236:239], v[156:159], v[48:51]
v_mfma_f32_16x16x32_bf16 v[60:63], a[240:243], v[156:159], v[60:63]
v_mfma_f32_16x16x32_bf16 v[72:75], a[244:247], v[156:159], v[72:75]
buffer_load_dwordx4 v239, s[12:15], s44 offen offset:3072 nt lds
v_mfma_f32_16x16x32_bf16 v[84:87], a[248:251], v[156:159], v[84:87]
v_mfma_f32_16x16x32_bf16 v[96:99], a[252:255], v[156:159], v[96:99]
s_waitcnt vmcnt(8) lgkmcnt(0)
s_barrier
v_mfma_f32_16x16x32_bf16 v[124:127], a[192:195], v[160:163], v[112:115]
ds_read_b64_tr_b16 a[224:225], v224 offset:49152
s_add_u32 s45, s58, s99
s_add_u32 m0, s47, 32768
v_mfma_f32_16x16x32_bf16 v[124:127], a[196:199], v[172:175], v[124:127]
ds_read_b64_tr_b16 a[226:227], v224 offset:53248
v_mfma_f32_16x16x32_bf16 v[124:127], a[200:203], v[184:187], v[124:127]
ds_read_b64_tr_b16 a[228:229], v225 offset:49152
v_mfma_f32_16x16x32_bf16 v[124:127], a[204:207], v[196:199], v[124:127]
ds_read_b64_tr_b16 a[230:231], v225 offset:53248
v_mfma_f32_16x16x32_bf16 v[136:139], a[208:211], v[160:163], v[112:115]
ds_read_b64_tr_b16 a[232:233], v226 offset:49152
ds_read_b64_tr_b16 a[234:235], v226 offset:53248
v_mfma_f32_16x16x32_bf16 v[136:139], a[212:215], v[172:175], v[136:139]
buffer_load_dwordx4 v240, s[32:35], s45 offen lds
v_mfma_f32_16x16x32_bf16 v[136:139], a[216:219], v[184:187], v[136:139]
ds_read_b64_tr_b16 a[236:237], v227 offset:49152
v_xor_b32 v3, s94, v2
v_mfma_f32_16x16x32_bf16 v[136:139], a[220:223], v[196:199], v[136:139]
ds_read_b64_tr_b16 a[238:239], v227 offset:53248
v_add_u32 v3, s59, v3
v_mfma_f32_16x16x32_bf16 v[128:131], a[192:195], v[164:167], v[116:119]
ds_read_b64_tr_b16 a[240:241], v228 offset:49152
v_mfma_f32_16x16x32_bf16 v[128:131], a[196:199], v[176:179], v[128:131]
ds_read_b64_tr_b16 a[242:243], v228 offset:53248
v_mfma_f32_16x16x32_bf16 v[128:131], a[200:203], v[188:191], v[128:131]
ds_read_b64_tr_b16 a[244:245], v229 offset:49152
ds_read_b64_tr_b16 a[246:247], v229 offset:53248
v_mfma_f32_16x16x32_bf16 v[128:131], a[204:207], v[200:203], v[128:131]
buffer_load_dwordx4 v241, s[32:35], s45 offen offset:1024 lds
v_mfma_f32_16x16x32_bf16 v[140:143], a[208:211], v[164:167], v[116:119]
ds_read_b64_tr_b16 a[248:249], v230 offset:49152
v_max3_f32 v244, v124, v125, v126
v_mfma_f32_16x16x32_bf16 v[140:143], a[212:215], v[176:179], v[140:143]
ds_read_b64_tr_b16 a[250:251], v230 offset:53248
v_max3_f32 v244, v244, v127, v136
v_mfma_f32_16x16x32_bf16 v[140:143], a[216:219], v[188:191], v[140:143]
ds_read_b64_tr_b16 a[252:253], v231 offset:49152
v_max3_f32 v244, v244, v137, v138
v_mfma_f32_16x16x32_bf16 v[140:143], a[220:223], v[200:203], v[140:143]
ds_read_b64_tr_b16 a[254:255], v231 offset:53248
ds_read_b128 v[208:211], v3 offset:0
v_max_f32 v244, v244, v139
v_mfma_f32_16x16x32_bf16 v[132:135], a[192:195], v[168:171], v[120:123]
buffer_load_dwordx4 v242, s[32:35], s45 offen offset:2048 lds
v_mfma_f32_16x16x32_bf16 v[132:135], a[196:199], v[180:183], v[132:135]
ds_read_b128 v[212:215], v3 offset:4096
v_mfma_f32_16x16x32_bf16 v[132:135], a[200:203], v[192:195], v[132:135]
ds_read_b128 v[216:219], v3 offset:8192
v_mfma_f32_16x16x32_bf16 v[132:135], a[204:207], v[204:207], v[132:135]
v_max3_f32 v245, v128, v129, v130
v_max3_f32 v245, v245, v131, v140
v_mfma_f32_16x16x32_bf16 v[144:147], a[208:211], v[168:171], v[120:123]
v_max3_f32 v245, v245, v141, v142
v_max_f32 v245, v245, v143
v_mfma_f32_16x16x32_bf16 v[144:147], a[212:215], v[180:183], v[144:147]
buffer_load_dwordx4 v243, s[32:35], s45 offen offset:3072 lds
v_mfma_f32_16x16x32_bf16 v[144:147], a[216:219], v[192:195], v[144:147]
v_mfma_f32_16x16x32_bf16 v[144:147], a[220:223], v[204:207], v[144:147]
s_waitcnt vmcnt(8) lgkmcnt(0)
s_barrier
v_mfma_f32_16x16x32_bf16 a[0:3], a[224:227], v[208:211], a[0:3]
ds_read_b64_tr_b16 a[192:193], v224 offset:0
s_add_u32 s44, s11, 122880
s_and_b32 s44, s44, 0x1ffff
v_mfma_f32_16x16x32_bf16 a[4:7], a[224:227], v[212:215], a[4:7]
ds_read_b64_tr_b16 a[194:195], v224 offset:4096
ds_read_b64_tr_b16 a[196:197], v225 offset:0
s_add_u32 s44, s44, s49
v_mfma_f32_16x16x32_bf16 a[8:11], a[224:227], v[216:219], a[8:11]
s_add_u32 m0, s47, 49152
s_nop 0
buffer_load_dwordx4 v236, s[16:19], s44 offen nt lds
v_mfma_f32_16x16x32_bf16 a[12:15], a[228:231], v[208:211], a[12:15]
ds_read_b64_tr_b16 a[198:199], v225 offset:4096
v_max3_f32 v246, v132, v133, v134
v_mfma_f32_16x16x32_bf16 a[16:19], a[228:231], v[212:215], a[16:19]
ds_read_b64_tr_b16 a[200:201], v226 offset:0
v_max3_f32 v246, v246, v135, v144
v_mfma_f32_16x16x32_bf16 a[20:23], a[228:231], v[216:219], a[20:23]
v_max3_f32 v246, v246, v145, v146
v_max_f32 v246, v246, v147
v_mfma_f32_16x16x32_bf16 a[24:27], a[232:235], v[208:211], a[24:27]
v_max3_f32 v247, v244, v245, v246
v_cmp_lt_f32 vcc, s50, v247
s_cbranch_vccnz L_rs20
L_rb20:
v_mfma_f32_16x16x32_bf16 a[28:31], a[232:235], v[212:215], a[28:31]
v_exp_f32 v124, v124
v_mfma_f32_16x16x32_bf16 a[32:35], a[232:235], v[216:219], a[32:35]
buffer_load_dwordx4 v237, s[16:19], s44 offen offset:1024 nt lds
v_mfma_f32_16x16x32_bf16 a[36:39], a[236:239], v[208:211], a[36:39]
ds_read_b64_tr_b16 a[202:203], v226 offset:4096
v_exp_f32 v125, v125
v_mfma_f32_16x16x32_bf16 a[40:43], a[236:239], v[212:215], a[40:43]
ds_read_b64_tr_b16 a[204:205], v227 offset:0
v_exp_f32 v126, v126
v_mfma_f32_16x16x32_bf16 a[44:47], a[236:239], v[216:219], a[44:47]
ds_read_b64_tr_b16 a[206:207], v227 offset:4096
v_exp_f32 v127, v127
v_mfma_f32_16x16x32_bf16 a[48:51], a[240:243], v[208:211], a[48:51]
ds_read_b64_tr_b16 a[208:209], v228 offset:0
v_exp_f32 v136, v136
v_mfma_f32_16x16x32_bf16 a[52:55], a[240:243], v[212:215], a[52:55]
ds_read_b64_tr_b16 a[210:211], v228 offset:4096
v_exp_f32 v137, v137
v_mfma_f32_16x16x32_bf16 a[56:59], a[240:243], v[216:219], a[56:59]
buffer_load_dwordx4 v238, s[16:19], s44 offen offset:2048 nt lds
v_mfma_f32_16x16x32_bf16 a[60:63], a[244:247], v[208:211], a[60:63]
ds_read_b64_tr_b16 a[212:213], v229 offset:0
v_exp_f32 v138, v138
v_mfma_f32_16x16x32_bf16 a[64:67], a[244:247], v[212:215], a[64:67]
ds_read_b64_tr_b16 a[214:215], v229 offset:4096
v_exp_f32 v139, v139
v_mfma_f32_16x16x32_bf16 a[68:71], a[244:247], v[216:219], a[68:71]
ds_read_b64_tr_b16 a[216:217], v230 offset:0
v_cvt_pk_bf16_f32 v148, v124, v125
v_mfma_f32_16x16x32_bf16 a[72:75], a[248:251], v[208:211], a[72:75]
ds_read_b64_tr_b16 a[218:219], v230 offset:4096
v_cvt_pk_bf16_f32 v149, v126, v127
v_mfma_f32_16x16x32_bf16 a[76:79], a[248:251], v[212:215], a[76:79]
ds_read_b64_tr_b16 a[220:221], v231 offset:0
ds_read_b64_tr_b16 a[222:223], v231 offset:4096
v_cvt_pk_bf16_f32 v150, v136, v137
v_mfma_f32_16x16x32_bf16 a[80:83], a[248:251], v[216:219], a[80:83]
buffer_load_dwordx4 v239, s[16:19], s44 offen offset:3072 nt lds
v_mfma_f32_16x16x32_bf16 a[84:87], a[252:255], v[208:211], a[84:87]
v_cvt_pk_bf16_f32 v151, v138, v139
v_exp_f32 v128, v128
v_mfma_f32_16x16x32_bf16 a[88:91], a[252:255], v[212:215], a[88:91]
v_exp_f32 v129, v129
v_exp_f32 v130, v130
v_mfma_f32_16x16x32_bf16 a[92:95], a[252:255], v[216:219], a[92:95]
v_exp_f32 v131, v131
s_waitcnt vmcnt(8) lgkmcnt(0)
s_barrier
v_mfma_f32_16x16x32_bf16 v[100:103], v[220:223], v[148:151], v[100:103]
s_add_u32 s49, s49, 131072
v_exp_f32 v140, v140
v_mfma_f32_16x16x32_bf16 v[4:7], a[192:195], v[148:151], v[4:7]
s_add_u32 s44, s11, 0
v_exp_f32 v141, v141
v_mfma_f32_16x16x32_bf16 v[16:19], a[196:199], v[148:151], v[16:19]
s_and_b32 s44, s44, 0x1ffff
v_exp_f32 v142, v142
v_mfma_f32_16x16x32_bf16 v[28:31], a[200:203], v[148:151], v[28:31]
s_add_u32 s44, s44, s49
v_exp_f32 v143, v143
v_mfma_f32_16x16x32_bf16 v[40:43], a[204:207], v[148:151], v[40:43]
s_add_u32 m0, s47, 0
v_cvt_pk_bf16_f32 v152, v128, v129
v_cvt_pk_bf16_f32 v153, v130, v131
v_mfma_f32_16x16x32_bf16 v[52:55], a[208:211], v[148:151], v[52:55]
v_cvt_pk_bf16_f32 v154, v140, v141
v_cvt_pk_bf16_f32 v155, v142, v143
v_mfma_f32_16x16x32_bf16 v[64:67], a[212:215], v[148:151], v[64:67]
v_exp_f32 v132, v132
v_mfma_f32_16x16x32_bf16 v[76:79], a[216:219], v[148:151], v[76:79]
buffer_load_dwordx4 v236, s[12:15], s44 offen nt lds
v_mfma_f32_16x16x32_bf16 v[88:91], a[220:223], v[148:151], v[88:91]
v_exp_f32 v133, v133
v_mfma_f32_16x16x32_bf16 v[104:107], v[220:223], v[152:155], v[104:107]
v_exp_f32 v134, v134
v_mfma_f32_16x16x32_bf16 v[8:11], a[192:195], v[152:155], v[8:11]
v_exp_f32 v135, v135
v_mfma_f32_16x16x32_bf16 v[20:23], a[196:199], v[152:155], v[20:23]
v_exp_f32 v144, v144
v_mfma_f32_16x16x32_bf16 v[32:35], a[200:203], v[152:155], v[32:35]
buffer_load_dwordx4 v237, s[12:15], s44 offen offset:1024 nt lds
v_mfma_f32_16x16x32_bf16 v[44:47], a[204:207], v[152:155], v[44:47]
v_exp_f32 v145, v145
v_mfma_f32_16x16x32_bf16 v[56:59], a[208:211], v[152:155], v[56:59]
v_exp_f32 v146, v146
v_mfma_f32_16x16x32_bf16 v[68:71], a[212:215], v[152:155], v[68:71]
ds_read_b128 a[224:227], v232 offset:16384
v_exp_f32 v147, v147
v_mfma_f32_16x16x32_bf16 v[80:83], a[216:219], v[152:155], v[80:83]
ds_read_b128 a[228:231], v233 offset:16384
v_cvt_pk_bf16_f32 v156, v132, v133
v_cvt_pk_bf16_f32 v157, v134, v135
v_mfma_f32_16x16x32_bf16 v[92:95], a[220:223], v[152:155], v[92:95]
ds_read_b128 a[232:235], v234 offset:16384
v_cvt_pk_bf16_f32 v158, v144, v145
v_cvt_pk_bf16_f32 v159, v146, v147
s_nop 1
v_mfma_f32_16x16x32_bf16 v[108:111], v[220:223], v[156:159], v[108:111]
ds_read_b128 a[236:239], v235 offset:16384
ds_read_b128 a[240:243], v232 offset:20480
v_mfma_f32_16x16x32_bf16 v[12:15], a[192:195], v[156:159], v[12:15]
ds_read_b128 a[244:247], v233 offset:20480
v_mfma_f32_16x16x32_bf16 v[24:27], a[196:199], v[156:159], v[24:27]
buffer_load_dwordx4 v238, s[12:15], s44 offen offset:2048 nt lds
v_mfma_f32_16x16x32_bf16 v[36:39], a[200:203], v[156:159], v[36:39]
ds_read_b128 a[248:251], v234 offset:20480
ds_read_b128 a[252:255], v235 offset:20480
v_mfma_f32_16x16x32_bf16 v[48:51], a[204:207], v[156:159], v[48:51]
v_mfma_f32_16x16x32_bf16 v[60:63], a[208:211], v[156:159], v[60:63]
v_mfma_f32_16x16x32_bf16 v[72:75], a[212:215], v[156:159], v[72:75]
buffer_load_dwordx4 v239, s[12:15], s44 offen offset:3072 nt lds
v_mfma_f32_16x16x32_bf16 v[84:87], a[216:219], v[156:159], v[84:87]
v_mfma_f32_16x16x32_bf16 v[96:99], a[220:223], v[156:159], v[96:99]
s_waitcnt vmcnt(8) lgkmcnt(0)
s_barrier
v_mfma_f32_16x16x32_bf16 v[124:127], a[224:227], v[160:163], v[112:115]
ds_read_b64_tr_b16 a[192:193], v224 offset:32768
s_add_u32 s44, s11, 0
s_and_b32 s44, s44, 0x1ffff
v_mfma_f32_16x16x32_bf16 v[124:127], a[228:231], v[172:175], v[124:127]
ds_read_b64_tr_b16 a[194:195], v224 offset:36864
s_add_u32 s44, s44, s49
s_add_u32 m0, s47, 16384
v_mfma_f32_16x16x32_bf16 v[124:127], a[232:235], v[184:187], v[124:127]
ds_read_b64_tr_b16 a[196:197], v225 offset:32768
v_mfma_f32_16x16x32_bf16 v[124:127], a[236:239], v[196:199], v[124:127]
ds_read_b64_tr_b16 a[198:199], v225 offset:36864
v_mfma_f32_16x16x32_bf16 v[136:139], a[240:243], v[160:163], v[112:115]
ds_read_b64_tr_b16 a[200:201], v226 offset:32768
ds_read_b64_tr_b16 a[202:203], v226 offset:36864
v_mfma_f32_16x16x32_bf16 v[136:139], a[244:247], v[172:175], v[136:139]
buffer_load_dwordx4 v236, s[16:19], s44 offen nt lds
v_mfma_f32_16x16x32_bf16 v[136:139], a[248:251], v[184:187], v[136:139]
ds_read_b64_tr_b16 a[204:205], v227 offset:32768
v_xor_b32 v3, s95, v2
v_mfma_f32_16x16x32_bf16 v[136:139], a[252:255], v[196:199], v[136:139]
ds_read_b64_tr_b16 a[206:207], v227 offset:36864
v_add_u32 v3, s59, v3
v_mfma_f32_16x16x32_bf16 v[128:131], a[224:227], v[164:167], v[116:119]
ds_read_b64_tr_b16 a[208:209], v228 offset:32768
v_mfma_f32_16x16x32_bf16 v[128:131], a[228:231], v[176:179], v[128:131]
ds_read_b64_tr_b16 a[210:211], v228 offset:36864
v_mfma_f32_16x16x32_bf16 v[128:131], a[232:235], v[188:191], v[128:131]
ds_read_b64_tr_b16 a[212:213], v229 offset:32768
ds_read_b64_tr_b16 a[214:215], v229 offset:36864
v_mfma_f32_16x16x32_bf16 v[128:131], a[236:239], v[200:203], v[128:131]
buffer_load_dwordx4 v237, s[16:19], s44 offen offset:1024 nt lds
v_mfma_f32_16x16x32_bf16 v[140:143], a[240:243], v[164:167], v[116:119]
ds_read_b64_tr_b16 a[216:217], v230 offset:32768
v_max3_f32 v244, v124, v125, v126
v_mfma_f32_16x16x32_bf16 v[140:143], a[244:247], v[176:179], v[140:143]
ds_read_b64_tr_b16 a[218:219], v230 offset:36864
v_max3_f32 v244, v244, v127, v136
v_mfma_f32_16x16x32_bf16 v[140:143], a[248:251], v[188:191], v[140:143]
ds_read_b64_tr_b16 a[220:221], v231 offset:32768
v_max3_f32 v244, v244, v137, v138
v_mfma_f32_16x16x32_bf16 v[140:143], a[252:255], v[200:203], v[140:143]
ds_read_b64_tr_b16 a[222:223], v231 offset:36864
ds_read_b128 v[208:211], v3 offset:0
v_max_f32 v244, v244, v139
v_mfma_f32_16x16x32_bf16 v[132:135], a[224:227], v[168:171], v[120:123]
buffer_load_dwordx4 v238, s[16:19], s44 offen offset:2048 nt lds
v_mfma_f32_16x16x32_bf16 v[132:135], a[228:231], v[180:183], v[132:135]
ds_read_b128 v[212:215], v3 offset:4096
v_mfma_f32_16x16x32_bf16 v[132:135], a[232:235], v[192:195], v[132:135]
ds_read_b128 v[216:219], v3 offset:8192
v_mfma_f32_16x16x32_bf16 v[132:135], a[236:239], v[204:207], v[132:135]
v_max3_f32 v245, v128, v129, v130
v_max3_f32 v245, v245, v131, v140
v_mfma_f32_16x16x32_bf16 v[144:147], a[240:243], v[168:171], v[120:123]
v_max3_f32 v245, v245, v141, v142
v_max_f32 v245, v245, v143
v_mfma_f32_16x16x32_bf16 v[144:147], a[244:247], v[180:183], v[144:147]
buffer_load_dwordx4 v239, s[16:19], s44 offen offset:3072 nt lds
v_mfma_f32_16x16x32_bf16 v[144:147], a[248:251], v[192:195], v[144:147]
v_mfma_f32_16x16x32_bf16 v[144:147], a[252:255], v[204:207], v[144:147]
s_waitcnt vmcnt(8) lgkmcnt(0)
s_barrier
v_mfma_f32_16x16x32_bf16 a[0:3], a[192:195], v[208:211], a[0:3]
ds_read_b64_tr_b16 a[224:225], v224 offset:49152
s_add_u32 s44, s11, 8192
s_and_b32 s44, s44, 0x1ffff
v_mfma_f32_16x16x32_bf16 a[4:7], a[192:195], v[212:215], a[4:7]
ds_read_b64_tr_b16 a[226:227], v224 offset:53248
ds_read_b64_tr_b16 a[228:229], v225 offset:49152
s_add_u32 s44, s44, s49
v_mfma_f32_16x16x32_bf16 a[8:11], a[192:195], v[216:219], a[8:11]
s_add_u32 m0, s47, 32768
s_nop 0
buffer_load_dwordx4 v236, s[12:15], s44 offen nt lds
v_mfma_f32_16x16x32_bf16 a[12:15], a[196:199], v[208:211], a[12:15]
ds_read_b64_tr_b16 a[230:231], v225 offset:53248
v_max3_f32 v246, v132, v133, v134
v_mfma_f32_16x16x32_bf16 a[16:19], a[196:199], v[212:215], a[16:19]
ds_read_b64_tr_b16 a[232:233], v226 offset:49152
v_max3_f32 v246, v246, v135, v144
v_mfma_f32_16x16x32_bf16 a[20:23], a[196:199], v[216:219], a[20:23]
v_max3_f32 v246, v246, v145, v146
v_max_f32 v246, v246, v147
v_mfma_f32_16x16x32_bf16 a[24:27], a[200:203], v[208:211], a[24:27]
v_max3_f32 v247, v244, v245, v246
v_cmp_lt_f32 vcc, s50, v247
s_cbranch_vccnz L_rs21
L_rb21:
v_mfma_f32_16x16x32_bf16 a[28:31], a[200:203], v[212:215], a[28:31]
v_exp_f32 v124, v124
v_mfma_f32_16x16x32_bf16 a[32:35], a[200:203], v[216:219], a[32:35]
buffer_load_dwordx4 v237, s[12:15], s44 offen offset:1024 nt lds
v_mfma_f32_16x16x32_bf16 a[36:39], a[204:207], v[208:211], a[36:39]
ds_read_b64_tr_b16 a[234:235], v226 offset:53248
v_exp_f32 v125, v125
v_mfma_f32_16x16x32_bf16 a[40:43], a[204:207], v[212:215], a[40:43]
ds_read_b64_tr_b16 a[236:237], v227 offset:49152
v_exp_f32 v126, v126
v_mfma_f32_16x16x32_bf16 a[44:47], a[204:207], v[216:219], a[44:47]
ds_read_b64_tr_b16 a[238:239], v227 offset:53248
v_exp_f32 v127, v127
v_mfma_f32_16x16x32_bf16 a[48:51], a[208:211], v[208:211], a[48:51]
ds_read_b64_tr_b16 a[240:241], v228 offset:49152
v_exp_f32 v136, v136
v_mfma_f32_16x16x32_bf16 a[52:55], a[208:211], v[212:215], a[52:55]
ds_read_b64_tr_b16 a[242:243], v228 offset:53248
v_exp_f32 v137, v137
v_mfma_f32_16x16x32_bf16 a[56:59], a[208:211], v[216:219], a[56:59]
buffer_load_dwordx4 v238, s[12:15], s44 offen offset:2048 nt lds
v_mfma_f32_16x16x32_bf16 a[60:63], a[212:215], v[208:211], a[60:63]
ds_read_b64_tr_b16 a[244:245], v229 offset:49152
v_exp_f32 v138, v138
v_mfma_f32_16x16x32_bf16 a[64:67], a[212:215], v[212:215], a[64:67]
ds_read_b64_tr_b16 a[246:247], v229 offset:53248
v_exp_f32 v139, v139
v_mfma_f32_16x16x32_bf16 a[68:71], a[212:215], v[216:219], a[68:71]
ds_read_b64_tr_b16 a[248:249], v230 offset:49152
v_cvt_pk_bf16_f32 v148, v124, v125
v_mfma_f32_16x16x32_bf16 a[72:75], a[216:219], v[208:211], a[72:75]
ds_read_b64_tr_b16 a[250:251], v230 offset:53248
v_cvt_pk_bf16_f32 v149, v126, v127
v_mfma_f32_16x16x32_bf16 a[76:79], a[216:219], v[212:215], a[76:79]
ds_read_b64_tr_b16 a[252:253], v231 offset:49152
ds_read_b64_tr_b16 a[254:255], v231 offset:53248
v_cvt_pk_bf16_f32 v150, v136, v137
v_mfma_f32_16x16x32_bf16 a[80:83], a[216:219], v[216:219], a[80:83]
buffer_load_dwordx4 v239, s[12:15], s44 offen offset:3072 nt lds
v_mfma_f32_16x16x32_bf16 a[84:87], a[220:223], v[208:211], a[84:87]
v_cvt_pk_bf16_f32 v151, v138, v139
v_exp_f32 v128, v128
v_mfma_f32_16x16x32_bf16 a[88:91], a[220:223], v[212:215], a[88:91]
v_exp_f32 v129, v129
v_exp_f32 v130, v130
v_mfma_f32_16x16x32_bf16 a[92:95], a[220:223], v[216:219], a[92:95]
v_exp_f32 v131, v131
s_nop 6
s_mov_b32 s55, 0x3e0293ee
v_accvgpr_read_b32 v160, a0
v_accvgpr_read_b32 v161, a1
v_accvgpr_read_b32 v162, a2
v_accvgpr_read_b32 v163, a3
v_accvgpr_read_b32 v208, a12
v_accvgpr_read_b32 v209, a13
v_accvgpr_read_b32 v210, a14
v_accvgpr_read_b32 v211, a15
v_mul_f32 v160, s55, v160
v_mul_f32 v161, s55, v161
v_mul_f32 v162, s55, v162
v_mul_f32 v163, s55, v163
v_mul_f32 v208, s55, v208
v_mul_f32 v209, s55, v209
v_mul_f32 v210, s55, v210
v_mul_f32 v211, s55, v211
v_cvt_pk_bf16_f32 v160, v160, v161
v_cvt_pk_bf16_f32 v161, v162, v163
v_cvt_pk_bf16_f32 v162, v208, v209
v_cvt_pk_bf16_f32 v163, v210, v211
v_accvgpr_read_b32 v172, a24
v_accvgpr_read_b32 v173, a25
v_accvgpr_read_b32 v174, a26
v_accvgpr_read_b32 v175, a27
v_accvgpr_read_b32 v212, a36
v_accvgpr_read_b32 v213, a37
v_accvgpr_read_b32 v214, a38
v_accvgpr_read_b32 v215, a39
v_mul_f32 v172, s55, v172
v_mul_f32 v173, s55, v173
v_permlane32_swap_b32 v160, v162
v_permlane32_swap_b32 v161, v163
v_mul_f32 v174, s55, v174
v_mul_f32 v175, s55, v175
v_mul_f32 v212, s55, v212
v_mul_f32 v213, s55, v213
v_mul_f32 v214, s55, v214
v_mul_f32 v215, s55, v215
v_cvt_pk_bf16_f32 v172, v172, v173
v_cvt_pk_bf16_f32 v173, v174, v175
v_cvt_pk_bf16_f32 v174, v212, v213
v_cvt_pk_bf16_f32 v175, v214, v215
v_permlane16_swap_b32 v160, v162
v_permlane16_swap_b32 v161, v163
v_accvgpr_read_b32 v184, a48
v_accvgpr_read_b32 v185, a49
v_accvgpr_read_b32 v186, a50
v_accvgpr_read_b32 v187, a51
v_accvgpr_read_b32 v216, a60
v_accvgpr_read_b32 v217, a61
v_accvgpr_read_b32 v218, a62
v_accvgpr_read_b32 v219, a63
v_mul_f32 v184, s55, v184
v_mul_f32 v185, s55, v185
v_permlane32_swap_b32 v172, v174
v_permlane32_swap_b32 v173, v175
v_mul_f32 v186, s55, v186
v_mul_f32 v187, s55, v187
v_mul_f32 v216, s55, v216
v_mul_f32 v217, s55, v217
v_mul_f32 v218, s55, v218
v_mul_f32 v219, s55, v219
v_cvt_pk_bf16_f32 v184, v184, v185
v_cvt_pk_bf16_f32 v185, v186, v187
v_cvt_pk_bf16_f32 v186, v216, v217
v_cvt_pk_bf16_f32 v187, v218, v219
v_permlane16_swap_b32 v172, v174
v_permlane16_swap_b32 v173, v175
v_accvgpr_read_b32 v196, a72
v_accvgpr_read_b32 v197, a73
v_accvgpr_read_b32 v198, a74
v_accvgpr_read_b32 v199, a75
v_accvgpr_read_b32 v208, a84
v_accvgpr_read_b32 v209, a85
v_accvgpr_read_b32 v210, a86
v_accvgpr_read_b32 v211, a87
v_mul_f32 v196, s55, v196
v_mul_f32 v197, s55, v197
v_permlane32_swap_b32 v184, v186
v_permlane32_swap_b32 v185, v187
v_mul_f32 v198, s55, v198
v_mul_f32 v199, s55, v199
v_mul_f32 v208, s55, v208
v_mul_f32 v209, s55, v209
v_mul_f32 v210, s55, v210
v_mul_f32 v211, s55, v211
v_cvt_pk_bf16_f32 v196, v196, v197
v_cvt_pk_bf16_f32 v197, v198, v199
v_cvt_pk_bf16_f32 v198, v208, v209
v_cvt_pk_bf16_f32 v199, v210, v211
v_permlane16_swap_b32 v184, v186
v_permlane16_swap_b32 v185, v187
v_accvgpr_read_b32 v164, a4
v_accvgpr_read_b32 v165, a5
v_accvgpr_read_b32 v166, a6
v_accvgpr_read_b32 v167, a7
v_accvgpr_read_b32 v212, a16
v_accvgpr_read_b32 v213, a17
v_accvgpr_read_b32 v214, a18
v_accvgpr_read_b32 v215, a19
v_mul_f32 v164, s55, v164
v_mul_f32 v165, s55, v165
v_permlane32_swap_b32 v196, v198
v_permlane32_swap_b32 v197, v199
v_mul_f32 v166, s55, v166
v_mul_f32 v167, s55, v167
v_mul_f32 v212, s55, v212
v_mul_f32 v213, s55, v213
v_mul_f32 v214, s55, v214
v_mul_f32 v215, s55, v215
v_cvt_pk_bf16_f32 v164, v164, v165
v_cvt_pk_bf16_f32 v165, v166, v167
v_cvt_pk_bf16_f32 v166, v212, v213
v_cvt_pk_bf16_f32 v167, v214, v215
v_permlane16_swap_b32 v196, v198
v_permlane16_swap_b32 v197, v199
v_accvgpr_read_b32 v176, a28
v_accvgpr_read_b32 v177, a29
v_accvgpr_read_b32 v178, a30
v_accvgpr_read_b32 v179, a31
v_accvgpr_read_b32 v216, a40
v_accvgpr_read_b32 v217, a41
v_accvgpr_read_b32 v218, a42
v_accvgpr_read_b32 v219, a43
v_mul_f32 v176, s55, v176
v_mul_f32 v177, s55, v177
v_permlane32_swap_b32 v164, v166
v_permlane32_swap_b32 v165, v167
v_mul_f32 v178, s55, v178
v_mul_f32 v179, s55, v179
v_mul_f32 v216, s55, v216
v_mul_f32 v217, s55, v217
v_mul_f32 v218, s55, v218
v_mul_f32 v219, s55, v219
v_cvt_pk_bf16_f32 v176, v176, v177
v_cvt_pk_bf16_f32 v177, v178, v179
v_cvt_pk_bf16_f32 v178, v216, v217
v_cvt_pk_bf16_f32 v179, v218, v219
v_permlane16_swap_b32 v164, v166
v_permlane16_swap_b32 v165, v167
v_accvgpr_read_b32 v188, a52
v_accvgpr_read_b32 v189, a53
v_accvgpr_read_b32 v190, a54
v_accvgpr_read_b32 v191, a55
v_accvgpr_read_b32 v208, a64
v_accvgpr_read_b32 v209, a65
v_accvgpr_read_b32 v210, a66
v_accvgpr_read_b32 v211, a67
v_mul_f32 v188, s55, v188
v_mul_f32 v189, s55, v189
v_permlane32_swap_b32 v176, v178
v_permlane32_swap_b32 v177, v179
v_mul_f32 v190, s55, v190
v_mul_f32 v191, s55, v191
v_mul_f32 v208, s55, v208
v_mul_f32 v209, s55, v209
v_mul_f32 v210, s55, v210
v_mul_f32 v211, s55, v211
v_cvt_pk_bf16_f32 v188, v188, v189
v_cvt_pk_bf16_f32 v189, v190, v191
v_cvt_pk_bf16_f32 v190, v208, v209
v_cvt_pk_bf16_f32 v191, v210, v211
v_permlane16_swap_b32 v176, v178
v_permlane16_swap_b32 v177, v179
v_accvgpr_read_b32 v200, a76
v_accvgpr_read_b32 v201, a77
v_accvgpr_read_b32 v202, a78
v_accvgpr_read_b32 v203, a79
v_accvgpr_read_b32 v212, a88
v_accvgpr_read_b32 v213, a89
v_accvgpr_read_b32 v214, a90
v_accvgpr_read_b32 v215, a91
v_mul_f32 v200, s55, v200
v_mul_f32 v201, s55, v201
v_permlane32_swap_b32 v188, v190
v_permlane32_swap_b32 v189, v191
v_mul_f32 v202, s55, v202
v_mul_f32 v203, s55, v203
v_mul_f32 v212, s55, v212
v_mul_f32 v213, s55, v213
v_mul_f32 v214, s55, v214
v_mul_f32 v215, s55, v215
v_cvt_pk_bf16_f32 v200, v200, v201
v_cvt_pk_bf16_f32 v201, v202, v203
v_cvt_pk_bf16_f32 v202, v212, v213
v_cvt_pk_bf16_f32 v203, v214, v215
v_permlane16_swap_b32 v188, v190
v_permlane16_swap_b32 v189, v191
v_accvgpr_read_b32 v168, a8
v_accvgpr_read_b32 v169, a9
v_accvgpr_read_b32 v170, a10
v_accvgpr_read_b32 v171, a11
v_accvgpr_read_b32 v216, a20
v_accvgpr_read_b32 v217, a21
v_accvgpr_read_b32 v218, a22
v_accvgpr_read_b32 v219, a23
v_mul_f32 v168, s55, v168
v_mul_f32 v169, s55, v169
v_permlane32_swap_b32 v200, v202
v_permlane32_swap_b32 v201, v203
v_mul_f32 v170, s55, v170
v_mul_f32 v171, s55, v171
v_mul_f32 v216, s55, v216
v_mul_f32 v217, s55, v217
v_mul_f32 v218, s55, v218
v_mul_f32 v219, s55, v219
v_cvt_pk_bf16_f32 v168, v168, v169
v_cvt_pk_bf16_f32 v169, v170, v171
v_cvt_pk_bf16_f32 v170, v216, v217
v_cvt_pk_bf16_f32 v171, v218, v219
v_permlane16_swap_b32 v200, v202
v_permlane16_swap_b32 v201, v203
v_accvgpr_read_b32 v180, a32
v_accvgpr_read_b32 v181, a33
v_accvgpr_read_b32 v182, a34
v_accvgpr_read_b32 v183, a35
v_accvgpr_read_b32 v208, a44
v_accvgpr_read_b32 v209, a45
v_accvgpr_read_b32 v210, a46
v_accvgpr_read_b32 v211, a47
v_mul_f32 v180, s55, v180
v_mul_f32 v181, s55, v181
v_permlane32_swap_b32 v168, v170
v_permlane32_swap_b32 v169, v171
v_mul_f32 v182, s55, v182
v_mul_f32 v183, s55, v183
v_mul_f32 v208, s55, v208
v_mul_f32 v209, s55, v209
v_mul_f32 v210, s55, v210
v_mul_f32 v211, s55, v211
v_cvt_pk_bf16_f32 v180, v180, v181
v_cvt_pk_bf16_f32 v181, v182, v183
v_cvt_pk_bf16_f32 v182, v208, v209
v_cvt_pk_bf16_f32 v183, v210, v211
v_permlane16_swap_b32 v168, v170
v_permlane16_swap_b32 v169, v171
v_accvgpr_read_b32 v192, a56
v_accvgpr_read_b32 v193, a57
v_accvgpr_read_b32 v194, a58
v_accvgpr_read_b32 v195, a59
v_accvgpr_read_b32 v212, a68
v_accvgpr_read_b32 v213, a69
v_accvgpr_read_b32 v214, a70
v_accvgpr_read_b32 v215, a71
v_mul_f32 v192, s55, v192
v_mul_f32 v193, s55, v193
v_permlane32_swap_b32 v180, v182
v_permlane32_swap_b32 v181, v183
v_mul_f32 v194, s55, v194
v_mul_f32 v195, s55, v195
v_mul_f32 v212, s55, v212
v_mul_f32 v213, s55, v213
v_mul_f32 v214, s55, v214
v_mul_f32 v215, s55, v215
v_cvt_pk_bf16_f32 v192, v192, v193
v_cvt_pk_bf16_f32 v193, v194, v195
v_cvt_pk_bf16_f32 v194, v212, v213
v_cvt_pk_bf16_f32 v195, v214, v215
v_permlane16_swap_b32 v180, v182
v_permlane16_swap_b32 v181, v183
v_accvgpr_read_b32 v204, a80
v_accvgpr_read_b32 v205, a81
v_accvgpr_read_b32 v206, a82
v_accvgpr_read_b32 v207, a83
v_accvgpr_read_b32 v216, a92
v_accvgpr_read_b32 v217, a93
v_accvgpr_read_b32 v218, a94
v_accvgpr_read_b32 v219, a95
v_mul_f32 v204, s55, v204
v_mul_f32 v205, s55, v205
v_permlane32_swap_b32 v192, v194
v_permlane32_swap_b32 v193, v195
v_mul_f32 v206, s55, v206
v_mul_f32 v207, s55, v207
v_mul_f32 v216, s55, v216
v_mul_f32 v217, s55, v217
v_mul_f32 v218, s55, v218
v_mul_f32 v219, s55, v219
v_cvt_pk_bf16_f32 v204, v204, v205
v_cvt_pk_bf16_f32 v205, v206, v207
v_cvt_pk_bf16_f32 v206, v216, v217
v_cvt_pk_bf16_f32 v207, v218, v219
v_permlane16_swap_b32 v192, v194
v_permlane16_swap_b32 v193, v195
s_nop 1
v_permlane32_swap_b32 v204, v206
v_permlane32_swap_b32 v205, v207
s_nop 1
v_permlane16_swap_b32 v204, v206
v_permlane16_swap_b32 v205, v207
s_waitcnt vmcnt(8) lgkmcnt(0)
s_barrier
v_mfma_f32_16x16x32_bf16 v[100:103], v[220:223], v[148:151], v[100:103]
s_mov_b32 s32, s28
v_exp_f32 v140, v140
v_mfma_f32_16x16x32_bf16 v[4:7], a[224:227], v[148:151], v[4:7]
s_and_b32 s33, s29, 0xffff
v_exp_f32 v141, v141
v_mfma_f32_16x16x32_bf16 v[16:19], a[228:231], v[148:151], v[16:19]
s_and_b32 s52, s10, 3
v_exp_f32 v142, v142
v_mfma_f32_16x16x32_bf16 v[28:31], a[232:235], v[148:151], v[28:31]
s_lshl_b32 s52, s52, 6
v_exp_f32 v143, v143
v_mfma_f32_16x16x32_bf16 v[40:43], a[236:239], v[148:151], v[40:43]
v_lshrrev_b32 v250, 4, v1
v_cvt_pk_bf16_f32 v152, v128, v129
v_cvt_pk_bf16_f32 v153, v130, v131
v_mfma_f32_16x16x32_bf16 v[52:55], a[240:243], v[148:151], v[52:55]
v_and_b32 v251, 15, v1
v_cvt_pk_bf16_f32 v154, v140, v141
v_cvt_pk_bf16_f32 v155, v142, v143
v_mfma_f32_16x16x32_bf16 v[64:67], a[244:247], v[148:151], v[64:67]
v_lshlrev_b32 v240, 1, v250
v_exp_f32 v132, v132
v_mfma_f32_16x16x32_bf16 v[76:79], a[248:251], v[148:151], v[76:79]
v_xor_b32 v251, v251, v240
v_lshlrev_b32 v251, 4, v251
v_xor_b32 v251, s52, v251
v_mul_u32_u24 v250, 1024, v250
v_add_u32 v240, v250, v251
v_xor_b32 v251, 0x80, v251
v_add_u32 v241, v250, v251
v_add_u32 v242, 6144, v240
v_add_u32 v243, 9216, v241
v_add_u32 v241, 3072, v241
s_add_u32 s45, s57, 0
s_add_u32 m0, s47, 49152
s_nop 0
buffer_load_dwordx4 v240, s[32:35], s45 offen lds
v_mfma_f32_16x16x32_bf16 v[88:91], a[252:255], v[148:151], v[88:91]
v_exp_f32 v133, v133
v_mfma_f32_16x16x32_bf16 v[104:107], v[220:223], v[152:155], v[104:107]
v_exp_f32 v134, v134
v_mfma_f32_16x16x32_bf16 v[8:11], a[224:227], v[152:155], v[8:11]
v_exp_f32 v135, v135
v_mfma_f32_16x16x32_bf16 v[20:23], a[228:231], v[152:155], v[20:23]
v_exp_f32 v144, v144
v_mfma_f32_16x16x32_bf16 v[32:35], a[232:235], v[152:155], v[32:35]
buffer_load_dwordx4 v241, s[32:35], s45 offen offset:1024 lds
v_mfma_f32_16x16x32_bf16 v[44:47], a[236:239], v[152:155], v[44:47]
v_exp_f32 v145, v145
v_mfma_f32_16x16x32_bf16 v[56:59], a[240:243], v[152:155], v[56:59]
v_exp_f32 v146, v146
v_mfma_f32_16x16x32_bf16 v[68:71], a[244:247], v[152:155], v[68:71]
ds_read_b128 a[192:195], v232 offset:0
v_exp_f32 v147, v147
v_mfma_f32_16x16x32_bf16 v[80:83], a[248:251], v[152:155], v[80:83]
ds_read_b128 a[196:199], v233 offset:0
v_cvt_pk_bf16_f32 v156, v132, v133
v_cvt_pk_bf16_f32 v157, v134, v135
v_mfma_f32_16x16x32_bf16 v[92:95], a[252:255], v[152:155], v[92:95]
ds_read_b128 a[200:203], v234 offset:0
v_cvt_pk_bf16_f32 v158, v144, v145
v_cvt_pk_bf16_f32 v159, v146, v147
s_nop 1
v_mfma_f32_16x16x32_bf16 v[108:111], v[220:223], v[156:159], v[108:111]
ds_read_b128 a[204:207], v235 offset:0
ds_read_b128 a[208:211], v232 offset:4096
v_mfma_f32_16x16x32_bf16 v[12:15], a[224:227], v[156:159], v[12:15]
ds_read_b128 a[212:215], v233 offset:4096
v_mfma_f32_16x16x32_bf16 v[24:27], a[228:231], v[156:159], v[24:27]
buffer_load_dwordx4 v242, s[32:35], s45 offen offset:2048 lds
v_mfma_f32_16x16x32_bf16 v[36:39], a[232:235], v[156:159], v[36:39]
ds_read_b128 a[216:219], v234 offset:4096
ds_read_b128 a[220:223], v235 offset:4096
v_mfma_f32_16x16x32_bf16 v[48:51], a[236:239], v[156:159], v[48:51]
v_mfma_f32_16x16x32_bf16 v[60:63], a[240:243], v[156:159], v[60:63]
v_mfma_f32_16x16x32_bf16 v[72:75], a[244:247], v[156:159], v[72:75]
buffer_load_dwordx4 v243, s[32:35], s45 offen offset:3072 lds
v_mfma_f32_16x16x32_bf16 v[84:87], a[248:251], v[156:159], v[84:87]
v_mfma_f32_16x16x32_bf16 v[96:99], a[252:255], v[156:159], v[96:99]
s_waitcnt vmcnt(8) lgkmcnt(0)
s_barrier
v_mfma_f32_16x16x32_bf16 v[124:127], a[192:195], v[160:163], 0
ds_read_b64_tr_b16 a[224:225], v224 offset:16384
s_add_u32 s44, s11, 8192
s_and_b32 s44, s44, 0x1ffff
v_mfma_f32_16x16x32_bf16 v[124:127], a[196:199], v[172:175], v[124:127]
ds_read_b64_tr_b16 a[226:227], v224 offset:20480
s_add_u32 s44, s44, s49
s_add_u32 m0, s47, 0
v_mfma_f32_16x16x32_bf16 v[124:127], a[200:203], v[184:187], v[124:127]
ds_read_b64_tr_b16 a[228:229], v225 offset:16384
v_mfma_f32_16x16x32_bf16 v[124:127], a[204:207], v[196:199], v[124:127]
ds_read_b64_tr_b16 a[230:231], v225 offset:20480
v_mfma_f32_16x16x32_bf16 v[136:139], a[208:211], v[160:163], 0
ds_read_b64_tr_b16 a[232:233], v226 offset:16384
ds_read_b64_tr_b16 a[234:235], v226 offset:20480
v_mfma_f32_16x16x32_bf16 v[136:139], a[212:215], v[172:175], v[136:139]
buffer_load_dwordx4 v236, s[16:19], s44 offen nt lds
v_mfma_f32_16x16x32_bf16 v[136:139], a[216:219], v[184:187], v[136:139]
ds_read_b64_tr_b16 a[236:237], v227 offset:16384
v_mfma_f32_16x16x32_bf16 v[136:139], a[220:223], v[196:199], v[136:139]
ds_read_b64_tr_b16 a[238:239], v227 offset:20480
v_mfma_f32_16x16x32_bf16 v[128:131], a[192:195], v[164:167], 0
ds_read_b64_tr_b16 a[240:241], v228 offset:16384
v_mfma_f32_16x16x32_bf16 v[128:131], a[196:199], v[176:179], v[128:131]
ds_read_b64_tr_b16 a[242:243], v228 offset:20480
v_mfma_f32_16x16x32_bf16 v[128:131], a[200:203], v[188:191], v[128:131]
ds_read_b64_tr_b16 a[244:245], v229 offset:16384
ds_read_b64_tr_b16 a[246:247], v229 offset:20480
v_mfma_f32_16x16x32_bf16 v[128:131], a[204:207], v[200:203], v[128:131]
buffer_load_dwordx4 v237, s[16:19], s44 offen offset:1024 nt lds
v_mfma_f32_16x16x32_bf16 v[140:143], a[208:211], v[164:167], 0
ds_read_b64_tr_b16 a[248:249], v230 offset:16384
v_max3_f32 v244, v124, v125, v126
v_mfma_f32_16x16x32_bf16 v[140:143], a[212:215], v[176:179], v[140:143]
ds_read_b64_tr_b16 a[250:251], v230 offset:20480
v_max3_f32 v244, v244, v127, v136
v_mfma_f32_16x16x32_bf16 v[140:143], a[216:219], v[188:191], v[140:143]
ds_read_b64_tr_b16 a[252:253], v231 offset:16384
v_max3_f32 v244, v244, v137, v138
v_mfma_f32_16x16x32_bf16 v[140:143], a[220:223], v[200:203], v[140:143]
ds_read_b64_tr_b16 a[254:255], v231 offset:20480
v_max_f32 v244, v244, v139
v_mfma_f32_16x16x32_bf16 v[132:135], a[192:195], v[168:171], 0
buffer_load_dwordx4 v238, s[16:19], s44 offen offset:2048 nt lds
v_mfma_f32_16x16x32_bf16 v[132:135], a[196:199], v[180:183], v[132:135]
v_mfma_f32_16x16x32_bf16 v[132:135], a[200:203], v[192:195], v[132:135]
v_mfma_f32_16x16x32_bf16 v[132:135], a[204:207], v[204:207], v[132:135]
v_max3_f32 v245, v128, v129, v130
v_max3_f32 v245, v245, v131, v140
v_mfma_f32_16x16x32_bf16 v[144:147], a[208:211], v[168:171], 0
v_max3_f32 v245, v245, v141, v142
v_max_f32 v245, v245, v143
v_mfma_f32_16x16x32_bf16 v[144:147], a[212:215], v[180:183], v[144:147]
buffer_load_dwordx4 v239, s[16:19], s44 offen offset:3072 nt lds
v_mfma_f32_16x16x32_bf16 v[144:147], a[216:219], v[192:195], v[144:147]
v_mfma_f32_16x16x32_bf16 v[144:147], a[220:223], v[204:207], v[144:147]
v_rcp_f32 v208, v100
s_nop 0
v_mul_f32 v4, v4, v208
v_mul_f32 v5, v5, v208
v_mul_f32 v6, v6, v208
v_mul_f32 v7, v7, v208
v_mul_f32 v16, v16, v208
v_mul_f32 v17, v17, v208
v_mul_f32 v18, v18, v208
v_mul_f32 v19, v19, v208
v_cvt_pk_bf16_f32 v4, v4, v5
v_cvt_pk_bf16_f32 v5, v6, v7
v_cvt_pk_bf16_f32 v6, v16, v17
v_cvt_pk_bf16_f32 v7, v18, v19
ds_write_b128 v252, v[4:7] offset:0
v_mul_f32 v28, v28, v208
v_mul_f32 v29, v29, v208
v_mul_f32 v30, v30, v208
v_mul_f32 v31, v31, v208
v_mul_f32 v40, v40, v208
v_mul_f32 v41, v41, v208
v_mul_f32 v42, v42, v208
v_mul_f32 v43, v43, v208
v_cvt_pk_bf16_f32 v28, v28, v29
v_cvt_pk_bf16_f32 v29, v30, v31
v_cvt_pk_bf16_f32 v30, v40, v41
v_cvt_pk_bf16_f32 v31, v42, v43
ds_write_b128 v252, v[28:31] offset:3072
v_mul_f32 v52, v52, v208
v_mul_f32 v53, v53, v208
v_mul_f32 v54, v54, v208
v_mul_f32 v55, v55, v208
v_mul_f32 v64, v64, v208
v_mul_f32 v65, v65, v208
v_mul_f32 v66, v66, v208
v_mul_f32 v67, v67, v208
v_cvt_pk_bf16_f32 v52, v52, v53
v_cvt_pk_bf16_f32 v53, v54, v55
v_cvt_pk_bf16_f32 v54, v64, v65
v_cvt_pk_bf16_f32 v55, v66, v67
ds_write_b128 v252, v[52:55] offset:6144
v_mul_f32 v76, v76, v208
v_mul_f32 v77, v77, v208
v_mul_f32 v78, v78, v208
v_mul_f32 v79, v79, v208
v_mul_f32 v88, v88, v208
v_mul_f32 v89, v89, v208
v_mul_f32 v90, v90, v208
v_mul_f32 v91, v91, v208
v_cvt_pk_bf16_f32 v76, v76, v77
v_cvt_pk_bf16_f32 v77, v78, v79
v_cvt_pk_bf16_f32 v78, v88, v89
v_cvt_pk_bf16_f32 v79, v90, v91
ds_write_b128 v252, v[76:79] offset:9216
v_rcp_f32 v209, v104
s_nop 0
v_mul_f32 v8, v8, v209
v_mul_f32 v9, v9, v209
v_mul_f32 v10, v10, v209
v_mul_f32 v11, v11, v209
v_mul_f32 v20, v20, v209
v_mul_f32 v21, v21, v209
v_mul_f32 v22, v22, v209
v_mul_f32 v23, v23, v209
v_cvt_pk_bf16_f32 v8, v8, v9
v_cvt_pk_bf16_f32 v9, v10, v11
v_cvt_pk_bf16_f32 v10, v20, v21
v_cvt_pk_bf16_f32 v11, v22, v23
ds_write_b128 v252, v[8:11] offset:1024
v_mul_f32 v32, v32, v209
v_mul_f32 v33, v33, v209
v_mul_f32 v34, v34, v209
v_mul_f32 v35, v35, v209
v_mul_f32 v44, v44, v209
v_mul_f32 v45, v45, v209
v_mul_f32 v46, v46, v209
v_mul_f32 v47, v47, v209
v_cvt_pk_bf16_f32 v32, v32, v33
v_cvt_pk_bf16_f32 v33, v34, v35
v_cvt_pk_bf16_f32 v34, v44, v45
v_cvt_pk_bf16_f32 v35, v46, v47
ds_write_b128 v252, v[32:35] offset:4096
v_mul_f32 v56, v56, v209
v_mul_f32 v57, v57, v209
v_mul_f32 v58, v58, v209
v_mul_f32 v59, v59, v209
v_mul_f32 v68, v68, v209
v_mul_f32 v69, v69, v209
v_mul_f32 v70, v70, v209
v_mul_f32 v71, v71, v209
v_cvt_pk_bf16_f32 v56, v56, v57
v_cvt_pk_bf16_f32 v57, v58, v59
v_cvt_pk_bf16_f32 v58, v68, v69
v_cvt_pk_bf16_f32 v59, v70, v71
ds_write_b128 v252, v[56:59] offset:7168
v_mul_f32 v80, v80, v209
v_mul_f32 v81, v81, v209
v_mul_f32 v82, v82, v209
v_mul_f32 v83, v83, v209
v_mul_f32 v92, v92, v209
v_mul_f32 v93, v93, v209
v_mul_f32 v94, v94, v209
v_mul_f32 v95, v95, v209
v_cvt_pk_bf16_f32 v80, v80, v81
v_cvt_pk_bf16_f32 v81, v82, v83
v_cvt_pk_bf16_f32 v82, v92, v93
v_cvt_pk_bf16_f32 v83, v94, v95
ds_write_b128 v252, v[80:83] offset:10240
v_rcp_f32 v210, v108
s_nop 0
v_mul_f32 v12, v12, v210
v_mul_f32 v13, v13, v210
v_mul_f32 v14, v14, v210
v_mul_f32 v15, v15, v210
v_mul_f32 v24, v24, v210
v_mul_f32 v25, v25, v210
v_mul_f32 v26, v26, v210
v_mul_f32 v27, v27, v210
v_cvt_pk_bf16_f32 v12, v12, v13
v_cvt_pk_bf16_f32 v13, v14, v15
v_cvt_pk_bf16_f32 v14, v24, v25
v_cvt_pk_bf16_f32 v15, v26, v27
ds_write_b128 v252, v[12:15] offset:2048
v_mul_f32 v36, v36, v210
v_mul_f32 v37, v37, v210
v_mul_f32 v38, v38, v210
v_mul_f32 v39, v39, v210
v_mul_f32 v48, v48, v210
v_mul_f32 v49, v49, v210
v_mul_f32 v50, v50, v210
v_mul_f32 v51, v51, v210
v_cvt_pk_bf16_f32 v36, v36, v37
v_cvt_pk_bf16_f32 v37, v38, v39
v_cvt_pk_bf16_f32 v38, v48, v49
v_cvt_pk_bf16_f32 v39, v50, v51
ds_write_b128 v252, v[36:39] offset:5120
v_mul_f32 v60, v60, v210
v_mul_f32 v61, v61, v210
v_mul_f32 v62, v62, v210
v_mul_f32 v63, v63, v210
v_mul_f32 v72, v72, v210
v_mul_f32 v73, v73, v210
v_mul_f32 v74, v74, v210
v_mul_f32 v75, v75, v210
v_cvt_pk_bf16_f32 v60, v60, v61
v_cvt_pk_bf16_f32 v61, v62, v63
v_cvt_pk_bf16_f32 v62, v72, v73
v_cvt_pk_bf16_f32 v63, v74, v75
ds_write_b128 v252, v[60:63] offset:8192
v_mul_f32 v84, v84, v210
v_mul_f32 v85, v85, v210
v_mul_f32 v86, v86, v210
v_mul_f32 v87, v87, v210
v_mul_f32 v96, v96, v210
v_mul_f32 v97, v97, v210
v_mul_f32 v98, v98, v210
v_mul_f32 v99, v99, v210
v_cvt_pk_bf16_f32 v84, v84, v85
v_cvt_pk_bf16_f32 v85, v86, v87
v_cvt_pk_bf16_f32 v86, v96, v97
v_cvt_pk_bf16_f32 v87, v98, v99
ds_write_b128 v252, v[84:87] offset:11264
s_mul_i32 s52, s6, 12288
s_add_u32 s52, s52, 65536
v_add_u32 v3, s52, v253
v_max3_f32 v246, v132, v133, v134
v_max3_f32 v246, v246, v135, v144
v_max3_f32 v246, v246, v145, v146
v_max_f32 v246, v246, v147
v_mov_b32 v247, v244
v_mov_b32 v248, v245
v_mov_b32 v249, v246
s_nop 0
v_permlane32_swap_b32 v244, v247
v_permlane32_swap_b32 v245, v248
v_permlane32_swap_b32 v246, v249
v_max_f32 v244, v244, v247
v_max_f32 v245, v245, v248
v_max_f32 v246, v246, v249
v_mov_b32 v247, v244
v_mov_b32 v248, v245
v_mov_b32 v249, v246
s_nop 0
v_permlane16_swap_b32 v244, v247
v_permlane16_swap_b32 v245, v248
v_permlane16_swap_b32 v246, v249
v_max_f32 v244, v244, v247
v_max_f32 v245, v245, v248
v_max_f32 v246, v246, v249
v_sub_f32 v124, v124, v244
v_sub_f32 v125, v125, v244
v_sub_f32 v126, v126, v244
v_sub_f32 v127, v127, v244
v_sub_f32 v136, v136, v244
v_sub_f32 v137, v137, v244
v_sub_f32 v138, v138, v244
v_sub_f32 v139, v139, v244
v_sub_f32 v112, 0, v244
v_sub_f32 v113, 0, v244
v_sub_f32 v114, 0, v244
v_sub_f32 v115, 0, v244
v_sub_f32 v128, v128, v245
v_sub_f32 v129, v129, v245
v_sub_f32 v130, v130, v245
v_sub_f32 v131, v131, v245
v_sub_f32 v140, v140, v245
v_sub_f32 v141, v141, v245
v_sub_f32 v142, v142, v245
v_sub_f32 v143, v143, v245
v_sub_f32 v116, 0, v245
v_sub_f32 v117, 0, v245
v_sub_f32 v118, 0, v245
v_sub_f32 v119, 0, v245
v_sub_f32 v132, v132, v246
v_sub_f32 v133, v133, v246
v_sub_f32 v134, v134, v246
v_sub_f32 v135, v135, v246
v_sub_f32 v144, v144, v246
v_sub_f32 v145, v145, v246
v_sub_f32 v146, v146, v246
v_sub_f32 v147, v147, v246
v_sub_f32 v120, 0, v246
v_sub_f32 v121, 0, v246
v_sub_f32 v122, 0, v246
v_sub_f32 v123, 0, v246
v_exp_f32 v124, v124
v_exp_f32 v125, v125
v_exp_f32 v126, v126
v_exp_f32 v127, v127
v_exp_f32 v136, v136
v_exp_f32 v137, v137
v_exp_f32 v138, v138
v_exp_f32 v139, v139
v_cvt_pk_bf16_f32 v148, v124, v125
v_cvt_pk_bf16_f32 v149, v126, v127
v_cvt_pk_bf16_f32 v150, v136, v137
v_cvt_pk_bf16_f32 v151, v138, v139
v_exp_f32 v128, v128
v_exp_f32 v129, v129
v_exp_f32 v130, v130
v_exp_f32 v131, v131
s_waitcnt vmcnt(8) lgkmcnt(0)
s_barrier
v_mfma_f32_16x16x32_bf16 v[100:103], v[220:223], v[148:151], 0
s_add_u32 s44, s11, 16384
v_exp_f32 v140, v140
v_mfma_f32_16x16x32_bf16 v[4:7], a[224:227], v[148:151], 0
s_and_b32 s44, s44, 0x1ffff
v_exp_f32 v141, v141
v_mfma_f32_16x16x32_bf16 v[16:19], a[228:231], v[148:151], 0
s_add_u32 s44, s44, s49
v_exp_f32 v142, v142
v_mfma_f32_16x16x32_bf16 v[28:31], a[232:235], v[148:151], 0
s_add_u32 m0, s47, 16384
v_exp_f32 v143, v143
v_mfma_f32_16x16x32_bf16 v[40:43], a[236:239], v[148:151], 0
v_cvt_pk_bf16_f32 v152, v128, v129
v_cvt_pk_bf16_f32 v153, v130, v131
v_mfma_f32_16x16x32_bf16 v[52:55], a[240:243], v[148:151], 0
v_cvt_pk_bf16_f32 v154, v140, v141
v_cvt_pk_bf16_f32 v155, v142, v143
v_mfma_f32_16x16x32_bf16 v[64:67], a[244:247], v[148:151], 0
v_exp_f32 v132, v132
v_mfma_f32_16x16x32_bf16 v[76:79], a[248:251], v[148:151], 0
buffer_load_dwordx4 v236, s[12:15], s44 offen nt lds
v_mfma_f32_16x16x32_bf16 v[88:91], a[252:255], v[148:151], 0
v_exp_f32 v133, v133
v_mfma_f32_16x16x32_bf16 v[104:107], v[220:223], v[152:155], 0
v_exp_f32 v134, v134
v_mfma_f32_16x16x32_bf16 v[8:11], a[224:227], v[152:155], 0
v_exp_f32 v135, v135
v_mfma_f32_16x16x32_bf16 v[20:23], a[228:231], v[152:155], 0
v_exp_f32 v144, v144
v_mfma_f32_16x16x32_bf16 v[32:35], a[232:235], v[152:155], 0
buffer_load_dwordx4 v237, s[12:15], s44 offen offset:1024 nt lds
v_mfma_f32_16x16x32_bf16 v[44:47], a[236:239], v[152:155], 0
v_exp_f32 v145, v145
v_mfma_f32_16x16x32_bf16 v[56:59], a[240:243], v[152:155], 0
v_exp_f32 v146, v146
v_mfma_f32_16x16x32_bf16 v[68:71], a[244:247], v[152:155], 0
ds_read_b128 a[192:195], v232 offset:32768
v_exp_f32 v147, v147
v_mfma_f32_16x16x32_bf16 v[80:83], a[248:251], v[152:155], 0
ds_read_b128 a[196:199], v233 offset:32768
v_cvt_pk_bf16_f32 v156, v132, v133
v_cvt_pk_bf16_f32 v157, v134, v135
v_mfma_f32_16x16x32_bf16 v[92:95], a[252:255], v[152:155], 0
ds_read_b128 a[200:203], v234 offset:32768
v_cvt_pk_bf16_f32 v158, v144, v145
v_cvt_pk_bf16_f32 v159, v146, v147
s_nop 1
v_mfma_f32_16x16x32_bf16 v[108:111], v[220:223], v[156:159], 0
ds_read_b128 a[204:207], v235 offset:32768
ds_read_b128 a[208:211], v232 offset:36864
v_mfma_f32_16x16x32_bf16 v[12:15], a[224:227], v[156:159], 0
ds_read_b128 a[212:215], v233 offset:36864
v_mfma_f32_16x16x32_bf16 v[24:27], a[228:231], v[156:159], 0
buffer_load_dwordx4 v238, s[12:15], s44 offen offset:2048 nt lds
v_mfma_f32_16x16x32_bf16 v[36:39], a[232:235], v[156:159], 0
ds_read_b128 a[216:219], v234 offset:36864
ds_read_b128 a[220:223], v235 offset:36864
v_mfma_f32_16x16x32_bf16 v[48:51], a[236:239], v[156:159], 0
v_mfma_f32_16x16x32_bf16 v[60:63], a[240:243], v[156:159], 0
v_mfma_f32_16x16x32_bf16 v[72:75], a[244:247], v[156:159], 0
buffer_load_dwordx4 v239, s[12:15], s44 offen offset:3072 nt lds
v_mfma_f32_16x16x32_bf16 v[84:87], a[248:251], v[156:159], 0
v_mfma_f32_16x16x32_bf16 v[96:99], a[252:255], v[156:159], 0
s_waitcnt vmcnt(8) lgkmcnt(0)
s_barrier
v_mfma_f32_16x16x32_bf16 v[124:127], a[192:195], v[160:163], v[112:115]
ds_read_b64_tr_b16 a[224:225], v224 offset:49152
s_add_u32 s45, s57, 0
s_add_u32 s45, s45, s30
v_mfma_f32_16x16x32_bf16 v[124:127], a[196:199], v[172:175], v[124:127]
ds_read_b64_tr_b16 a[226:227], v224 offset:53248
s_add_u32 m0, s47, 32768
v_mfma_f32_16x16x32_bf16 v[124:127], a[200:203], v[184:187], v[124:127]
ds_read_b64_tr_b16 a[228:229], v225 offset:49152
v_mfma_f32_16x16x32_bf16 v[124:127], a[204:207], v[196:199], v[124:127]
ds_read_b64_tr_b16 a[230:231], v225 offset:53248
v_mfma_f32_16x16x32_bf16 v[136:139], a[208:211], v[160:163], v[112:115]
ds_read_b64_tr_b16 a[232:233], v226 offset:49152
ds_read_b64_tr_b16 a[234:235], v226 offset:53248
v_mfma_f32_16x16x32_bf16 v[136:139], a[212:215], v[172:175], v[136:139]
buffer_load_dwordx4 v240, s[32:35], s45 offen lds
v_mfma_f32_16x16x32_bf16 v[136:139], a[216:219], v[184:187], v[136:139]
ds_read_b64_tr_b16 a[236:237], v227 offset:49152
v_mfma_f32_16x16x32_bf16 v[136:139], a[220:223], v[196:199], v[136:139]
ds_read_b64_tr_b16 a[238:239], v227 offset:53248
v_mfma_f32_16x16x32_bf16 v[128:131], a[192:195], v[164:167], v[116:119]
ds_read_b64_tr_b16 a[240:241], v228 offset:49152
v_mfma_f32_16x16x32_bf16 v[128:131], a[196:199], v[176:179], v[128:131]
ds_read_b64_tr_b16 a[242:243], v228 offset:53248
v_mfma_f32_16x16x32_bf16 v[128:131], a[200:203], v[188:191], v[128:131]
ds_read_b64_tr_b16 a[244:245], v229 offset:49152
ds_read_b64_tr_b16 a[246:247], v229 offset:53248
v_mfma_f32_16x16x32_bf16 v[128:131], a[204:207], v[200:203], v[128:131]
buffer_load_dwordx4 v241, s[32:35], s45 offen offset:1024 lds
v_mfma_f32_16x16x32_bf16 v[140:143], a[208:211], v[164:167], v[116:119]
ds_read_b64_tr_b16 a[248:249], v230 offset:49152
v_max3_f32 v244, v124, v125, v126
v_mfma_f32_16x16x32_bf16 v[140:143], a[212:215], v[176:179], v[140:143]
ds_read_b64_tr_b16 a[250:251], v230 offset:53248
v_max3_f32 v244, v244, v127, v136
v_mfma_f32_16x16x32_bf16 v[140:143], a[216:219], v[188:191], v[140:143]
ds_read_b64_tr_b16 a[252:253], v231 offset:49152
v_max3_f32 v244, v244, v137, v138
v_mfma_f32_16x16x32_bf16 v[140:143], a[220:223], v[200:203], v[140:143]
ds_read_b64_tr_b16 a[254:255], v231 offset:53248
ds_read_b128 v[208:211], v3 offset:0
v_max_f32 v244, v244, v139
v_mfma_f32_16x16x32_bf16 v[132:135], a[192:195], v[168:171], v[120:123]
buffer_load_dwordx4 v242, s[32:35], s45 offen offset:2048 lds
v_mfma_f32_16x16x32_bf16 v[132:135], a[196:199], v[180:183], v[132:135]
ds_read_b128 v[212:215], v3 offset:1024
v_mfma_f32_16x16x32_bf16 v[132:135], a[200:203], v[192:195], v[132:135]
ds_read_b128 v[216:219], v3 offset:2048
v_mfma_f32_16x16x32_bf16 v[132:135], a[204:207], v[204:207], v[132:135]
v_max3_f32 v245, v128, v129, v130
v_max3_f32 v245, v245, v131, v140
v_mfma_f32_16x16x32_bf16 v[144:147], a[208:211], v[168:171], v[120:123]
v_max3_f32 v245, v245, v141, v142
v_max_f32 v245, v245, v143
v_mfma_f32_16x16x32_bf16 v[144:147], a[212:215], v[180:183], v[144:147]
buffer_load_dwordx4 v243, s[32:35], s45 offen offset:3072 lds
v_mfma_f32_16x16x32_bf16 v[144:147], a[216:219], v[192:195], v[144:147]
v_mfma_f32_16x16x32_bf16 v[144:147], a[220:223], v[204:207], v[144:147]
s_waitcnt vmcnt(8) lgkmcnt(0)
s_barrier
v_mfma_f32_16x16x32_bf16 a[0:3], a[224:227], v[208:211], 0
ds_read_b64_tr_b16 a[192:193], v224 offset:0
s_add_u32 s44, s11, 16384
s_and_b32 s44, s44, 0x1ffff
v_mfma_f32_16x16x32_bf16 a[4:7], a[224:227], v[212:215], 0
ds_read_b64_tr_b16 a[194:195], v224 offset:4096
ds_read_b64_tr_b16 a[196:197], v225 offset:0
s_add_u32 s44, s44, s49
v_mfma_f32_16x16x32_bf16 a[8:11], a[224:227], v[216:219], 0
s_add_u32 m0, s47, 49152
s_nop 0
buffer_load_dwordx4 v236, s[16:19], s44 offen nt lds
v_mfma_f32_16x16x32_bf16 a[12:15], a[228:231], v[208:211], 0
ds_read_b64_tr_b16 a[198:199], v225 offset:4096
v_max3_f32 v246, v132, v133, v134
v_mfma_f32_16x16x32_bf16 a[16:19], a[228:231], v[212:215], 0
ds_read_b64_tr_b16 a[200:201], v226 offset:0
v_max3_f32 v246, v246, v135, v144
v_mfma_f32_16x16x32_bf16 a[20:23], a[228:231], v[216:219], 0
v_max3_f32 v246, v246, v145, v146
v_max_f32 v246, v246, v147
v_mfma_f32_16x16x32_bf16 a[24:27], a[232:235], v[208:211], 0
v_max3_f32 v247, v244, v245, v246
v_cmp_lt_f32 vcc, s50, v247
s_cbranch_vccnz L_rs22
L_rb22:
v_mfma_f32_16x16x32_bf16 a[28:31], a[232:235], v[212:215], 0
v_exp_f32 v124, v124
v_mfma_f32_16x16x32_bf16 a[32:35], a[232:235], v[216:219], 0
buffer_load_dwordx4 v237, s[16:19], s44 offen offset:1024 nt lds
v_mfma_f32_16x16x32_bf16 a[36:39], a[236:239], v[208:211], 0
ds_read_b64_tr_b16 a[202:203], v226 offset:4096
v_exp_f32 v125, v125
v_mfma_f32_16x16x32_bf16 a[40:43], a[236:239], v[212:215], 0
ds_read_b64_tr_b16 a[204:205], v227 offset:0
v_exp_f32 v126, v126
v_mfma_f32_16x16x32_bf16 a[44:47], a[236:239], v[216:219], 0
ds_read_b64_tr_b16 a[206:207], v227 offset:4096
v_exp_f32 v127, v127
v_mfma_f32_16x16x32_bf16 a[48:51], a[240:243], v[208:211], 0
ds_read_b64_tr_b16 a[208:209], v228 offset:0
v_exp_f32 v136, v136
v_mfma_f32_16x16x32_bf16 a[52:55], a[240:243], v[212:215], 0
ds_read_b64_tr_b16 a[210:211], v228 offset:4096
v_exp_f32 v137, v137
v_mfma_f32_16x16x32_bf16 a[56:59], a[240:243], v[216:219], 0
buffer_load_dwordx4 v238, s[16:19], s44 offen offset:2048 nt lds
v_mfma_f32_16x16x32_bf16 a[60:63], a[244:247], v[208:211], 0
ds_read_b64_tr_b16 a[212:213], v229 offset:0
v_exp_f32 v138, v138
v_mfma_f32_16x16x32_bf16 a[64:67], a[244:247], v[212:215], 0
ds_read_b64_tr_b16 a[214:215], v229 offset:4096
v_exp_f32 v139, v139
v_mfma_f32_16x16x32_bf16 a[68:71], a[244:247], v[216:219], 0
ds_read_b64_tr_b16 a[216:217], v230 offset:0
v_cvt_pk_bf16_f32 v148, v124, v125
v_mfma_f32_16x16x32_bf16 a[72:75], a[248:251], v[208:211], 0
ds_read_b64_tr_b16 a[218:219], v230 offset:4096
v_cvt_pk_bf16_f32 v149, v126, v127
v_mfma_f32_16x16x32_bf16 a[76:79], a[248:251], v[212:215], 0
ds_read_b64_tr_b16 a[220:221], v231 offset:0
ds_read_b64_tr_b16 a[222:223], v231 offset:4096
v_cvt_pk_bf16_f32 v150, v136, v137
v_mfma_f32_16x16x32_bf16 a[80:83], a[248:251], v[216:219], 0
buffer_load_dwordx4 v239, s[16:19], s44 offen offset:3072 nt lds
v_mfma_f32_16x16x32_bf16 a[84:87], a[252:255], v[208:211], 0
v_cvt_pk_bf16_f32 v151, v138, v139
v_exp_f32 v128, v128
v_mfma_f32_16x16x32_bf16 a[88:91], a[252:255], v[212:215], 0
v_exp_f32 v129, v129
v_exp_f32 v130, v130
v_mfma_f32_16x16x32_bf16 a[92:95], a[252:255], v[216:219], 0
v_exp_f32 v131, v131
s_waitcnt vmcnt(8) lgkmcnt(0)
s_barrier
v_mfma_f32_16x16x32_bf16 v[100:103], v[220:223], v[148:151], v[100:103]
s_add_u32 s44, s11, 24576
v_exp_f32 v140, v140
v_mfma_f32_16x16x32_bf16 v[4:7], a[192:195], v[148:151], v[4:7]
s_and_b32 s44, s44, 0x1ffff
v_exp_f32 v141, v141
v_mfma_f32_16x16x32_bf16 v[16:19], a[196:199], v[148:151], v[16:19]
s_add_u32 s44, s44, s49
v_exp_f32 v142, v142
v_mfma_f32_16x16x32_bf16 v[28:31], a[200:203], v[148:151], v[28:31]
s_add_u32 m0, s47, 0
v_exp_f32 v143, v143
v_mfma_f32_16x16x32_bf16 v[40:43], a[204:207], v[148:151], v[40:43]
v_cvt_pk_bf16_f32 v152, v128, v129
v_cvt_pk_bf16_f32 v153, v130, v131
v_mfma_f32_16x16x32_bf16 v[52:55], a[208:211], v[148:151], v[52:55]
v_cvt_pk_bf16_f32 v154, v140, v141
v_cvt_pk_bf16_f32 v155, v142, v143
v_mfma_f32_16x16x32_bf16 v[64:67], a[212:215], v[148:151], v[64:67]
v_exp_f32 v132, v132
v_mfma_f32_16x16x32_bf16 v[76:79], a[216:219], v[148:151], v[76:79]
buffer_load_dwordx4 v236, s[12:15], s44 offen nt lds
v_mfma_f32_16x16x32_bf16 v[88:91], a[220:223], v[148:151], v[88:91]
v_exp_f32 v133, v133
v_mfma_f32_16x16x32_bf16 v[104:107], v[220:223], v[152:155], v[104:107]
v_exp_f32 v134, v134
v_mfma_f32_16x16x32_bf16 v[8:11], a[192:195], v[152:155], v[8:11]
v_exp_f32 v135, v135
v_mfma_f32_16x16x32_bf16 v[20:23], a[196:199], v[152:155], v[20:23]
v_exp_f32 v144, v144
v_mfma_f32_16x16x32_bf16 v[32:35], a[200:203], v[152:155], v[32:35]
buffer_load_dwordx4 v237, s[12:15], s44 offen offset:1024 nt lds
v_mfma_f32_16x16x32_bf16 v[44:47], a[204:207], v[152:155], v[44:47]
v_exp_f32 v145, v145
v_mfma_f32_16x16x32_bf16 v[56:59], a[208:211], v[152:155], v[56:59]
v_exp_f32 v146, v146
v_mfma_f32_16x16x32_bf16 v[68:71], a[212:215], v[152:155], v[68:71]
ds_read_b128 a[224:227], v232 offset:16384
v_exp_f32 v147, v147
v_mfma_f32_16x16x32_bf16 v[80:83], a[216:219], v[152:155], v[80:83]
ds_read_b128 a[228:231], v233 offset:16384
v_cvt_pk_bf16_f32 v156, v132, v133
v_cvt_pk_bf16_f32 v157, v134, v135
v_mfma_f32_16x16x32_bf16 v[92:95], a[220:223], v[152:155], v[92:95]
ds_read_b128 a[232:235], v234 offset:16384
v_cvt_pk_bf16_f32 v158, v144, v145
v_cvt_pk_bf16_f32 v159, v146, v147
s_nop 1
v_mfma_f32_16x16x32_bf16 v[108:111], v[220:223], v[156:159], v[108:111]
ds_read_b128 a[236:239], v235 offset:16384
ds_read_b128 a[240:243], v232 offset:20480
v_mfma_f32_16x16x32_bf16 v[12:15], a[192:195], v[156:159], v[12:15]
ds_read_b128 a[244:247], v233 offset:20480
v_mfma_f32_16x16x32_bf16 v[24:27], a[196:199], v[156:159], v[24:27]
buffer_load_dwordx4 v238, s[12:15], s44 offen offset:2048 nt lds
v_mfma_f32_16x16x32_bf16 v[36:39], a[200:203], v[156:159], v[36:39]
ds_read_b128 a[248:251], v234 offset:20480
ds_read_b128 a[252:255], v235 offset:20480
v_mfma_f32_16x16x32_bf16 v[48:51], a[204:207], v[156:159], v[48:51]
v_mfma_f32_16x16x32_bf16 v[60:63], a[208:211], v[156:159], v[60:63]
v_mfma_f32_16x16x32_bf16 v[72:75], a[212:215], v[156:159], v[72:75]
buffer_load_dwordx4 v239, s[12:15], s44 offen offset:3072 nt lds
v_mfma_f32_16x16x32_bf16 v[84:87], a[216:219], v[156:159], v[84:87]
v_mfma_f32_16x16x32_bf16 v[96:99], a[220:223], v[156:159], v[96:99]
s_waitcnt vmcnt(8) lgkmcnt(0)
s_barrier
v_mfma_f32_16x16x32_bf16 v[124:127], a[224:227], v[160:163], v[112:115]
ds_read_b64_tr_b16 a[192:193], v224 offset:32768
s_add_u32 s45, s57, 32768
s_add_u32 m0, s47, 16384
v_mfma_f32_16x16x32_bf16 v[124:127], a[228:231], v[172:175], v[124:127]
ds_read_b64_tr_b16 a[194:195], v224 offset:36864
v_mfma_f32_16x16x32_bf16 v[124:127], a[232:235], v[184:187], v[124:127]
ds_read_b64_tr_b16 a[196:197], v225 offset:32768
v_mfma_f32_16x16x32_bf16 v[124:127], a[236:239], v[196:199], v[124:127]
ds_read_b64_tr_b16 a[198:199], v225 offset:36864
v_mfma_f32_16x16x32_bf16 v[136:139], a[240:243], v[160:163], v[112:115]
ds_read_b64_tr_b16 a[200:201], v226 offset:32768
ds_read_b64_tr_b16 a[202:203], v226 offset:36864
v_mfma_f32_16x16x32_bf16 v[136:139], a[244:247], v[172:175], v[136:139]
buffer_load_dwordx4 v240, s[32:35], s45 offen lds
v_mfma_f32_16x16x32_bf16 v[136:139], a[248:251], v[184:187], v[136:139]
ds_read_b64_tr_b16 a[204:205], v227 offset:32768
v_mfma_f32_16x16x32_bf16 v[136:139], a[252:255], v[196:199], v[136:139]
ds_read_b64_tr_b16 a[206:207], v227 offset:36864
v_mfma_f32_16x16x32_bf16 v[128:131], a[224:227], v[164:167], v[116:119]
ds_read_b64_tr_b16 a[208:209], v228 offset:32768
v_mfma_f32_16x16x32_bf16 v[128:131], a[228:231], v[176:179], v[128:131]
ds_read_b64_tr_b16 a[210:211], v228 offset:36864
v_mfma_f32_16x16x32_bf16 v[128:131], a[232:235], v[188:191], v[128:131]
ds_read_b64_tr_b16 a[212:213], v229 offset:32768
ds_read_b64_tr_b16 a[214:215], v229 offset:36864
v_mfma_f32_16x16x32_bf16 v[128:131], a[236:239], v[200:203], v[128:131]
buffer_load_dwordx4 v241, s[32:35], s45 offen offset:1024 lds
v_mfma_f32_16x16x32_bf16 v[140:143], a[240:243], v[164:167], v[116:119]
ds_read_b64_tr_b16 a[216:217], v230 offset:32768
v_max3_f32 v244, v124, v125, v126
v_mfma_f32_16x16x32_bf16 v[140:143], a[244:247], v[176:179], v[140:143]
ds_read_b64_tr_b16 a[218:219], v230 offset:36864
v_max3_f32 v244, v244, v127, v136
v_mfma_f32_16x16x32_bf16 v[140:143], a[248:251], v[188:191], v[140:143]
ds_read_b64_tr_b16 a[220:221], v231 offset:32768
v_max3_f32 v244, v244, v137, v138
v_mfma_f32_16x16x32_bf16 v[140:143], a[252:255], v[200:203], v[140:143]
ds_read_b64_tr_b16 a[222:223], v231 offset:36864
v_max_f32 v244, v244, v139
v_mfma_f32_16x16x32_bf16 v[132:135], a[224:227], v[168:171], v[120:123]
buffer_load_dwordx4 v242, s[32:35], s45 offen offset:2048 lds
v_mfma_f32_16x16x32_bf16 v[132:135], a[228:231], v[180:183], v[132:135]
v_mfma_f32_16x16x32_bf16 v[132:135], a[232:235], v[192:195], v[132:135]
v_mfma_f32_16x16x32_bf16 v[132:135], a[236:239], v[204:207], v[132:135]
v_max3_f32 v245, v128, v129, v130
v_max3_f32 v245, v245, v131, v140
v_mfma_f32_16x16x32_bf16 v[144:147], a[240:243], v[168:171], v[120:123]
v_max3_f32 v245, v245, v141, v142
v_max_f32 v245, v245, v143
v_mfma_f32_16x16x32_bf16 v[144:147], a[244:247], v[180:183], v[144:147]
buffer_load_dwordx4 v243, s[32:35], s45 offen offset:3072 lds
v_mfma_f32_16x16x32_bf16 v[144:147], a[248:251], v[192:195], v[144:147]
v_mfma_f32_16x16x32_bf16 v[144:147], a[252:255], v[204:207], v[144:147]
s_waitcnt vmcnt(8) lgkmcnt(0)
s_barrier
v_mfma_f32_16x16x32_bf16 a[96:99], a[192:195], v[208:211], 0
ds_read_b64_tr_b16 a[224:225], v224 offset:49152
s_add_u32 s44, s11, 24576
s_and_b32 s44, s44, 0x1ffff
v_mfma_f32_16x16x32_bf16 a[100:103], a[192:195], v[212:215], 0
ds_read_b64_tr_b16 a[226:227], v224 offset:53248
ds_read_b64_tr_b16 a[228:229], v225 offset:49152
s_add_u32 s44, s44, s49
v_mfma_f32_16x16x32_bf16 a[104:107], a[192:195], v[216:219], 0
s_add_u32 m0, s47, 32768
s_nop 0
buffer_load_dwordx4 v236, s[16:19], s44 offen nt lds
v_mfma_f32_16x16x32_bf16 a[108:111], a[196:199], v[208:211], 0
ds_read_b64_tr_b16 a[230:231], v225 offset:53248
v_max3_f32 v246, v132, v133, v134
v_mfma_f32_16x16x32_bf16 a[112:115], a[196:199], v[212:215], 0
ds_read_b64_tr_b16 a[232:233], v226 offset:49152
v_max3_f32 v246, v246, v135, v144
v_mfma_f32_16x16x32_bf16 a[116:119], a[196:199], v[216:219], 0
v_max3_f32 v246, v246, v145, v146
v_max_f32 v246, v246, v147
v_mfma_f32_16x16x32_bf16 a[120:123], a[200:203], v[208:211], 0
v_max3_f32 v247, v244, v245, v246
v_cmp_lt_f32 vcc, s50, v247
s_cbranch_vccnz L_rs23
L_rb23:
v_mfma_f32_16x16x32_bf16 a[124:127], a[200:203], v[212:215], 0
v_exp_f32 v124, v124
v_mfma_f32_16x16x32_bf16 a[128:131], a[200:203], v[216:219], 0
buffer_load_dwordx4 v237, s[16:19], s44 offen offset:1024 nt lds
v_mfma_f32_16x16x32_bf16 a[132:135], a[204:207], v[208:211], 0
ds_read_b64_tr_b16 a[234:235], v226 offset:53248
v_exp_f32 v125, v125
v_mfma_f32_16x16x32_bf16 a[136:139], a[204:207], v[212:215], 0
ds_read_b64_tr_b16 a[236:237], v227 offset:49152
v_exp_f32 v126, v126
v_mfma_f32_16x16x32_bf16 a[140:143], a[204:207], v[216:219], 0
ds_read_b64_tr_b16 a[238:239], v227 offset:53248
v_exp_f32 v127, v127
v_mfma_f32_16x16x32_bf16 a[144:147], a[208:211], v[208:211], 0
ds_read_b64_tr_b16 a[240:241], v228 offset:49152
v_exp_f32 v136, v136
v_mfma_f32_16x16x32_bf16 a[148:151], a[208:211], v[212:215], 0
ds_read_b64_tr_b16 a[242:243], v228 offset:53248
v_exp_f32 v137, v137
v_mfma_f32_16x16x32_bf16 a[152:155], a[208:211], v[216:219], 0
buffer_load_dwordx4 v238, s[16:19], s44 offen offset:2048 nt lds
v_mfma_f32_16x16x32_bf16 a[156:159], a[212:215], v[208:211], 0
ds_read_b64_tr_b16 a[244:245], v229 offset:49152
v_exp_f32 v138, v138
v_mfma_f32_16x16x32_bf16 a[160:163], a[212:215], v[212:215], 0
ds_read_b64_tr_b16 a[246:247], v229 offset:53248
v_exp_f32 v139, v139
v_mfma_f32_16x16x32_bf16 a[164:167], a[212:215], v[216:219], 0
ds_read_b64_tr_b16 a[248:249], v230 offset:49152
v_cvt_pk_bf16_f32 v148, v124, v125
v_mfma_f32_16x16x32_bf16 a[168:171], a[216:219], v[208:211], 0
ds_read_b64_tr_b16 a[250:251], v230 offset:53248
v_cvt_pk_bf16_f32 v149, v126, v127
v_mfma_f32_16x16x32_bf16 a[172:175], a[216:219], v[212:215], 0
ds_read_b64_tr_b16 a[252:253], v231 offset:49152
ds_read_b64_tr_b16 a[254:255], v231 offset:53248
v_cvt_pk_bf16_f32 v150, v136, v137
v_mfma_f32_16x16x32_bf16 a[176:179], a[216:219], v[216:219], 0
buffer_load_dwordx4 v239, s[16:19], s44 offen offset:3072 nt lds
v_mfma_f32_16x16x32_bf16 a[180:183], a[220:223], v[208:211], 0
v_cvt_pk_bf16_f32 v151, v138, v139
v_exp_f32 v128, v128
v_mfma_f32_16x16x32_bf16 a[184:187], a[220:223], v[212:215], 0
v_exp_f32 v129, v129
v_exp_f32 v130, v130
v_mfma_f32_16x16x32_bf16 a[188:191], a[220:223], v[216:219], 0
v_exp_f32 v131, v131
s_waitcnt vmcnt(8) lgkmcnt(0)
s_barrier
v_mfma_f32_16x16x32_bf16 v[100:103], v[220:223], v[148:151], v[100:103]
s_add_u32 s44, s11, 32768
v_exp_f32 v140, v140
v_mfma_f32_16x16x32_bf16 v[4:7], a[224:227], v[148:151], v[4:7]
s_and_b32 s44, s44, 0x1ffff
v_exp_f32 v141, v141
v_mfma_f32_16x16x32_bf16 v[16:19], a[228:231], v[148:151], v[16:19]
s_add_u32 s44, s44, s49
v_exp_f32 v142, v142
v_mfma_f32_16x16x32_bf16 v[28:31], a[232:235], v[148:151], v[28:31]
s_add_u32 m0, s47, 49152
v_exp_f32 v143, v143
v_mfma_f32_16x16x32_bf16 v[40:43], a[236:239], v[148:151], v[40:43]
v_cvt_pk_bf16_f32 v152, v128, v129
v_cvt_pk_bf16_f32 v153, v130, v131
v_mfma_f32_16x16x32_bf16 v[52:55], a[240:243], v[148:151], v[52:55]
v_cvt_pk_bf16_f32 v154, v140, v141
v_cvt_pk_bf16_f32 v155, v142, v143
v_mfma_f32_16x16x32_bf16 v[64:67], a[244:247], v[148:151], v[64:67]
v_exp_f32 v132, v132
v_mfma_f32_16x16x32_bf16 v[76:79], a[248:251], v[148:151], v[76:79]
buffer_load_dwordx4 v236, s[12:15], s44 offen nt lds
v_mfma_f32_16x16x32_bf16 v[88:91], a[252:255], v[148:151], v[88:91]
v_exp_f32 v133, v133
v_mfma_f32_16x16x32_bf16 v[104:107], v[220:223], v[152:155], v[104:107]
v_exp_f32 v134, v134
v_mfma_f32_16x16x32_bf16 v[8:11], a[224:227], v[152:155], v[8:11]
v_exp_f32 v135, v135
v_mfma_f32_16x16x32_bf16 v[20:23], a[228:231], v[152:155], v[20:23]
v_exp_f32 v144, v144
v_mfma_f32_16x16x32_bf16 v[32:35], a[232:235], v[152:155], v[32:35]
buffer_load_dwordx4 v237, s[12:15], s44 offen offset:1024 nt lds
v_mfma_f32_16x16x32_bf16 v[44:47], a[236:239], v[152:155], v[44:47]
v_exp_f32 v145, v145
v_mfma_f32_16x16x32_bf16 v[56:59], a[240:243], v[152:155], v[56:59]
v_exp_f32 v146, v146
v_mfma_f32_16x16x32_bf16 v[68:71], a[244:247], v[152:155], v[68:71]
ds_read_b128 a[192:195], v232 offset:0
v_exp_f32 v147, v147
v_mfma_f32_16x16x32_bf16 v[80:83], a[248:251], v[152:155], v[80:83]
ds_read_b128 a[196:199], v233 offset:0
v_cvt_pk_bf16_f32 v156, v132, v133
v_cvt_pk_bf16_f32 v157, v134, v135
v_mfma_f32_16x16x32_bf16 v[92:95], a[252:255], v[152:155], v[92:95]
ds_read_b128 a[200:203], v234 offset:0
v_cvt_pk_bf16_f32 v158, v144, v145
v_cvt_pk_bf16_f32 v159, v146, v147
s_nop 1
v_mfma_f32_16x16x32_bf16 v[108:111], v[220:223], v[156:159], v[108:111]
ds_read_b128 a[204:207], v235 offset:0
ds_read_b128 a[208:211], v232 offset:4096
v_mfma_f32_16x16x32_bf16 v[12:15], a[224:227], v[156:159], v[12:15]
ds_read_b128 a[212:215], v233 offset:4096
v_mfma_f32_16x16x32_bf16 v[24:27], a[228:231], v[156:159], v[24:27]
buffer_load_dwordx4 v238, s[12:15], s44 offen offset:2048 nt lds
v_mfma_f32_16x16x32_bf16 v[36:39], a[232:235], v[156:159], v[36:39]
ds_read_b128 a[216:219], v234 offset:4096
ds_read_b128 a[220:223], v235 offset:4096
v_mfma_f32_16x16x32_bf16 v[48:51], a[236:239], v[156:159], v[48:51]
v_mfma_f32_16x16x32_bf16 v[60:63], a[240:243], v[156:159], v[60:63]
v_mfma_f32_16x16x32_bf16 v[72:75], a[244:247], v[156:159], v[72:75]
buffer_load_dwordx4 v239, s[12:15], s44 offen offset:3072 nt lds
v_mfma_f32_16x16x32_bf16 v[84:87], a[248:251], v[156:159], v[84:87]
L_here24:
s_getpc_b64 s[36:37]
L_pc25:
v_mfma_f32_16x16x32_bf16 v[96:99], a[252:255], v[156:159], v[96:99]
s_add_u32 s36, s36, L_here24-L_pc25
s_addc_u32 s37, s37, -1
s_and_b32 s37, s37, 0xffff
s_mov_b32 s38, L_codeend-L_here24
s_mov_b32 s39, 0x20000
s_and_b32 s52, s7, 7
s_lshl_b32 s52, s52, 2
s_add_u32 s52, s52, s4
s_lshl_b32 s52, s52, 11
v_and_b32 v248, 15, v1
v_lshlrev_b32 v248, 7, v248
buffer_load_dword v254, v248, s[36:39], s52 offen
s_waitcnt vmcnt(9) lgkmcnt(0)
s_barrier
v_mfma_f32_16x16x32_bf16 v[124:127], a[192:195], v[160:163], v[112:115]
ds_read_b64_tr_b16 a[224:225], v224 offset:16384
s_add_u32 s45, s57, 32768
s_add_u32 s45, s45, s30
v_mfma_f32_16x16x32_bf16 v[124:127], a[196:199], v[172:175], v[124:127]
ds_read_b64_tr_b16 a[226:227], v224 offset:20480
s_add_u32 m0, s47, 0
v_mfma_f32_16x16x32_bf16 v[124:127], a[200:203], v[184:187], v[124:127]
ds_read_b64_tr_b16 a[228:229], v225 offset:16384
v_mfma_f32_16x16x32_bf16 v[124:127], a[204:207], v[196:199], v[124:127]
ds_read_b64_tr_b16 a[230:231], v225 offset:20480
v_mfma_f32_16x16x32_bf16 v[136:139], a[208:211], v[160:163], v[112:115]
ds_read_b64_tr_b16 a[232:233], v226 offset:16384
ds_read_b64_tr_b16 a[234:235], v226 offset:20480
v_mfma_f32_16x16x32_bf16 v[136:139], a[212:215], v[172:175], v[136:139]
buffer_load_dwordx4 v240, s[32:35], s45 offen lds
v_mfma_f32_16x16x32_bf16 v[136:139], a[216:219], v[184:187], v[136:139]
ds_read_b64_tr_b16 a[236:237], v227 offset:16384
v_mfma_f32_16x16x32_bf16 v[136:139], a[220:223], v[196:199], v[136:139]
ds_read_b64_tr_b16 a[238:239], v227 offset:20480
v_mfma_f32_16x16x32_bf16 v[128:131], a[192:195], v[164:167], v[116:119]
ds_read_b64_tr_b16 a[240:241], v228 offset:16384
v_mfma_f32_16x16x32_bf16 v[128:131], a[196:199], v[176:179], v[128:131]
ds_read_b64_tr_b16 a[242:243], v228 offset:20480
v_mfma_f32_16x16x32_bf16 v[128:131], a[200:203], v[188:191], v[128:131]
ds_read_b64_tr_b16 a[244:245], v229 offset:16384
ds_read_b64_tr_b16 a[246:247], v229 offset:20480
v_mfma_f32_16x16x32_bf16 v[128:131], a[204:207], v[200:203], v[128:131]
buffer_load_dwordx4 v241, s[32:35], s45 offen offset:1024 lds
v_mfma_f32_16x16x32_bf16 v[140:143], a[208:211], v[164:167], v[116:119]
ds_read_b64_tr_b16 a[248:249], v230 offset:16384
v_max3_f32 v244, v124, v125, v126
v_mfma_f32_16x16x32_bf16 v[140:143], a[212:215], v[176:179], v[140:143]
ds_read_b64_tr_b16 a[250:251], v230 offset:20480
v_max3_f32 v244, v244, v127, v136
v_mfma_f32_16x16x32_bf16 v[140:143], a[216:219], v[188:191], v[140:143]
ds_read_b64_tr_b16 a[252:253], v231 offset:16384
v_max3_f32 v244, v244, v137, v138
v_mfma_f32_16x16x32_bf16 v[140:143], a[220:223], v[200:203], v[140:143]
ds_read_b64_tr_b16 a[254:255], v231 offset:20480
ds_read_b128 v[208:211], v3 offset:3072
v_max_f32 v244, v244, v139
v_mfma_f32_16x16x32_bf16 v[132:135], a[192:195], v[168:171], v[120:123]
buffer_load_dwordx4 v242, s[32:35], s45 offen offset:2048 lds
v_mfma_f32_16x16x32_bf16 v[132:135], a[196:199], v[180:183], v[132:135]
ds_read_b128 v[212:215], v3 offset:4096
v_mfma_f32_16x16x32_bf16 v[132:135], a[200:203], v[192:195], v[132:135]
ds_read_b128 v[216:219], v3 offset:5120
v_mfma_f32_16x16x32_bf16 v[132:135], a[204:207], v[204:207], v[132:135]
v_max3_f32 v245, v128, v129, v130
v_max3_f32 v245, v245, v131, v140
v_mfma_f32_16x16x32_bf16 v[144:147], a[208:211], v[168:171], v[120:123]
v_max3_f32 v245, v245, v141, v142
v_max_f32 v245, v245, v143
v_mfma_f32_16x16x32_bf16 v[144:147], a[212:215], v[180:183], v[144:147]
buffer_load_dwordx4 v243, s[32:35], s45 offen offset:3072 lds
v_mfma_f32_16x16x32_bf16 v[144:147], a[216:219], v[192:195], v[144:147]
v_mfma_f32_16x16x32_bf16 v[144:147], a[220:223], v[204:207], v[144:147]
s_waitcnt vmcnt(9) lgkmcnt(0)
s_barrier
v_mfma_f32_16x16x32_bf16 a[0:3], a[224:227], v[208:211], a[0:3]
ds_read_b64_tr_b16 a[192:193], v224 offset:32768
s_add_u32 s44, s11, 32768
s_and_b32 s44, s44, 0x1ffff
v_mfma_f32_16x16x32_bf16 a[4:7], a[224:227], v[212:215], a[4:7]
ds_read_b64_tr_b16 a[194:195], v224 offset:36864
ds_read_b64_tr_b16 a[196:197], v225 offset:32768
s_add_u32 s44, s44, s49
v_mfma_f32_16x16x32_bf16 a[8:11], a[224:227], v[216:219], a[8:11]
s_add_u32 m0, s47, 16384
s_nop 0
buffer_load_dwordx4 v236, s[16:19], s44 offen nt lds
v_mfma_f32_16x16x32_bf16 a[12:15], a[228:231], v[208:211], a[12:15]
ds_read_b64_tr_b16 a[198:199], v225 offset:36864
v_max3_f32 v246, v132, v133, v134
v_mfma_f32_16x16x32_bf16 a[16:19], a[228:231], v[212:215], a[16:19]
ds_read_b64_tr_b16 a[200:201], v226 offset:32768
v_max3_f32 v246, v246, v135, v144
v_mfma_f32_16x16x32_bf16 a[20:23], a[228:231], v[216:219], a[20:23]
v_max3_f32 v246, v246, v145, v146
v_max_f32 v246, v246, v147
v_mfma_f32_16x16x32_bf16 a[24:27], a[232:235], v[208:211], a[24:27]
v_max3_f32 v247, v244, v245, v246
v_cmp_lt_f32 vcc, s50, v247
s_cbranch_vccnz L_rs26
L_rb26:
v_mfma_f32_16x16x32_bf16 a[28:31], a[232:235], v[212:215], a[28:31]
v_exp_f32 v124, v124
v_mfma_f32_16x16x32_bf16 a[32:35], a[232:235], v[216:219], a[32:35]
buffer_load_dwordx4 v237, s[16:19], s44 offen offset:1024 nt lds
v_mfma_f32_16x16x32_bf16 a[36:39], a[236:239], v[208:211], a[36:39]
ds_read_b64_tr_b16 a[202:203], v226 offset:36864
v_exp_f32 v125, v125
v_mfma_f32_16x16x32_bf16 a[40:43], a[236:239], v[212:215], a[40:43]
ds_read_b64_tr_b16 a[204:205], v227 offset:32768
v_exp_f32 v126, v126
v_mfma_f32_16x16x32_bf16 a[44:47], a[236:239], v[216:219], a[44:47]
ds_read_b64_tr_b16 a[206:207], v227 offset:36864
v_exp_f32 v127, v127
v_mfma_f32_16x16x32_bf16 a[48:51], a[240:243], v[208:211], a[48:51]
ds_read_b64_tr_b16 a[208:209], v228 offset:32768
v_exp_f32 v136, v136
v_mfma_f32_16x16x32_bf16 a[52:55], a[240:243], v[212:215], a[52:55]
ds_read_b64_tr_b16 a[210:211], v228 offset:36864
v_exp_f32 v137, v137
v_mfma_f32_16x16x32_bf16 a[56:59], a[240:243], v[216:219], a[56:59]
buffer_load_dwordx4 v238, s[16:19], s44 offen offset:2048 nt lds
v_mfma_f32_16x16x32_bf16 a[60:63], a[244:247], v[208:211], a[60:63]
ds_read_b64_tr_b16 a[212:213], v229 offset:32768
v_exp_f32 v138, v138
v_mfma_f32_16x16x32_bf16 a[64:67], a[244:247], v[212:215], a[64:67]
ds_read_b64_tr_b16 a[214:215], v229 offset:36864
v_exp_f32 v139, v139
v_mfma_f32_16x16x32_bf16 a[68:71], a[244:247], v[216:219], a[68:71]
ds_read_b64_tr_b16 a[216:217], v230 offset:32768
v_cvt_pk_bf16_f32 v148, v124, v125
v_mfma_f32_16x16x32_bf16 a[72:75], a[248:251], v[208:211], a[72:75]
ds_read_b64_tr_b16 a[218:219], v230 offset:36864
v_cvt_pk_bf16_f32 v149, v126, v127
v_mfma_f32_16x16x32_bf16 a[76:79], a[248:251], v[212:215], a[76:79]
ds_read_b64_tr_b16 a[220:221], v231 offset:32768
ds_read_b64_tr_b16 a[222:223], v231 offset:36864
v_cvt_pk_bf16_f32 v150, v136, v137
v_mfma_f32_16x16x32_bf16 a[80:83], a[248:251], v[216:219], a[80:83]
buffer_load_dwordx4 v239, s[16:19], s44 offen offset:3072 nt lds
v_mfma_f32_16x16x32_bf16 a[84:87], a[252:255], v[208:211], a[84:87]
v_cvt_pk_bf16_f32 v151, v138, v139
v_exp_f32 v128, v128
v_mfma_f32_16x16x32_bf16 a[88:91], a[252:255], v[212:215], a[88:91]
v_exp_f32 v129, v129
v_exp_f32 v130, v130
v_mfma_f32_16x16x32_bf16 a[92:95], a[252:255], v[216:219], a[92:95]
v_exp_f32 v131, v131
s_waitcnt vmcnt(9) lgkmcnt(0)
s_barrier
v_mfma_f32_16x16x32_bf16 v[100:103], v[220:223], v[148:151], v[100:103]
s_add_u32 s44, s11, 40960
v_exp_f32 v140, v140
v_mfma_f32_16x16x32_bf16 v[4:7], a[192:195], v[148:151], v[4:7]
s_and_b32 s44, s44, 0x1ffff
v_exp_f32 v141, v141
v_mfma_f32_16x16x32_bf16 v[16:19], a[196:199], v[148:151], v[16:19]
s_add_u32 s44, s44, s49
v_exp_f32 v142, v142
v_mfma_f32_16x16x32_bf16 v[28:31], a[200:203], v[148:151], v[28:31]
s_add_u32 m0, s47, 32768
v_exp_f32 v143, v143
v_mfma_f32_16x16x32_bf16 v[40:43], a[204:207], v[148:151], v[40:43]
v_cvt_pk_bf16_f32 v152, v128, v129
v_cvt_pk_bf16_f32 v153, v130, v131
v_mfma_f32_16x16x32_bf16 v[52:55], a[208:211], v[148:151], v[52:55]
v_cvt_pk_bf16_f32 v154, v140, v141
v_cvt_pk_bf16_f32 v155, v142, v143
v_mfma_f32_16x16x32_bf16 v[64:67], a[212:215], v[148:151], v[64:67]
v_exp_f32 v132, v132
v_mfma_f32_16x16x32_bf16 v[76:79], a[216:219], v[148:151], v[76:79]
buffer_load_dwordx4 v236, s[12:15], s44 offen nt lds
v_mfma_f32_16x16x32_bf16 v[88:91], a[220:223], v[148:151], v[88:91]
v_exp_f32 v133, v133
v_mfma_f32_16x16x32_bf16 v[104:107], v[220:223], v[152:155], v[104:107]
v_exp_f32 v134, v134
v_mfma_f32_16x16x32_bf16 v[8:11], a[192:195], v[152:155], v[8:11]
v_exp_f32 v135, v135
v_mfma_f32_16x16x32_bf16 v[20:23], a[196:199], v[152:155], v[20:23]
v_exp_f32 v144, v144
v_mfma_f32_16x16x32_bf16 v[32:35], a[200:203], v[152:155], v[32:35]
buffer_load_dwordx4 v237, s[12:15], s44 offen offset:1024 nt lds
v_mfma_f32_16x16x32_bf16 v[44:47], a[204:207], v[152:155], v[44:47]
v_exp_f32 v145, v145
v_mfma_f32_16x16x32_bf16 v[56:59], a[208:211], v[152:155], v[56:59]
v_exp_f32 v146, v146
v_mfma_f32_16x16x32_bf16 v[68:71], a[212:215], v[152:155], v[68:71]
ds_read_b128 a[224:227], v232 offset:49152
v_exp_f32 v147, v147
v_mfma_f32_16x16x32_bf16 v[80:83], a[216:219], v[152:155], v[80:83]
ds_read_b128 a[228:231], v233 offset:49152
v_cvt_pk_bf16_f32 v156, v132, v133
v_cvt_pk_bf16_f32 v157, v134, v135
v_mfma_f32_16x16x32_bf16 v[92:95], a[220:223], v[152:155], v[92:95]
ds_read_b128 a[232:235], v234 offset:49152
v_cvt_pk_bf16_f32 v158, v144, v145
v_cvt_pk_bf16_f32 v159, v146, v147
s_nop 1
v_mfma_f32_16x16x32_bf16 v[108:111], v[220:223], v[156:159], v[108:111]
ds_read_b128 a[236:239], v235 offset:49152
ds_read_b128 a[240:243], v232 offset:53248
v_mfma_f32_16x16x32_bf16 v[12:15], a[192:195], v[156:159], v[12:15]
ds_read_b128 a[244:247], v233 offset:53248
v_mfma_f32_16x16x32_bf16 v[24:27], a[196:199], v[156:159], v[24:27]
buffer_load_dwordx4 v238, s[12:15], s44 offen offset:2048 nt lds
v_mfma_f32_16x16x32_bf16 v[36:39], a[200:203], v[156:159], v[36:39]
ds_read_b128 a[248:251], v234 offset:53248
ds_read_b128 a[252:255], v235 offset:53248
v_mfma_f32_16x16x32_bf16 v[48:51], a[204:207], v[156:159], v[48:51]
v_mfma_f32_16x16x32_bf16 v[60:63], a[208:211], v[156:159], v[60:63]
v_mfma_f32_16x16x32_bf16 v[72:75], a[212:215], v[156:159], v[72:75]
buffer_load_dwordx4 v239, s[12:15], s44 offen offset:3072 nt lds
v_mfma_f32_16x16x32_bf16 v[84:87], a[216:219], v[156:159], v[84:87]
v_mfma_f32_16x16x32_bf16 v[96:99], a[220:223], v[156:159], v[96:99]
s_waitcnt vmcnt(8) lgkmcnt(0)
s_barrier
v_mfma_f32_16x16x32_bf16 v[124:127], a[224:227], v[160:163], v[112:115]
ds_read_b64_tr_b16 a[192:193], v224 offset:0
s_add_u32 s45, s57, 65536
s_add_u32 m0, s47, 49152
v_mfma_f32_16x16x32_bf16 v[124:127], a[228:231], v[172:175], v[124:127]
ds_read_b64_tr_b16 a[194:195], v224 offset:4096
v_mfma_f32_16x16x32_bf16 v[124:127], a[232:235], v[184:187], v[124:127]
ds_read_b64_tr_b16 a[196:197], v225 offset:0
v_mfma_f32_16x16x32_bf16 v[124:127], a[236:239], v[196:199], v[124:127]
ds_read_b64_tr_b16 a[198:199], v225 offset:4096
v_mfma_f32_16x16x32_bf16 v[136:139], a[240:243], v[160:163], v[112:115]
ds_read_b64_tr_b16 a[200:201], v226 offset:0
ds_read_b64_tr_b16 a[202:203], v226 offset:4096
v_mfma_f32_16x16x32_bf16 v[136:139], a[244:247], v[172:175], v[136:139]
buffer_load_dwordx4 v240, s[32:35], s45 offen lds
v_mfma_f32_16x16x32_bf16 v[136:139], a[248:251], v[184:187], v[136:139]
ds_read_b64_tr_b16 a[204:205], v227 offset:0
v_mfma_f32_16x16x32_bf16 v[136:139], a[252:255], v[196:199], v[136:139]
ds_read_b64_tr_b16 a[206:207], v227 offset:4096
v_mfma_f32_16x16x32_bf16 v[128:131], a[224:227], v[164:167], v[116:119]
ds_read_b64_tr_b16 a[208:209], v228 offset:0
v_mfma_f32_16x16x32_bf16 v[128:131], a[228:231], v[176:179], v[128:131]
ds_read_b64_tr_b16 a[210:211], v228 offset:4096
v_mfma_f32_16x16x32_bf16 v[128:131], a[232:235], v[188:191], v[128:131]
ds_read_b64_tr_b16 a[212:213], v229 offset:0
ds_read_b64_tr_b16 a[214:215], v229 offset:4096
v_mfma_f32_16x16x32_bf16 v[128:131], a[236:239], v[200:203], v[128:131]
buffer_load_dwordx4 v241, s[32:35], s45 offen offset:1024 lds
v_mfma_f32_16x16x32_bf16 v[140:143], a[240:243], v[164:167], v[116:119]
ds_read_b64_tr_b16 a[216:217], v230 offset:0
v_max3_f32 v244, v124, v125, v126
v_mfma_f32_16x16x32_bf16 v[140:143], a[244:247], v[176:179], v[140:143]
ds_read_b64_tr_b16 a[218:219], v230 offset:4096
v_max3_f32 v244, v244, v127, v136
v_mfma_f32_16x16x32_bf16 v[140:143], a[248:251], v[188:191], v[140:143]
ds_read_b64_tr_b16 a[220:221], v231 offset:0
v_max3_f32 v244, v244, v137, v138
v_mfma_f32_16x16x32_bf16 v[140:143], a[252:255], v[200:203], v[140:143]
ds_read_b64_tr_b16 a[222:223], v231 offset:4096
v_max_f32 v244, v244, v139
v_mfma_f32_16x16x32_bf16 v[132:135], a[224:227], v[168:171], v[120:123]
buffer_load_dwordx4 v242, s[32:35], s45 offen offset:2048 lds
v_mfma_f32_16x16x32_bf16 v[132:135], a[228:231], v[180:183], v[132:135]
v_mfma_f32_16x16x32_bf16 v[132:135], a[232:235], v[192:195], v[132:135]
v_mfma_f32_16x16x32_bf16 v[132:135], a[236:239], v[204:207], v[132:135]
v_max3_f32 v245, v128, v129, v130
v_max3_f32 v245, v245, v131, v140
v_mfma_f32_16x16x32_bf16 v[144:147], a[240:243], v[168:171], v[120:123]
v_max3_f32 v245, v245, v141, v142
v_max_f32 v245, v245, v143
v_mfma_f32_16x16x32_bf16 v[144:147], a[244:247], v[180:183], v[144:147]
buffer_load_dwordx4 v243, s[32:35], s45 offen offset:3072 lds
v_mfma_f32_16x16x32_bf16 v[144:147], a[248:251], v[192:195], v[144:147]
v_mfma_f32_16x16x32_bf16 v[144:147], a[252:255], v[204:207], v[144:147]
s_waitcnt vmcnt(8) lgkmcnt(0)
s_barrier
v_mfma_f32_16x16x32_bf16 a[96:99], a[192:195], v[208:211], a[96:99]
ds_read_b64_tr_b16 a[224:225], v224 offset:16384
s_add_u32 s44, s11, 40960
s_and_b32 s44, s44, 0x1ffff
v_mfma_f32_16x16x32_bf16 a[100:103], a[192:195], v[212:215], a[100:103]
ds_read_b64_tr_b16 a[226:227], v224 offset:20480
ds_read_b64_tr_b16 a[228:229], v225 offset:16384
s_add_u32 s44, s44, s49
v_mfma_f32_16x16x32_bf16 a[104:107], a[192:195], v[216:219], a[104:107]
s_add_u32 m0, s47, 0
s_nop 0
buffer_load_dwordx4 v236, s[16:19], s44 offen nt lds
v_mfma_f32_16x16x32_bf16 a[108:111], a[196:199], v[208:211], a[108:111]
ds_read_b64_tr_b16 a[230:231], v225 offset:20480
v_max3_f32 v246, v132, v133, v134
v_mfma_f32_16x16x32_bf16 a[112:115], a[196:199], v[212:215], a[112:115]
ds_read_b64_tr_b16 a[232:233], v226 offset:16384
v_max3_f32 v246, v246, v135, v144
v_mfma_f32_16x16x32_bf16 a[116:119], a[196:199], v[216:219], a[116:119]
v_max3_f32 v246, v246, v145, v146
v_max_f32 v246, v246, v147
v_mfma_f32_16x16x32_bf16 a[120:123], a[200:203], v[208:211], a[120:123]
v_max3_f32 v247, v244, v245, v246
v_cmp_lt_f32 vcc, s50, v247
s_cbranch_vccnz L_rs27
L_rb27:
v_mfma_f32_16x16x32_bf16 a[124:127], a[200:203], v[212:215], a[124:127]
v_exp_f32 v124, v124
v_mfma_f32_16x16x32_bf16 a[128:131], a[200:203], v[216:219], a[128:131]
buffer_load_dwordx4 v237, s[16:19], s44 offen offset:1024 nt lds
v_mfma_f32_16x16x32_bf16 a[132:135], a[204:207], v[208:211], a[132:135]
ds_read_b64_tr_b16 a[234:235], v226 offset:20480
v_exp_f32 v125, v125
v_mfma_f32_16x16x32_bf16 a[136:139], a[204:207], v[212:215], a[136:139]
ds_read_b64_tr_b16 a[236:237], v227 offset:16384
v_exp_f32 v126, v126
v_mfma_f32_16x16x32_bf16 a[140:143], a[204:207], v[216:219], a[140:143]
ds_read_b64_tr_b16 a[238:239], v227 offset:20480
v_exp_f32 v127, v127
v_mfma_f32_16x16x32_bf16 a[144:147], a[208:211], v[208:211], a[144:147]
ds_read_b64_tr_b16 a[240:241], v228 offset:16384
v_exp_f32 v136, v136
v_mfma_f32_16x16x32_bf16 a[148:151], a[208:211], v[212:215], a[148:151]
ds_read_b64_tr_b16 a[242:243], v228 offset:20480
v_exp_f32 v137, v137
v_mfma_f32_16x16x32_bf16 a[152:155], a[208:211], v[216:219], a[152:155]
buffer_load_dwordx4 v238, s[16:19], s44 offen offset:2048 nt lds
v_mfma_f32_16x16x32_bf16 a[156:159], a[212:215], v[208:211], a[156:159]
ds_read_b64_tr_b16 a[244:245], v229 offset:16384
v_exp_f32 v138, v138
v_mfma_f32_16x16x32_bf16 a[160:163], a[212:215], v[212:215], a[160:163]
ds_read_b64_tr_b16 a[246:247], v229 offset:20480
v_exp_f32 v139, v139
v_mfma_f32_16x16x32_bf16 a[164:167], a[212:215], v[216:219], a[164:167]
ds_read_b64_tr_b16 a[248:249], v230 offset:16384
v_cvt_pk_bf16_f32 v148, v124, v125
v_mfma_f32_16x16x32_bf16 a[168:171], a[216:219], v[208:211], a[168:171]
ds_read_b64_tr_b16 a[250:251], v230 offset:20480
v_cvt_pk_bf16_f32 v149, v126, v127
v_mfma_f32_16x16x32_bf16 a[172:175], a[216:219], v[212:215], a[172:175]
ds_read_b64_tr_b16 a[252:253], v231 offset:16384
ds_read_b64_tr_b16 a[254:255], v231 offset:20480
v_cvt_pk_bf16_f32 v150, v136, v137
v_mfma_f32_16x16x32_bf16 a[176:179], a[216:219], v[216:219], a[176:179]
buffer_load_dwordx4 v239, s[16:19], s44 offen offset:3072 nt lds
v_mfma_f32_16x16x32_bf16 a[180:183], a[220:223], v[208:211], a[180:183]
v_cvt_pk_bf16_f32 v151, v138, v139
v_exp_f32 v128, v128
v_mfma_f32_16x16x32_bf16 a[184:187], a[220:223], v[212:215], a[184:187]
v_exp_f32 v129, v129
v_exp_f32 v130, v130
v_mfma_f32_16x16x32_bf16 a[188:191], a[220:223], v[216:219], a[188:191]
v_exp_f32 v131, v131
s_waitcnt vmcnt(8) lgkmcnt(0)
s_barrier
v_mfma_f32_16x16x32_bf16 v[100:103], v[220:223], v[148:151], v[100:103]
s_add_u32 s44, s11, 49152
v_exp_f32 v140, v140
v_mfma_f32_16x16x32_bf16 v[4:7], a[224:227], v[148:151], v[4:7]
s_and_b32 s44, s44, 0x1ffff
v_exp_f32 v141, v141
v_mfma_f32_16x16x32_bf16 v[16:19], a[228:231], v[148:151], v[16:19]
s_add_u32 s44, s44, s49
v_exp_f32 v142, v142
v_mfma_f32_16x16x32_bf16 v[28:31], a[232:235], v[148:151], v[28:31]
s_add_u32 m0, s47, 16384
v_exp_f32 v143, v143
v_mfma_f32_16x16x32_bf16 v[40:43], a[236:239], v[148:151], v[40:43]
v_cvt_pk_bf16_f32 v152, v128, v129
v_cvt_pk_bf16_f32 v153, v130, v131
v_mfma_f32_16x16x32_bf16 v[52:55], a[240:243], v[148:151], v[52:55]
v_cvt_pk_bf16_f32 v154, v140, v141
v_cvt_pk_bf16_f32 v155, v142, v143
v_mfma_f32_16x16x32_bf16 v[64:67], a[244:247], v[148:151], v[64:67]
v_exp_f32 v132, v132
v_mfma_f32_16x16x32_bf16 v[76:79], a[248:251], v[148:151], v[76:79]
buffer_load_dwordx4 v236, s[12:15], s44 offen nt lds
v_mfma_f32_16x16x32_bf16 v[88:91], a[252:255], v[148:151], v[88:91]
v_exp_f32 v133, v133
v_mfma_f32_16x16x32_bf16 v[104:107], v[220:223], v[152:155], v[104:107]
v_exp_f32 v134, v134
v_mfma_f32_16x16x32_bf16 v[8:11], a[224:227], v[152:155], v[8:11]
v_exp_f32 v135, v135
v_mfma_f32_16x16x32_bf16 v[20:23], a[228:231], v[152:155], v[20:23]
v_exp_f32 v144, v144
v_mfma_f32_16x16x32_bf16 v[32:35], a[232:235], v[152:155], v[32:35]
buffer_load_dwordx4 v237, s[12:15], s44 offen offset:1024 nt lds
v_mfma_f32_16x16x32_bf16 v[44:47], a[236:239], v[152:155], v[44:47]
v_exp_f32 v145, v145
v_mfma_f32_16x16x32_bf16 v[56:59], a[240:243], v[152:155], v[56:59]
v_exp_f32 v146, v146
v_mfma_f32_16x16x32_bf16 v[68:71], a[244:247], v[152:155], v[68:71]
ds_read_b128 a[192:195], v232 offset:32768
v_exp_f32 v147, v147
v_mfma_f32_16x16x32_bf16 v[80:83], a[248:251], v[152:155], v[80:83]
ds_read_b128 a[196:199], v233 offset:32768
v_cvt_pk_bf16_f32 v156, v132, v133
v_cvt_pk_bf16_f32 v157, v134, v135
v_mfma_f32_16x16x32_bf16 v[92:95], a[252:255], v[152:155], v[92:95]
ds_read_b128 a[200:203], v234 offset:32768
v_cvt_pk_bf16_f32 v158, v144, v145
v_cvt_pk_bf16_f32 v159, v146, v147
s_nop 1
v_mfma_f32_16x16x32_bf16 v[108:111], v[220:223], v[156:159], v[108:111]
ds_read_b128 a[204:207], v235 offset:32768
ds_read_b128 a[208:211], v232 offset:36864
v_mfma_f32_16x16x32_bf16 v[12:15], a[224:227], v[156:159], v[12:15]
ds_read_b128 a[212:215], v233 offset:36864
v_mfma_f32_16x16x32_bf16 v[24:27], a[228:231], v[156:159], v[24:27]
buffer_load_dwordx4 v238, s[12:15], s44 offen offset:2048 nt lds
v_mfma_f32_16x16x32_bf16 v[36:39], a[232:235], v[156:159], v[36:39]
ds_read_b128 a[216:219], v234 offset:36864
ds_read_b128 a[220:223], v235 offset:36864
v_mfma_f32_16x16x32_bf16 v[48:51], a[236:239], v[156:159], v[48:51]
v_mfma_f32_16x16x32_bf16 v[60:63], a[240:243], v[156:159], v[60:63]
v_mfma_f32_16x16x32_bf16 v[72:75], a[244:247], v[156:159], v[72:75]
buffer_load_dwordx4 v239, s[12:15], s44 offen offset:3072 nt lds
v_mfma_f32_16x16x32_bf16 v[84:87], a[248:251], v[156:159], v[84:87]
v_mfma_f32_16x16x32_bf16 v[96:99], a[252:255], v[156:159], v[96:99]
s_waitcnt vmcnt(8) lgkmcnt(0)
s_barrier
v_mfma_f32_16x16x32_bf16 v[124:127], a[192:195], v[160:163], v[112:115]
ds_read_b64_tr_b16 a[224:225], v224 offset:49152
s_add_u32 s45, s57, 65536
s_add_u32 s45, s45, s30
v_mfma_f32_16x16x32_bf16 v[124:127], a[196:199], v[172:175], v[124:127]
ds_read_b64_tr_b16 a[226:227], v224 offset:53248
s_add_u32 m0, s47, 32768
v_mfma_f32_16x16x32_bf16 v[124:127], a[200:203], v[184:187], v[124:127]
ds_read_b64_tr_b16 a[228:229], v225 offset:49152
v_mfma_f32_16x16x32_bf16 v[124:127], a[204:207], v[196:199], v[124:127]
ds_read_b64_tr_b16 a[230:231], v225 offset:53248
v_mfma_f32_16x16x32_bf16 v[136:139], a[208:211], v[160:163], v[112:115]
ds_read_b64_tr_b16 a[232:233], v226 offset:49152
ds_read_b64_tr_b16 a[234:235], v226 offset:53248
v_mfma_f32_16x16x32_bf16 v[136:139], a[212:215], v[172:175], v[136:139]
buffer_load_dwordx4 v240, s[32:35], s45 offen lds
v_mfma_f32_16x16x32_bf16 v[136:139], a[216:219], v[184:187], v[136:139]
ds_read_b64_tr_b16 a[236:237], v227 offset:49152
v_mfma_f32_16x16x32_bf16 v[136:139], a[220:223], v[196:199], v[136:139]
ds_read_b64_tr_b16 a[238:239], v227 offset:53248
v_mfma_f32_16x16x32_bf16 v[128:131], a[192:195], v[164:167], v[116:119]
ds_read_b64_tr_b16 a[240:241], v228 offset:49152
v_mfma_f32_16x16x32_bf16 v[128:131], a[196:199], v[176:179], v[128:131]
ds_read_b64_tr_b16 a[242:243], v228 offset:53248
v_mfma_f32_16x16x32_bf16 v[128:131], a[200:203], v[188:191], v[128:131]
ds_read_b64_tr_b16 a[244:245], v229 offset:49152
ds_read_b64_tr_b16 a[246:247], v229 offset:53248
v_mfma_f32_16x16x32_bf16 v[128:131], a[204:207], v[200:203], v[128:131]
buffer_load_dwordx4 v241, s[32:35], s45 offen offset:1024 lds
v_mfma_f32_16x16x32_bf16 v[140:143], a[208:211], v[164:167], v[116:119]
ds_read_b64_tr_b16 a[248:249], v230 offset:49152
v_max3_f32 v244, v124, v125, v126
v_mfma_f32_16x16x32_bf16 v[140:143], a[212:215], v[176:179], v[140:143]
ds_read_b64_tr_b16 a[250:251], v230 offset:53248
v_max3_f32 v244, v244, v127, v136
v_mfma_f32_16x16x32_bf16 v[140:143], a[216:219], v[188:191], v[140:143]
ds_read_b64_tr_b16 a[252:253], v231 offset:49152
v_max3_f32 v244, v244, v137, v138
v_mfma_f32_16x16x32_bf16 v[140:143], a[220:223], v[200:203], v[140:143]
ds_read_b64_tr_b16 a[254:255], v231 offset:53248
ds_read_b128 v[208:211], v3 offset:6144
v_max_f32 v244, v244, v139
v_mfma_f32_16x16x32_bf16 v[132:135], a[192:195], v[168:171], v[120:123]
buffer_load_dwordx4 v242, s[32:35], s45 offen offset:2048 lds
v_mfma_f32_16x16x32_bf16 v[132:135], a[196:199], v[180:183], v[132:135]
ds_read_b128 v[212:215], v3 offset:7168
v_mfma_f32_16x16x32_bf16 v[132:135], a[200:203], v[192:195], v[132:135]
ds_read_b128 v[216:219], v3 offset:8192
v_mfma_f32_16x16x32_bf16 v[132:135], a[204:207], v[204:207], v[132:135]
v_max3_f32 v245, v128, v129, v130
v_max3_f32 v245, v245, v131, v140
v_mfma_f32_16x16x32_bf16 v[144:147], a[208:211], v[168:171], v[120:123]
v_max3_f32 v245, v245, v141, v142
v_max_f32 v245, v245, v143
v_mfma_f32_16x16x32_bf16 v[144:147], a[212:215], v[180:183], v[144:147]
buffer_load_dwordx4 v243, s[32:35], s45 offen offset:3072 lds
v_mfma_f32_16x16x32_bf16 v[144:147], a[216:219], v[192:195], v[144:147]
v_mfma_f32_16x16x32_bf16 v[144:147], a[220:223], v[204:207], v[144:147]
s_waitcnt vmcnt(8) lgkmcnt(0)
s_barrier
v_mfma_f32_16x16x32_bf16 a[0:3], a[224:227], v[208:211], a[0:3]
ds_read_b64_tr_b16 a[192:193], v224 offset:0
s_add_u32 s44, s11, 49152
s_and_b32 s44, s44, 0x1ffff
v_mfma_f32_16x16x32_bf16 a[4:7], a[224:227], v[212:215], a[4:7]
ds_read_b64_tr_b16 a[194:195], v224 offset:4096
ds_read_b64_tr_b16 a[196:197], v225 offset:0
s_add_u32 s44, s44, s49
v_mfma_f32_16x16x32_bf16 a[8:11], a[224:227], v[216:219], a[8:11]
s_add_u32 m0, s47, 49152
s_nop 0
buffer_load_dwordx4 v236, s[16:19], s44 offen nt lds
v_mfma_f32_16x16x32_bf16 a[12:15], a[228:231], v[208:211], a[12:15]
ds_read_b64_tr_b16 a[198:199], v225 offset:4096
v_max3_f32 v246, v132, v133, v134
v_mfma_f32_16x16x32_bf16 a[16:19], a[228:231], v[212:215], a[16:19]
ds_read_b64_tr_b16 a[200:201], v226 offset:0
v_max3_f32 v246, v246, v135, v144
v_mfma_f32_16x16x32_bf16 a[20:23], a[228:231], v[216:219], a[20:23]
v_max3_f32 v246, v246, v145, v146
v_max_f32 v246, v246, v147
v_mfma_f32_16x16x32_bf16 a[24:27], a[232:235], v[208:211], a[24:27]
v_max3_f32 v247, v244, v245, v246
v_cmp_lt_f32 vcc, s50, v247
s_cbranch_vccnz L_rs28
L_rb28:
v_mfma_f32_16x16x32_bf16 a[28:31], a[232:235], v[212:215], a[28:31]
v_exp_f32 v124, v124
v_mfma_f32_16x16x32_bf16 a[32:35], a[232:235], v[216:219], a[32:35]
buffer_load_dwordx4 v237, s[16:19], s44 offen offset:1024 nt lds
v_mfma_f32_16x16x32_bf16 a[36:39], a[236:239], v[208:211], a[36:39]
ds_read_b64_tr_b16 a[202:203], v226 offset:4096
v_exp_f32 v125, v125
v_mfma_f32_16x16x32_bf16 a[40:43], a[236:239], v[212:215], a[40:43]
ds_read_b64_tr_b16 a[204:205], v227 offset:0
v_exp_f32 v126, v126
v_mfma_f32_16x16x32_bf16 a[44:47], a[236:239], v[216:219], a[44:47]
ds_read_b64_tr_b16 a[206:207], v227 offset:4096
v_exp_f32 v127, v127
v_mfma_f32_16x16x32_bf16 a[48:51], a[240:243], v[208:211], a[48:51]
ds_read_b64_tr_b16 a[208:209], v228 offset:0
v_exp_f32 v136, v136
v_mfma_f32_16x16x32_bf16 a[52:55], a[240:243], v[212:215], a[52:55]
ds_read_b64_tr_b16 a[210:211], v228 offset:4096
v_exp_f32 v137, v137
v_mfma_f32_16x16x32_bf16 a[56:59], a[240:243], v[216:219], a[56:59]
buffer_load_dwordx4 v238, s[16:19], s44 offen offset:2048 nt lds
v_mfma_f32_16x16x32_bf16 a[60:63], a[244:247], v[208:211], a[60:63]
ds_read_b64_tr_b16 a[212:213], v229 offset:0
v_exp_f32 v138, v138
v_mfma_f32_16x16x32_bf16 a[64:67], a[244:247], v[212:215], a[64:67]
ds_read_b64_tr_b16 a[214:215], v229 offset:4096
v_exp_f32 v139, v139
v_mfma_f32_16x16x32_bf16 a[68:71], a[244:247], v[216:219], a[68:71]
ds_read_b64_tr_b16 a[216:217], v230 offset:0
v_cvt_pk_bf16_f32 v148, v124, v125
v_mfma_f32_16x16x32_bf16 a[72:75], a[248:251], v[208:211], a[72:75]
ds_read_b64_tr_b16 a[218:219], v230 offset:4096
v_cvt_pk_bf16_f32 v149, v126, v127
v_mfma_f32_16x16x32_bf16 a[76:79], a[248:251], v[212:215], a[76:79]
ds_read_b64_tr_b16 a[220:221], v231 offset:0
ds_read_b64_tr_b16 a[222:223], v231 offset:4096
v_cvt_pk_bf16_f32 v150, v136, v137
v_mfma_f32_16x16x32_bf16 a[80:83], a[248:251], v[216:219], a[80:83]
buffer_load_dwordx4 v239, s[16:19], s44 offen offset:3072 nt lds
v_mfma_f32_16x16x32_bf16 a[84:87], a[252:255], v[208:211], a[84:87]
v_cvt_pk_bf16_f32 v151, v138, v139
v_exp_f32 v128, v128
v_mfma_f32_16x16x32_bf16 a[88:91], a[252:255], v[212:215], a[88:91]
v_exp_f32 v129, v129
v_exp_f32 v130, v130
v_mfma_f32_16x16x32_bf16 a[92:95], a[252:255], v[216:219], a[92:95]
v_exp_f32 v131, v131
s_waitcnt vmcnt(8) lgkmcnt(0)
s_barrier
v_mfma_f32_16x16x32_bf16 v[100:103], v[220:223], v[148:151], v[100:103]
s_add_u32 s44, s11, 57344
v_exp_f32 v140, v140
v_mfma_f32_16x16x32_bf16 v[4:7], a[192:195], v[148:151], v[4:7]
s_and_b32 s44, s44, 0x1ffff
v_exp_f32 v141, v141
v_mfma_f32_16x16x32_bf16 v[16:19], a[196:199], v[148:151], v[16:19]
s_add_u32 s44, s44, s49
v_exp_f32 v142, v142
v_mfma_f32_16x16x32_bf16 v[28:31], a[200:203], v[148:151], v[28:31]
s_add_u32 m0, s47, 0
v_exp_f32 v143, v143
v_mfma_f32_16x16x32_bf16 v[40:43], a[204:207], v[148:151], v[40:43]
v_cvt_pk_bf16_f32 v152, v128, v129
v_cvt_pk_bf16_f32 v153, v130, v131
v_mfma_f32_16x16x32_bf16 v[52:55], a[208:211], v[148:151], v[52:55]
v_cvt_pk_bf16_f32 v154, v140, v141
v_cvt_pk_bf16_f32 v155, v142, v143
v_mfma_f32_16x16x32_bf16 v[64:67], a[212:215], v[148:151], v[64:67]
v_exp_f32 v132, v132
v_mfma_f32_16x16x32_bf16 v[76:79], a[216:219], v[148:151], v[76:79]
buffer_load_dwordx4 v236, s[12:15], s44 offen nt lds
v_mfma_f32_16x16x32_bf16 v[88:91], a[220:223], v[148:151], v[88:91]
v_exp_f32 v133, v133
v_mfma_f32_16x16x32_bf16 v[104:107], v[220:223], v[152:155], v[104:107]
v_exp_f32 v134, v134
v_mfma_f32_16x16x32_bf16 v[8:11], a[192:195], v[152:155], v[8:11]
v_exp_f32 v135, v135
v_mfma_f32_16x16x32_bf16 v[20:23], a[196:199], v[152:155], v[20:23]
v_exp_f32 v144, v144
v_mfma_f32_16x16x32_bf16 v[32:35], a[200:203], v[152:155], v[32:35]
buffer_load_dwordx4 v237, s[12:15], s44 offen offset:1024 nt lds
v_mfma_f32_16x16x32_bf16 v[44:47], a[204:207], v[152:155], v[44:47]
v_exp_f32 v145, v145
v_mfma_f32_16x16x32_bf16 v[56:59], a[208:211], v[152:155], v[56:59]
v_exp_f32 v146, v146
v_mfma_f32_16x16x32_bf16 v[68:71], a[212:215], v[152:155], v[68:71]
ds_read_b128 a[224:227], v232 offset:16384
v_exp_f32 v147, v147
v_mfma_f32_16x16x32_bf16 v[80:83], a[216:219], v[152:155], v[80:83]
ds_read_b128 a[228:231], v233 offset:16384
v_cvt_pk_bf16_f32 v156, v132, v133
v_cvt_pk_bf16_f32 v157, v134, v135
v_mfma_f32_16x16x32_bf16 v[92:95], a[220:223], v[152:155], v[92:95]
ds_read_b128 a[232:235], v234 offset:16384
v_cvt_pk_bf16_f32 v158, v144, v145
v_cvt_pk_bf16_f32 v159, v146, v147
s_nop 1
v_mfma_f32_16x16x32_bf16 v[108:111], v[220:223], v[156:159], v[108:111]
ds_read_b128 a[236:239], v235 offset:16384
ds_read_b128 a[240:243], v232 offset:20480
v_mfma_f32_16x16x32_bf16 v[12:15], a[192:195], v[156:159], v[12:15]
ds_read_b128 a[244:247], v233 offset:20480
v_mfma_f32_16x16x32_bf16 v[24:27], a[196:199], v[156:159], v[24:27]
buffer_load_dwordx4 v238, s[12:15], s44 offen offset:2048 nt lds
v_mfma_f32_16x16x32_bf16 v[36:39], a[200:203], v[156:159], v[36:39]
ds_read_b128 a[248:251], v234 offset:20480
ds_read_b128 a[252:255], v235 offset:20480
v_mfma_f32_16x16x32_bf16 v[48:51], a[204:207], v[156:159], v[48:51]
v_mfma_f32_16x16x32_bf16 v[60:63], a[208:211], v[156:159], v[60:63]
v_mfma_f32_16x16x32_bf16 v[72:75], a[212:215], v[156:159], v[72:75]
buffer_load_dwordx4 v239, s[12:15], s44 offen offset:3072 nt lds
v_mfma_f32_16x16x32_bf16 v[84:87], a[216:219], v[156:159], v[84:87]
v_mfma_f32_16x16x32_bf16 v[96:99], a[220:223], v[156:159], v[96:99]
s_waitcnt vmcnt(8) lgkmcnt(0)
s_barrier
v_mfma_f32_16x16x32_bf16 v[124:127], a[224:227], v[160:163], v[112:115]
ds_read_b64_tr_b16 a[192:193], v224 offset:32768
s_add_u32 s45, s57, 98304
s_add_u32 m0, s47, 16384
v_mfma_f32_16x16x32_bf16 v[124:127], a[228:231], v[172:175], v[124:127]
ds_read_b64_tr_b16 a[194:195], v224 offset:36864
v_mfma_f32_16x16x32_bf16 v[124:127], a[232:235], v[184:187], v[124:127]
ds_read_b64_tr_b16 a[196:197], v225 offset:32768
v_mfma_f32_16x16x32_bf16 v[124:127], a[236:239], v[196:199], v[124:127]
ds_read_b64_tr_b16 a[198:199], v225 offset:36864
v_mfma_f32_16x16x32_bf16 v[136:139], a[240:243], v[160:163], v[112:115]
ds_read_b64_tr_b16 a[200:201], v226 offset:32768
ds_read_b64_tr_b16 a[202:203], v226 offset:36864
v_mfma_f32_16x16x32_bf16 v[136:139], a[244:247], v[172:175], v[136:139]
buffer_load_dwordx4 v240, s[32:35], s45 offen lds
v_mfma_f32_16x16x32_bf16 v[136:139], a[248:251], v[184:187], v[136:139]
ds_read_b64_tr_b16 a[204:205], v227 offset:32768
v_mfma_f32_16x16x32_bf16 v[136:139], a[252:255], v[196:199], v[136:139]
ds_read_b64_tr_b16 a[206:207], v227 offset:36864
v_mfma_f32_16x16x32_bf16 v[128:131], a[224:227], v[164:167], v[116:119]
ds_read_b64_tr_b16 a[208:209], v228 offset:32768
v_mfma_f32_16x16x32_bf16 v[128:131], a[228:231], v[176:179], v[128:131]
ds_read_b64_tr_b16 a[210:211], v228 offset:36864
v_mfma_f32_16x16x32_bf16 v[128:131], a[232:235], v[188:191], v[128:131]
ds_read_b64_tr_b16 a[212:213], v229 offset:32768
ds_read_b64_tr_b16 a[214:215], v229 offset:36864
v_mfma_f32_16x16x32_bf16 v[128:131], a[236:239], v[200:203], v[128:131]
buffer_load_dwordx4 v241, s[32:35], s45 offen offset:1024 lds
v_mfma_f32_16x16x32_bf16 v[140:143], a[240:243], v[164:167], v[116:119]
ds_read_b64_tr_b16 a[216:217], v230 offset:32768
v_max3_f32 v244, v124, v125, v126
v_mfma_f32_16x16x32_bf16 v[140:143], a[244:247], v[176:179], v[140:143]
ds_read_b64_tr_b16 a[218:219], v230 offset:36864
v_max3_f32 v244, v244, v127, v136
v_mfma_f32_16x16x32_bf16 v[140:143], a[248:251], v[188:191], v[140:143]
ds_read_b64_tr_b16 a[220:221], v231 offset:32768
v_max3_f32 v244, v244, v137, v138
v_mfma_f32_16x16x32_bf16 v[140:143], a[252:255], v[200:203], v[140:143]
ds_read_b64_tr_b16 a[222:223], v231 offset:36864
v_max_f32 v244, v244, v139
v_mfma_f32_16x16x32_bf16 v[132:135], a[224:227], v[168:171], v[120:123]
buffer_load_dwordx4 v242, s[32:35], s45 offen offset:2048 lds
v_mfma_f32_16x16x32_bf16 v[132:135], a[228:231], v[180:183], v[132:135]
v_mfma_f32_16x16x32_bf16 v[132:135], a[232:235], v[192:195], v[132:135]
v_mfma_f32_16x16x32_bf16 v[132:135], a[236:239], v[204:207], v[132:135]
v_max3_f32 v245, v128, v129, v130
v_max3_f32 v245, v245, v131, v140
v_mfma_f32_16x16x32_bf16 v[144:147], a[240:243], v[168:171], v[120:123]
v_max3_f32 v245, v245, v141, v142
v_max_f32 v245, v245, v143
v_mfma_f32_16x16x32_bf16 v[144:147], a[244:247], v[180:183], v[144:147]
buffer_load_dwordx4 v243, s[32:35], s45 offen offset:3072 lds
v_mfma_f32_16x16x32_bf16 v[144:147], a[248:251], v[192:195], v[144:147]
v_mfma_f32_16x16x32_bf16 v[144:147], a[252:255], v[204:207], v[144:147]
s_waitcnt vmcnt(8) lgkmcnt(0)
s_barrier
v_mfma_f32_16x16x32_bf16 a[96:99], a[192:195], v[208:211], a[96:99]
ds_read_b64_tr_b16 a[224:225], v224 offset:49152
s_add_u32 s44, s11, 57344
s_and_b32 s44, s44, 0x1ffff
v_mfma_f32_16x16x32_bf16 a[100:103], a[192:195], v[212:215], a[100:103]
ds_read_b64_tr_b16 a[226:227], v224 offset:53248
ds_read_b64_tr_b16 a[228:229], v225 offset:49152
s_add_u32 s44, s44, s49
v_mfma_f32_16x16x32_bf16 a[104:107], a[192:195], v[216:219], a[104:107]
s_add_u32 m0, s47, 32768
s_nop 0
buffer_load_dwordx4 v236, s[16:19], s44 offen nt lds
v_mfma_f32_16x16x32_bf16 a[108:111], a[196:199], v[208:211], a[108:111]
ds_read_b64_tr_b16 a[230:231], v225 offset:53248
v_max3_f32 v246, v132, v133, v134
v_mfma_f32_16x16x32_bf16 a[112:115], a[196:199], v[212:215], a[112:115]
ds_read_b64_tr_b16 a[232:233], v226 offset:49152
v_max3_f32 v246, v246, v135, v144
v_mfma_f32_16x16x32_bf16 a[116:119], a[196:199], v[216:219], a[116:119]
v_max3_f32 v246, v246, v145, v146
v_max_f32 v246, v246, v147
v_mfma_f32_16x16x32_bf16 a[120:123], a[200:203], v[208:211], a[120:123]
v_max3_f32 v247, v244, v245, v246
v_cmp_lt_f32 vcc, s50, v247
s_cbranch_vccnz L_rs29
L_rb29:
v_mfma_f32_16x16x32_bf16 a[124:127], a[200:203], v[212:215], a[124:127]
v_exp_f32 v124, v124
v_mfma_f32_16x16x32_bf16 a[128:131], a[200:203], v[216:219], a[128:131]
buffer_load_dwordx4 v237, s[16:19], s44 offen offset:1024 nt lds
v_mfma_f32_16x16x32_bf16 a[132:135], a[204:207], v[208:211], a[132:135]
ds_read_b64_tr_b16 a[234:235], v226 offset:53248
v_exp_f32 v125, v125
v_mfma_f32_16x16x32_bf16 a[136:139], a[204:207], v[212:215], a[136:139]
ds_read_b64_tr_b16 a[236:237], v227 offset:49152
v_exp_f32 v126, v126
v_mfma_f32_16x16x32_bf16 a[140:143], a[204:207], v[216:219], a[140:143]
ds_read_b64_tr_b16 a[238:239], v227 offset:53248
v_exp_f32 v127, v127
v_mfma_f32_16x16x32_bf16 a[144:147], a[208:211], v[208:211], a[144:147]
ds_read_b64_tr_b16 a[240:241], v228 offset:49152
v_exp_f32 v136, v136
v_mfma_f32_16x16x32_bf16 a[148:151], a[208:211], v[212:215], a[148:151]
ds_read_b64_tr_b16 a[242:243], v228 offset:53248
v_exp_f32 v137, v137
v_mfma_f32_16x16x32_bf16 a[152:155], a[208:211], v[216:219], a[152:155]
buffer_load_dwordx4 v238, s[16:19], s44 offen offset:2048 nt lds
v_mfma_f32_16x16x32_bf16 a[156:159], a[212:215], v[208:211], a[156:159]
ds_read_b64_tr_b16 a[244:245], v229 offset:49152
v_exp_f32 v138, v138
v_mfma_f32_16x16x32_bf16 a[160:163], a[212:215], v[212:215], a[160:163]
ds_read_b64_tr_b16 a[246:247], v229 offset:53248
v_exp_f32 v139, v139
v_mfma_f32_16x16x32_bf16 a[164:167], a[212:215], v[216:219], a[164:167]
ds_read_b64_tr_b16 a[248:249], v230 offset:49152
v_cvt_pk_bf16_f32 v148, v124, v125
v_mfma_f32_16x16x32_bf16 a[168:171], a[216:219], v[208:211], a[168:171]
ds_read_b64_tr_b16 a[250:251], v230 offset:53248
v_cvt_pk_bf16_f32 v149, v126, v127
v_mfma_f32_16x16x32_bf16 a[172:175], a[216:219], v[212:215], a[172:175]
ds_read_b64_tr_b16 a[252:253], v231 offset:49152
ds_read_b64_tr_b16 a[254:255], v231 offset:53248
v_cvt_pk_bf16_f32 v150, v136, v137
v_mfma_f32_16x16x32_bf16 a[176:179], a[216:219], v[216:219], a[176:179]
buffer_load_dwordx4 v239, s[16:19], s44 offen offset:3072 nt lds
v_mfma_f32_16x16x32_bf16 a[180:183], a[220:223], v[208:211], a[180:183]
v_cvt_pk_bf16_f32 v151, v138, v139
v_exp_f32 v128, v128
v_mfma_f32_16x16x32_bf16 a[184:187], a[220:223], v[212:215], a[184:187]
v_exp_f32 v129, v129
v_exp_f32 v130, v130
v_mfma_f32_16x16x32_bf16 a[188:191], a[220:223], v[216:219], a[188:191]
v_exp_f32 v131, v131
s_waitcnt vmcnt(8) lgkmcnt(0)
s_barrier
v_mfma_f32_16x16x32_bf16 v[100:103], v[220:223], v[148:151], v[100:103]
s_add_u32 s44, s11, 65536
v_exp_f32 v140, v140
v_mfma_f32_16x16x32_bf16 v[4:7], a[224:227], v[148:151], v[4:7]
s_and_b32 s44, s44, 0x1ffff
v_exp_f32 v141, v141
v_mfma_f32_16x16x32_bf16 v[16:19], a[228:231], v[148:151], v[16:19]
s_add_u32 s44, s44, s49
v_exp_f32 v142, v142
v_mfma_f32_16x16x32_bf16 v[28:31], a[232:235], v[148:151], v[28:31]
s_add_u32 m0, s47, 49152
v_exp_f32 v143, v143
v_mfma_f32_16x16x32_bf16 v[40:43], a[236:239], v[148:151], v[40:43]
v_cvt_pk_bf16_f32 v152, v128, v129
v_cvt_pk_bf16_f32 v153, v130, v131
v_mfma_f32_16x16x32_bf16 v[52:55], a[240:243], v[148:151], v[52:55]
v_cvt_pk_bf16_f32 v154, v140, v141
v_cvt_pk_bf16_f32 v155, v142, v143
v_mfma_f32_16x16x32_bf16 v[64:67], a[244:247], v[148:151], v[64:67]
v_exp_f32 v132, v132
v_mfma_f32_16x16x32_bf16 v[76:79], a[248:251], v[148:151], v[76:79]
buffer_load_dwordx4 v236, s[12:15], s44 offen nt lds
v_mfma_f32_16x16x32_bf16 v[88:91], a[252:255], v[148:151], v[88:91]
v_exp_f32 v133, v133
v_mfma_f32_16x16x32_bf16 v[104:107], v[220:223], v[152:155], v[104:107]
v_exp_f32 v134, v134
v_mfma_f32_16x16x32_bf16 v[8:11], a[224:227], v[152:155], v[8:11]
v_exp_f32 v135, v135
v_mfma_f32_16x16x32_bf16 v[20:23], a[228:231], v[152:155], v[20:23]
v_exp_f32 v144, v144
v_mfma_f32_16x16x32_bf16 v[32:35], a[232:235], v[152:155], v[32:35]
buffer_load_dwordx4 v237, s[12:15], s44 offen offset:1024 nt lds
v_mfma_f32_16x16x32_bf16 v[44:47], a[236:239], v[152:155], v[44:47]
v_exp_f32 v145, v145
v_mfma_f32_16x16x32_bf16 v[56:59], a[240:243], v[152:155], v[56:59]
v_exp_f32 v146, v146
v_mfma_f32_16x16x32_bf16 v[68:71], a[244:247], v[152:155], v[68:71]
ds_read_b128 a[192:195], v232 offset:0
v_exp_f32 v147, v147
v_mfma_f32_16x16x32_bf16 v[80:83], a[248:251], v[152:155], v[80:83]
ds_read_b128 a[196:199], v233 offset:0
v_cvt_pk_bf16_f32 v156, v132, v133
v_cvt_pk_bf16_f32 v157, v134, v135
v_mfma_f32_16x16x32_bf16 v[92:95], a[252:255], v[152:155], v[92:95]
ds_read_b128 a[200:203], v234 offset:0
v_cvt_pk_bf16_f32 v158, v144, v145
v_cvt_pk_bf16_f32 v159, v146, v147
s_nop 1
v_mfma_f32_16x16x32_bf16 v[108:111], v[220:223], v[156:159], v[108:111]
ds_read_b128 a[204:207], v235 offset:0
ds_read_b128 a[208:211], v232 offset:4096
v_mfma_f32_16x16x32_bf16 v[12:15], a[224:227], v[156:159], v[12:15]
ds_read_b128 a[212:215], v233 offset:4096
v_mfma_f32_16x16x32_bf16 v[24:27], a[228:231], v[156:159], v[24:27]
buffer_load_dwordx4 v238, s[12:15], s44 offen offset:2048 nt lds
v_mfma_f32_16x16x32_bf16 v[36:39], a[232:235], v[156:159], v[36:39]
ds_read_b128 a[216:219], v234 offset:4096
ds_read_b128 a[220:223], v235 offset:4096
v_mfma_f32_16x16x32_bf16 v[48:51], a[236:239], v[156:159], v[48:51]
v_mfma_f32_16x16x32_bf16 v[60:63], a[240:243], v[156:159], v[60:63]
v_mfma_f32_16x16x32_bf16 v[72:75], a[244:247], v[156:159], v[72:75]
buffer_load_dwordx4 v239, s[12:15], s44 offen offset:3072 nt lds
v_mfma_f32_16x16x32_bf16 v[84:87], a[248:251], v[156:159], v[84:87]
v_mfma_f32_16x16x32_bf16 v[96:99], a[252:255], v[156:159], v[96:99]
s_waitcnt vmcnt(8) lgkmcnt(0)
s_barrier
v_mfma_f32_16x16x32_bf16 v[124:127], a[192:195], v[160:163], v[112:115]
ds_read_b64_tr_b16 a[224:225], v224 offset:16384
s_add_u32 s45, s57, 98304
s_add_u32 s45, s45, s30
v_mfma_f32_16x16x32_bf16 v[124:127], a[196:199], v[172:175], v[124:127]
ds_read_b64_tr_b16 a[226:227], v224 offset:20480
s_add_u32 m0, s47, 0
v_mfma_f32_16x16x32_bf16 v[124:127], a[200:203], v[184:187], v[124:127]
ds_read_b64_tr_b16 a[228:229], v225 offset:16384
v_mfma_f32_16x16x32_bf16 v[124:127], a[204:207], v[196:199], v[124:127]
ds_read_b64_tr_b16 a[230:231], v225 offset:20480
v_mfma_f32_16x16x32_bf16 v[136:139], a[208:211], v[160:163], v[112:115]
ds_read_b64_tr_b16 a[232:233], v226 offset:16384
ds_read_b64_tr_b16 a[234:235], v226 offset:20480
v_mfma_f32_16x16x32_bf16 v[136:139], a[212:215], v[172:175], v[136:139]
buffer_load_dwordx4 v240, s[32:35], s45 offen lds
v_mfma_f32_16x16x32_bf16 v[136:139], a[216:219], v[184:187], v[136:139]
ds_read_b64_tr_b16 a[236:237], v227 offset:16384
v_mfma_f32_16x16x32_bf16 v[136:139], a[220:223], v[196:199], v[136:139]
ds_read_b64_tr_b16 a[238:239], v227 offset:20480
v_mfma_f32_16x16x32_bf16 v[128:131], a[192:195], v[164:167], v[116:119]
ds_read_b64_tr_b16 a[240:241], v228 offset:16384
v_mfma_f32_16x16x32_bf16 v[128:131], a[196:199], v[176:179], v[128:131]
ds_read_b64_tr_b16 a[242:243], v228 offset:20480
v_mfma_f32_16x16x32_bf16 v[128:131], a[200:203], v[188:191], v[128:131]
ds_read_b64_tr_b16 a[244:245], v229 offset:16384
ds_read_b64_tr_b16 a[246:247], v229 offset:20480
v_mfma_f32_16x16x32_bf16 v[128:131], a[204:207], v[200:203], v[128:131]
buffer_load_dwordx4 v241, s[32:35], s45 offen offset:1024 lds
v_mfma_f32_16x16x32_bf16 v[140:143], a[208:211], v[164:167], v[116:119]
ds_read_b64_tr_b16 a[248:249], v230 offset:16384
v_max3_f32 v244, v124, v125, v126
v_mfma_f32_16x16x32_bf16 v[140:143], a[212:215], v[176:179], v[140:143]
ds_read_b64_tr_b16 a[250:251], v230 offset:20480
v_max3_f32 v244, v244, v127, v136
v_mfma_f32_16x16x32_bf16 v[140:143], a[216:219], v[188:191], v[140:143]
ds_read_b64_tr_b16 a[252:253], v231 offset:16384
v_max3_f32 v244, v244, v137, v138
v_mfma_f32_16x16x32_bf16 v[140:143], a[220:223], v[200:203], v[140:143]
ds_read_b64_tr_b16 a[254:255], v231 offset:20480
ds_read_b128 v[208:211], v3 offset:9216
v_max_f32 v244, v244, v139
v_mfma_f32_16x16x32_bf16 v[132:135], a[192:195], v[168:171], v[120:123]
buffer_load_dwordx4 v242, s[32:35], s45 offen offset:2048 lds
v_mfma_f32_16x16x32_bf16 v[132:135], a[196:199], v[180:183], v[132:135]
ds_read_b128 v[212:215], v3 offset:10240
v_mfma_f32_16x16x32_bf16 v[132:135], a[200:203], v[192:195], v[132:135]
ds_read_b128 v[216:219], v3 offset:11264
v_mfma_f32_16x16x32_bf16 v[132:135], a[204:207], v[204:207], v[132:135]
v_max3_f32 v245, v128, v129, v130
v_max3_f32 v245, v245, v131, v140
v_mfma_f32_16x16x32_bf16 v[144:147], a[208:211], v[168:171], v[120:123]
v_max3_f32 v245, v245, v141, v142
v_max_f32 v245, v245, v143
v_mfma_f32_16x16x32_bf16 v[144:147], a[212:215], v[180:183], v[144:147]
buffer_load_dwordx4 v243, s[32:35], s45 offen offset:3072 lds
v_mfma_f32_16x16x32_bf16 v[144:147], a[216:219], v[192:195], v[144:147]
v_mfma_f32_16x16x32_bf16 v[144:147], a[220:223], v[204:207], v[144:147]
s_waitcnt vmcnt(8) lgkmcnt(0)
s_barrier
v_mfma_f32_16x16x32_bf16 a[0:3], a[224:227], v[208:211], a[0:3]
ds_read_b64_tr_b16 a[192:193], v224 offset:32768
s_add_u32 s44, s11, 65536
s_and_b32 s44, s44, 0x1ffff
v_mfma_f32_16x16x32_bf16 a[4:7], a[224:227], v[212:215], a[4:7]
ds_read_b64_tr_b16 a[194:195], v224 offset:36864
ds_read_b64_tr_b16 a[196:197], v225 offset:32768
s_add_u32 s44, s44, s49
v_mfma_f32_16x16x32_bf16 a[8:11], a[224:227], v[216:219], a[8:11]
s_add_u32 m0, s47, 16384
s_nop 0
buffer_load_dwordx4 v236, s[16:19], s44 offen nt lds
v_mfma_f32_16x16x32_bf16 a[12:15], a[228:231], v[208:211], a[12:15]
ds_read_b64_tr_b16 a[198:199], v225 offset:36864
v_max3_f32 v246, v132, v133, v134
v_mfma_f32_16x16x32_bf16 a[16:19], a[228:231], v[212:215], a[16:19]
ds_read_b64_tr_b16 a[200:201], v226 offset:32768
v_max3_f32 v246, v246, v135, v144
v_mfma_f32_16x16x32_bf16 a[20:23], a[228:231], v[216:219], a[20:23]
v_max3_f32 v246, v246, v145, v146
v_max_f32 v246, v246, v147
v_mfma_f32_16x16x32_bf16 a[24:27], a[232:235], v[208:211], a[24:27]
v_max3_f32 v247, v244, v245, v246
v_cmp_lt_f32 vcc, s50, v247
s_cbranch_vccnz L_rs30
L_rb30:
v_mfma_f32_16x16x32_bf16 a[28:31], a[232:235], v[212:215], a[28:31]
v_exp_f32 v124, v124
v_mfma_f32_16x16x32_bf16 a[32:35], a[232:235], v[216:219], a[32:35]
buffer_load_dwordx4 v237, s[16:19], s44 offen offset:1024 nt lds
v_mfma_f32_16x16x32_bf16 a[36:39], a[236:239], v[208:211], a[36:39]
ds_read_b64_tr_b16 a[202:203], v226 offset:36864
v_exp_f32 v125, v125
v_mfma_f32_16x16x32_bf16 a[40:43], a[236:239], v[212:215], a[40:43]
ds_read_b64_tr_b16 a[204:205], v227 offset:32768
v_exp_f32 v126, v126
v_mfma_f32_16x16x32_bf16 a[44:47], a[236:239], v[216:219], a[44:47]
ds_read_b64_tr_b16 a[206:207], v227 offset:36864
v_exp_f32 v127, v127
v_mfma_f32_16x16x32_bf16 a[48:51], a[240:243], v[208:211], a[48:51]
ds_read_b64_tr_b16 a[208:209], v228 offset:32768
v_exp_f32 v136, v136
v_mfma_f32_16x16x32_bf16 a[52:55], a[240:243], v[212:215], a[52:55]
ds_read_b64_tr_b16 a[210:211], v228 offset:36864
v_exp_f32 v137, v137
v_mfma_f32_16x16x32_bf16 a[56:59], a[240:243], v[216:219], a[56:59]
buffer_load_dwordx4 v238, s[16:19], s44 offen offset:2048 nt lds
v_mfma_f32_16x16x32_bf16 a[60:63], a[244:247], v[208:211], a[60:63]
ds_read_b64_tr_b16 a[212:213], v229 offset:32768
v_exp_f32 v138, v138
v_mfma_f32_16x16x32_bf16 a[64:67], a[244:247], v[212:215], a[64:67]
ds_read_b64_tr_b16 a[214:215], v229 offset:36864
v_exp_f32 v139, v139
v_mfma_f32_16x16x32_bf16 a[68:71], a[244:247], v[216:219], a[68:71]
ds_read_b64_tr_b16 a[216:217], v230 offset:32768
v_cvt_pk_bf16_f32 v148, v124, v125
v_mfma_f32_16x16x32_bf16 a[72:75], a[248:251], v[208:211], a[72:75]
ds_read_b64_tr_b16 a[218:219], v230 offset:36864
v_cvt_pk_bf16_f32 v149, v126, v127
v_mfma_f32_16x16x32_bf16 a[76:79], a[248:251], v[212:215], a[76:79]
ds_read_b64_tr_b16 a[220:221], v231 offset:32768
ds_read_b64_tr_b16 a[222:223], v231 offset:36864
v_cvt_pk_bf16_f32 v150, v136, v137
v_mfma_f32_16x16x32_bf16 a[80:83], a[248:251], v[216:219], a[80:83]
buffer_load_dwordx4 v239, s[16:19], s44 offen offset:3072 nt lds
v_mfma_f32_16x16x32_bf16 a[84:87], a[252:255], v[208:211], a[84:87]
v_cvt_pk_bf16_f32 v151, v138, v139
v_exp_f32 v128, v128
v_mfma_f32_16x16x32_bf16 a[88:91], a[252:255], v[212:215], a[88:91]
v_exp_f32 v129, v129
v_exp_f32 v130, v130
v_mfma_f32_16x16x32_bf16 a[92:95], a[252:255], v[216:219], a[92:95]
v_exp_f32 v131, v131
s_waitcnt vmcnt(8) lgkmcnt(0)
s_barrier
v_mfma_f32_16x16x32_bf16 v[100:103], v[220:223], v[148:151], v[100:103]
s_add_u32 s44, s11, 73728
v_exp_f32 v140, v140
v_mfma_f32_16x16x32_bf16 v[4:7], a[192:195], v[148:151], v[4:7]
s_and_b32 s44, s44, 0x1ffff
v_exp_f32 v141, v141
v_mfma_f32_16x16x32_bf16 v[16:19], a[196:199], v[148:151], v[16:19]
s_add_u32 s44, s44, s49
v_exp_f32 v142, v142
v_mfma_f32_16x16x32_bf16 v[28:31], a[200:203], v[148:151], v[28:31]
s_add_u32 m0, s47, 32768
v_exp_f32 v143, v143
v_mfma_f32_16x16x32_bf16 v[40:43], a[204:207], v[148:151], v[40:43]
v_cvt_pk_bf16_f32 v152, v128, v129
v_cvt_pk_bf16_f32 v153, v130, v131
v_mfma_f32_16x16x32_bf16 v[52:55], a[208:211], v[148:151], v[52:55]
v_cvt_pk_bf16_f32 v154, v140, v141
v_cvt_pk_bf16_f32 v155, v142, v143
v_mfma_f32_16x16x32_bf16 v[64:67], a[212:215], v[148:151], v[64:67]
v_exp_f32 v132, v132
v_mfma_f32_16x16x32_bf16 v[76:79], a[216:219], v[148:151], v[76:79]
buffer_load_dwordx4 v236, s[12:15], s44 offen nt lds
v_mfma_f32_16x16x32_bf16 v[88:91], a[220:223], v[148:151], v[88:91]
v_exp_f32 v133, v133
v_mfma_f32_16x16x32_bf16 v[104:107], v[220:223], v[152:155], v[104:107]
v_exp_f32 v134, v134
v_mfma_f32_16x16x32_bf16 v[8:11], a[192:195], v[152:155], v[8:11]
v_exp_f32 v135, v135
v_mfma_f32_16x16x32_bf16 v[20:23], a[196:199], v[152:155], v[20:23]
v_exp_f32 v144, v144
v_mfma_f32_16x16x32_bf16 v[32:35], a[200:203], v[152:155], v[32:35]
buffer_load_dwordx4 v237, s[12:15], s44 offen offset:1024 nt lds
v_mfma_f32_16x16x32_bf16 v[44:47], a[204:207], v[152:155], v[44:47]
v_exp_f32 v145, v145
v_mfma_f32_16x16x32_bf16 v[56:59], a[208:211], v[152:155], v[56:59]
v_exp_f32 v146, v146
v_mfma_f32_16x16x32_bf16 v[68:71], a[212:215], v[152:155], v[68:71]
ds_read_b128 a[224:227], v232 offset:49152
v_exp_f32 v147, v147
v_mfma_f32_16x16x32_bf16 v[80:83], a[216:219], v[152:155], v[80:83]
ds_read_b128 a[228:231], v233 offset:49152
v_cvt_pk_bf16_f32 v156, v132, v133
v_cvt_pk_bf16_f32 v157, v134, v135
v_mfma_f32_16x16x32_bf16 v[92:95], a[220:223], v[152:155], v[92:95]
ds_read_b128 a[232:235], v234 offset:49152
v_cvt_pk_bf16_f32 v158, v144, v145
v_cvt_pk_bf16_f32 v159, v146, v147
s_nop 1
v_mfma_f32_16x16x32_bf16 v[108:111], v[220:223], v[156:159], v[108:111]
ds_read_b128 a[236:239], v235 offset:49152
ds_read_b128 a[240:243], v232 offset:53248
v_mfma_f32_16x16x32_bf16 v[12:15], a[192:195], v[156:159], v[12:15]
ds_read_b128 a[244:247], v233 offset:53248
v_mfma_f32_16x16x32_bf16 v[24:27], a[196:199], v[156:159], v[24:27]
buffer_load_dwordx4 v238, s[12:15], s44 offen offset:2048 nt lds
v_mfma_f32_16x16x32_bf16 v[36:39], a[200:203], v[156:159], v[36:39]
ds_read_b128 a[248:251], v234 offset:53248
ds_read_b128 a[252:255], v235 offset:53248
v_mfma_f32_16x16x32_bf16 v[48:51], a[204:207], v[156:159], v[48:51]
v_mfma_f32_16x16x32_bf16 v[60:63], a[208:211], v[156:159], v[60:63]
v_mfma_f32_16x16x32_bf16 v[72:75], a[212:215], v[156:159], v[72:75]
buffer_load_dwordx4 v239, s[12:15], s44 offen offset:3072 nt lds
v_mfma_f32_16x16x32_bf16 v[84:87], a[216:219], v[156:159], v[84:87]
v_mfma_f32_16x16x32_bf16 v[96:99], a[220:223], v[156:159], v[96:99]
s_waitcnt vmcnt(8) lgkmcnt(0)
s_barrier
v_mfma_f32_16x16x32_bf16 v[124:127], a[224:227], v[160:163], v[112:115]
ds_read_b64_tr_b16 a[192:193], v224 offset:0
s_add_u32 s45, s57, 262144
s_add_u32 m0, s47, 49152
v_mfma_f32_16x16x32_bf16 v[124:127], a[228:231], v[172:175], v[124:127]
ds_read_b64_tr_b16 a[194:195], v224 offset:4096
v_mfma_f32_16x16x32_bf16 v[124:127], a[232:235], v[184:187], v[124:127]
ds_read_b64_tr_b16 a[196:197], v225 offset:0
v_mfma_f32_16x16x32_bf16 v[124:127], a[236:239], v[196:199], v[124:127]
ds_read_b64_tr_b16 a[198:199], v225 offset:4096
v_mfma_f32_16x16x32_bf16 v[136:139], a[240:243], v[160:163], v[112:115]
ds_read_b64_tr_b16 a[200:201], v226 offset:0
ds_read_b64_tr_b16 a[202:203], v226 offset:4096
v_mfma_f32_16x16x32_bf16 v[136:139], a[244:247], v[172:175], v[136:139]
buffer_load_dwordx4 v240, s[32:35], s45 offen lds
v_mfma_f32_16x16x32_bf16 v[136:139], a[248:251], v[184:187], v[136:139]
ds_read_b64_tr_b16 a[204:205], v227 offset:0
v_mfma_f32_16x16x32_bf16 v[136:139], a[252:255], v[196:199], v[136:139]
ds_read_b64_tr_b16 a[206:207], v227 offset:4096
v_mfma_f32_16x16x32_bf16 v[128:131], a[224:227], v[164:167], v[116:119]
ds_read_b64_tr_b16 a[208:209], v228 offset:0
v_mfma_f32_16x16x32_bf16 v[128:131], a[228:231], v[176:179], v[128:131]
ds_read_b64_tr_b16 a[210:211], v228 offset:4096
v_mfma_f32_16x16x32_bf16 v[128:131], a[232:235], v[188:191], v[128:131]
ds_read_b64_tr_b16 a[212:213], v229 offset:0
ds_read_b64_tr_b16 a[214:215], v229 offset:4096
v_mfma_f32_16x16x32_bf16 v[128:131], a[236:239], v[200:203], v[128:131]
buffer_load_dwordx4 v241, s[32:35], s45 offen offset:1024 lds
v_mfma_f32_16x16x32_bf16 v[140:143], a[240:243], v[164:167], v[116:119]
ds_read_b64_tr_b16 a[216:217], v230 offset:0
v_max3_f32 v244, v124, v125, v126
v_mfma_f32_16x16x32_bf16 v[140:143], a[244:247], v[176:179], v[140:143]
ds_read_b64_tr_b16 a[218:219], v230 offset:4096
v_max3_f32 v244, v244, v127, v136
v_mfma_f32_16x16x32_bf16 v[140:143], a[248:251], v[188:191], v[140:143]
ds_read_b64_tr_b16 a[220:221], v231 offset:0
v_max3_f32 v244, v244, v137, v138
v_mfma_f32_16x16x32_bf16 v[140:143], a[252:255], v[200:203], v[140:143]
ds_read_b64_tr_b16 a[222:223], v231 offset:4096
v_max_f32 v244, v244, v139
v_mfma_f32_16x16x32_bf16 v[132:135], a[224:227], v[168:171], v[120:123]
buffer_load_dwordx4 v242, s[32:35], s45 offen offset:2048 lds
v_mfma_f32_16x16x32_bf16 v[132:135], a[228:231], v[180:183], v[132:135]
v_mfma_f32_16x16x32_bf16 v[132:135], a[232:235], v[192:195], v[132:135]
v_mfma_f32_16x16x32_bf16 v[132:135], a[236:239], v[204:207], v[132:135]
v_max3_f32 v245, v128, v129, v130
v_max3_f32 v245, v245, v131, v140
v_mfma_f32_16x16x32_bf16 v[144:147], a[240:243], v[168:171], v[120:123]
v_max3_f32 v245, v245, v141, v142
v_max_f32 v245, v245, v143
v_mfma_f32_16x16x32_bf16 v[144:147], a[244:247], v[180:183], v[144:147]
buffer_load_dwordx4 v243, s[32:35], s45 offen offset:3072 lds
v_mfma_f32_16x16x32_bf16 v[144:147], a[248:251], v[192:195], v[144:147]
v_mfma_f32_16x16x32_bf16 v[144:147], a[252:255], v[204:207], v[144:147]
s_waitcnt vmcnt(8) lgkmcnt(0)
s_barrier
v_mfma_f32_16x16x32_bf16 a[96:99], a[192:195], v[208:211], a[96:99]
ds_read_b64_tr_b16 a[224:225], v224 offset:16384
s_add_u32 s44, s11, 73728
s_and_b32 s44, s44, 0x1ffff
v_mfma_f32_16x16x32_bf16 a[100:103], a[192:195], v[212:215], a[100:103]
ds_read_b64_tr_b16 a[226:227], v224 offset:20480
ds_read_b64_tr_b16 a[228:229], v225 offset:16384
s_add_u32 s44, s44, s49
v_mfma_f32_16x16x32_bf16 a[104:107], a[192:195], v[216:219], a[104:107]
s_add_u32 m0, s47, 0
s_nop 0
buffer_load_dwordx4 v236, s[16:19], s44 offen nt lds
v_mfma_f32_16x16x32_bf16 a[108:111], a[196:199], v[208:211], a[108:111]
ds_read_b64_tr_b16 a[230:231], v225 offset:20480
v_max3_f32 v246, v132, v133, v134
v_mfma_f32_16x16x32_bf16 a[112:115], a[196:199], v[212:215], a[112:115]
ds_read_b64_tr_b16 a[232:233], v226 offset:16384
v_max3_f32 v246, v246, v135, v144
v_mfma_f32_16x16x32_bf16 a[116:119], a[196:199], v[216:219], a[116:119]
v_max3_f32 v246, v246, v145, v146
v_max_f32 v246, v246, v147
v_mfma_f32_16x16x32_bf16 a[120:123], a[200:203], v[208:211], a[120:123]
v_max3_f32 v247, v244, v245, v246
v_cmp_lt_f32 vcc, s50, v247
s_cbranch_vccnz L_rs31
L_rb31:
v_mfma_f32_16x16x32_bf16 a[124:127], a[200:203], v[212:215], a[124:127]
v_exp_f32 v124, v124
v_mfma_f32_16x16x32_bf16 a[128:131], a[200:203], v[216:219], a[128:131]
buffer_load_dwordx4 v237, s[16:19], s44 offen offset:1024 nt lds
v_mfma_f32_16x16x32_bf16 a[132:135], a[204:207], v[208:211], a[132:135]
ds_read_b64_tr_b16 a[234:235], v226 offset:20480
v_exp_f32 v125, v125
v_mfma_f32_16x16x32_bf16 a[136:139], a[204:207], v[212:215], a[136:139]
ds_read_b64_tr_b16 a[236:237], v227 offset:16384
v_exp_f32 v126, v126
v_mfma_f32_16x16x32_bf16 a[140:143], a[204:207], v[216:219], a[140:143]
ds_read_b64_tr_b16 a[238:239], v227 offset:20480
v_exp_f32 v127, v127
v_mfma_f32_16x16x32_bf16 a[144:147], a[208:211], v[208:211], a[144:147]
ds_read_b64_tr_b16 a[240:241], v228 offset:16384
v_exp_f32 v136, v136
v_mfma_f32_16x16x32_bf16 a[148:151], a[208:211], v[212:215], a[148:151]
ds_read_b64_tr_b16 a[242:243], v228 offset:20480
v_exp_f32 v137, v137
v_mfma_f32_16x16x32_bf16 a[152:155], a[208:211], v[216:219], a[152:155]
buffer_load_dwordx4 v238, s[16:19], s44 offen offset:2048 nt lds
v_mfma_f32_16x16x32_bf16 a[156:159], a[212:215], v[208:211], a[156:159]
ds_read_b64_tr_b16 a[244:245], v229 offset:16384
v_exp_f32 v138, v138
v_mfma_f32_16x16x32_bf16 a[160:163], a[212:215], v[212:215], a[160:163]
ds_read_b64_tr_b16 a[246:247], v229 offset:20480
v_exp_f32 v139, v139
v_mfma_f32_16x16x32_bf16 a[164:167], a[212:215], v[216:219], a[164:167]
ds_read_b64_tr_b16 a[248:249], v230 offset:16384
v_cvt_pk_bf16_f32 v148, v124, v125
v_mfma_f32_16x16x32_bf16 a[168:171], a[216:219], v[208:211], a[168:171]
ds_read_b64_tr_b16 a[250:251], v230 offset:20480
v_cvt_pk_bf16_f32 v149, v126, v127
v_mfma_f32_16x16x32_bf16 a[172:175], a[216:219], v[212:215], a[172:175]
ds_read_b64_tr_b16 a[252:253], v231 offset:16384
ds_read_b64_tr_b16 a[254:255], v231 offset:20480
v_cvt_pk_bf16_f32 v150, v136, v137
v_mfma_f32_16x16x32_bf16 a[176:179], a[216:219], v[216:219], a[176:179]
buffer_load_dwordx4 v239, s[16:19], s44 offen offset:3072 nt lds
v_mfma_f32_16x16x32_bf16 a[180:183], a[220:223], v[208:211], a[180:183]
v_cvt_pk_bf16_f32 v151, v138, v139
v_exp_f32 v128, v128
v_mfma_f32_16x16x32_bf16 a[184:187], a[220:223], v[212:215], a[184:187]
v_exp_f32 v129, v129
v_exp_f32 v130, v130
v_mfma_f32_16x16x32_bf16 a[188:191], a[220:223], v[216:219], a[188:191]
v_exp_f32 v131, v131
s_waitcnt vmcnt(8) lgkmcnt(0)
s_barrier
v_mfma_f32_16x16x32_bf16 v[100:103], v[220:223], v[148:151], v[100:103]
s_add_u32 s44, s11, 81920
v_exp_f32 v140, v140
v_mfma_f32_16x16x32_bf16 v[4:7], a[224:227], v[148:151], v[4:7]
s_and_b32 s44, s44, 0x1ffff
v_exp_f32 v141, v141
v_mfma_f32_16x16x32_bf16 v[16:19], a[228:231], v[148:151], v[16:19]
s_add_u32 s44, s44, s49
v_exp_f32 v142, v142
v_mfma_f32_16x16x32_bf16 v[28:31], a[232:235], v[148:151], v[28:31]
s_add_u32 m0, s47, 16384
v_exp_f32 v143, v143
v_mfma_f32_16x16x32_bf16 v[40:43], a[236:239], v[148:151], v[40:43]
v_cvt_pk_bf16_f32 v152, v128, v129
v_cvt_pk_bf16_f32 v153, v130, v131
v_mfma_f32_16x16x32_bf16 v[52:55], a[240:243], v[148:151], v[52:55]
v_cvt_pk_bf16_f32 v154, v140, v141
v_cvt_pk_bf16_f32 v155, v142, v143
v_mfma_f32_16x16x32_bf16 v[64:67], a[244:247], v[148:151], v[64:67]
v_exp_f32 v132, v132
v_mfma_f32_16x16x32_bf16 v[76:79], a[248:251], v[148:151], v[76:79]
buffer_load_dwordx4 v236, s[12:15], s44 offen nt lds
v_mfma_f32_16x16x32_bf16 v[88:91], a[252:255], v[148:151], v[88:91]
v_exp_f32 v133, v133
v_mfma_f32_16x16x32_bf16 v[104:107], v[220:223], v[152:155], v[104:107]
v_exp_f32 v134, v134
v_mfma_f32_16x16x32_bf16 v[8:11], a[224:227], v[152:155], v[8:11]
v_exp_f32 v135, v135
v_mfma_f32_16x16x32_bf16 v[20:23], a[228:231], v[152:155], v[20:23]
v_exp_f32 v144, v144
v_mfma_f32_16x16x32_bf16 v[32:35], a[232:235], v[152:155], v[32:35]
buffer_load_dwordx4 v237, s[12:15], s44 offen offset:1024 nt lds
v_mfma_f32_16x16x32_bf16 v[44:47], a[236:239], v[152:155], v[44:47]
v_exp_f32 v145, v145
v_mfma_f32_16x16x32_bf16 v[56:59], a[240:243], v[152:155], v[56:59]
v_exp_f32 v146, v146
v_mfma_f32_16x16x32_bf16 v[68:71], a[244:247], v[152:155], v[68:71]
ds_read_b128 a[192:195], v232 offset:32768
v_exp_f32 v147, v147
v_mfma_f32_16x16x32_bf16 v[80:83], a[248:251], v[152:155], v[80:83]
ds_read_b128 a[196:199], v233 offset:32768
v_cvt_pk_bf16_f32 v156, v132, v133
v_cvt_pk_bf16_f32 v157, v134, v135
v_mfma_f32_16x16x32_bf16 v[92:95], a[252:255], v[152:155], v[92:95]
ds_read_b128 a[200:203], v234 offset:32768
v_cvt_pk_bf16_f32 v158, v144, v145
v_cvt_pk_bf16_f32 v159, v146, v147
s_nop 1
v_mfma_f32_16x16x32_bf16 v[108:111], v[220:223], v[156:159], v[108:111]
ds_read_b128 a[204:207], v235 offset:32768
ds_read_b128 a[208:211], v232 offset:36864
v_mfma_f32_16x16x32_bf16 v[12:15], a[224:227], v[156:159], v[12:15]
ds_read_b128 a[212:215], v233 offset:36864
v_mfma_f32_16x16x32_bf16 v[24:27], a[228:231], v[156:159], v[24:27]
buffer_load_dwordx4 v238, s[12:15], s44 offen offset:2048 nt lds
v_mfma_f32_16x16x32_bf16 v[36:39], a[232:235], v[156:159], v[36:39]
ds_read_b128 a[216:219], v234 offset:36864
ds_read_b128 a[220:223], v235 offset:36864
v_mfma_f32_16x16x32_bf16 v[48:51], a[236:239], v[156:159], v[48:51]
v_mfma_f32_16x16x32_bf16 v[60:63], a[240:243], v[156:159], v[60:63]
v_mfma_f32_16x16x32_bf16 v[72:75], a[244:247], v[156:159], v[72:75]
buffer_load_dwordx4 v239, s[12:15], s44 offen offset:3072 nt lds
v_mfma_f32_16x16x32_bf16 v[84:87], a[248:251], v[156:159], v[84:87]
v_mfma_f32_16x16x32_bf16 v[96:99], a[252:255], v[156:159], v[96:99]
s_waitcnt vmcnt(8) lgkmcnt(0)
s_barrier
v_mfma_f32_16x16x32_bf16 v[124:127], a[192:195], v[160:163], v[112:115]
ds_read_b64_tr_b16 a[224:225], v224 offset:49152
s_add_u32 s45, s57, 262144
s_add_u32 s45, s45, s30
v_mfma_f32_16x16x32_bf16 v[124:127], a[196:199], v[172:175], v[124:127]
ds_read_b64_tr_b16 a[226:227], v224 offset:53248
s_add_u32 m0, s47, 32768
v_mfma_f32_16x16x32_bf16 v[124:127], a[200:203], v[184:187], v[124:127]
ds_read_b64_tr_b16 a[228:229], v225 offset:49152
v_mfma_f32_16x16x32_bf16 v[124:127], a[204:207], v[196:199], v[124:127]
ds_read_b64_tr_b16 a[230:231], v225 offset:53248
v_mfma_f32_16x16x32_bf16 v[136:139], a[208:211], v[160:163], v[112:115]
ds_read_b64_tr_b16 a[232:233], v226 offset:49152
ds_read_b64_tr_b16 a[234:235], v226 offset:53248
v_mfma_f32_16x16x32_bf16 v[136:139], a[212:215], v[172:175], v[136:139]
buffer_load_dwordx4 v240, s[32:35], s45 offen lds
v_mfma_f32_16x16x32_bf16 v[136:139], a[216:219], v[184:187], v[136:139]
ds_read_b64_tr_b16 a[236:237], v227 offset:49152
v_mfma_f32_16x16x32_bf16 v[136:139], a[220:223], v[196:199], v[136:139]
ds_read_b64_tr_b16 a[238:239], v227 offset:53248
v_mfma_f32_16x16x32_bf16 v[128:131], a[192:195], v[164:167], v[116:119]
ds_read_b64_tr_b16 a[240:241], v228 offset:49152
v_mfma_f32_16x16x32_bf16 v[128:131], a[196:199], v[176:179], v[128:131]
ds_read_b64_tr_b16 a[242:243], v228 offset:53248
v_mfma_f32_16x16x32_bf16 v[128:131], a[200:203], v[188:191], v[128:131]
ds_read_b64_tr_b16 a[244:245], v229 offset:49152
ds_read_b64_tr_b16 a[246:247], v229 offset:53248
v_mfma_f32_16x16x32_bf16 v[128:131], a[204:207], v[200:203], v[128:131]
buffer_load_dwordx4 v241, s[32:35], s45 offen offset:1024 lds
v_mfma_f32_16x16x32_bf16 v[140:143], a[208:211], v[164:167], v[116:119]
ds_read_b64_tr_b16 a[248:249], v230 offset:49152
v_max3_f32 v244, v124, v125, v126
v_mfma_f32_16x16x32_bf16 v[140:143], a[212:215], v[176:179], v[140:143]
ds_read_b64_tr_b16 a[250:251], v230 offset:53248
v_max3_f32 v244, v244, v127, v136
v_mfma_f32_16x16x32_bf16 v[140:143], a[216:219], v[188:191], v[140:143]
ds_read_b64_tr_b16 a[252:253], v231 offset:49152
v_max3_f32 v244, v244, v137, v138
v_mfma_f32_16x16x32_bf16 v[140:143], a[220:223], v[200:203], v[140:143]
ds_read_b64_tr_b16 a[254:255], v231 offset:53248
ds_read_b128 v[208:211], v3 offset:24576
v_max_f32 v244, v244, v139
v_mfma_f32_16x16x32_bf16 v[132:135], a[192:195], v[168:171], v[120:123]
buffer_load_dwordx4 v242, s[32:35], s45 offen offset:2048 lds
v_mfma_f32_16x16x32_bf16 v[132:135], a[196:199], v[180:183], v[132:135]
ds_read_b128 v[212:215], v3 offset:25600
v_mfma_f32_16x16x32_bf16 v[132:135], a[200:203], v[192:195], v[132:135]
ds_read_b128 v[216:219], v3 offset:26624
v_mfma_f32_16x16x32_bf16 v[132:135], a[204:207], v[204:207], v[132:135]
v_max3_f32 v245, v128, v129, v130
v_max3_f32 v245, v245, v131, v140
v_mfma_f32_16x16x32_bf16 v[144:147], a[208:211], v[168:171], v[120:123]
v_max3_f32 v245, v245, v141, v142
v_max_f32 v245, v245, v143
v_mfma_f32_16x16x32_bf16 v[144:147], a[212:215], v[180:183], v[144:147]
buffer_load_dwordx4 v243, s[32:35], s45 offen offset:3072 lds
v_mfma_f32_16x16x32_bf16 v[144:147], a[216:219], v[192:195], v[144:147]
v_mfma_f32_16x16x32_bf16 v[144:147], a[220:223], v[204:207], v[144:147]
s_waitcnt vmcnt(8) lgkmcnt(0)
s_barrier
v_mfma_f32_16x16x32_bf16 a[0:3], a[224:227], v[208:211], a[0:3]
ds_read_b64_tr_b16 a[192:193], v224 offset:0
s_add_u32 s44, s11, 81920
s_and_b32 s44, s44, 0x1ffff
v_mfma_f32_16x16x32_bf16 a[4:7], a[224:227], v[212:215], a[4:7]
ds_read_b64_tr_b16 a[194:195], v224 offset:4096
ds_read_b64_tr_b16 a[196:197], v225 offset:0
s_add_u32 s44, s44, s49
v_mfma_f32_16x16x32_bf16 a[8:11], a[224:227], v[216:219], a[8:11]
s_add_u32 m0, s47, 49152
s_nop 0
buffer_load_dwordx4 v236, s[16:19], s44 offen nt lds
v_mfma_f32_16x16x32_bf16 a[12:15], a[228:231], v[208:211], a[12:15]
ds_read_b64_tr_b16 a[198:199], v225 offset:4096
v_max3_f32 v246, v132, v133, v134
v_mfma_f32_16x16x32_bf16 a[16:19], a[228:231], v[212:215], a[16:19]
ds_read_b64_tr_b16 a[200:201], v226 offset:0
v_max3_f32 v246, v246, v135, v144
v_mfma_f32_16x16x32_bf16 a[20:23], a[228:231], v[216:219], a[20:23]
v_max3_f32 v246, v246, v145, v146
v_max_f32 v246, v246, v147
v_mfma_f32_16x16x32_bf16 a[24:27], a[232:235], v[208:211], a[24:27]
v_max3_f32 v247, v244, v245, v246
v_cmp_lt_f32 vcc, s50, v247
s_cbranch_vccnz L_rs32
L_rb32:
v_mfma_f32_16x16x32_bf16 a[28:31], a[232:235], v[212:215], a[28:31]
v_exp_f32 v124, v124
v_mfma_f32_16x16x32_bf16 a[32:35], a[232:235], v[216:219], a[32:35]
buffer_load_dwordx4 v237, s[16:19], s44 offen offset:1024 nt lds
v_mfma_f32_16x16x32_bf16 a[36:39], a[236:239], v[208:211], a[36:39]
ds_read_b64_tr_b16 a[202:203], v226 offset:4096
v_exp_f32 v125, v125
v_mfma_f32_16x16x32_bf16 a[40:43], a[236:239], v[212:215], a[40:43]
ds_read_b64_tr_b16 a[204:205], v227 offset:0
v_exp_f32 v126, v126
v_mfma_f32_16x16x32_bf16 a[44:47], a[236:239], v[216:219], a[44:47]
ds_read_b64_tr_b16 a[206:207], v227 offset:4096
v_exp_f32 v127, v127
v_mfma_f32_16x16x32_bf16 a[48:51], a[240:243], v[208:211], a[48:51]
ds_read_b64_tr_b16 a[208:209], v228 offset:0
v_exp_f32 v136, v136
v_mfma_f32_16x16x32_bf16 a[52:55], a[240:243], v[212:215], a[52:55]
ds_read_b64_tr_b16 a[210:211], v228 offset:4096
v_exp_f32 v137, v137
v_mfma_f32_16x16x32_bf16 a[56:59], a[240:243], v[216:219], a[56:59]
buffer_load_dwordx4 v238, s[16:19], s44 offen offset:2048 nt lds
v_mfma_f32_16x16x32_bf16 a[60:63], a[244:247], v[208:211], a[60:63]
ds_read_b64_tr_b16 a[212:213], v229 offset:0
v_exp_f32 v138, v138
v_mfma_f32_16x16x32_bf16 a[64:67], a[244:247], v[212:215], a[64:67]
ds_read_b64_tr_b16 a[214:215], v229 offset:4096
v_exp_f32 v139, v139
v_mfma_f32_16x16x32_bf16 a[68:71], a[244:247], v[216:219], a[68:71]
ds_read_b64_tr_b16 a[216:217], v230 offset:0
v_cvt_pk_bf16_f32 v148, v124, v125
v_mfma_f32_16x16x32_bf16 a[72:75], a[248:251], v[208:211], a[72:75]
ds_read_b64_tr_b16 a[218:219], v230 offset:4096
v_cvt_pk_bf16_f32 v149, v126, v127
v_mfma_f32_16x16x32_bf16 a[76:79], a[248:251], v[212:215], a[76:79]
ds_read_b64_tr_b16 a[220:221], v231 offset:0
ds_read_b64_tr_b16 a[222:223], v231 offset:4096
v_cvt_pk_bf16_f32 v150, v136, v137
v_mfma_f32_16x16x32_bf16 a[80:83], a[248:251], v[216:219], a[80:83]
buffer_load_dwordx4 v239, s[16:19], s44 offen offset:3072 nt lds
v_mfma_f32_16x16x32_bf16 a[84:87], a[252:255], v[208:211], a[84:87]
v_cvt_pk_bf16_f32 v151, v138, v139
v_exp_f32 v128, v128
v_mfma_f32_16x16x32_bf16 a[88:91], a[252:255], v[212:215], a[88:91]
v_exp_f32 v129, v129
v_exp_f32 v130, v130
v_mfma_f32_16x16x32_bf16 a[92:95], a[252:255], v[216:219], a[92:95]
v_exp_f32 v131, v131
s_waitcnt vmcnt(8) lgkmcnt(0)
s_barrier
v_mfma_f32_16x16x32_bf16 v[100:103], v[220:223], v[148:151], v[100:103]
s_add_u32 s44, s11, 90112
v_exp_f32 v140, v140
v_mfma_f32_16x16x32_bf16 v[4:7], a[192:195], v[148:151], v[4:7]
s_and_b32 s44, s44, 0x1ffff
v_exp_f32 v141, v141
v_mfma_f32_16x16x32_bf16 v[16:19], a[196:199], v[148:151], v[16:19]
s_add_u32 s44, s44, s49
v_exp_f32 v142, v142
v_mfma_f32_16x16x32_bf16 v[28:31], a[200:203], v[148:151], v[28:31]
s_add_u32 m0, s47, 0
v_exp_f32 v143, v143
v_mfma_f32_16x16x32_bf16 v[40:43], a[204:207], v[148:151], v[40:43]
v_cvt_pk_bf16_f32 v152, v128, v129
v_cvt_pk_bf16_f32 v153, v130, v131
v_mfma_f32_16x16x32_bf16 v[52:55], a[208:211], v[148:151], v[52:55]
v_cvt_pk_bf16_f32 v154, v140, v141
v_cvt_pk_bf16_f32 v155, v142, v143
v_mfma_f32_16x16x32_bf16 v[64:67], a[212:215], v[148:151], v[64:67]
v_exp_f32 v132, v132
v_mfma_f32_16x16x32_bf16 v[76:79], a[216:219], v[148:151], v[76:79]
buffer_load_dwordx4 v236, s[12:15], s44 offen nt lds
v_mfma_f32_16x16x32_bf16 v[88:91], a[220:223], v[148:151], v[88:91]
v_exp_f32 v133, v133
v_mfma_f32_16x16x32_bf16 v[104:107], v[220:223], v[152:155], v[104:107]
v_exp_f32 v134, v134
v_mfma_f32_16x16x32_bf16 v[8:11], a[192:195], v[152:155], v[8:11]
v_exp_f32 v135, v135
v_mfma_f32_16x16x32_bf16 v[20:23], a[196:199], v[152:155], v[20:23]
v_exp_f32 v144, v144
v_mfma_f32_16x16x32_bf16 v[32:35], a[200:203], v[152:155], v[32:35]
buffer_load_dwordx4 v237, s[12:15], s44 offen offset:1024 nt lds
v_mfma_f32_16x16x32_bf16 v[44:47], a[204:207], v[152:155], v[44:47]
v_exp_f32 v145, v145
v_mfma_f32_16x16x32_bf16 v[56:59], a[208:211], v[152:155], v[56:59]
v_exp_f32 v146, v146
v_mfma_f32_16x16x32_bf16 v[68:71], a[212:215], v[152:155], v[68:71]
ds_read_b128 a[224:227], v232 offset:16384
v_exp_f32 v147, v147
v_mfma_f32_16x16x32_bf16 v[80:83], a[216:219], v[152:155], v[80:83]
ds_read_b128 a[228:231], v233 offset:16384
v_cvt_pk_bf16_f32 v156, v132, v133
v_cvt_pk_bf16_f32 v157, v134, v135
v_mfma_f32_16x16x32_bf16 v[92:95], a[220:223], v[152:155], v[92:95]
ds_read_b128 a[232:235], v234 offset:16384
v_cvt_pk_bf16_f32 v158, v144, v145
v_cvt_pk_bf16_f32 v159, v146, v147
s_nop 1
v_mfma_f32_16x16x32_bf16 v[108:111], v[220:223], v[156:159], v[108:111]
ds_read_b128 a[236:239], v235 offset:16384
ds_read_b128 a[240:243], v232 offset:20480
v_mfma_f32_16x16x32_bf16 v[12:15], a[192:195], v[156:159], v[12:15]
ds_read_b128 a[244:247], v233 offset:20480
v_mfma_f32_16x16x32_bf16 v[24:27], a[196:199], v[156:159], v[24:27]
buffer_load_dwordx4 v238, s[12:15], s44 offen offset:2048 nt lds
v_mfma_f32_16x16x32_bf16 v[36:39], a[200:203], v[156:159], v[36:39]
ds_read_b128 a[248:251], v234 offset:20480
ds_read_b128 a[252:255], v235 offset:20480
v_mfma_f32_16x16x32_bf16 v[48:51], a[204:207], v[156:159], v[48:51]
v_mfma_f32_16x16x32_bf16 v[60:63], a[208:211], v[156:159], v[60:63]
v_mfma_f32_16x16x32_bf16 v[72:75], a[212:215], v[156:159], v[72:75]
buffer_load_dwordx4 v239, s[12:15], s44 offen offset:3072 nt lds
v_mfma_f32_16x16x32_bf16 v[84:87], a[216:219], v[156:159], v[84:87]
v_mfma_f32_16x16x32_bf16 v[96:99], a[220:223], v[156:159], v[96:99]
s_waitcnt vmcnt(8) lgkmcnt(0)
s_barrier
v_mfma_f32_16x16x32_bf16 v[124:127], a[224:227], v[160:163], v[112:115]
ds_read_b64_tr_b16 a[192:193], v224 offset:32768
s_add_u32 s45, s57, 294912
s_add_u32 m0, s47, 16384
v_mfma_f32_16x16x32_bf16 v[124:127], a[228:231], v[172:175], v[124:127]
ds_read_b64_tr_b16 a[194:195], v224 offset:36864
v_mfma_f32_16x16x32_bf16 v[124:127], a[232:235], v[184:187], v[124:127]
ds_read_b64_tr_b16 a[196:197], v225 offset:32768
v_mfma_f32_16x16x32_bf16 v[124:127], a[236:239], v[196:199], v[124:127]
ds_read_b64_tr_b16 a[198:199], v225 offset:36864
v_mfma_f32_16x16x32_bf16 v[136:139], a[240:243], v[160:163], v[112:115]
ds_read_b64_tr_b16 a[200:201], v226 offset:32768
ds_read_b64_tr_b16 a[202:203], v226 offset:36864
v_mfma_f32_16x16x32_bf16 v[136:139], a[244:247], v[172:175], v[136:139]
buffer_load_dwordx4 v240, s[32:35], s45 offen lds
v_mfma_f32_16x16x32_bf16 v[136:139], a[248:251], v[184:187], v[136:139]
ds_read_b64_tr_b16 a[204:205], v227 offset:32768
v_mfma_f32_16x16x32_bf16 v[136:139], a[252:255], v[196:199], v[136:139]
ds_read_b64_tr_b16 a[206:207], v227 offset:36864
v_mfma_f32_16x16x32_bf16 v[128:131], a[224:227], v[164:167], v[116:119]
ds_read_b64_tr_b16 a[208:209], v228 offset:32768
v_mfma_f32_16x16x32_bf16 v[128:131], a[228:231], v[176:179], v[128:131]
ds_read_b64_tr_b16 a[210:211], v228 offset:36864
v_mfma_f32_16x16x32_bf16 v[128:131], a[232:235], v[188:191], v[128:131]
ds_read_b64_tr_b16 a[212:213], v229 offset:32768
ds_read_b64_tr_b16 a[214:215], v229 offset:36864
v_mfma_f32_16x16x32_bf16 v[128:131], a[236:239], v[200:203], v[128:131]
buffer_load_dwordx4 v241, s[32:35], s45 offen offset:1024 lds
v_mfma_f32_16x16x32_bf16 v[140:143], a[240:243], v[164:167], v[116:119]
ds_read_b64_tr_b16 a[216:217], v230 offset:32768
v_max3_f32 v244, v124, v125, v126
v_mfma_f32_16x16x32_bf16 v[140:143], a[244:247], v[176:179], v[140:143]
ds_read_b64_tr_b16 a[218:219], v230 offset:36864
v_max3_f32 v244, v244, v127, v136
v_mfma_f32_16x16x32_bf16 v[140:143], a[248:251], v[188:191], v[140:143]
ds_read_b64_tr_b16 a[220:221], v231 offset:32768
v_max3_f32 v244, v244, v137, v138
v_mfma_f32_16x16x32_bf16 v[140:143], a[252:255], v[200:203], v[140:143]
ds_read_b64_tr_b16 a[222:223], v231 offset:36864
v_max_f32 v244, v244, v139
v_mfma_f32_16x16x32_bf16 v[132:135], a[224:227], v[168:171], v[120:123]
buffer_load_dwordx4 v242, s[32:35], s45 offen offset:2048 lds
v_mfma_f32_16x16x32_bf16 v[132:135], a[228:231], v[180:183], v[132:135]
v_mfma_f32_16x16x32_bf16 v[132:135], a[232:235], v[192:195], v[132:135]
v_mfma_f32_16x16x32_bf16 v[132:135], a[236:239], v[204:207], v[132:135]
v_max3_f32 v245, v128, v129, v130
v_max3_f32 v245, v245, v131, v140
v_mfma_f32_16x16x32_bf16 v[144:147], a[240:243], v[168:171], v[120:123]
v_max3_f32 v245, v245, v141, v142
v_max_f32 v245, v245, v143
v_mfma_f32_16x16x32_bf16 v[144:147], a[244:247], v[180:183], v[144:147]
buffer_load_dwordx4 v243, s[32:35], s45 offen offset:3072 lds
v_mfma_f32_16x16x32_bf16 v[144:147], a[248:251], v[192:195], v[144:147]
v_mfma_f32_16x16x32_bf16 v[144:147], a[252:255], v[204:207], v[144:147]
s_waitcnt vmcnt(8) lgkmcnt(0)
s_barrier
v_mfma_f32_16x16x32_bf16 a[96:99], a[192:195], v[208:211], a[96:99]
ds_read_b64_tr_b16 a[224:225], v224 offset:49152
s_add_u32 s44, s11, 90112
s_and_b32 s44, s44, 0x1ffff
v_mfma_f32_16x16x32_bf16 a[100:103], a[192:195], v[212:215], a[100:103]
ds_read_b64_tr_b16 a[226:227], v224 offset:53248
ds_read_b64_tr_b16 a[228:229], v225 offset:49152
s_add_u32 s44, s44, s49
v_mfma_f32_16x16x32_bf16 a[104:107], a[192:195], v[216:219], a[104:107]
s_add_u32 m0, s47, 32768
s_nop 0
buffer_load_dwordx4 v236, s[16:19], s44 offen nt lds
v_mfma_f32_16x16x32_bf16 a[108:111], a[196:199], v[208:211], a[108:111]
ds_read_b64_tr_b16 a[230:231], v225 offset:53248
v_max3_f32 v246, v132, v133, v134
v_mfma_f32_16x16x32_bf16 a[112:115], a[196:199], v[212:215], a[112:115]
ds_read_b64_tr_b16 a[232:233], v226 offset:49152
v_max3_f32 v246, v246, v135, v144
v_mfma_f32_16x16x32_bf16 a[116:119], a[196:199], v[216:219], a[116:119]
v_max3_f32 v246, v246, v145, v146
v_max_f32 v246, v246, v147
v_mfma_f32_16x16x32_bf16 a[120:123], a[200:203], v[208:211], a[120:123]
v_max3_f32 v247, v244, v245, v246
v_cmp_lt_f32 vcc, s50, v247
s_cbranch_vccnz L_rs33
L_rb33:
v_mfma_f32_16x16x32_bf16 a[124:127], a[200:203], v[212:215], a[124:127]
v_exp_f32 v124, v124
v_mfma_f32_16x16x32_bf16 a[128:131], a[200:203], v[216:219], a[128:131]
buffer_load_dwordx4 v237, s[16:19], s44 offen offset:1024 nt lds
v_mfma_f32_16x16x32_bf16 a[132:135], a[204:207], v[208:211], a[132:135]
ds_read_b64_tr_b16 a[234:235], v226 offset:53248
v_exp_f32 v125, v125
v_mfma_f32_16x16x32_bf16 a[136:139], a[204:207], v[212:215], a[136:139]
ds_read_b64_tr_b16 a[236:237], v227 offset:49152
v_exp_f32 v126, v126
v_mfma_f32_16x16x32_bf16 a[140:143], a[204:207], v[216:219], a[140:143]
ds_read_b64_tr_b16 a[238:239], v227 offset:53248
v_exp_f32 v127, v127
v_mfma_f32_16x16x32_bf16 a[144:147], a[208:211], v[208:211], a[144:147]
ds_read_b64_tr_b16 a[240:241], v228 offset:49152
v_exp_f32 v136, v136
v_mfma_f32_16x16x32_bf16 a[148:151], a[208:211], v[212:215], a[148:151]
ds_read_b64_tr_b16 a[242:243], v228 offset:53248
v_exp_f32 v137, v137
v_mfma_f32_16x16x32_bf16 a[152:155], a[208:211], v[216:219], a[152:155]
buffer_load_dwordx4 v238, s[16:19], s44 offen offset:2048 nt lds
v_mfma_f32_16x16x32_bf16 a[156:159], a[212:215], v[208:211], a[156:159]
ds_read_b64_tr_b16 a[244:245], v229 offset:49152
v_exp_f32 v138, v138
v_mfma_f32_16x16x32_bf16 a[160:163], a[212:215], v[212:215], a[160:163]
ds_read_b64_tr_b16 a[246:247], v229 offset:53248
v_exp_f32 v139, v139
v_mfma_f32_16x16x32_bf16 a[164:167], a[212:215], v[216:219], a[164:167]
ds_read_b64_tr_b16 a[248:249], v230 offset:49152
v_cvt_pk_bf16_f32 v148, v124, v125
v_mfma_f32_16x16x32_bf16 a[168:171], a[216:219], v[208:211], a[168:171]
ds_read_b64_tr_b16 a[250:251], v230 offset:53248
v_cvt_pk_bf16_f32 v149, v126, v127
v_mfma_f32_16x16x32_bf16 a[172:175], a[216:219], v[212:215], a[172:175]
ds_read_b64_tr_b16 a[252:253], v231 offset:49152
ds_read_b64_tr_b16 a[254:255], v231 offset:53248
v_cvt_pk_bf16_f32 v150, v136, v137
v_mfma_f32_16x16x32_bf16 a[176:179], a[216:219], v[216:219], a[176:179]
buffer_load_dwordx4 v239, s[16:19], s44 offen offset:3072 nt lds
v_mfma_f32_16x16x32_bf16 a[180:183], a[220:223], v[208:211], a[180:183]
v_cvt_pk_bf16_f32 v151, v138, v139
v_exp_f32 v128, v128
v_mfma_f32_16x16x32_bf16 a[184:187], a[220:223], v[212:215], a[184:187]
v_exp_f32 v129, v129
v_exp_f32 v130, v130
v_mfma_f32_16x16x32_bf16 a[188:191], a[220:223], v[216:219], a[188:191]
v_exp_f32 v131, v131
s_waitcnt vmcnt(8) lgkmcnt(0)
s_barrier
v_mfma_f32_16x16x32_bf16 v[100:103], v[220:223], v[148:151], v[100:103]
s_add_u32 s44, s11, 98304
v_exp_f32 v140, v140
v_mfma_f32_16x16x32_bf16 v[4:7], a[224:227], v[148:151], v[4:7]
s_and_b32 s44, s44, 0x1ffff
v_exp_f32 v141, v141
v_mfma_f32_16x16x32_bf16 v[16:19], a[228:231], v[148:151], v[16:19]
s_add_u32 s44, s44, s49
v_exp_f32 v142, v142
v_mfma_f32_16x16x32_bf16 v[28:31], a[232:235], v[148:151], v[28:31]
s_add_u32 m0, s47, 49152
v_exp_f32 v143, v143
v_mfma_f32_16x16x32_bf16 v[40:43], a[236:239], v[148:151], v[40:43]
v_cvt_pk_bf16_f32 v152, v128, v129
v_cvt_pk_bf16_f32 v153, v130, v131
v_mfma_f32_16x16x32_bf16 v[52:55], a[240:243], v[148:151], v[52:55]
v_cvt_pk_bf16_f32 v154, v140, v141
v_cvt_pk_bf16_f32 v155, v142, v143
v_mfma_f32_16x16x32_bf16 v[64:67], a[244:247], v[148:151], v[64:67]
v_exp_f32 v132, v132
v_mfma_f32_16x16x32_bf16 v[76:79], a[248:251], v[148:151], v[76:79]
buffer_load_dwordx4 v236, s[12:15], s44 offen nt lds
v_mfma_f32_16x16x32_bf16 v[88:91], a[252:255], v[148:151], v[88:91]
v_exp_f32 v133, v133
v_mfma_f32_16x16x32_bf16 v[104:107], v[220:223], v[152:155], v[104:107]
v_exp_f32 v134, v134
v_mfma_f32_16x16x32_bf16 v[8:11], a[224:227], v[152:155], v[8:11]
v_exp_f32 v135, v135
v_mfma_f32_16x16x32_bf16 v[20:23], a[228:231], v[152:155], v[20:23]
v_exp_f32 v144, v144
v_mfma_f32_16x16x32_bf16 v[32:35], a[232:235], v[152:155], v[32:35]
buffer_load_dwordx4 v237, s[12:15], s44 offen offset:1024 nt lds
v_mfma_f32_16x16x32_bf16 v[44:47], a[236:239], v[152:155], v[44:47]
v_exp_f32 v145, v145
v_mfma_f32_16x16x32_bf16 v[56:59], a[240:243], v[152:155], v[56:59]
v_exp_f32 v146, v146
v_mfma_f32_16x16x32_bf16 v[68:71], a[244:247], v[152:155], v[68:71]
ds_read_b128 a[192:195], v232 offset:0
v_exp_f32 v147, v147
v_mfma_f32_16x16x32_bf16 v[80:83], a[248:251], v[152:155], v[80:83]
ds_read_b128 a[196:199], v233 offset:0
v_cvt_pk_bf16_f32 v156, v132, v133
v_cvt_pk_bf16_f32 v157, v134, v135
v_mfma_f32_16x16x32_bf16 v[92:95], a[252:255], v[152:155], v[92:95]
ds_read_b128 a[200:203], v234 offset:0
v_cvt_pk_bf16_f32 v158, v144, v145
v_cvt_pk_bf16_f32 v159, v146, v147
s_nop 1
v_mfma_f32_16x16x32_bf16 v[108:111], v[220:223], v[156:159], v[108:111]
ds_read_b128 a[204:207], v235 offset:0
ds_read_b128 a[208:211], v232 offset:4096
v_mfma_f32_16x16x32_bf16 v[12:15], a[224:227], v[156:159], v[12:15]
ds_read_b128 a[212:215], v233 offset:4096
v_mfma_f32_16x16x32_bf16 v[24:27], a[228:231], v[156:159], v[24:27]
buffer_load_dwordx4 v238, s[12:15], s44 offen offset:2048 nt lds
v_mfma_f32_16x16x32_bf16 v[36:39], a[232:235], v[156:159], v[36:39]
ds_read_b128 a[216:219], v234 offset:4096
ds_read_b128 a[220:223], v235 offset:4096
v_mfma_f32_16x16x32_bf16 v[48:51], a[236:239], v[156:159], v[48:51]
v_mfma_f32_16x16x32_bf16 v[60:63], a[240:243], v[156:159], v[60:63]
v_mfma_f32_16x16x32_bf16 v[72:75], a[244:247], v[156:159], v[72:75]
buffer_load_dwordx4 v239, s[12:15], s44 offen offset:3072 nt lds
v_mfma_f32_16x16x32_bf16 v[84:87], a[248:251], v[156:159], v[84:87]
L_here34:
s_getpc_b64 s[36:37]
L_pc35:
v_mfma_f32_16x16x32_bf16 v[96:99], a[252:255], v[156:159], v[96:99]
s_add_u32 s36, s36, L_here34-L_pc35
s_addc_u32 s37, s37, -1
s_and_b32 s37, s37, 0xffff
s_mov_b32 s38, L_codeend-L_here34
s_mov_b32 s39, 0x20000
s_and_b32 s52, s7, 7
s_lshl_b32 s52, s52, 2
s_add_u32 s52, s52, s4
s_lshl_b32 s52, s52, 11
v_and_b32 v248, 15, v1
v_lshlrev_b32 v248, 7, v248
buffer_load_dword v254, v248, s[36:39], s52 offen
s_waitcnt vmcnt(9) lgkmcnt(0)
s_barrier
v_mfma_f32_16x16x32_bf16 v[124:127], a[192:195], v[160:163], v[112:115]
ds_read_b64_tr_b16 a[224:225], v224 offset:16384
s_add_u32 s45, s57, 294912
s_add_u32 s45, s45, s30
v_mfma_f32_16x16x32_bf16 v[124:127], a[196:199], v[172:175], v[124:127]
ds_read_b64_tr_b16 a[226:227], v224 offset:20480
s_add_u32 m0, s47, 0
v_mfma_f32_16x16x32_bf16 v[124:127], a[200:203], v[184:187], v[124:127]
ds_read_b64_tr_b16 a[228:229], v225 offset:16384
v_mfma_f32_16x16x32_bf16 v[124:127], a[204:207], v[196:199], v[124:127]
ds_read_b64_tr_b16 a[230:231], v225 offset:20480
v_mfma_f32_16x16x32_bf16 v[136:139], a[208:211], v[160:163], v[112:115]
ds_read_b64_tr_b16 a[232:233], v226 offset:16384
ds_read_b64_tr_b16 a[234:235], v226 offset:20480
v_mfma_f32_16x16x32_bf16 v[136:139], a[212:215], v[172:175], v[136:139]
buffer_load_dwordx4 v240, s[32:35], s45 offen lds
v_mfma_f32_16x16x32_bf16 v[136:139], a[216:219], v[184:187], v[136:139]
ds_read_b64_tr_b16 a[236:237], v227 offset:16384
v_mfma_f32_16x16x32_bf16 v[136:139], a[220:223], v[196:199], v[136:139]
ds_read_b64_tr_b16 a[238:239], v227 offset:20480
v_mfma_f32_16x16x32_bf16 v[128:131], a[192:195], v[164:167], v[116:119]
ds_read_b64_tr_b16 a[240:241], v228 offset:16384
v_mfma_f32_16x16x32_bf16 v[128:131], a[196:199], v[176:179], v[128:131]
ds_read_b64_tr_b16 a[242:243], v228 offset:20480
v_mfma_f32_16x16x32_bf16 v[128:131], a[200:203], v[188:191], v[128:131]
ds_read_b64_tr_b16 a[244:245], v229 offset:16384
ds_read_b64_tr_b16 a[246:247], v229 offset:20480
v_mfma_f32_16x16x32_bf16 v[128:131], a[204:207], v[200:203], v[128:131]
buffer_load_dwordx4 v241, s[32:35], s45 offen offset:1024 lds
v_mfma_f32_16x16x32_bf16 v[140:143], a[208:211], v[164:167], v[116:119]
ds_read_b64_tr_b16 a[248:249], v230 offset:16384
v_max3_f32 v244, v124, v125, v126
v_mfma_f32_16x16x32_bf16 v[140:143], a[212:215], v[176:179], v[140:143]
ds_read_b64_tr_b16 a[250:251], v230 offset:20480
v_max3_f32 v244, v244, v127, v136
v_mfma_f32_16x16x32_bf16 v[140:143], a[216:219], v[188:191], v[140:143]
ds_read_b64_tr_b16 a[252:253], v231 offset:16384
v_max3_f32 v244, v244, v137, v138
v_mfma_f32_16x16x32_bf16 v[140:143], a[220:223], v[200:203], v[140:143]
ds_read_b64_tr_b16 a[254:255], v231 offset:20480
ds_read_b128 v[208:211], v3 offset:27648
v_max_f32 v244, v244, v139
v_mfma_f32_16x16x32_bf16 v[132:135], a[192:195], v[168:171], v[120:123]
buffer_load_dwordx4 v242, s[32:35], s45 offen offset:2048 lds
v_mfma_f32_16x16x32_bf16 v[132:135], a[196:199], v[180:183], v[132:135]
ds_read_b128 v[212:215], v3 offset:28672
v_mfma_f32_16x16x32_bf16 v[132:135], a[200:203], v[192:195], v[132:135]
ds_read_b128 v[216:219], v3 offset:29696
v_mfma_f32_16x16x32_bf16 v[132:135], a[204:207], v[204:207], v[132:135]
v_max3_f32 v245, v128, v129, v130
v_max3_f32 v245, v245, v131, v140
v_mfma_f32_16x16x32_bf16 v[144:147], a[208:211], v[168:171], v[120:123]
v_max3_f32 v245, v245, v141, v142
v_max_f32 v245, v245, v143
v_mfma_f32_16x16x32_bf16 v[144:147], a[212:215], v[180:183], v[144:147]
buffer_load_dwordx4 v243, s[32:35], s45 offen offset:3072 lds
v_mfma_f32_16x16x32_bf16 v[144:147], a[216:219], v[192:195], v[144:147]
v_mfma_f32_16x16x32_bf16 v[144:147], a[220:223], v[204:207], v[144:147]
s_waitcnt vmcnt(9) lgkmcnt(0)
s_barrier
v_mfma_f32_16x16x32_bf16 a[0:3], a[224:227], v[208:211], a[0:3]
ds_read_b64_tr_b16 a[192:193], v224 offset:32768
s_add_u32 s44, s11, 98304
s_and_b32 s44, s44, 0x1ffff
v_mfma_f32_16x16x32_bf16 a[4:7], a[224:227], v[212:215], a[4:7]
ds_read_b64_tr_b16 a[194:195], v224 offset:36864
ds_read_b64_tr_b16 a[196:197], v225 offset:32768
s_add_u32 s44, s44, s49
v_mfma_f32_16x16x32_bf16 a[8:11], a[224:227], v[216:219], a[8:11]
s_add_u32 m0, s47, 16384
s_nop 0
buffer_load_dwordx4 v236, s[16:19], s44 offen nt lds
v_mfma_f32_16x16x32_bf16 a[12:15], a[228:231], v[208:211], a[12:15]
ds_read_b64_tr_b16 a[198:199], v225 offset:36864
v_max3_f32 v246, v132, v133, v134
v_mfma_f32_16x16x32_bf16 a[16:19], a[228:231], v[212:215], a[16:19]
ds_read_b64_tr_b16 a[200:201], v226 offset:32768
v_max3_f32 v246, v246, v135, v144
v_mfma_f32_16x16x32_bf16 a[20:23], a[228:231], v[216:219], a[20:23]
v_max3_f32 v246, v246, v145, v146
v_max_f32 v246, v246, v147
v_mfma_f32_16x16x32_bf16 a[24:27], a[232:235], v[208:211], a[24:27]
v_max3_f32 v247, v244, v245, v246
v_cmp_lt_f32 vcc, s50, v247
s_cbranch_vccnz L_rs36
L_rb36:
v_mfma_f32_16x16x32_bf16 a[28:31], a[232:235], v[212:215], a[28:31]
v_exp_f32 v124, v124
v_mfma_f32_16x16x32_bf16 a[32:35], a[232:235], v[216:219], a[32:35]
buffer_load_dwordx4 v237, s[16:19], s44 offen offset:1024 nt lds
v_mfma_f32_16x16x32_bf16 a[36:39], a[236:239], v[208:211], a[36:39]
ds_read_b64_tr_b16 a[202:203], v226 offset:36864
v_exp_f32 v125, v125
v_mfma_f32_16x16x32_bf16 a[40:43], a[236:239], v[212:215], a[40:43]
ds_read_b64_tr_b16 a[204:205], v227 offset:32768
v_exp_f32 v126, v126
v_mfma_f32_16x16x32_bf16 a[44:47], a[236:239], v[216:219], a[44:47]
ds_read_b64_tr_b16 a[206:207], v227 offset:36864
v_exp_f32 v127, v127
v_mfma_f32_16x16x32_bf16 a[48:51], a[240:243], v[208:211], a[48:51]
ds_read_b64_tr_b16 a[208:209], v228 offset:32768
v_exp_f32 v136, v136
v_mfma_f32_16x16x32_bf16 a[52:55], a[240:243], v[212:215], a[52:55]
ds_read_b64_tr_b16 a[210:211], v228 offset:36864
v_exp_f32 v137, v137
v_mfma_f32_16x16x32_bf16 a[56:59], a[240:243], v[216:219], a[56:59]
buffer_load_dwordx4 v238, s[16:19], s44 offen offset:2048 nt lds
v_mfma_f32_16x16x32_bf16 a[60:63], a[244:247], v[208:211], a[60:63]
ds_read_b64_tr_b16 a[212:213], v229 offset:32768
v_exp_f32 v138, v138
v_mfma_f32_16x16x32_bf16 a[64:67], a[244:247], v[212:215], a[64:67]
ds_read_b64_tr_b16 a[214:215], v229 offset:36864
v_exp_f32 v139, v139
v_mfma_f32_16x16x32_bf16 a[68:71], a[244:247], v[216:219], a[68:71]
ds_read_b64_tr_b16 a[216:217], v230 offset:32768
v_cvt_pk_bf16_f32 v148, v124, v125
v_mfma_f32_16x16x32_bf16 a[72:75], a[248:251], v[208:211], a[72:75]
ds_read_b64_tr_b16 a[218:219], v230 offset:36864
v_cvt_pk_bf16_f32 v149, v126, v127
v_mfma_f32_16x16x32_bf16 a[76:79], a[248:251], v[212:215], a[76:79]
ds_read_b64_tr_b16 a[220:221], v231 offset:32768
ds_read_b64_tr_b16 a[222:223], v231 offset:36864
v_cvt_pk_bf16_f32 v150, v136, v137
v_mfma_f32_16x16x32_bf16 a[80:83], a[248:251], v[216:219], a[80:83]
buffer_load_dwordx4 v239, s[16:19], s44 offen offset:3072 nt lds
v_mfma_f32_16x16x32_bf16 a[84:87], a[252:255], v[208:211], a[84:87]
v_cvt_pk_bf16_f32 v151, v138, v139
v_exp_f32 v128, v128
v_mfma_f32_16x16x32_bf16 a[88:91], a[252:255], v[212:215], a[88:91]
v_exp_f32 v129, v129
v_exp_f32 v130, v130
v_mfma_f32_16x16x32_bf16 a[92:95], a[252:255], v[216:219], a[92:95]
v_exp_f32 v131, v131
s_waitcnt vmcnt(9) lgkmcnt(0)
s_barrier
v_mfma_f32_16x16x32_bf16 v[100:103], v[220:223], v[148:151], v[100:103]
s_add_u32 s44, s11, 106496
v_exp_f32 v140, v140
v_mfma_f32_16x16x32_bf16 v[4:7], a[192:195], v[148:151], v[4:7]
s_and_b32 s44, s44, 0x1ffff
v_exp_f32 v141, v141
v_mfma_f32_16x16x32_bf16 v[16:19], a[196:199], v[148:151], v[16:19]
s_add_u32 s44, s44, s49
v_exp_f32 v142, v142
v_mfma_f32_16x16x32_bf16 v[28:31], a[200:203], v[148:151], v[28:31]
s_add_u32 m0, s47, 32768
v_exp_f32 v143, v143
v_mfma_f32_16x16x32_bf16 v[40:43], a[204:207], v[148:151], v[40:43]
v_cvt_pk_bf16_f32 v152, v128, v129
v_cvt_pk_bf16_f32 v153, v130, v131
v_mfma_f32_16x16x32_bf16 v[52:55], a[208:211], v[148:151], v[52:55]
v_cvt_pk_bf16_f32 v154, v140, v141
v_cvt_pk_bf16_f32 v155, v142, v143
v_mfma_f32_16x16x32_bf16 v[64:67], a[212:215], v[148:151], v[64:67]
v_exp_f32 v132, v132
v_mfma_f32_16x16x32_bf16 v[76:79], a[216:219], v[148:151], v[76:79]
buffer_load_dwordx4 v236, s[12:15], s44 offen nt lds
v_mfma_f32_16x16x32_bf16 v[88:91], a[220:223], v[148:151], v[88:91]
v_exp_f32 v133, v133
v_mfma_f32_16x16x32_bf16 v[104:107], v[220:223], v[152:155], v[104:107]
v_exp_f32 v134, v134
v_mfma_f32_16x16x32_bf16 v[8:11], a[192:195], v[152:155], v[8:11]
v_exp_f32 v135, v135
v_mfma_f32_16x16x32_bf16 v[20:23], a[196:199], v[152:155], v[20:23]
v_exp_f32 v144, v144
v_mfma_f32_16x16x32_bf16 v[32:35], a[200:203], v[152:155], v[32:35]
buffer_load_dwordx4 v237, s[12:15], s44 offen offset:1024 nt lds
v_mfma_f32_16x16x32_bf16 v[44:47], a[204:207], v[152:155], v[44:47]
v_exp_f32 v145, v145
v_mfma_f32_16x16x32_bf16 v[56:59], a[208:211], v[152:155], v[56:59]
v_exp_f32 v146, v146
v_mfma_f32_16x16x32_bf16 v[68:71], a[212:215], v[152:155], v[68:71]
ds_read_b128 a[224:227], v232 offset:49152
v_exp_f32 v147, v147
v_mfma_f32_16x16x32_bf16 v[80:83], a[216:219], v[152:155], v[80:83]
ds_read_b128 a[228:231], v233 offset:49152
v_cvt_pk_bf16_f32 v156, v132, v133
v_cvt_pk_bf16_f32 v157, v134, v135
v_mfma_f32_16x16x32_bf16 v[92:95], a[220:223], v[152:155], v[92:95]
ds_read_b128 a[232:235], v234 offset:49152
v_cvt_pk_bf16_f32 v158, v144, v145
v_cvt_pk_bf16_f32 v159, v146, v147
s_nop 1
v_mfma_f32_16x16x32_bf16 v[108:111], v[220:223], v[156:159], v[108:111]
ds_read_b128 a[236:239], v235 offset:49152
ds_read_b128 a[240:243], v232 offset:53248
v_mfma_f32_16x16x32_bf16 v[12:15], a[192:195], v[156:159], v[12:15]
ds_read_b128 a[244:247], v233 offset:53248
v_mfma_f32_16x16x32_bf16 v[24:27], a[196:199], v[156:159], v[24:27]
buffer_load_dwordx4 v238, s[12:15], s44 offen offset:2048 nt lds
v_mfma_f32_16x16x32_bf16 v[36:39], a[200:203], v[156:159], v[36:39]
ds_read_b128 a[248:251], v234 offset:53248
ds_read_b128 a[252:255], v235 offset:53248
v_mfma_f32_16x16x32_bf16 v[48:51], a[204:207], v[156:159], v[48:51]
v_mfma_f32_16x16x32_bf16 v[60:63], a[208:211], v[156:159], v[60:63]
v_mfma_f32_16x16x32_bf16 v[72:75], a[212:215], v[156:159], v[72:75]
buffer_load_dwordx4 v239, s[12:15], s44 offen offset:3072 nt lds
v_mfma_f32_16x16x32_bf16 v[84:87], a[216:219], v[156:159], v[84:87]
v_mfma_f32_16x16x32_bf16 v[96:99], a[220:223], v[156:159], v[96:99]
s_waitcnt vmcnt(8) lgkmcnt(0)
s_barrier
v_mfma_f32_16x16x32_bf16 v[124:127], a[224:227], v[160:163], v[112:115]
ds_read_b64_tr_b16 a[192:193], v224 offset:0
s_add_u32 s45, s57, 327680
s_add_u32 m0, s47, 49152
v_mfma_f32_16x16x32_bf16 v[124:127], a[228:231], v[172:175], v[124:127]
ds_read_b64_tr_b16 a[194:195], v224 offset:4096
v_mfma_f32_16x16x32_bf16 v[124:127], a[232:235], v[184:187], v[124:127]
ds_read_b64_tr_b16 a[196:197], v225 offset:0
v_mfma_f32_16x16x32_bf16 v[124:127], a[236:239], v[196:199], v[124:127]
ds_read_b64_tr_b16 a[198:199], v225 offset:4096
v_mfma_f32_16x16x32_bf16 v[136:139], a[240:243], v[160:163], v[112:115]
ds_read_b64_tr_b16 a[200:201], v226 offset:0
ds_read_b64_tr_b16 a[202:203], v226 offset:4096
v_mfma_f32_16x16x32_bf16 v[136:139], a[244:247], v[172:175], v[136:139]
buffer_load_dwordx4 v240, s[32:35], s45 offen lds
v_mfma_f32_16x16x32_bf16 v[136:139], a[248:251], v[184:187], v[136:139]
ds_read_b64_tr_b16 a[204:205], v227 offset:0
v_mfma_f32_16x16x32_bf16 v[136:139], a[252:255], v[196:199], v[136:139]
ds_read_b64_tr_b16 a[206:207], v227 offset:4096
v_mfma_f32_16x16x32_bf16 v[128:131], a[224:227], v[164:167], v[116:119]
ds_read_b64_tr_b16 a[208:209], v228 offset:0
v_mfma_f32_16x16x32_bf16 v[128:131], a[228:231], v[176:179], v[128:131]
ds_read_b64_tr_b16 a[210:211], v228 offset:4096
v_mfma_f32_16x16x32_bf16 v[128:131], a[232:235], v[188:191], v[128:131]
ds_read_b64_tr_b16 a[212:213], v229 offset:0
ds_read_b64_tr_b16 a[214:215], v229 offset:4096
v_mfma_f32_16x16x32_bf16 v[128:131], a[236:239], v[200:203], v[128:131]
buffer_load_dwordx4 v241, s[32:35], s45 offen offset:1024 lds
v_mfma_f32_16x16x32_bf16 v[140:143], a[240:243], v[164:167], v[116:119]
ds_read_b64_tr_b16 a[216:217], v230 offset:0
v_max3_f32 v244, v124, v125, v126
v_mfma_f32_16x16x32_bf16 v[140:143], a[244:247], v[176:179], v[140:143]
ds_read_b64_tr_b16 a[218:219], v230 offset:4096
v_max3_f32 v244, v244, v127, v136
v_mfma_f32_16x16x32_bf16 v[140:143], a[248:251], v[188:191], v[140:143]
ds_read_b64_tr_b16 a[220:221], v231 offset:0
v_max3_f32 v244, v244, v137, v138
v_mfma_f32_16x16x32_bf16 v[140:143], a[252:255], v[200:203], v[140:143]
ds_read_b64_tr_b16 a[222:223], v231 offset:4096
v_max_f32 v244, v244, v139
v_mfma_f32_16x16x32_bf16 v[132:135], a[224:227], v[168:171], v[120:123]
buffer_load_dwordx4 v242, s[32:35], s45 offen offset:2048 lds
v_mfma_f32_16x16x32_bf16 v[132:135], a[228:231], v[180:183], v[132:135]
v_mfma_f32_16x16x32_bf16 v[132:135], a[232:235], v[192:195], v[132:135]
v_mfma_f32_16x16x32_bf16 v[132:135], a[236:239], v[204:207], v[132:135]
v_max3_f32 v245, v128, v129, v130
v_max3_f32 v245, v245, v131, v140
v_mfma_f32_16x16x32_bf16 v[144:147], a[240:243], v[168:171], v[120:123]
v_max3_f32 v245, v245, v141, v142
v_max_f32 v245, v245, v143
v_mfma_f32_16x16x32_bf16 v[144:147], a[244:247], v[180:183], v[144:147]
buffer_load_dwordx4 v243, s[32:35], s45 offen offset:3072 lds
v_mfma_f32_16x16x32_bf16 v[144:147], a[248:251], v[192:195], v[144:147]
v_mfma_f32_16x16x32_bf16 v[144:147], a[252:255], v[204:207], v[144:147]
s_waitcnt vmcnt(8) lgkmcnt(0)
s_barrier
v_mfma_f32_16x16x32_bf16 a[96:99], a[192:195], v[208:211], a[96:99]
ds_read_b64_tr_b16 a[224:225], v224 offset:16384
s_add_u32 s44, s11, 106496
s_and_b32 s44, s44, 0x1ffff
v_mfma_f32_16x16x32_bf16 a[100:103], a[192:195], v[212:215], a[100:103]
ds_read_b64_tr_b16 a[226:227], v224 offset:20480
ds_read_b64_tr_b16 a[228:229], v225 offset:16384
s_add_u32 s44, s44, s49
v_mfma_f32_16x16x32_bf16 a[104:107], a[192:195], v[216:219], a[104:107]
s_add_u32 m0, s47, 0
s_nop 0
buffer_load_dwordx4 v236, s[16:19], s44 offen nt lds
v_mfma_f32_16x16x32_bf16 a[108:111], a[196:199], v[208:211], a[108:111]
ds_read_b64_tr_b16 a[230:231], v225 offset:20480
v_max3_f32 v246, v132, v133, v134
v_mfma_f32_16x16x32_bf16 a[112:115], a[196:199], v[212:215], a[112:115]
ds_read_b64_tr_b16 a[232:233], v226 offset:16384
v_max3_f32 v246, v246, v135, v144
v_mfma_f32_16x16x32_bf16 a[116:119], a[196:199], v[216:219], a[116:119]
v_max3_f32 v246, v246, v145, v146
v_max_f32 v246, v246, v147
v_mfma_f32_16x16x32_bf16 a[120:123], a[200:203], v[208:211], a[120:123]
v_max3_f32 v247, v244, v245, v246
v_cmp_lt_f32 vcc, s50, v247
s_cbranch_vccnz L_rs37
L_rb37:
v_mfma_f32_16x16x32_bf16 a[124:127], a[200:203], v[212:215], a[124:127]
v_exp_f32 v124, v124
v_mfma_f32_16x16x32_bf16 a[128:131], a[200:203], v[216:219], a[128:131]
buffer_load_dwordx4 v237, s[16:19], s44 offen offset:1024 nt lds
v_mfma_f32_16x16x32_bf16 a[132:135], a[204:207], v[208:211], a[132:135]
ds_read_b64_tr_b16 a[234:235], v226 offset:20480
v_exp_f32 v125, v125
v_mfma_f32_16x16x32_bf16 a[136:139], a[204:207], v[212:215], a[136:139]
ds_read_b64_tr_b16 a[236:237], v227 offset:16384
v_exp_f32 v126, v126
v_mfma_f32_16x16x32_bf16 a[140:143], a[204:207], v[216:219], a[140:143]
ds_read_b64_tr_b16 a[238:239], v227 offset:20480
v_exp_f32 v127, v127
v_mfma_f32_16x16x32_bf16 a[144:147], a[208:211], v[208:211], a[144:147]
ds_read_b64_tr_b16 a[240:241], v228 offset:16384
v_exp_f32 v136, v136
v_mfma_f32_16x16x32_bf16 a[148:151], a[208:211], v[212:215], a[148:151]
ds_read_b64_tr_b16 a[242:243], v228 offset:20480
v_exp_f32 v137, v137
v_mfma_f32_16x16x32_bf16 a[152:155], a[208:211], v[216:219], a[152:155]
buffer_load_dwordx4 v238, s[16:19], s44 offen offset:2048 nt lds
v_mfma_f32_16x16x32_bf16 a[156:159], a[212:215], v[208:211], a[156:159]
ds_read_b64_tr_b16 a[244:245], v229 offset:16384
v_exp_f32 v138, v138
v_mfma_f32_16x16x32_bf16 a[160:163], a[212:215], v[212:215], a[160:163]
ds_read_b64_tr_b16 a[246:247], v229 offset:20480
v_exp_f32 v139, v139
v_mfma_f32_16x16x32_bf16 a[164:167], a[212:215], v[216:219], a[164:167]
ds_read_b64_tr_b16 a[248:249], v230 offset:16384
v_cvt_pk_bf16_f32 v148, v124, v125
v_mfma_f32_16x16x32_bf16 a[168:171], a[216:219], v[208:211], a[168:171]
ds_read_b64_tr_b16 a[250:251], v230 offset:20480
v_cvt_pk_bf16_f32 v149, v126, v127
v_mfma_f32_16x16x32_bf16 a[172:175], a[216:219], v[212:215], a[172:175]
ds_read_b64_tr_b16 a[252:253], v231 offset:16384
ds_read_b64_tr_b16 a[254:255], v231 offset:20480
v_cvt_pk_bf16_f32 v150, v136, v137
v_mfma_f32_16x16x32_bf16 a[176:179], a[216:219], v[216:219], a[176:179]
buffer_load_dwordx4 v239, s[16:19], s44 offen offset:3072 nt lds
v_mfma_f32_16x16x32_bf16 a[180:183], a[220:223], v[208:211], a[180:183]
v_cvt_pk_bf16_f32 v151, v138, v139
v_exp_f32 v128, v128
v_mfma_f32_16x16x32_bf16 a[184:187], a[220:223], v[212:215], a[184:187]
v_exp_f32 v129, v129
v_exp_f32 v130, v130
v_mfma_f32_16x16x32_bf16 a[188:191], a[220:223], v[216:219], a[188:191]
v_exp_f32 v131, v131
s_waitcnt vmcnt(8) lgkmcnt(0)
s_barrier
v_mfma_f32_16x16x32_bf16 v[100:103], v[220:223], v[148:151], v[100:103]
s_add_u32 s44, s11, 114688
v_exp_f32 v140, v140
v_mfma_f32_16x16x32_bf16 v[4:7], a[224:227], v[148:151], v[4:7]
s_and_b32 s44, s44, 0x1ffff
v_exp_f32 v141, v141
v_mfma_f32_16x16x32_bf16 v[16:19], a[228:231], v[148:151], v[16:19]
s_add_u32 s44, s44, s49
v_exp_f32 v142, v142
v_mfma_f32_16x16x32_bf16 v[28:31], a[232:235], v[148:151], v[28:31]
s_add_u32 m0, s47, 16384
v_exp_f32 v143, v143
v_mfma_f32_16x16x32_bf16 v[40:43], a[236:239], v[148:151], v[40:43]
v_cvt_pk_bf16_f32 v152, v128, v129
v_cvt_pk_bf16_f32 v153, v130, v131
v_mfma_f32_16x16x32_bf16 v[52:55], a[240:243], v[148:151], v[52:55]
v_cvt_pk_bf16_f32 v154, v140, v141
v_cvt_pk_bf16_f32 v155, v142, v143
v_mfma_f32_16x16x32_bf16 v[64:67], a[244:247], v[148:151], v[64:67]
v_exp_f32 v132, v132
v_mfma_f32_16x16x32_bf16 v[76:79], a[248:251], v[148:151], v[76:79]
buffer_load_dwordx4 v236, s[12:15], s44 offen nt lds
v_mfma_f32_16x16x32_bf16 v[88:91], a[252:255], v[148:151], v[88:91]
v_exp_f32 v133, v133
v_mfma_f32_16x16x32_bf16 v[104:107], v[220:223], v[152:155], v[104:107]
v_exp_f32 v134, v134
v_mfma_f32_16x16x32_bf16 v[8:11], a[224:227], v[152:155], v[8:11]
v_exp_f32 v135, v135
v_mfma_f32_16x16x32_bf16 v[20:23], a[228:231], v[152:155], v[20:23]
v_exp_f32 v144, v144
v_mfma_f32_16x16x32_bf16 v[32:35], a[232:235], v[152:155], v[32:35]
buffer_load_dwordx4 v237, s[12:15], s44 offen offset:1024 nt lds
v_mfma_f32_16x16x32_bf16 v[44:47], a[236:239], v[152:155], v[44:47]
v_exp_f32 v145, v145
v_mfma_f32_16x16x32_bf16 v[56:59], a[240:243], v[152:155], v[56:59]
v_exp_f32 v146, v146
v_mfma_f32_16x16x32_bf16 v[68:71], a[244:247], v[152:155], v[68:71]
ds_read_b128 a[192:195], v232 offset:32768
v_exp_f32 v147, v147
v_mfma_f32_16x16x32_bf16 v[80:83], a[248:251], v[152:155], v[80:83]
ds_read_b128 a[196:199], v233 offset:32768
v_cvt_pk_bf16_f32 v156, v132, v133
v_cvt_pk_bf16_f32 v157, v134, v135
v_mfma_f32_16x16x32_bf16 v[92:95], a[252:255], v[152:155], v[92:95]
ds_read_b128 a[200:203], v234 offset:32768
v_cvt_pk_bf16_f32 v158, v144, v145
v_cvt_pk_bf16_f32 v159, v146, v147
s_nop 1
v_mfma_f32_16x16x32_bf16 v[108:111], v[220:223], v[156:159], v[108:111]
ds_read_b128 a[204:207], v235 offset:32768
ds_read_b128 a[208:211], v232 offset:36864
v_mfma_f32_16x16x32_bf16 v[12:15], a[224:227], v[156:159], v[12:15]
ds_read_b128 a[212:215], v233 offset:36864
v_mfma_f32_16x16x32_bf16 v[24:27], a[228:231], v[156:159], v[24:27]
buffer_load_dwordx4 v238, s[12:15], s44 offen offset:2048 nt lds
v_mfma_f32_16x16x32_bf16 v[36:39], a[232:235], v[156:159], v[36:39]
ds_read_b128 a[216:219], v234 offset:36864
ds_read_b128 a[220:223], v235 offset:36864
v_mfma_f32_16x16x32_bf16 v[48:51], a[236:239], v[156:159], v[48:51]
v_mfma_f32_16x16x32_bf16 v[60:63], a[240:243], v[156:159], v[60:63]
v_mfma_f32_16x16x32_bf16 v[72:75], a[244:247], v[156:159], v[72:75]
buffer_load_dwordx4 v239, s[12:15], s44 offen offset:3072 nt lds
v_mfma_f32_16x16x32_bf16 v[84:87], a[248:251], v[156:159], v[84:87]
v_mfma_f32_16x16x32_bf16 v[96:99], a[252:255], v[156:159], v[96:99]
s_waitcnt vmcnt(8) lgkmcnt(0)
s_barrier
v_mfma_f32_16x16x32_bf16 v[124:127], a[192:195], v[160:163], v[112:115]
ds_read_b64_tr_b16 a[224:225], v224 offset:49152
s_add_u32 s45, s57, 327680
s_add_u32 s45, s45, s30
v_mfma_f32_16x16x32_bf16 v[124:127], a[196:199], v[172:175], v[124:127]
ds_read_b64_tr_b16 a[226:227], v224 offset:53248
s_add_u32 m0, s47, 32768
v_mfma_f32_16x16x32_bf16 v[124:127], a[200:203], v[184:187], v[124:127]
ds_read_b64_tr_b16 a[228:229], v225 offset:49152
v_mfma_f32_16x16x32_bf16 v[124:127], a[204:207], v[196:199], v[124:127]
ds_read_b64_tr_b16 a[230:231], v225 offset:53248
v_mfma_f32_16x16x32_bf16 v[136:139], a[208:211], v[160:163], v[112:115]
ds_read_b64_tr_b16 a[232:233], v226 offset:49152
ds_read_b64_tr_b16 a[234:235], v226 offset:53248
v_mfma_f32_16x16x32_bf16 v[136:139], a[212:215], v[172:175], v[136:139]
buffer_load_dwordx4 v240, s[32:35], s45 offen lds
v_mfma_f32_16x16x32_bf16 v[136:139], a[216:219], v[184:187], v[136:139]
ds_read_b64_tr_b16 a[236:237], v227 offset:49152
v_mfma_f32_16x16x32_bf16 v[136:139], a[220:223], v[196:199], v[136:139]
ds_read_b64_tr_b16 a[238:239], v227 offset:53248
v_mfma_f32_16x16x32_bf16 v[128:131], a[192:195], v[164:167], v[116:119]
ds_read_b64_tr_b16 a[240:241], v228 offset:49152
v_mfma_f32_16x16x32_bf16 v[128:131], a[196:199], v[176:179], v[128:131]
ds_read_b64_tr_b16 a[242:243], v228 offset:53248
v_mfma_f32_16x16x32_bf16 v[128:131], a[200:203], v[188:191], v[128:131]
ds_read_b64_tr_b16 a[244:245], v229 offset:49152
ds_read_b64_tr_b16 a[246:247], v229 offset:53248
v_mfma_f32_16x16x32_bf16 v[128:131], a[204:207], v[200:203], v[128:131]
buffer_load_dwordx4 v241, s[32:35], s45 offen offset:1024 lds
v_mfma_f32_16x16x32_bf16 v[140:143], a[208:211], v[164:167], v[116:119]
ds_read_b64_tr_b16 a[248:249], v230 offset:49152
v_max3_f32 v244, v124, v125, v126
v_mfma_f32_16x16x32_bf16 v[140:143], a[212:215], v[176:179], v[140:143]
ds_read_b64_tr_b16 a[250:251], v230 offset:53248
v_max3_f32 v244, v244, v127, v136
v_mfma_f32_16x16x32_bf16 v[140:143], a[216:219], v[188:191], v[140:143]
ds_read_b64_tr_b16 a[252:253], v231 offset:49152
v_max3_f32 v244, v244, v137, v138
v_mfma_f32_16x16x32_bf16 v[140:143], a[220:223], v[200:203], v[140:143]
ds_read_b64_tr_b16 a[254:255], v231 offset:53248
ds_read_b128 v[208:211], v3 offset:30720
v_max_f32 v244, v244, v139
v_mfma_f32_16x16x32_bf16 v[132:135], a[192:195], v[168:171], v[120:123]
buffer_load_dwordx4 v242, s[32:35], s45 offen offset:2048 lds
v_mfma_f32_16x16x32_bf16 v[132:135], a[196:199], v[180:183], v[132:135]
ds_read_b128 v[212:215], v3 offset:31744
v_mfma_f32_16x16x32_bf16 v[132:135], a[200:203], v[192:195], v[132:135]
ds_read_b128 v[216:219], v3 offset:32768
v_mfma_f32_16x16x32_bf16 v[132:135], a[204:207], v[204:207], v[132:135]
v_max3_f32 v245, v128, v129, v130
v_max3_f32 v245, v245, v131, v140
v_mfma_f32_16x16x32_bf16 v[144:147], a[208:211], v[168:171], v[120:123]
v_max3_f32 v245, v245, v141, v142
v_max_f32 v245, v245, v143
v_mfma_f32_16x16x32_bf16 v[144:147], a[212:215], v[180:183], v[144:147]
buffer_load_dwordx4 v243, s[32:35], s45 offen offset:3072 lds
v_mfma_f32_16x16x32_bf16 v[144:147], a[216:219], v[192:195], v[144:147]
v_mfma_f32_16x16x32_bf16 v[144:147], a[220:223], v[204:207], v[144:147]
s_waitcnt vmcnt(8) lgkmcnt(0)
s_barrier
v_mfma_f32_16x16x32_bf16 a[0:3], a[224:227], v[208:211], a[0:3]
ds_read_b64_tr_b16 a[192:193], v224 offset:0
s_add_u32 s44, s11, 114688
s_and_b32 s44, s44, 0x1ffff
v_mfma_f32_16x16x32_bf16 a[4:7], a[224:227], v[212:215], a[4:7]
ds_read_b64_tr_b16 a[194:195], v224 offset:4096
ds_read_b64_tr_b16 a[196:197], v225 offset:0
s_add_u32 s44, s44, s49
v_mfma_f32_16x16x32_bf16 a[8:11], a[224:227], v[216:219], a[8:11]
s_add_u32 m0, s47, 49152
s_nop 0
buffer_load_dwordx4 v236, s[16:19], s44 offen nt lds
v_mfma_f32_16x16x32_bf16 a[12:15], a[228:231], v[208:211], a[12:15]
ds_read_b64_tr_b16 a[198:199], v225 offset:4096
v_max3_f32 v246, v132, v133, v134
v_mfma_f32_16x16x32_bf16 a[16:19], a[228:231], v[212:215], a[16:19]
ds_read_b64_tr_b16 a[200:201], v226 offset:0
v_max3_f32 v246, v246, v135, v144
v_mfma_f32_16x16x32_bf16 a[20:23], a[228:231], v[216:219], a[20:23]
v_max3_f32 v246, v246, v145, v146
v_max_f32 v246, v246, v147
v_mfma_f32_16x16x32_bf16 a[24:27], a[232:235], v[208:211], a[24:27]
v_max3_f32 v247, v244, v245, v246
v_cmp_lt_f32 vcc, s50, v247
s_cbranch_vccnz L_rs38
L_rb38:
v_mfma_f32_16x16x32_bf16 a[28:31], a[232:235], v[212:215], a[28:31]
v_exp_f32 v124, v124
v_mfma_f32_16x16x32_bf16 a[32:35], a[232:235], v[216:219], a[32:35]
buffer_load_dwordx4 v237, s[16:19], s44 offen offset:1024 nt lds
v_mfma_f32_16x16x32_bf16 a[36:39], a[236:239], v[208:211], a[36:39]
ds_read_b64_tr_b16 a[202:203], v226 offset:4096
v_exp_f32 v125, v125
v_mfma_f32_16x16x32_bf16 a[40:43], a[236:239], v[212:215], a[40:43]
ds_read_b64_tr_b16 a[204:205], v227 offset:0
v_exp_f32 v126, v126
v_mfma_f32_16x16x32_bf16 a[44:47], a[236:239], v[216:219], a[44:47]
ds_read_b64_tr_b16 a[206:207], v227 offset:4096
v_exp_f32 v127, v127
v_mfma_f32_16x16x32_bf16 a[48:51], a[240:243], v[208:211], a[48:51]
ds_read_b64_tr_b16 a[208:209], v228 offset:0
v_exp_f32 v136, v136
v_mfma_f32_16x16x32_bf16 a[52:55], a[240:243], v[212:215], a[52:55]
ds_read_b64_tr_b16 a[210:211], v228 offset:4096
v_exp_f32 v137, v137
v_mfma_f32_16x16x32_bf16 a[56:59], a[240:243], v[216:219], a[56:59]
buffer_load_dwordx4 v238, s[16:19], s44 offen offset:2048 nt lds
v_mfma_f32_16x16x32_bf16 a[60:63], a[244:247], v[208:211], a[60:63]
ds_read_b64_tr_b16 a[212:213], v229 offset:0
v_exp_f32 v138, v138
v_mfma_f32_16x16x32_bf16 a[64:67], a[244:247], v[212:215], a[64:67]
ds_read_b64_tr_b16 a[214:215], v229 offset:4096
v_exp_f32 v139, v139
v_mfma_f32_16x16x32_bf16 a[68:71], a[244:247], v[216:219], a[68:71]
ds_read_b64_tr_b16 a[216:217], v230 offset:0
v_cvt_pk_bf16_f32 v148, v124, v125
v_mfma_f32_16x16x32_bf16 a[72:75], a[248:251], v[208:211], a[72:75]
ds_read_b64_tr_b16 a[218:219], v230 offset:4096
v_cvt_pk_bf16_f32 v149, v126, v127
v_mfma_f32_16x16x32_bf16 a[76:79], a[248:251], v[212:215], a[76:79]
ds_read_b64_tr_b16 a[220:221], v231 offset:0
ds_read_b64_tr_b16 a[222:223], v231 offset:4096
v_cvt_pk_bf16_f32 v150, v136, v137
v_mfma_f32_16x16x32_bf16 a[80:83], a[248:251], v[216:219], a[80:83]
buffer_load_dwordx4 v239, s[16:19], s44 offen offset:3072 nt lds
v_mfma_f32_16x16x32_bf16 a[84:87], a[252:255], v[208:211], a[84:87]
v_cvt_pk_bf16_f32 v151, v138, v139
v_exp_f32 v128, v128
v_mfma_f32_16x16x32_bf16 a[88:91], a[252:255], v[212:215], a[88:91]
v_exp_f32 v129, v129
v_exp_f32 v130, v130
v_mfma_f32_16x16x32_bf16 a[92:95], a[252:255], v[216:219], a[92:95]
v_exp_f32 v131, v131
s_waitcnt vmcnt(8) lgkmcnt(0)
s_barrier
v_mfma_f32_16x16x32_bf16 v[100:103], v[220:223], v[148:151], v[100:103]
s_add_u32 s44, s11, 122880
v_exp_f32 v140, v140
v_mfma_f32_16x16x32_bf16 v[4:7], a[192:195], v[148:151], v[4:7]
s_and_b32 s44, s44, 0x1ffff
v_exp_f32 v141, v141
v_mfma_f32_16x16x32_bf16 v[16:19], a[196:199], v[148:151], v[16:19]
s_add_u32 s44, s44, s49
v_exp_f32 v142, v142
v_mfma_f32_16x16x32_bf16 v[28:31], a[200:203], v[148:151], v[28:31]
s_add_u32 m0, s47, 0
v_exp_f32 v143, v143
v_mfma_f32_16x16x32_bf16 v[40:43], a[204:207], v[148:151], v[40:43]
v_cvt_pk_bf16_f32 v152, v128, v129
v_cvt_pk_bf16_f32 v153, v130, v131
v_mfma_f32_16x16x32_bf16 v[52:55], a[208:211], v[148:151], v[52:55]
v_cvt_pk_bf16_f32 v154, v140, v141
v_cvt_pk_bf16_f32 v155, v142, v143
v_mfma_f32_16x16x32_bf16 v[64:67], a[212:215], v[148:151], v[64:67]
v_exp_f32 v132, v132
v_mfma_f32_16x16x32_bf16 v[76:79], a[216:219], v[148:151], v[76:79]
buffer_load_dwordx4 v236, s[12:15], s44 offen nt lds
v_mfma_f32_16x16x32_bf16 v[88:91], a[220:223], v[148:151], v[88:91]
v_exp_f32 v133, v133
v_mfma_f32_16x16x32_bf16 v[104:107], v[220:223], v[152:155], v[104:107]
v_exp_f32 v134, v134
v_mfma_f32_16x16x32_bf16 v[8:11], a[192:195], v[152:155], v[8:11]
v_exp_f32 v135, v135
v_mfma_f32_16x16x32_bf16 v[20:23], a[196:199], v[152:155], v[20:23]
v_exp_f32 v144, v144
v_mfma_f32_16x16x32_bf16 v[32:35], a[200:203], v[152:155], v[32:35]
buffer_load_dwordx4 v237, s[12:15], s44 offen offset:1024 nt lds
v_mfma_f32_16x16x32_bf16 v[44:47], a[204:207], v[152:155], v[44:47]
v_exp_f32 v145, v145
v_mfma_f32_16x16x32_bf16 v[56:59], a[208:211], v[152:155], v[56:59]
v_exp_f32 v146, v146
v_mfma_f32_16x16x32_bf16 v[68:71], a[212:215], v[152:155], v[68:71]
ds_read_b128 a[224:227], v232 offset:16384
v_exp_f32 v147, v147
v_mfma_f32_16x16x32_bf16 v[80:83], a[216:219], v[152:155], v[80:83]
ds_read_b128 a[228:231], v233 offset:16384
v_cvt_pk_bf16_f32 v156, v132, v133
v_cvt_pk_bf16_f32 v157, v134, v135
v_mfma_f32_16x16x32_bf16 v[92:95], a[220:223], v[152:155], v[92:95]
ds_read_b128 a[232:235], v234 offset:16384
v_cvt_pk_bf16_f32 v158, v144, v145
v_cvt_pk_bf16_f32 v159, v146, v147
s_nop 1
v_mfma_f32_16x16x32_bf16 v[108:111], v[220:223], v[156:159], v[108:111]
ds_read_b128 a[236:239], v235 offset:16384
ds_read_b128 a[240:243], v232 offset:20480
v_mfma_f32_16x16x32_bf16 v[12:15], a[192:195], v[156:159], v[12:15]
ds_read_b128 a[244:247], v233 offset:20480
v_mfma_f32_16x16x32_bf16 v[24:27], a[196:199], v[156:159], v[24:27]
buffer_load_dwordx4 v238, s[12:15], s44 offen offset:2048 nt lds
v_mfma_f32_16x16x32_bf16 v[36:39], a[200:203], v[156:159], v[36:39]
ds_read_b128 a[248:251], v234 offset:20480
ds_read_b128 a[252:255], v235 offset:20480
v_mfma_f32_16x16x32_bf16 v[48:51], a[204:207], v[156:159], v[48:51]
v_mfma_f32_16x16x32_bf16 v[60:63], a[208:211], v[156:159], v[60:63]
v_mfma_f32_16x16x32_bf16 v[72:75], a[212:215], v[156:159], v[72:75]
buffer_load_dwordx4 v239, s[12:15], s44 offen offset:3072 nt lds
v_mfma_f32_16x16x32_bf16 v[84:87], a[216:219], v[156:159], v[84:87]
v_mfma_f32_16x16x32_bf16 v[96:99], a[220:223], v[156:159], v[96:99]
s_waitcnt vmcnt(8) lgkmcnt(0)
s_barrier
v_mfma_f32_16x16x32_bf16 v[124:127], a[224:227], v[160:163], v[112:115]
ds_read_b64_tr_b16 a[192:193], v224 offset:32768
s_add_u32 s45, s57, 360448
s_add_u32 m0, s47, 16384
v_mfma_f32_16x16x32_bf16 v[124:127], a[228:231], v[172:175], v[124:127]
ds_read_b64_tr_b16 a[194:195], v224 offset:36864
v_mfma_f32_16x16x32_bf16 v[124:127], a[232:235], v[184:187], v[124:127]
ds_read_b64_tr_b16 a[196:197], v225 offset:32768
v_mfma_f32_16x16x32_bf16 v[124:127], a[236:239], v[196:199], v[124:127]
ds_read_b64_tr_b16 a[198:199], v225 offset:36864
v_mfma_f32_16x16x32_bf16 v[136:139], a[240:243], v[160:163], v[112:115]
ds_read_b64_tr_b16 a[200:201], v226 offset:32768
ds_read_b64_tr_b16 a[202:203], v226 offset:36864
v_mfma_f32_16x16x32_bf16 v[136:139], a[244:247], v[172:175], v[136:139]
buffer_load_dwordx4 v240, s[32:35], s45 offen lds
v_mfma_f32_16x16x32_bf16 v[136:139], a[248:251], v[184:187], v[136:139]
ds_read_b64_tr_b16 a[204:205], v227 offset:32768
v_mfma_f32_16x16x32_bf16 v[136:139], a[252:255], v[196:199], v[136:139]
ds_read_b64_tr_b16 a[206:207], v227 offset:36864
v_mfma_f32_16x16x32_bf16 v[128:131], a[224:227], v[164:167], v[116:119]
ds_read_b64_tr_b16 a[208:209], v228 offset:32768
v_mfma_f32_16x16x32_bf16 v[128:131], a[228:231], v[176:179], v[128:131]
ds_read_b64_tr_b16 a[210:211], v228 offset:36864
v_mfma_f32_16x16x32_bf16 v[128:131], a[232:235], v[188:191], v[128:131]
ds_read_b64_tr_b16 a[212:213], v229 offset:32768
ds_read_b64_tr_b16 a[214:215], v229 offset:36864
v_mfma_f32_16x16x32_bf16 v[128:131], a[236:239], v[200:203], v[128:131]
buffer_load_dwordx4 v241, s[32:35], s45 offen offset:1024 lds
v_mfma_f32_16x16x32_bf16 v[140:143], a[240:243], v[164:167], v[116:119]
ds_read_b64_tr_b16 a[216:217], v230 offset:32768
v_max3_f32 v244, v124, v125, v126
v_mfma_f32_16x16x32_bf16 v[140:143], a[244:247], v[176:179], v[140:143]
ds_read_b64_tr_b16 a[218:219], v230 offset:36864
v_max3_f32 v244, v244, v127, v136
v_mfma_f32_16x16x32_bf16 v[140:143], a[248:251], v[188:191], v[140:143]
ds_read_b64_tr_b16 a[220:221], v231 offset:32768
v_max3_f32 v244, v244, v137, v138
v_mfma_f32_16x16x32_bf16 v[140:143], a[252:255], v[200:203], v[140:143]
ds_read_b64_tr_b16 a[222:223], v231 offset:36864
v_max_f32 v244, v244, v139
v_mfma_f32_16x16x32_bf16 v[132:135], a[224:227], v[168:171], v[120:123]
buffer_load_dwordx4 v242, s[32:35], s45 offen offset:2048 lds
v_mfma_f32_16x16x32_bf16 v[132:135], a[228:231], v[180:183], v[132:135]
v_mfma_f32_16x16x32_bf16 v[132:135], a[232:235], v[192:195], v[132:135]
v_mfma_f32_16x16x32_bf16 v[132:135], a[236:239], v[204:207], v[132:135]
v_max3_f32 v245, v128, v129, v130
v_max3_f32 v245, v245, v131, v140
v_mfma_f32_16x16x32_bf16 v[144:147], a[240:243], v[168:171], v[120:123]
v_max3_f32 v245, v245, v141, v142
v_max_f32 v245, v245, v143
v_mfma_f32_16x16x32_bf16 v[144:147], a[244:247], v[180:183], v[144:147]
buffer_load_dwordx4 v243, s[32:35], s45 offen offset:3072 lds
v_mfma_f32_16x16x32_bf16 v[144:147], a[248:251], v[192:195], v[144:147]
v_mfma_f32_16x16x32_bf16 v[144:147], a[252:255], v[204:207], v[144:147]
s_waitcnt vmcnt(8) lgkmcnt(0)
s_barrier
v_mfma_f32_16x16x32_bf16 a[96:99], a[192:195], v[208:211], a[96:99]
ds_read_b64_tr_b16 a[224:225], v224 offset:49152
s_add_u32 s45, s57, 360448
s_add_u32 s45, s45, s30
v_mfma_f32_16x16x32_bf16 a[100:103], a[192:195], v[212:215], a[100:103]
ds_read_b64_tr_b16 a[226:227], v224 offset:53248
ds_read_b64_tr_b16 a[228:229], v225 offset:49152
s_add_u32 m0, s47, 32768
v_mfma_f32_16x16x32_bf16 a[104:107], a[192:195], v[216:219], a[104:107]
buffer_load_dwordx4 v240, s[32:35], s45 offen lds
v_mfma_f32_16x16x32_bf16 a[108:111], a[196:199], v[208:211], a[108:111]
ds_read_b64_tr_b16 a[230:231], v225 offset:53248
v_max3_f32 v246, v132, v133, v134
v_mfma_f32_16x16x32_bf16 a[112:115], a[196:199], v[212:215], a[112:115]
ds_read_b64_tr_b16 a[232:233], v226 offset:49152
v_max3_f32 v246, v246, v135, v144
v_mfma_f32_16x16x32_bf16 a[116:119], a[196:199], v[216:219], a[116:119]
v_max3_f32 v246, v246, v145, v146
v_max_f32 v246, v246, v147
v_mfma_f32_16x16x32_bf16 a[120:123], a[200:203], v[208:211], a[120:123]
v_max3_f32 v247, v244, v245, v246
v_cmp_lt_f32 vcc, s50, v247
s_cbranch_vccnz L_rs39
L_rb39:
v_mfma_f32_16x16x32_bf16 a[124:127], a[200:203], v[212:215], a[124:127]
v_exp_f32 v124, v124
v_mfma_f32_16x16x32_bf16 a[128:131], a[200:203], v[216:219], a[128:131]
buffer_load_dwordx4 v241, s[32:35], s45 offen offset:1024 lds
v_mfma_f32_16x16x32_bf16 a[132:135], a[204:207], v[208:211], a[132:135]
ds_read_b64_tr_b16 a[234:235], v226 offset:53248
v_exp_f32 v125, v125
v_mfma_f32_16x16x32_bf16 a[136:139], a[204:207], v[212:215], a[136:139]
ds_read_b64_tr_b16 a[236:237], v227 offset:49152
v_exp_f32 v126, v126
v_mfma_f32_16x16x32_bf16 a[140:143], a[204:207], v[216:219], a[140:143]
ds_read_b64_tr_b16 a[238:239], v227 offset:53248
v_exp_f32 v127, v127
v_mfma_f32_16x16x32_bf16 a[144:147], a[208:211], v[208:211], a[144:147]
ds_read_b64_tr_b16 a[240:241], v228 offset:49152
v_exp_f32 v136, v136
v_mfma_f32_16x16x32_bf16 a[148:151], a[208:211], v[212:215], a[148:151]
ds_read_b64_tr_b16 a[242:243], v228 offset:53248
v_exp_f32 v137, v137
v_mfma_f32_16x16x32_bf16 a[152:155], a[208:211], v[216:219], a[152:155]
buffer_load_dwordx4 v242, s[32:35], s45 offen offset:2048 lds
v_mfma_f32_16x16x32_bf16 a[156:159], a[212:215], v[208:211], a[156:159]
ds_read_b64_tr_b16 a[244:245], v229 offset:49152
v_exp_f32 v138, v138
v_mfma_f32_16x16x32_bf16 a[160:163], a[212:215], v[212:215], a[160:163]
ds_read_b64_tr_b16 a[246:247], v229 offset:53248
v_exp_f32 v139, v139
v_mfma_f32_16x16x32_bf16 a[164:167], a[212:215], v[216:219], a[164:167]
ds_read_b64_tr_b16 a[248:249], v230 offset:49152
v_cvt_pk_bf16_f32 v148, v124, v125
v_mfma_f32_16x16x32_bf16 a[168:171], a[216:219], v[208:211], a[168:171]
ds_read_b64_tr_b16 a[250:251], v230 offset:53248
v_cvt_pk_bf16_f32 v149, v126, v127
v_mfma_f32_16x16x32_bf16 a[172:175], a[216:219], v[212:215], a[172:175]
ds_read_b64_tr_b16 a[252:253], v231 offset:49152
ds_read_b64_tr_b16 a[254:255], v231 offset:53248
v_cvt_pk_bf16_f32 v150, v136, v137
v_mfma_f32_16x16x32_bf16 a[176:179], a[216:219], v[216:219], a[176:179]
buffer_load_dwordx4 v243, s[32:35], s45 offen offset:3072 lds
v_mfma_f32_16x16x32_bf16 a[180:183], a[220:223], v[208:211], a[180:183]
v_cvt_pk_bf16_f32 v151, v138, v139
v_exp_f32 v128, v128
v_mfma_f32_16x16x32_bf16 a[184:187], a[220:223], v[212:215], a[184:187]
v_exp_f32 v129, v129
v_exp_f32 v130, v130
v_mfma_f32_16x16x32_bf16 a[188:191], a[220:223], v[216:219], a[188:191]
v_exp_f32 v131, v131
s_waitcnt vmcnt(8) lgkmcnt(0)
s_barrier
v_mfma_f32_16x16x32_bf16 v[100:103], v[220:223], v[148:151], v[100:103]
s_and_b32 s52, s10, 1
v_exp_f32 v140, v140
v_mfma_f32_16x16x32_bf16 v[4:7], a[224:227], v[148:151], v[4:7]
s_lshl_b32 s52, s52, 2
v_exp_f32 v141, v141
v_mfma_f32_16x16x32_bf16 v[16:19], a[228:231], v[148:151], v[16:19]
v_lshrrev_b32 v250, 3, v1
v_exp_f32 v142, v142
v_mfma_f32_16x16x32_bf16 v[28:31], a[232:235], v[148:151], v[28:31]
v_and_b32 v251, 7, v1
v_exp_f32 v143, v143
v_mfma_f32_16x16x32_bf16 v[40:43], a[236:239], v[148:151], v[40:43]
v_and_b32 v240, 6, v250
v_cvt_pk_bf16_f32 v152, v128, v129
v_cvt_pk_bf16_f32 v153, v130, v131
v_mfma_f32_16x16x32_bf16 v[52:55], a[240:243], v[148:151], v[52:55]
v_xor_b32 v251, v251, v240
v_cvt_pk_bf16_f32 v154, v140, v141
v_cvt_pk_bf16_f32 v155, v142, v143
v_mfma_f32_16x16x32_bf16 v[64:67], a[244:247], v[148:151], v[64:67]
v_xor_b32 v251, s52, v251
v_exp_f32 v132, v132
v_mfma_f32_16x16x32_bf16 v[76:79], a[248:251], v[148:151], v[76:79]
v_lshlrev_b32 v251, 4, v251
v_lshl_add_u32 v240, v250, 10, v251
v_add_u32 v241, 7168, v240
v_add_u32 v242, 14336, v240
v_add_u32 v243, 21504, v240
s_xor_b32 s45, s31, 0
s_add_u32 s45, s45, s64
s_add_u32 m0, s47, 49152
s_nop 0
buffer_load_dwordx4 v240, s[32:35], s45 offen lds
v_mfma_f32_16x16x32_bf16 v[88:91], a[252:255], v[148:151], v[88:91]
v_exp_f32 v133, v133
v_mfma_f32_16x16x32_bf16 v[104:107], v[220:223], v[152:155], v[104:107]
v_exp_f32 v134, v134
v_mfma_f32_16x16x32_bf16 v[8:11], a[224:227], v[152:155], v[8:11]
v_exp_f32 v135, v135
v_mfma_f32_16x16x32_bf16 v[20:23], a[228:231], v[152:155], v[20:23]
v_exp_f32 v144, v144
v_mfma_f32_16x16x32_bf16 v[32:35], a[232:235], v[152:155], v[32:35]
buffer_load_dwordx4 v241, s[32:35], s45 offen offset:1024 lds
v_mfma_f32_16x16x32_bf16 v[44:47], a[236:239], v[152:155], v[44:47]
v_exp_f32 v145, v145
v_mfma_f32_16x16x32_bf16 v[56:59], a[240:243], v[152:155], v[56:59]
v_exp_f32 v146, v146
v_mfma_f32_16x16x32_bf16 v[68:71], a[244:247], v[152:155], v[68:71]
ds_read_b128 a[192:195], v232 offset:0
v_exp_f32 v147, v147
v_mfma_f32_16x16x32_bf16 v[80:83], a[248:251], v[152:155], v[80:83]
ds_read_b128 a[196:199], v233 offset:0
v_cvt_pk_bf16_f32 v156, v132, v133
v_cvt_pk_bf16_f32 v157, v134, v135
v_mfma_f32_16x16x32_bf16 v[92:95], a[252:255], v[152:155], v[92:95]
ds_read_b128 a[200:203], v234 offset:0
v_cvt_pk_bf16_f32 v158, v144, v145
v_cvt_pk_bf16_f32 v159, v146, v147
s_nop 1
v_mfma_f32_16x16x32_bf16 v[108:111], v[220:223], v[156:159], v[108:111]
ds_read_b128 a[204:207], v235 offset:0
ds_read_b128 a[208:211], v232 offset:4096
v_mfma_f32_16x16x32_bf16 v[12:15], a[224:227], v[156:159], v[12:15]
ds_read_b128 a[212:215], v233 offset:4096
v_mfma_f32_16x16x32_bf16 v[24:27], a[228:231], v[156:159], v[24:27]
buffer_load_dwordx4 v242, s[32:35], s45 offen offset:2048 lds
v_mfma_f32_16x16x32_bf16 v[36:39], a[232:235], v[156:159], v[36:39]
ds_read_b128 a[216:219], v234 offset:4096
ds_read_b128 a[220:223], v235 offset:4096
v_mfma_f32_16x16x32_bf16 v[48:51], a[236:239], v[156:159], v[48:51]
v_mfma_f32_16x16x32_bf16 v[60:63], a[240:243], v[156:159], v[60:63]
v_mfma_f32_16x16x32_bf16 v[72:75], a[244:247], v[156:159], v[72:75]
buffer_load_dwordx4 v243, s[32:35], s45 offen offset:3072 lds
v_mfma_f32_16x16x32_bf16 v[84:87], a[248:251], v[156:159], v[84:87]
v_mfma_f32_16x16x32_bf16 v[96:99], a[252:255], v[156:159], v[96:99]
s_waitcnt vmcnt(8) lgkmcnt(0)
s_barrier
v_mfma_f32_16x16x32_bf16 v[124:127], a[192:195], v[160:163], v[112:115]
ds_read_b64_tr_b16 a[224:225], v224 offset:16384
s_add_u32 s44, s11, 122880
s_and_b32 s44, s44, 0x1ffff
v_mfma_f32_16x16x32_bf16 v[124:127], a[196:199], v[172:175], v[124:127]
ds_read_b64_tr_b16 a[226:227], v224 offset:20480
s_add_u32 s44, s44, s49
s_add_u32 m0, s47, 0
v_mfma_f32_16x16x32_bf16 v[124:127], a[200:203], v[184:187], v[124:127]
ds_read_b64_tr_b16 a[228:229], v225 offset:16384
v_mfma_f32_16x16x32_bf16 v[124:127], a[204:207], v[196:199], v[124:127]
ds_read_b64_tr_b16 a[230:231], v225 offset:20480
v_mfma_f32_16x16x32_bf16 v[136:139], a[208:211], v[160:163], v[112:115]
ds_read_b64_tr_b16 a[232:233], v226 offset:16384
ds_read_b64_tr_b16 a[234:235], v226 offset:20480
v_mfma_f32_16x16x32_bf16 v[136:139], a[212:215], v[172:175], v[136:139]
buffer_load_dwordx4 v236, s[16:19], s44 offen nt lds
v_mfma_f32_16x16x32_bf16 v[136:139], a[216:219], v[184:187], v[136:139]
ds_read_b64_tr_b16 a[236:237], v227 offset:16384
v_mfma_f32_16x16x32_bf16 v[136:139], a[220:223], v[196:199], v[136:139]
ds_read_b64_tr_b16 a[238:239], v227 offset:20480
v_mfma_f32_16x16x32_bf16 v[128:131], a[192:195], v[164:167], v[116:119]
ds_read_b64_tr_b16 a[240:241], v228 offset:16384
v_mfma_f32_16x16x32_bf16 v[128:131], a[196:199], v[176:179], v[128:131]
ds_read_b64_tr_b16 a[242:243], v228 offset:20480
v_mfma_f32_16x16x32_bf16 v[128:131], a[200:203], v[188:191], v[128:131]
ds_read_b64_tr_b16 a[244:245], v229 offset:16384
ds_read_b64_tr_b16 a[246:247], v229 offset:20480
v_mfma_f32_16x16x32_bf16 v[128:131], a[204:207], v[200:203], v[128:131]
buffer_load_dwordx4 v237, s[16:19], s44 offen offset:1024 nt lds
v_mfma_f32_16x16x32_bf16 v[140:143], a[208:211], v[164:167], v[116:119]
ds_read_b64_tr_b16 a[248:249], v230 offset:16384
v_max3_f32 v244, v124, v125, v126
v_mfma_f32_16x16x32_bf16 v[140:143], a[212:215], v[176:179], v[140:143]
ds_read_b64_tr_b16 a[250:251], v230 offset:20480
v_max3_f32 v244, v244, v127, v136
v_mfma_f32_16x16x32_bf16 v[140:143], a[216:219], v[188:191], v[140:143]
ds_read_b64_tr_b16 a[252:253], v231 offset:16384
v_max3_f32 v244, v244, v137, v138
v_mfma_f32_16x16x32_bf16 v[140:143], a[220:223], v[200:203], v[140:143]
ds_read_b64_tr_b16 a[254:255], v231 offset:20480
ds_read_b128 v[208:211], v3 offset:33792
v_max_f32 v244, v244, v139
v_mfma_f32_16x16x32_bf16 v[132:135], a[192:195], v[168:171], v[120:123]
buffer_load_dwordx4 v238, s[16:19], s44 offen offset:2048 nt lds
v_mfma_f32_16x16x32_bf16 v[132:135], a[196:199], v[180:183], v[132:135]
ds_read_b128 v[212:215], v3 offset:34816
v_mfma_f32_16x16x32_bf16 v[132:135], a[200:203], v[192:195], v[132:135]
ds_read_b128 v[216:219], v3 offset:35840
v_mfma_f32_16x16x32_bf16 v[132:135], a[204:207], v[204:207], v[132:135]
v_max3_f32 v245, v128, v129, v130
v_max3_f32 v245, v245, v131, v140
v_mfma_f32_16x16x32_bf16 v[144:147], a[208:211], v[168:171], v[120:123]
v_max3_f32 v245, v245, v141, v142
v_max_f32 v245, v245, v143
v_mfma_f32_16x16x32_bf16 v[144:147], a[212:215], v[180:183], v[144:147]
buffer_load_dwordx4 v239, s[16:19], s44 offen offset:3072 nt lds
v_mfma_f32_16x16x32_bf16 v[144:147], a[216:219], v[192:195], v[144:147]
v_mfma_f32_16x16x32_bf16 v[144:147], a[220:223], v[204:207], v[144:147]
s_waitcnt vmcnt(8) lgkmcnt(0)
s_barrier
v_mfma_f32_16x16x32_bf16 a[0:3], a[224:227], v[208:211], a[0:3]
ds_read_b64_tr_b16 a[192:193], v224 offset:32768
s_xor_b32 s45, s31, 128
s_add_u32 s45, s45, s64
v_mfma_f32_16x16x32_bf16 a[4:7], a[224:227], v[212:215], a[4:7]
ds_read_b64_tr_b16 a[194:195], v224 offset:36864
s_add_u32 m0, s47, 16384
v_mfma_f32_16x16x32_bf16 a[8:11], a[224:227], v[216:219], a[8:11]
ds_read_b64_tr_b16 a[196:197], v225 offset:32768
v_mfma_f32_16x16x32_bf16 a[12:15], a[228:231], v[208:211], a[12:15]
buffer_load_dwordx4 v240, s[32:35], s45 offen lds
v_mfma_f32_16x16x32_bf16 a[16:19], a[228:231], v[212:215], a[16:19]
ds_read_b64_tr_b16 a[198:199], v225 offset:36864
v_max3_f32 v246, v132, v133, v134
v_max3_f32 v246, v246, v135, v144
v_mfma_f32_16x16x32_bf16 a[20:23], a[228:231], v[216:219], a[20:23]
ds_read_b64_tr_b16 a[200:201], v226 offset:32768
v_max3_f32 v246, v246, v145, v146
v_max_f32 v246, v246, v147
v_mfma_f32_16x16x32_bf16 a[24:27], a[232:235], v[208:211], a[24:27]
ds_read_b64_tr_b16 a[202:203], v226 offset:36864
v_max3_f32 v247, v244, v245, v246
v_cmp_lt_f32 vcc, s50, v247
v_mfma_f32_16x16x32_bf16 a[28:31], a[232:235], v[212:215], a[28:31]
ds_read_b64_tr_b16 a[204:205], v227 offset:32768
s_cbranch_vccnz L_rs40
L_rb40:
v_exp_f32 v124, v124
v_mfma_f32_16x16x32_bf16 a[32:35], a[232:235], v[216:219], a[32:35]
ds_read_b64_tr_b16 a[206:207], v227 offset:36864
v_exp_f32 v125, v125
v_exp_f32 v126, v126
v_mfma_f32_16x16x32_bf16 a[36:39], a[236:239], v[208:211], a[36:39]
buffer_load_dwordx4 v241, s[32:35], s45 offen offset:1024 lds
v_mfma_f32_16x16x32_bf16 a[40:43], a[236:239], v[212:215], a[40:43]
ds_read_b64_tr_b16 a[208:209], v228 offset:32768
v_exp_f32 v127, v127
v_exp_f32 v136, v136
v_mfma_f32_16x16x32_bf16 a[44:47], a[236:239], v[216:219], a[44:47]
ds_read_b64_tr_b16 a[210:211], v228 offset:36864
v_exp_f32 v137, v137
v_exp_f32 v138, v138
v_mfma_f32_16x16x32_bf16 a[48:51], a[240:243], v[208:211], a[48:51]
ds_read_b64_tr_b16 a[212:213], v229 offset:32768
v_exp_f32 v139, v139
v_exp_f32 v128, v128
v_mfma_f32_16x16x32_bf16 a[52:55], a[240:243], v[212:215], a[52:55]
ds_read_b64_tr_b16 a[214:215], v229 offset:36864
v_exp_f32 v129, v129
v_mfma_f32_16x16x32_bf16 a[56:59], a[240:243], v[216:219], a[56:59]
ds_read_b64_tr_b16 a[216:217], v230 offset:32768
v_exp_f32 v130, v130
v_mfma_f32_16x16x32_bf16 a[60:63], a[244:247], v[208:211], a[60:63]
ds_read_b64_tr_b16 a[218:219], v230 offset:36864
v_exp_f32 v131, v131
v_mfma_f32_16x16x32_bf16 a[64:67], a[244:247], v[212:215], a[64:67]
buffer_load_dwordx4 v242, s[32:35], s45 offen offset:2048 lds
v_mfma_f32_16x16x32_bf16 a[68:71], a[244:247], v[216:219], a[68:71]
ds_read_b64_tr_b16 a[220:221], v231 offset:32768
v_cvt_pk_bf16_f32 v148, v124, v125
v_mfma_f32_16x16x32_bf16 a[72:75], a[248:251], v[208:211], a[72:75]
ds_read_b64_tr_b16 a[222:223], v231 offset:36864
v_cvt_pk_bf16_f32 v149, v126, v127
v_mfma_f32_16x16x32_bf16 a[76:79], a[248:251], v[212:215], a[76:79]
v_cvt_pk_bf16_f32 v150, v136, v137
v_cvt_pk_bf16_f32 v151, v138, v139
v_mfma_f32_16x16x32_bf16 a[80:83], a[248:251], v[216:219], a[80:83]
v_exp_f32 v140, v140
v_exp_f32 v141, v141
v_mfma_f32_16x16x32_bf16 a[84:87], a[252:255], v[208:211], a[84:87]
v_mfma_f32_16x16x32_bf16 a[88:91], a[252:255], v[212:215], a[88:91]
buffer_load_dwordx4 v243, s[32:35], s45 offen offset:3072 lds
v_mfma_f32_16x16x32_bf16 a[92:95], a[252:255], v[216:219], a[92:95]
s_waitcnt vmcnt(12) lgkmcnt(0)
s_barrier
v_mfma_f32_16x16x32_bf16 a[96:99], a[192:195], v[208:211], a[96:99]
v_exp_f32 v142, v142
v_exp_f32 v143, v143
v_mfma_f32_16x16x32_bf16 a[100:103], a[192:195], v[212:215], a[100:103]
v_exp_f32 v132, v132
v_exp_f32 v133, v133
v_mfma_f32_16x16x32_bf16 a[104:107], a[192:195], v[216:219], a[104:107]
v_exp_f32 v134, v134
v_exp_f32 v135, v135
v_mfma_f32_16x16x32_bf16 a[108:111], a[196:199], v[208:211], a[108:111]
v_cvt_pk_bf16_f32 v152, v128, v129
v_cvt_pk_bf16_f32 v153, v130, v131
v_mfma_f32_16x16x32_bf16 a[112:115], a[196:199], v[212:215], a[112:115]
v_cvt_pk_bf16_f32 v154, v140, v141
v_cvt_pk_bf16_f32 v155, v142, v143
v_mfma_f32_16x16x32_bf16 a[116:119], a[196:199], v[216:219], a[116:119]
v_exp_f32 v144, v144
v_exp_f32 v145, v145
v_mfma_f32_16x16x32_bf16 a[120:123], a[200:203], v[208:211], a[120:123]
v_exp_f32 v146, v146
v_exp_f32 v147, v147
v_mfma_f32_16x16x32_bf16 a[124:127], a[200:203], v[212:215], a[124:127]
s_nop 0
v_cvt_pk_bf16_f32 v156, v132, v133
v_mfma_f32_16x16x32_bf16 a[128:131], a[200:203], v[216:219], a[128:131]
v_cvt_pk_bf16_f32 v157, v134, v135
v_cvt_pk_bf16_f32 v158, v144, v145
v_mfma_f32_16x16x32_bf16 a[132:135], a[204:207], v[208:211], a[132:135]
v_cvt_pk_bf16_f32 v159, v146, v147
v_lshrrev_b32 v248, 2, v1
v_mfma_f32_16x16x32_bf16 a[136:139], a[204:207], v[212:215], a[136:139]
v_bfe_u32 v249, v1, 3, 2
v_lshlrev_b32 v249, 5, v249
v_mfma_f32_16x16x32_bf16 a[140:143], a[204:207], v[216:219], a[140:143]
v_lshl_add_u32 v248, v248, 7, v249
v_and_b32 v249, 3, v1
v_mfma_f32_16x16x32_bf16 a[144:147], a[208:211], v[208:211], a[144:147]
v_lshl_add_u32 v248, v249, 3, v248
s_lshl_b32 s53, s5, 13
v_mfma_f32_16x16x32_bf16 a[148:151], a[208:211], v[212:215], a[148:151]
v_xor_b32 v232, 0, v248
v_add_u32 v232, s53, v232
v_mfma_f32_16x16x32_bf16 a[152:155], a[208:211], v[216:219], a[152:155]
v_xor_b32 v233, 32, v248
v_add_u32 v233, s53, v233
v_mfma_f32_16x16x32_bf16 a[156:159], a[212:215], v[208:211], a[156:159]
v_xor_b32 v234, 64, v248
v_add_u32 v234, s53, v234
v_mfma_f32_16x16x32_bf16 a[160:163], a[212:215], v[212:215], a[160:163]
v_xor_b32 v235, 96, v248
v_add_u32 v235, s53, v235
v_mfma_f32_16x16x32_bf16 a[164:167], a[212:215], v[216:219], a[164:167]
s_xor_b32 s53, s4, 2
s_mul_i32 s53, s53, 12288
v_mfma_f32_16x16x32_bf16 a[168:171], a[216:219], v[208:211], a[168:171]
s_add_u32 s53, s53, 65536
v_add_u32 v3, s53, v253
v_mfma_f32_16x16x32_bf16 a[172:175], a[216:219], v[212:215], a[172:175]
v_mfma_f32_16x16x32_bf16 a[176:179], a[216:219], v[216:219], a[176:179]
v_mfma_f32_16x16x32_bf16 a[180:183], a[220:223], v[208:211], a[180:183]
v_mfma_f32_16x16x32_bf16 a[184:187], a[220:223], v[212:215], a[184:187]
v_mfma_f32_16x16x32_bf16 a[188:191], a[220:223], v[216:219], a[188:191]
s_waitcnt vmcnt(8) lgkmcnt(0)
s_barrier
ds_read_b64_tr_b16 a[192:193], v232 offset:49152
ds_read_b64_tr_b16 a[194:195], v232 offset:51200
ds_read_b64_tr_b16 a[196:197], v233 offset:49152
ds_read_b64_tr_b16 a[198:199], v233 offset:51200
ds_read_b64_tr_b16 a[200:201], v234 offset:49152
ds_read_b64_tr_b16 a[202:203], v234 offset:51200
ds_read_b64_tr_b16 a[204:205], v235 offset:49152
ds_read_b64_tr_b16 a[206:207], v235 offset:51200
ds_read_b64_tr_b16 a[208:209], v232 offset:53248
ds_read_b64_tr_b16 a[210:211], v232 offset:55296
ds_read_b64_tr_b16 a[212:213], v233 offset:53248
ds_read_b64_tr_b16 a[214:215], v233 offset:55296
ds_read_b64_tr_b16 a[216:217], v234 offset:53248
ds_read_b64_tr_b16 a[218:219], v234 offset:55296
ds_read_b64_tr_b16 a[220:221], v235 offset:53248
ds_read_b64_tr_b16 a[222:223], v235 offset:55296
s_waitcnt vmcnt(4) lgkmcnt(0)
s_barrier
ds_read_b64_tr_b16 a[224:225], v224 offset:0
ds_read_b64_tr_b16 a[226:227], v224 offset:4096
ds_read_b64_tr_b16 a[228:229], v225 offset:0
ds_read_b64_tr_b16 a[230:231], v225 offset:4096
ds_read_b64_tr_b16 a[232:233], v226 offset:0
ds_read_b64_tr_b16 a[234:235], v226 offset:4096
ds_read_b64_tr_b16 a[236:237], v227 offset:0
ds_read_b64_tr_b16 a[238:239], v227 offset:4096
ds_read_b64_tr_b16 a[240:241], v228 offset:0
ds_read_b64_tr_b16 a[242:243], v228 offset:4096
ds_read_b64_tr_b16 a[244:245], v229 offset:0
ds_read_b64_tr_b16 a[246:247], v229 offset:4096
v_mfma_f32_16x16x32_bf16 v[100:103], v[220:223], v[148:151], v[100:103]
ds_read_b64_tr_b16 a[248:249], v230 offset:0
ds_read_b64_tr_b16 a[250:251], v230 offset:4096
ds_read_b64_tr_b16 a[252:253], v231 offset:0
ds_read_b64_tr_b16 a[254:255], v231 offset:4096
s_waitcnt lgkmcnt(14)
v_mfma_f32_16x16x32_bf16 v[4:7], a[224:227], v[148:151], v[4:7]
s_waitcnt lgkmcnt(12)
v_mfma_f32_16x16x32_bf16 v[16:19], a[228:231], v[148:151], v[16:19]
s_xor_b32 s45, s31, 0
s_add_u32 s45, s45, s65
s_add_u32 m0, s47, 32768
s_nop 0
buffer_load_dwordx4 v240, s[32:35], s45 offen lds
s_waitcnt lgkmcnt(10)
v_mfma_f32_16x16x32_bf16 v[28:31], a[232:235], v[148:151], v[28:31]
s_waitcnt lgkmcnt(8)
v_mfma_f32_16x16x32_bf16 v[40:43], a[236:239], v[148:151], v[40:43]
buffer_load_dwordx4 v241, s[32:35], s45 offen offset:1024 lds
s_waitcnt lgkmcnt(6)
v_mfma_f32_16x16x32_bf16 v[52:55], a[240:243], v[148:151], v[52:55]
s_waitcnt lgkmcnt(4)
v_mfma_f32_16x16x32_bf16 v[64:67], a[244:247], v[148:151], v[64:67]
buffer_load_dwordx4 v242, s[32:35], s45 offen offset:2048 lds
s_waitcnt lgkmcnt(2)
v_mfma_f32_16x16x32_bf16 v[76:79], a[248:251], v[148:151], v[76:79]
s_waitcnt lgkmcnt(0)
v_mfma_f32_16x16x32_bf16 v[88:91], a[252:255], v[148:151], v[88:91]
buffer_load_dwordx4 v243, s[32:35], s45 offen offset:3072 lds
v_mfma_f32_16x16x32_bf16 v[104:107], v[220:223], v[152:155], v[104:107]
s_xor_b32 s45, s31, 0
s_add_u32 s45, s45, s66
s_add_u32 m0, s47, 49152
v_mfma_f32_16x16x32_bf16 v[8:11], a[224:227], v[152:155], v[8:11]
buffer_load_dwordx4 v240, s[32:35], s45 offen lds
v_mfma_f32_16x16x32_bf16 v[20:23], a[228:231], v[152:155], v[20:23]
v_mfma_f32_16x16x32_bf16 v[32:35], a[232:235], v[152:155], v[32:35]
v_rcp_f32 v208, v100
s_nop 0
v_mfma_f32_16x16x32_bf16 v[44:47], a[236:239], v[152:155], v[44:47]
v_mul_f32 v4, v4, v208
v_mul_f32 v5, v5, v208
v_mfma_f32_16x16x32_bf16 v[56:59], a[240:243], v[152:155], v[56:59]
v_mul_f32 v6, v6, v208
v_mul_f32 v7, v7, v208
v_mfma_f32_16x16x32_bf16 v[68:71], a[244:247], v[152:155], v[68:71]
v_mul_f32 v16, v16, v208
v_mul_f32 v17, v17, v208
v_mfma_f32_16x16x32_bf16 v[80:83], a[248:251], v[152:155], v[80:83]
buffer_load_dwordx4 v241, s[32:35], s45 offen offset:1024 lds
v_mfma_f32_16x16x32_bf16 v[92:95], a[252:255], v[152:155], v[92:95]
v_mul_f32 v18, v18, v208
v_mul_f32 v19, v19, v208
v_mfma_f32_16x16x32_bf16 v[108:111], v[220:223], v[156:159], v[108:111]
v_cvt_pk_bf16_f32 v4, v4, v5
v_cvt_pk_bf16_f32 v5, v6, v7
v_mfma_f32_16x16x32_bf16 v[12:15], a[224:227], v[156:159], v[12:15]
v_cvt_pk_bf16_f32 v6, v16, v17
v_cvt_pk_bf16_f32 v7, v18, v19
v_mfma_f32_16x16x32_bf16 v[24:27], a[228:231], v[156:159], v[24:27]
v_mul_f32 v28, v28, v208
v_mul_f32 v29, v29, v208
v_mfma_f32_16x16x32_bf16 v[36:39], a[232:235], v[156:159], v[36:39]
buffer_load_dwordx4 v242, s[32:35], s45 offen offset:2048 lds
v_mfma_f32_16x16x32_bf16 v[48:51], a[236:239], v[156:159], v[48:51]
v_mul_f32 v30, v30, v208
v_mul_f32 v31, v31, v208
v_mfma_f32_16x16x32_bf16 v[60:63], a[240:243], v[156:159], v[60:63]
v_mul_f32 v40, v40, v208
v_mul_f32 v41, v41, v208
v_mfma_f32_16x16x32_bf16 v[72:75], a[244:247], v[156:159], v[72:75]
v_mul_f32 v42, v42, v208
v_mul_f32 v43, v43, v208
v_mfma_f32_16x16x32_bf16 v[84:87], a[248:251], v[156:159], v[84:87]
v_cvt_pk_bf16_f32 v28, v28, v29
v_cvt_pk_bf16_f32 v29, v30, v31
v_mfma_f32_16x16x32_bf16 v[96:99], a[252:255], v[156:159], v[96:99]
buffer_load_dwordx4 v243, s[32:35], s45 offen offset:3072 lds
s_xor_b32 s45, s31, 0
s_add_u32 s45, s45, s67
s_add_u32 m0, s47, 114688
s_nop 0
buffer_load_dwordx4 v240, s[32:35], s45 offen lds
buffer_load_dwordx4 v241, s[32:35], s45 offen offset:1024 lds
buffer_load_dwordx4 v242, s[32:35], s45 offen offset:2048 lds
buffer_load_dwordx4 v243, s[32:35], s45 offen offset:3072 lds
v_cvt_pk_bf16_f32 v30, v40, v41
v_cvt_pk_bf16_f32 v31, v42, v43
v_rcp_f32 v209, v104
s_nop 0
v_mul_f32 v8, v8, v209
v_mul_f32 v9, v9, v209
v_mul_f32 v10, v10, v209
v_mul_f32 v11, v11, v209
v_mul_f32 v20, v20, v209
v_mul_f32 v21, v21, v209
v_mul_f32 v22, v22, v209
v_mul_f32 v23, v23, v209
v_cvt_pk_bf16_f32 v8, v8, v9
v_cvt_pk_bf16_f32 v9, v10, v11
v_cvt_pk_bf16_f32 v10, v20, v21
v_cvt_pk_bf16_f32 v11, v22, v23
v_mul_f32 v32, v32, v209
v_mul_f32 v33, v33, v209
v_mul_f32 v34, v34, v209
v_mul_f32 v35, v35, v209
v_mul_f32 v44, v44, v209
v_mul_f32 v45, v45, v209
v_mul_f32 v46, v46, v209
v_mul_f32 v47, v47, v209
v_cvt_pk_bf16_f32 v32, v32, v33
v_cvt_pk_bf16_f32 v33, v34, v35
v_cvt_pk_bf16_f32 v34, v44, v45
v_cvt_pk_bf16_f32 v35, v46, v47
v_rcp_f32 v210, v108
s_nop 0
v_mul_f32 v12, v12, v210
v_mul_f32 v13, v13, v210
v_mul_f32 v14, v14, v210
v_mul_f32 v15, v15, v210
v_mul_f32 v24, v24, v210
v_mul_f32 v25, v25, v210
v_mul_f32 v26, v26, v210
v_mul_f32 v27, v27, v210
v_cvt_pk_bf16_f32 v12, v12, v13
v_cvt_pk_bf16_f32 v13, v14, v15
v_cvt_pk_bf16_f32 v14, v24, v25
v_cvt_pk_bf16_f32 v15, v26, v27
v_mul_f32 v36, v36, v210
v_mul_f32 v37, v37, v210
v_mul_f32 v38, v38, v210
v_mul_f32 v39, v39, v210
v_mul_f32 v48, v48, v210
v_mul_f32 v49, v49, v210
v_mul_f32 v50, v50, v210
v_mul_f32 v51, v51, v210
v_cvt_pk_bf16_f32 v36, v36, v37
v_cvt_pk_bf16_f32 v37, v38, v39
v_cvt_pk_bf16_f32 v38, v48, v49
v_cvt_pk_bf16_f32 v39, v50, v51
s_waitcnt vmcnt(12) lgkmcnt(0)
s_barrier
v_mfma_f32_16x16x32_bf16 a[0:3], a[192:195], v[4:7], a[0:3]
ds_read_b64_tr_b16 a[224:225], v232 offset:16384
ds_read_b64_tr_b16 a[226:227], v232 offset:18432
v_mul_f32 v52, v52, v208
v_mul_f32 v53, v53, v208
v_mul_f32 v54, v54, v208
v_mfma_f32_16x16x32_bf16 a[4:7], a[192:195], v[8:11], a[4:7]
ds_read_b64_tr_b16 a[228:229], v233 offset:16384
ds_write_b128 v252, v[4:7] offset:0
v_mul_f32 v55, v55, v208
v_mul_f32 v64, v64, v208
v_mul_f32 v65, v65, v208
v_mfma_f32_16x16x32_bf16 a[8:11], a[192:195], v[12:15], a[8:11]
ds_read_b64_tr_b16 a[230:231], v233 offset:18432
ds_read_b64_tr_b16 a[232:233], v234 offset:16384
v_mul_f32 v66, v66, v208
v_mul_f32 v67, v67, v208
v_cvt_pk_bf16_f32 v52, v52, v53
v_mfma_f32_16x16x32_bf16 a[12:15], a[196:199], v[4:7], a[12:15]
s_xor_b32 s45, s31, 128
s_add_u32 s45, s45, s65
s_add_u32 m0, s47, 0
s_nop 0
buffer_load_dwordx4 v240, s[32:35], s45 offen lds
v_mfma_f32_16x16x32_bf16 a[16:19], a[196:199], v[8:11], a[16:19]
ds_read_b64_tr_b16 a[234:235], v234 offset:18432
ds_write_b128 v252, v[8:11] offset:1024
v_cvt_pk_bf16_f32 v53, v54, v55
v_cvt_pk_bf16_f32 v54, v64, v65
v_cvt_pk_bf16_f32 v55, v66, v67
v_mfma_f32_16x16x32_bf16 a[20:23], a[196:199], v[12:15], a[20:23]
ds_read_b64_tr_b16 a[236:237], v235 offset:16384
v_mul_f32 v56, v56, v209
v_mul_f32 v57, v57, v209
v_mfma_f32_16x16x32_bf16 a[24:27], a[200:203], v[4:7], a[24:27]
ds_read_b64_tr_b16 a[238:239], v235 offset:18432
v_mul_f32 v58, v58, v209
v_mul_f32 v59, v59, v209
v_mfma_f32_16x16x32_bf16 a[28:31], a[200:203], v[8:11], a[28:31]
ds_write_b128 v252, v[12:15] offset:2048
v_mul_f32 v68, v68, v209
v_mul_f32 v69, v69, v209
v_mfma_f32_16x16x32_bf16 a[32:35], a[200:203], v[12:15], a[32:35]
ds_read_b64_tr_b16 a[240:241], v232 offset:20480
v_mul_f32 v70, v70, v209
v_mul_f32 v71, v71, v209
v_mfma_f32_16x16x32_bf16 a[36:39], a[204:207], v[4:7], a[36:39]
buffer_load_dwordx4 v241, s[32:35], s45 offen offset:1024 lds
v_mfma_f32_16x16x32_bf16 a[40:43], a[204:207], v[8:11], a[40:43]
ds_read_b64_tr_b16 a[242:243], v232 offset:22528
v_cvt_pk_bf16_f32 v56, v56, v57
v_cvt_pk_bf16_f32 v57, v58, v59
v_mfma_f32_16x16x32_bf16 a[44:47], a[204:207], v[12:15], a[44:47]
ds_read_b64_tr_b16 a[244:245], v233 offset:20480
v_cvt_pk_bf16_f32 v58, v68, v69
v_cvt_pk_bf16_f32 v59, v70, v71
v_mfma_f32_16x16x32_bf16 a[0:3], a[208:211], v[28:31], a[0:3]
ds_write_b128 v252, v[28:31] offset:3072
v_mul_f32 v60, v60, v210
v_mul_f32 v61, v61, v210
v_mfma_f32_16x16x32_bf16 a[4:7], a[208:211], v[32:35], a[4:7]
ds_read_b64_tr_b16 a[246:247], v233 offset:22528
v_mul_f32 v62, v62, v210
v_mul_f32 v63, v63, v210
v_mfma_f32_16x16x32_bf16 a[8:11], a[208:211], v[36:39], a[8:11]
ds_read_b64_tr_b16 a[248:249], v234 offset:20480
v_mul_f32 v72, v72, v210
v_mul_f32 v73, v73, v210
v_mfma_f32_16x16x32_bf16 a[12:15], a[212:215], v[28:31], a[12:15]
ds_read_b64_tr_b16 a[250:251], v234 offset:22528
v_mul_f32 v74, v74, v210
v_mul_f32 v75, v75, v210
v_mfma_f32_16x16x32_bf16 a[16:19], a[212:215], v[32:35], a[16:19]
buffer_load_dwordx4 v242, s[32:35], s45 offen offset:2048 lds
v_mfma_f32_16x16x32_bf16 a[20:23], a[212:215], v[36:39], a[20:23]
ds_write_b128 v252, v[32:35] offset:4096
v_cvt_pk_bf16_f32 v60, v60, v61
v_cvt_pk_bf16_f32 v61, v62, v63
v_mfma_f32_16x16x32_bf16 a[24:27], a[216:219], v[28:31], a[24:27]
ds_read_b64_tr_b16 a[252:253], v235 offset:20480
v_cvt_pk_bf16_f32 v62, v72, v73
v_cvt_pk_bf16_f32 v63, v74, v75
v_mfma_f32_16x16x32_bf16 a[28:31], a[216:219], v[32:35], a[28:31]
ds_read_b64_tr_b16 a[254:255], v235 offset:22528
v_add_u32 v224, 0x10000, v232
v_add_u32 v228, 0x20000, v232
v_mfma_f32_16x16x32_bf16 a[32:35], a[216:219], v[36:39], a[32:35]
v_add_u32 v225, 0x10000, v233
v_add_u32 v229, 0x20000, v233
v_mfma_f32_16x16x32_bf16 a[36:39], a[220:223], v[28:31], a[36:39]
v_add_u32 v226, 0x10000, v234
v_add_u32 v230, 0x20000, v234
v_mfma_f32_16x16x32_bf16 a[40:43], a[220:223], v[32:35], a[40:43]
buffer_load_dwordx4 v243, s[32:35], s45 offen offset:3072 lds
v_mfma_f32_16x16x32_bf16 a[44:47], a[220:223], v[36:39], a[44:47]
v_add_u32 v227, 0x10000, v235
v_add_u32 v231, 0x20000, v235
s_waitcnt vmcnt(12) lgkmcnt(0)
s_barrier
v_mfma_f32_16x16x32_bf16 a[48:51], a[224:227], v[4:7], a[48:51]
ds_read_b64_tr_b16 a[192:193], v232 offset:32768
ds_read_b64_tr_b16 a[194:195], v232 offset:34816
v_mul_f32 v76, v76, v208
v_mul_f32 v77, v77, v208
v_mul_f32 v78, v78, v208
v_mfma_f32_16x16x32_bf16 a[52:55], a[224:227], v[8:11], a[52:55]
ds_read_b64_tr_b16 a[196:197], v233 offset:32768
ds_read_b64_tr_b16 a[198:199], v233 offset:34816
v_mul_f32 v79, v79, v208
v_mul_f32 v88, v88, v208
v_mul_f32 v89, v89, v208
v_mfma_f32_16x16x32_bf16 a[56:59], a[224:227], v[12:15], a[56:59]
ds_write_b128 v252, v[36:39] offset:5120
ds_read_b64_tr_b16 a[200:201], v234 offset:32768
v_mul_f32 v90, v90, v208
v_mul_f32 v91, v91, v208
v_cvt_pk_bf16_f32 v76, v76, v77
v_mfma_f32_16x16x32_bf16 a[60:63], a[228:231], v[4:7], a[60:63]
s_xor_b32 s45, s31, 128
s_add_u32 s45, s45, s66
s_add_u32 m0, s47, 16384
s_nop 0
buffer_load_dwordx4 v240, s[32:35], s45 offen lds
v_mfma_f32_16x16x32_bf16 a[64:67], a[228:231], v[8:11], a[64:67]
ds_read_b64_tr_b16 a[202:203], v234 offset:34816
ds_read_b64_tr_b16 a[204:205], v235 offset:32768
v_cvt_pk_bf16_f32 v77, v78, v79
v_cvt_pk_bf16_f32 v78, v88, v89
v_cvt_pk_bf16_f32 v79, v90, v91
v_mfma_f32_16x16x32_bf16 a[68:71], a[228:231], v[12:15], a[68:71]
ds_write_b128 v252, v[52:55] offset:6144
ds_read_b64_tr_b16 a[206:207], v235 offset:34816
v_mul_f32 v80, v80, v209
v_mul_f32 v81, v81, v209
v_mfma_f32_16x16x32_bf16 a[72:75], a[232:235], v[4:7], a[72:75]
buffer_load_dwordx4 v241, s[32:35], s45 offen offset:1024 lds
v_mfma_f32_16x16x32_bf16 a[76:79], a[232:235], v[8:11], a[76:79]
ds_read_b64_tr_b16 a[208:209], v232 offset:36864
ds_read_b64_tr_b16 a[210:211], v232 offset:38912
v_mul_f32 v82, v82, v209
v_mul_f32 v83, v83, v209
v_mfma_f32_16x16x32_bf16 a[80:83], a[232:235], v[12:15], a[80:83]
buffer_load_dwordx4 v242, s[32:35], s45 offen offset:2048 lds
v_mfma_f32_16x16x32_bf16 a[84:87], a[236:239], v[4:7], a[84:87]
ds_write_b128 v252, v[56:59] offset:7168
ds_read_b64_tr_b16 a[212:213], v233 offset:36864
v_mul_f32 v92, v92, v209
v_mul_f32 v93, v93, v209
v_mfma_f32_16x16x32_bf16 a[88:91], a[236:239], v[8:11], a[88:91]
ds_read_b64_tr_b16 a[214:215], v233 offset:38912
v_mul_f32 v94, v94, v209
v_mul_f32 v95, v95, v209
v_mfma_f32_16x16x32_bf16 a[92:95], a[236:239], v[12:15], a[92:95]
buffer_load_dwordx4 v243, s[32:35], s45 offen offset:3072 lds
v_mfma_f32_16x16x32_bf16 a[48:51], a[240:243], v[28:31], a[48:51]
ds_read_b64_tr_b16 a[216:217], v234 offset:36864
v_cvt_pk_bf16_f32 v80, v80, v81
v_cvt_pk_bf16_f32 v81, v82, v83
v_mfma_f32_16x16x32_bf16 a[52:55], a[240:243], v[32:35], a[52:55]
ds_write_b128 v252, v[60:63] offset:8192
v_cvt_pk_bf16_f32 v82, v92, v93
v_cvt_pk_bf16_f32 v83, v94, v95
v_mfma_f32_16x16x32_bf16 a[56:59], a[240:243], v[36:39], a[56:59]
s_xor_b32 s45, s31, 128
s_add_u32 s45, s45, s67
s_add_u32 m0, s47, 131072
s_nop 0
buffer_load_dwordx4 v240, s[32:35], s45 offen lds
v_mfma_f32_16x16x32_bf16 a[60:63], a[244:247], v[28:31], a[60:63]
ds_read_b64_tr_b16 a[218:219], v234 offset:38912
v_mul_f32 v84, v84, v210
v_mul_f32 v85, v85, v210
v_mfma_f32_16x16x32_bf16 a[64:67], a[244:247], v[32:35], a[64:67]
ds_read_b64_tr_b16 a[220:221], v235 offset:36864
v_mul_f32 v86, v86, v210
v_mul_f32 v87, v87, v210
v_mfma_f32_16x16x32_bf16 a[68:71], a[244:247], v[36:39], a[68:71]
buffer_load_dwordx4 v241, s[32:35], s45 offen offset:1024 lds
v_mfma_f32_16x16x32_bf16 a[72:75], a[248:251], v[28:31], a[72:75]
ds_read_b64_tr_b16 a[222:223], v235 offset:38912
v_mul_f32 v96, v96, v210
v_mul_f32 v97, v97, v210
v_mfma_f32_16x16x32_bf16 a[76:79], a[248:251], v[32:35], a[76:79]
buffer_load_dwordx4 v242, s[32:35], s45 offen offset:2048 lds
v_mfma_f32_16x16x32_bf16 a[80:83], a[248:251], v[36:39], a[80:83]
v_mul_f32 v98, v98, v210
v_mul_f32 v99, v99, v210
v_mfma_f32_16x16x32_bf16 a[84:87], a[252:255], v[28:31], a[84:87]
v_cvt_pk_bf16_f32 v84, v84, v85
v_cvt_pk_bf16_f32 v85, v86, v87
v_mfma_f32_16x16x32_bf16 a[88:91], a[252:255], v[32:35], a[88:91]
buffer_load_dwordx4 v243, s[32:35], s45 offen offset:3072 lds
v_mfma_f32_16x16x32_bf16 a[92:95], a[252:255], v[36:39], a[92:95]
v_cvt_pk_bf16_f32 v86, v96, v97
v_cvt_pk_bf16_f32 v87, v98, v99
s_waitcnt vmcnt(16) lgkmcnt(0)
s_barrier
v_mfma_f32_16x16x32_bf16 a[0:3], a[192:195], v[52:55], a[0:3]
ds_read_b64_tr_b16 a[224:225], v232 offset:49152
ds_read_b64_tr_b16 a[226:227], v232 offset:51200
s_xor_b32 s45, s31, 256
v_mfma_f32_16x16x32_bf16 a[4:7], a[192:195], v[56:59], a[4:7]
ds_read_b128 v[16:19], v3 offset:0
ds_read_b64_tr_b16 a[228:229], v233 offset:49152
s_add_u32 s45, s45, s64
v_mfma_f32_16x16x32_bf16 a[8:11], a[192:195], v[60:63], a[8:11]
ds_read_b64_tr_b16 a[230:231], v233 offset:51200
ds_read_b128 v[20:23], v3 offset:1024
s_add_u32 m0, s47, 32768
v_mfma_f32_16x16x32_bf16 a[12:15], a[196:199], v[52:55], a[12:15]
buffer_load_dwordx4 v240, s[32:35], s45 offen lds
v_mfma_f32_16x16x32_bf16 a[16:19], a[196:199], v[56:59], a[16:19]
ds_read_b64_tr_b16 a[232:233], v234 offset:49152
ds_write_b128 v252, v[76:79] offset:9216
v_mfma_f32_16x16x32_bf16 a[20:23], a[196:199], v[60:63], a[20:23]
ds_read_b64_tr_b16 a[234:235], v234 offset:51200
ds_read_b64_tr_b16 a[236:237], v235 offset:49152
v_mfma_f32_16x16x32_bf16 a[24:27], a[200:203], v[52:55], a[24:27]
buffer_load_dwordx4 v241, s[32:35], s45 offen offset:1024 lds
v_mfma_f32_16x16x32_bf16 a[28:31], a[200:203], v[56:59], a[28:31]
ds_read_b128 v[24:27], v3 offset:2048
ds_read_b64_tr_b16 a[238:239], v235 offset:51200
v_mfma_f32_16x16x32_bf16 a[32:35], a[200:203], v[60:63], a[32:35]
buffer_load_dwordx4 v242, s[32:35], s45 offen offset:2048 lds
v_mfma_f32_16x16x32_bf16 a[36:39], a[204:207], v[52:55], a[36:39]
ds_read_b128 v[40:43], v3 offset:3072
ds_read_b64_tr_b16 a[240:241], v232 offset:53248
v_mfma_f32_16x16x32_bf16 a[40:43], a[204:207], v[56:59], a[40:43]
ds_read_b64_tr_b16 a[242:243], v232 offset:55296
ds_write_b128 v252, v[80:83] offset:10240
v_mfma_f32_16x16x32_bf16 a[44:47], a[204:207], v[60:63], a[44:47]
buffer_load_dwordx4 v243, s[32:35], s45 offen offset:3072 lds
v_mfma_f32_16x16x32_bf16 a[0:3], a[208:211], v[76:79], a[0:3]
ds_read_b64_tr_b16 a[244:245], v233 offset:53248
ds_read_b64_tr_b16 a[246:247], v233 offset:55296
s_xor_b32 s45, s31, 256
v_mfma_f32_16x16x32_bf16 a[4:7], a[208:211], v[80:83], a[4:7]
ds_read_b128 v[44:47], v3 offset:4096
ds_read_b64_tr_b16 a[248:249], v234 offset:53248
s_add_u32 s45, s45, s65
v_mfma_f32_16x16x32_bf16 a[8:11], a[208:211], v[84:87], a[8:11]
s_add_u32 m0, s47, 147456
s_nop 0
buffer_load_dwordx4 v240, s[32:35], s45 offen lds
v_mfma_f32_16x16x32_bf16 a[12:15], a[212:215], v[76:79], a[12:15]
ds_read_b128 v[48:51], v3 offset:5120
ds_read_b64_tr_b16 a[250:251], v234 offset:55296
v_mfma_f32_16x16x32_bf16 a[16:19], a[212:215], v[80:83], a[16:19]
ds_read_b64_tr_b16 a[252:253], v235 offset:53248
ds_write_b128 v252, v[84:87] offset:11264
v_mfma_f32_16x16x32_bf16 a[20:23], a[212:215], v[84:87], a[20:23]
buffer_load_dwordx4 v241, s[32:35], s45 offen offset:1024 lds
v_mfma_f32_16x16x32_bf16 a[24:27], a[216:219], v[76:79], a[24:27]
ds_read_b64_tr_b16 a[254:255], v235 offset:55296
v_mfma_f32_16x16x32_bf16 a[28:31], a[216:219], v[80:83], a[28:31]
buffer_load_dwordx4 v242, s[32:35], s45 offen offset:2048 lds
v_mfma_f32_16x16x32_bf16 a[32:35], a[216:219], v[84:87], a[32:35]
v_mfma_f32_16x16x32_bf16 a[36:39], a[220:223], v[76:79], a[36:39]
v_mfma_f32_16x16x32_bf16 a[40:43], a[220:223], v[80:83], a[40:43]
buffer_load_dwordx4 v243, s[32:35], s45 offen offset:3072 lds
v_mfma_f32_16x16x32_bf16 a[44:47], a[220:223], v[84:87], a[44:47]
s_waitcnt vmcnt(20) lgkmcnt(0)
s_barrier
v_mfma_f32_16x16x32_bf16 a[0:3], a[224:227], v[16:19], a[0:3]
ds_read_b64_tr_b16 a[192:193], v224 offset:49152
ds_read_b64_tr_b16 a[194:195], v224 offset:51200
v_and_b32 v152, 7, v1
v_mfma_f32_16x16x32_bf16 a[4:7], a[224:227], v[20:23], a[4:7]
ds_read_b64_tr_b16 a[196:197], v225 offset:49152
ds_read_b128 v[64:67], v3 offset:6144
v_xor_b32 v152, s10, v152
v_mfma_f32_16x16x32_bf16 a[8:11], a[224:227], v[24:27], a[8:11]
ds_read_b64_tr_b16 a[198:199], v225 offset:51200
ds_read_b64_tr_b16 a[200:201], v226 offset:49152
v_lshlrev_b32 v152, 7, v152
v_mfma_f32_16x16x32_bf16 a[12:15], a[228:231], v[16:19], a[12:15]
s_xor_b32 s45, s31, 256
s_add_u32 s45, s45, s66
s_add_u32 m0, s47, 49152
s_nop 0
buffer_load_dwordx4 v240, s[32:35], s45 offen lds
v_mfma_f32_16x16x32_bf16 a[16:19], a[228:231], v[20:23], a[16:19]
ds_read_b128 v[68:71], v3 offset:7168
ds_read_b64_tr_b16 a[202:203], v226 offset:51200
v_mov_b32 v155, 0
v_mfma_f32_16x16x32_bf16 a[20:23], a[228:231], v[24:27], a[20:23]
ds_read_b64_tr_b16 a[204:205], v227 offset:49152
ds_read_b128 v[72:75], v3 offset:8192
v_readlane_b32 s24, v255, 7
v_mfma_f32_16x16x32_bf16 a[24:27], a[232:235], v[16:19], a[24:27]
ds_read_b64_tr_b16 a[206:207], v227 offset:51200
v_and_b32 v156, 15, v1
v_mfma_f32_16x16x32_bf16 a[28:31], a[232:235], v[20:23], a[28:31]
ds_read_b64_tr_b16 a[208:209], v224 offset:53248
v_lshlrev_b32 v156, 11, v156
v_mfma_f32_16x16x32_bf16 a[32:35], a[232:235], v[24:27], a[32:35]
ds_read_b64_tr_b16 a[210:211], v224 offset:55296
v_lshrrev_b32 v153, 4, v1
v_mfma_f32_16x16x32_bf16 a[36:39], a[236:239], v[16:19], a[36:39]
buffer_load_dwordx4 v241, s[32:35], s45 offen offset:1024 lds
v_mfma_f32_16x16x32_bf16 a[40:43], a[236:239], v[20:23], a[40:43]
ds_read_b128 v[88:91], v3 offset:9216
v_lshl_add_u32 v156, v153, 4, v156
v_mfma_f32_16x16x32_bf16 a[44:47], a[236:239], v[24:27], a[44:47]
ds_read_b64_tr_b16 a[212:213], v225 offset:53248
v_mfma_f32_16x16x32_bf16 a[0:3], a[240:243], v[40:43], a[0:3]
ds_read_b64_tr_b16 a[214:215], v225 offset:55296
v_mfma_f32_16x16x32_bf16 a[4:7], a[240:243], v[44:47], a[4:7]
ds_read_b128 v[92:95], v3 offset:10240
v_mfma_f32_16x16x32_bf16 a[8:11], a[240:243], v[48:51], a[8:11]
ds_read_b64_tr_b16 a[216:217], v226 offset:53248
v_mfma_f32_16x16x32_bf16 a[12:15], a[244:247], v[40:43], a[12:15]
ds_read_b64_tr_b16 a[218:219], v226 offset:55296
v_mfma_f32_16x16x32_bf16 a[16:19], a[244:247], v[44:47], a[16:19]
buffer_load_dwordx4 v242, s[32:35], s45 offen offset:2048 lds
v_mfma_f32_16x16x32_bf16 a[20:23], a[244:247], v[48:51], a[20:23]
ds_read_b128 v[96:99], v3 offset:11264
v_mfma_f32_16x16x32_bf16 a[24:27], a[248:251], v[40:43], a[24:27]
ds_read_b64_tr_b16 a[220:221], v227 offset:53248
v_mfma_f32_16x16x32_bf16 a[28:31], a[248:251], v[44:47], a[28:31]
ds_read_b64_tr_b16 a[222:223], v227 offset:55296
v_mfma_f32_16x16x32_bf16 a[32:35], a[248:251], v[48:51], a[32:35]
v_mfma_f32_16x16x32_bf16 a[36:39], a[252:255], v[40:43], a[36:39]
v_mfma_f32_16x16x32_bf16 a[40:43], a[252:255], v[44:47], a[40:43]
buffer_load_dwordx4 v243, s[32:35], s45 offen offset:3072 lds
v_mfma_f32_16x16x32_bf16 a[44:47], a[252:255], v[48:51], a[44:47]
s_waitcnt vmcnt(20) lgkmcnt(0)
s_barrier
v_mfma_f32_16x16x32_bf16 a[0:3], a[192:195], v[64:67], a[0:3]
ds_read_b64_tr_b16 a[224:225], v232 offset:0
ds_read_b64_tr_b16 a[226:227], v232 offset:2048
s_xor_b32 s45, s31, 256
v_mfma_f32_16x16x32_bf16 a[4:7], a[192:195], v[68:71], a[4:7]
ds_read_b64_tr_b16 a[228:229], v233 offset:0
ds_read_b64_tr_b16 a[230:231], v233 offset:2048
s_add_u32 s45, s45, s67
v_mfma_f32_16x16x32_bf16 a[8:11], a[192:195], v[72:75], a[8:11]
ds_read_b64_tr_b16 a[232:233], v234 offset:0
ds_read_b64_tr_b16 a[234:235], v234 offset:2048
s_add_u32 m0, s47, 114688
v_mfma_f32_16x16x32_bf16 a[12:15], a[196:199], v[64:67], a[12:15]
buffer_load_dwordx4 v240, s[32:35], s45 offen lds
v_mfma_f32_16x16x32_bf16 a[16:19], a[196:199], v[68:71], a[16:19]
ds_read_b64_tr_b16 a[236:237], v235 offset:0
v_mfma_f32_16x16x32_bf16 a[20:23], a[196:199], v[72:75], a[20:23]
ds_read_b64_tr_b16 a[238:239], v235 offset:2048
v_mfma_f32_16x16x32_bf16 a[24:27], a[200:203], v[64:67], a[24:27]
buffer_load_dwordx4 v241, s[32:35], s45 offen offset:1024 lds
v_mfma_f32_16x16x32_bf16 a[28:31], a[200:203], v[68:71], a[28:31]
ds_read_b64_tr_b16 a[240:241], v232 offset:4096
v_mfma_f32_16x16x32_bf16 a[32:35], a[200:203], v[72:75], a[32:35]
buffer_load_dwordx4 v242, s[32:35], s45 offen offset:2048 lds
v_mfma_f32_16x16x32_bf16 a[36:39], a[204:207], v[64:67], a[36:39]
ds_read_b64_tr_b16 a[242:243], v232 offset:6144
v_mfma_f32_16x16x32_bf16 a[40:43], a[204:207], v[68:71], a[40:43]
ds_read_b64_tr_b16 a[244:245], v233 offset:4096
v_mfma_f32_16x16x32_bf16 a[44:47], a[204:207], v[72:75], a[44:47]
buffer_load_dwordx4 v243, s[32:35], s45 offen offset:3072 lds
v_mfma_f32_16x16x32_bf16 a[0:3], a[208:211], v[88:91], a[0:3]
ds_read_b64_tr_b16 a[246:247], v233 offset:6144
s_xor_b32 s45, s31, 384
s_add_u32 s45, s45, s64
v_mfma_f32_16x16x32_bf16 a[4:7], a[208:211], v[92:95], a[4:7]
ds_read_b64_tr_b16 a[248:249], v234 offset:4096
s_add_u32 m0, s47, 65536
v_mfma_f32_16x16x32_bf16 a[8:11], a[208:211], v[96:99], a[8:11]
buffer_load_dwordx4 v240, s[32:35], s45 offen lds
v_mfma_f32_16x16x32_bf16 a[12:15], a[212:215], v[88:91], a[12:15]
ds_read_b64_tr_b16 a[250:251], v234 offset:6144
v_mfma_f32_16x16x32_bf16 a[16:19], a[212:215], v[92:95], a[16:19]
ds_read_b64_tr_b16 a[252:253], v235 offset:4096
v_mfma_f32_16x16x32_bf16 a[20:23], a[212:215], v[96:99], a[20:23]
buffer_load_dwordx4 v241, s[32:35], s45 offen offset:1024 lds
v_mfma_f32_16x16x32_bf16 a[24:27], a[216:219], v[88:91], a[24:27]
ds_read_b64_tr_b16 a[254:255], v235 offset:6144
v_mfma_f32_16x16x32_bf16 a[28:31], a[216:219], v[92:95], a[28:31]
buffer_load_dwordx4 v242, s[32:35], s45 offen offset:2048 lds
v_mfma_f32_16x16x32_bf16 a[32:35], a[216:219], v[96:99], a[32:35]
v_mfma_f32_16x16x32_bf16 a[36:39], a[220:223], v[88:91], a[36:39]
v_mfma_f32_16x16x32_bf16 a[40:43], a[220:223], v[92:95], a[40:43]
buffer_load_dwordx4 v243, s[32:35], s45 offen offset:3072 lds
v_mfma_f32_16x16x32_bf16 a[44:47], a[220:223], v[96:99], a[44:47]
s_waitcnt vmcnt(24) lgkmcnt(0)
s_barrier
v_mfma_f32_16x16x32_bf16 a[48:51], a[224:227], v[52:55], a[48:51]
ds_read_b64_tr_b16 a[192:193], v232 offset:16384
s_and_b32 s24, s24, -8
s_mov_b32 s96, 0x00003f80
v_mfma_f32_16x16x32_bf16 a[52:55], a[224:227], v[56:59], a[52:55]
ds_read_b64_tr_b16 a[194:195], v232 offset:18432
s_mov_b32 s97, 0x3f800000
s_mov_b32 s12, s20
v_mfma_f32_16x16x32_bf16 a[56:59], a[224:227], v[60:63], a[56:59]
ds_read_b64_tr_b16 a[196:197], v233 offset:16384
s_and_b32 s13, s21, 0xffff
s_mov_b32 s14, 3145728
v_mfma_f32_16x16x32_bf16 a[60:63], a[228:231], v[52:55], a[60:63]
s_xor_b32 s45, s31, 384
s_add_u32 s45, s45, s65
s_add_u32 m0, s47, 0
s_nop 0
buffer_load_dwordx4 v240, s[32:35], s45 offen lds
v_mfma_f32_16x16x32_bf16 a[64:67], a[228:231], v[56:59], a[64:67]
ds_read_b64_tr_b16 a[198:199], v233 offset:18432
s_xor_b32 s61, s10, 0
s_mul_i32 s61, s61, 24576
v_mfma_f32_16x16x32_bf16 a[68:71], a[228:231], v[60:63], a[68:71]
ds_read_b64_tr_b16 a[200:201], v234 offset:16384
s_add_u32 s61, s61, s63
v_accvgpr_read_b32 v100, a0
v_mfma_f32_16x16x32_bf16 a[72:75], a[232:235], v[52:55], a[72:75]
ds_read_b64_tr_b16 a[202:203], v234 offset:18432
v_accvgpr_read_b32 v101, a1
v_accvgpr_read_b32 v102, a2
v_mfma_f32_16x16x32_bf16 a[76:79], a[232:235], v[56:59], a[76:79]
ds_read_b64_tr_b16 a[204:205], v235 offset:16384
v_accvgpr_read_b32 v103, a3
v_accvgpr_read_b32 v104, a12
v_mfma_f32_16x16x32_bf16 a[80:83], a[232:235], v[60:63], a[80:83]
ds_read_b64_tr_b16 a[206:207], v235 offset:18432
v_accvgpr_read_b32 v105, a13
v_accvgpr_read_b32 v106, a14
v_mfma_f32_16x16x32_bf16 a[84:87], a[236:239], v[52:55], a[84:87]
buffer_load_dwordx4 v241, s[32:35], s45 offen offset:1024 lds
v_mfma_f32_16x16x32_bf16 a[88:91], a[236:239], v[56:59], a[88:91]
ds_read_b64_tr_b16 a[208:209], v232 offset:20480
v_accvgpr_read_b32 v107, a15
v_cvt_pk_bf16_f32 v100, v100, v101
v_mfma_f32_16x16x32_bf16 a[92:95], a[236:239], v[60:63], a[92:95]
ds_read_b64_tr_b16 a[210:211], v232 offset:22528
v_cvt_pk_bf16_f32 v101, v102, v103
v_cvt_pk_bf16_f32 v102, v104, v105
v_mfma_f32_16x16x32_bf16 a[48:51], a[240:243], v[76:79], a[48:51]
ds_read_b64_tr_b16 a[212:213], v233 offset:20480
v_cvt_pk_bf16_f32 v103, v106, v107
v_mfma_f32_16x16x32_bf16 a[52:55], a[240:243], v[80:83], a[52:55]
buffer_store_dwordx4 v[100:103], v253, s[40:43], s61 offen sc1
v_mfma_f32_16x16x32_bf16 a[56:59], a[240:243], v[84:87], a[56:59]
ds_read_b64_tr_b16 a[214:215], v233 offset:22528
v_accvgpr_read_b32 v108, a4
v_accvgpr_read_b32 v109, a5
v_mfma_f32_16x16x32_bf16 a[60:63], a[244:247], v[76:79], a[60:63]
ds_read_b64_tr_b16 a[216:217], v234 offset:20480
v_accvgpr_read_b32 v110, a6
v_accvgpr_read_b32 v111, a7
v_mfma_f32_16x16x32_bf16 a[64:67], a[244:247], v[80:83], a[64:67]
buffer_load_dwordx4 v242, s[32:35], s45 offen offset:2048 lds
v_mfma_f32_16x16x32_bf16 a[68:71], a[244:247], v[84:87], a[68:71]
ds_read_b64_tr_b16 a[218:219], v234 offset:22528
v_accvgpr_read_b32 v112, a16
v_accvgpr_read_b32 v113, a17
v_mfma_f32_16x16x32_bf16 a[72:75], a[248:251], v[76:79], a[72:75]
ds_read_b64_tr_b16 a[220:221], v235 offset:20480
v_accvgpr_read_b32 v114, a18
v_accvgpr_read_b32 v115, a19
v_mfma_f32_16x16x32_bf16 a[76:79], a[248:251], v[80:83], a[76:79]
ds_read_b64_tr_b16 a[222:223], v235 offset:22528
v_cvt_pk_bf16_f32 v108, v108, v109
v_mfma_f32_16x16x32_bf16 a[80:83], a[248:251], v[84:87], a[80:83]
v_cvt_pk_bf16_f32 v109, v110, v111
v_cvt_pk_bf16_f32 v110, v112, v113
v_mfma_f32_16x16x32_bf16 a[84:87], a[252:255], v[76:79], a[84:87]
v_cvt_pk_bf16_f32 v111, v114, v115
v_mfma_f32_16x16x32_bf16 a[88:91], a[252:255], v[80:83], a[88:91]
buffer_load_dwordx4 v243, s[32:35], s45 offen offset:3072 lds
v_mfma_f32_16x16x32_bf16 a[92:95], a[252:255], v[84:87], a[92:95]
s_waitcnt vmcnt(25) lgkmcnt(0)
s_barrier
v_mfma_f32_16x16x32_bf16 a[48:51], a[192:195], v[16:19], a[48:51]
ds_read_b64_tr_b16 a[224:225], v228 offset:0
s_xor_b32 s45, s31, 384
s_add_u32 s45, s45, s66
v_mfma_f32_16x16x32_bf16 a[52:55], a[192:195], v[20:23], a[52:55]
ds_read_b64_tr_b16 a[226:227], v228 offset:2048
s_add_u32 m0, s47, 16384
v_mfma_f32_16x16x32_bf16 a[56:59], a[192:195], v[24:27], a[56:59]
ds_read_b64_tr_b16 a[228:229], v229 offset:0
v_mfma_f32_16x16x32_bf16 a[60:63], a[196:199], v[16:19], a[60:63]
buffer_load_dwordx4 v240, s[32:35], s45 offen lds
v_mfma_f32_16x16x32_bf16 a[64:67], a[196:199], v[20:23], a[64:67]
buffer_store_dwordx4 v[108:111], v253, s[40:43], s61 offen offset:1024 sc1
v_mfma_f32_16x16x32_bf16 a[68:71], a[196:199], v[24:27], a[68:71]
ds_read_b64_tr_b16 a[230:231], v229 offset:2048
v_accvgpr_read_b32 v116, a8
v_accvgpr_read_b32 v117, a9
v_mfma_f32_16x16x32_bf16 a[72:75], a[200:203], v[16:19], a[72:75]
ds_read_b64_tr_b16 a[232:233], v230 offset:0
v_accvgpr_read_b32 v118, a10
v_accvgpr_read_b32 v119, a11
v_mfma_f32_16x16x32_bf16 a[76:79], a[200:203], v[20:23], a[76:79]
ds_read_b64_tr_b16 a[234:235], v230 offset:2048
v_accvgpr_read_b32 v120, a20
v_accvgpr_read_b32 v121, a21
v_mfma_f32_16x16x32_bf16 a[80:83], a[200:203], v[24:27], a[80:83]
ds_read_b64_tr_b16 a[236:237], v231 offset:0
v_accvgpr_read_b32 v122, a22
v_accvgpr_read_b32 v123, a23
v_mfma_f32_16x16x32_bf16 a[84:87], a[204:207], v[16:19], a[84:87]
buffer_load_dwordx4 v241, s[32:35], s45 offen offset:1024 lds
v_mfma_f32_16x16x32_bf16 a[88:91], a[204:207], v[20:23], a[88:91]
ds_read_b64_tr_b16 a[238:239], v231 offset:2048
v_cvt_pk_bf16_f32 v116, v116, v117
v_cvt_pk_bf16_f32 v117, v118, v119
v_mfma_f32_16x16x32_bf16 a[92:95], a[204:207], v[24:27], a[92:95]
ds_read_b64_tr_b16 a[240:241], v228 offset:4096
v_cvt_pk_bf16_f32 v118, v120, v121
v_cvt_pk_bf16_f32 v119, v122, v123
v_mfma_f32_16x16x32_bf16 a[48:51], a[208:211], v[40:43], a[48:51]
buffer_store_dwordx4 v[116:119], v253, s[40:43], s61 offen offset:2048 sc1
v_mfma_f32_16x16x32_bf16 a[52:55], a[208:211], v[44:47], a[52:55]
ds_read_b64_tr_b16 a[242:243], v228 offset:6144
ds_read_b64_tr_b16 a[244:245], v229 offset:4096
s_xor_b32 s61, s10, 1
s_mul_i32 s61, s61, 24576
v_mfma_f32_16x16x32_bf16 a[56:59], a[208:211], v[48:51], a[56:59]
ds_read_b64_tr_b16 a[246:247], v229 offset:6144
s_add_u32 s61, s61, s63
v_accvgpr_read_b32 v124, a24
v_mfma_f32_16x16x32_bf16 a[60:63], a[212:215], v[40:43], a[60:63]
ds_read_b64_tr_b16 a[248:249], v230 offset:4096
v_accvgpr_read_b32 v125, a25
v_accvgpr_read_b32 v126, a26
v_mfma_f32_16x16x32_bf16 a[64:67], a[212:215], v[44:47], a[64:67]
buffer_load_dwordx4 v242, s[32:35], s45 offen offset:2048 lds
v_mfma_f32_16x16x32_bf16 a[68:71], a[212:215], v[48:51], a[68:71]
ds_read_b64_tr_b16 a[250:251], v230 offset:6144
v_accvgpr_read_b32 v127, a27
v_accvgpr_read_b32 v128, a36
v_mfma_f32_16x16x32_bf16 a[72:75], a[216:219], v[40:43], a[72:75]
ds_read_b64_tr_b16 a[252:253], v231 offset:4096
v_accvgpr_read_b32 v129, a37
v_accvgpr_read_b32 v130, a38
v_mfma_f32_16x16x32_bf16 a[76:79], a[216:219], v[44:47], a[76:79]
ds_read_b64_tr_b16 a[254:255], v231 offset:6144
v_accvgpr_read_b32 v131, a39
v_mfma_f32_16x16x32_bf16 a[80:83], a[216:219], v[48:51], a[80:83]
v_cvt_pk_bf16_f32 v124, v124, v125
v_cvt_pk_bf16_f32 v125, v126, v127
v_mfma_f32_16x16x32_bf16 a[84:87], a[220:223], v[40:43], a[84:87]
v_cvt_pk_bf16_f32 v126, v128, v129
v_mfma_f32_16x16x32_bf16 a[88:91], a[220:223], v[44:47], a[88:91]
buffer_load_dwordx4 v243, s[32:35], s45 offen offset:3072 lds
v_mfma_f32_16x16x32_bf16 a[92:95], a[220:223], v[48:51], a[92:95]
s_waitcnt vmcnt(27) lgkmcnt(0)
s_barrier
v_mfma_f32_16x16x32_bf16 a[48:51], a[224:227], v[64:67], a[48:51]
ds_read_b64_tr_b16 a[192:193], v232 offset:32768
s_xor_b32 s45, s31, 384
s_add_u32 s45, s45, s67
v_mfma_f32_16x16x32_bf16 a[52:55], a[224:227], v[68:71], a[52:55]
ds_read_b64_tr_b16 a[194:195], v232 offset:34816
s_add_u32 m0, s47, 81920
v_mfma_f32_16x16x32_bf16 a[56:59], a[224:227], v[72:75], a[56:59]
ds_read_b64_tr_b16 a[196:197], v233 offset:32768
v_mfma_f32_16x16x32_bf16 a[60:63], a[228:231], v[64:67], a[60:63]
buffer_load_dwordx4 v240, s[32:35], s45 offen lds
v_mfma_f32_16x16x32_bf16 a[64:67], a[228:231], v[68:71], a[64:67]
ds_read_b64_tr_b16 a[198:199], v233 offset:34816
v_cvt_pk_bf16_f32 v127, v130, v131
v_mfma_f32_16x16x32_bf16 a[68:71], a[228:231], v[72:75], a[68:71]
buffer_store_dwordx4 v[124:127], v253, s[40:43], s61 offen sc1
v_mfma_f32_16x16x32_bf16 a[72:75], a[232:235], v[64:67], a[72:75]
ds_read_b64_tr_b16 a[200:201], v234 offset:32768
v_accvgpr_read_b32 v132, a28
v_accvgpr_read_b32 v133, a29
v_mfma_f32_16x16x32_bf16 a[76:79], a[232:235], v[68:71], a[76:79]
ds_read_b64_tr_b16 a[202:203], v234 offset:34816
v_accvgpr_read_b32 v134, a30
v_accvgpr_read_b32 v135, a31
v_mfma_f32_16x16x32_bf16 a[80:83], a[232:235], v[72:75], a[80:83]
ds_read_b64_tr_b16 a[204:205], v235 offset:32768
v_accvgpr_read_b32 v136, a40
v_accvgpr_read_b32 v137, a41
v_mfma_f32_16x16x32_bf16 a[84:87], a[236:239], v[64:67], a[84:87]
buffer_load_dwordx4 v241, s[32:35], s45 offen offset:1024 lds
v_mfma_f32_16x16x32_bf16 a[88:91], a[236:239], v[68:71], a[88:91]
ds_read_b64_tr_b16 a[206:207], v235 offset:34816
v_accvgpr_read_b32 v138, a42
v_accvgpr_read_b32 v139, a43
v_mfma_f32_16x16x32_bf16 a[92:95], a[236:239], v[72:75], a[92:95]
ds_read_b64_tr_b16 a[208:209], v232 offset:36864
v_cvt_pk_bf16_f32 v132, v132, v133
v_cvt_pk_bf16_f32 v133, v134, v135
v_mfma_f32_16x16x32_bf16 a[48:51], a[240:243], v[88:91], a[48:51]
ds_read_b64_tr_b16 a[210:211], v232 offset:38912
v_cvt_pk_bf16_f32 v134, v136, v137
v_cvt_pk_bf16_f32 v135, v138, v139
v_mfma_f32_16x16x32_bf16 a[52:55], a[240:243], v[92:95], a[52:55]
buffer_store_dwordx4 v[132:135], v253, s[40:43], s61 offen offset:1024 sc1
v_mfma_f32_16x16x32_bf16 a[56:59], a[240:243], v[96:99], a[56:59]
ds_read_b64_tr_b16 a[212:213], v233 offset:36864
ds_read_b64_tr_b16 a[214:215], v233 offset:38912
v_accvgpr_read_b32 v140, a32
v_accvgpr_read_b32 v141, a33
v_mfma_f32_16x16x32_bf16 a[60:63], a[244:247], v[88:91], a[60:63]
ds_read_b64_tr_b16 a[216:217], v234 offset:36864
v_accvgpr_read_b32 v142, a34
v_accvgpr_read_b32 v143, a35
v_mfma_f32_16x16x32_bf16 a[64:67], a[244:247], v[92:95], a[64:67]
buffer_load_dwordx4 v242, s[32:35], s45 offen offset:2048 lds
v_mfma_f32_16x16x32_bf16 a[68:71], a[244:247], v[96:99], a[68:71]
ds_read_b64_tr_b16 a[218:219], v234 offset:38912
v_accvgpr_read_b32 v144, a44
v_accvgpr_read_b32 v145, a45
v_mfma_f32_16x16x32_bf16 a[72:75], a[248:251], v[88:91], a[72:75]
ds_read_b64_tr_b16 a[220:221], v235 offset:36864
v_accvgpr_read_b32 v146, a46
v_accvgpr_read_b32 v147, a47
v_mfma_f32_16x16x32_bf16 a[76:79], a[248:251], v[92:95], a[76:79]
ds_read_b64_tr_b16 a[222:223], v235 offset:38912
v_cvt_pk_bf16_f32 v140, v140, v141
v_cvt_pk_bf16_f32 v141, v142, v143
v_mfma_f32_16x16x32_bf16 a[80:83], a[248:251], v[96:99], a[80:83]
v_cvt_pk_bf16_f32 v142, v144, v145
v_cvt_pk_bf16_f32 v143, v146, v147
v_mfma_f32_16x16x32_bf16 a[84:87], a[252:255], v[88:91], a[84:87]
buffer_store_dwordx4 v[140:143], v253, s[40:43], s61 offen offset:2048 sc1
v_mfma_f32_16x16x32_bf16 a[88:91], a[252:255], v[92:95], a[88:91]
buffer_load_dwordx4 v243, s[32:35], s45 offen offset:3072 lds
v_mfma_f32_16x16x32_bf16 a[92:95], a[252:255], v[96:99], a[92:95]
s_waitcnt vmcnt(30) lgkmcnt(0)
s_barrier
v_mfma_f32_16x16x32_bf16 a[96:99], a[192:195], v[4:7], a[96:99]
ds_read_b64_tr_b16 a[224:225], v228 offset:16384
v_mfma_f32_16x16x32_bf16 a[100:103], a[192:195], v[8:11], a[100:103]
ds_read_b64_tr_b16 a[226:227], v228 offset:18432
v_mfma_f32_16x16x32_bf16 a[104:107], a[192:195], v[12:15], a[104:107]
ds_read_b64_tr_b16 a[228:229], v229 offset:16384
v_mfma_f32_16x16x32_bf16 a[108:111], a[196:199], v[4:7], a[108:111]
ds_read_b64_tr_b16 a[230:231], v229 offset:18432
s_xor_b32 s61, s10, 2
v_mfma_f32_16x16x32_bf16 a[112:115], a[196:199], v[8:11], a[112:115]
ds_read_b64_tr_b16 a[232:233], v230 offset:16384
s_mul_i32 s61, s61, 24576
v_mfma_f32_16x16x32_bf16 a[116:119], a[196:199], v[12:15], a[116:119]
ds_read_b64_tr_b16 a[234:235], v230 offset:18432
s_add_u32 s61, s61, s63
v_mfma_f32_16x16x32_bf16 a[120:123], a[200:203], v[4:7], a[120:123]
ds_read_b64_tr_b16 a[236:237], v231 offset:16384
v_accvgpr_read_b32 v100, a48
v_mfma_f32_16x16x32_bf16 a[124:127], a[200:203], v[8:11], a[124:127]
ds_read_b64_tr_b16 a[238:239], v231 offset:18432
v_accvgpr_read_b32 v101, a49
v_mfma_f32_16x16x32_bf16 a[128:131], a[200:203], v[12:15], a[128:131]
ds_read_b64_tr_b16 a[240:241], v228 offset:20480
v_accvgpr_read_b32 v102, a50
v_mfma_f32_16x16x32_bf16 a[132:135], a[204:207], v[4:7], a[132:135]
ds_read_b64_tr_b16 a[242:243], v228 offset:22528
v_accvgpr_read_b32 v103, a51
v_mfma_f32_16x16x32_bf16 a[136:139], a[204:207], v[8:11], a[136:139]
ds_read_b64_tr_b16 a[244:245], v229 offset:20480
v_accvgpr_read_b32 v104, a60
v_mfma_f32_16x16x32_bf16 a[140:143], a[204:207], v[12:15], a[140:143]
ds_read_b64_tr_b16 a[246:247], v229 offset:22528
v_accvgpr_read_b32 v105, a61
v_mfma_f32_16x16x32_bf16 a[96:99], a[208:211], v[28:31], a[96:99]
ds_read_b64_tr_b16 a[248:249], v230 offset:20480
v_accvgpr_read_b32 v106, a62
v_mfma_f32_16x16x32_bf16 a[100:103], a[208:211], v[32:35], a[100:103]
ds_read_b64_tr_b16 a[250:251], v230 offset:22528
v_accvgpr_read_b32 v107, a63
v_mfma_f32_16x16x32_bf16 a[104:107], a[208:211], v[36:39], a[104:107]
ds_read_b64_tr_b16 a[252:253], v231 offset:20480
v_cvt_pk_bf16_f32 v100, v100, v101
v_mfma_f32_16x16x32_bf16 a[108:111], a[212:215], v[28:31], a[108:111]
ds_read_b64_tr_b16 a[254:255], v231 offset:22528
v_cvt_pk_bf16_f32 v101, v102, v103
v_mfma_f32_16x16x32_bf16 a[112:115], a[212:215], v[32:35], a[112:115]
v_cvt_pk_bf16_f32 v102, v104, v105
v_cvt_pk_bf16_f32 v103, v106, v107
v_mfma_f32_16x16x32_bf16 a[116:119], a[212:215], v[36:39], a[116:119]
buffer_store_dwordx4 v[100:103], v253, s[40:43], s61 offen sc1
v_mfma_f32_16x16x32_bf16 a[120:123], a[216:219], v[28:31], a[120:123]
v_accvgpr_read_b32 v108, a52
v_accvgpr_read_b32 v109, a53
v_mfma_f32_16x16x32_bf16 a[124:127], a[216:219], v[32:35], a[124:127]
v_accvgpr_read_b32 v110, a54
v_accvgpr_read_b32 v111, a55
v_mfma_f32_16x16x32_bf16 a[128:131], a[216:219], v[36:39], a[128:131]
v_accvgpr_read_b32 v112, a64
v_mfma_f32_16x16x32_bf16 a[132:135], a[220:223], v[28:31], a[132:135]
v_mfma_f32_16x16x32_bf16 a[136:139], a[220:223], v[32:35], a[136:139]
v_mfma_f32_16x16x32_bf16 a[140:143], a[220:223], v[36:39], a[140:143]
s_waitcnt vmcnt(27) lgkmcnt(0)
s_barrier
v_mfma_f32_16x16x32_bf16 a[96:99], a[224:227], v[52:55], a[96:99]
ds_read_b64_tr_b16 a[192:193], v232 offset:49152
v_mfma_f32_16x16x32_bf16 a[100:103], a[224:227], v[56:59], a[100:103]
ds_read_b64_tr_b16 a[194:195], v232 offset:51200
v_mfma_f32_16x16x32_bf16 a[104:107], a[224:227], v[60:63], a[104:107]
ds_read_b64_tr_b16 a[196:197], v233 offset:49152
v_mfma_f32_16x16x32_bf16 a[108:111], a[228:231], v[52:55], a[108:111]
ds_read_b64_tr_b16 a[198:199], v233 offset:51200
v_accvgpr_read_b32 v113, a65
v_mfma_f32_16x16x32_bf16 a[112:115], a[228:231], v[56:59], a[112:115]
ds_read_b64_tr_b16 a[200:201], v234 offset:49152
v_accvgpr_read_b32 v114, a66
v_mfma_f32_16x16x32_bf16 a[116:119], a[228:231], v[60:63], a[116:119]
ds_read_b64_tr_b16 a[202:203], v234 offset:51200
v_accvgpr_read_b32 v115, a67
v_mfma_f32_16x16x32_bf16 a[120:123], a[232:235], v[52:55], a[120:123]
ds_read_b64_tr_b16 a[204:205], v235 offset:49152
v_cvt_pk_bf16_f32 v108, v108, v109
v_mfma_f32_16x16x32_bf16 a[124:127], a[232:235], v[56:59], a[124:127]
ds_read_b64_tr_b16 a[206:207], v235 offset:51200
v_cvt_pk_bf16_f32 v109, v110, v111
v_mfma_f32_16x16x32_bf16 a[128:131], a[232:235], v[60:63], a[128:131]
ds_read_b64_tr_b16 a[208:209], v232 offset:53248
v_cvt_pk_bf16_f32 v110, v112, v113
v_mfma_f32_16x16x32_bf16 a[132:135], a[236:239], v[52:55], a[132:135]
ds_read_b64_tr_b16 a[210:211], v232 offset:55296
v_cvt_pk_bf16_f32 v111, v114, v115
v_mfma_f32_16x16x32_bf16 a[136:139], a[236:239], v[56:59], a[136:139]
buffer_store_dwordx4 v[108:111], v253, s[40:43], s61 offen offset:1024 sc1
v_mfma_f32_16x16x32_bf16 a[140:143], a[236:239], v[60:63], a[140:143]
ds_read_b64_tr_b16 a[212:213], v233 offset:53248
v_accvgpr_read_b32 v116, a56
v_mfma_f32_16x16x32_bf16 a[96:99], a[240:243], v[76:79], a[96:99]
ds_read_b64_tr_b16 a[214:215], v233 offset:55296
v_accvgpr_read_b32 v117, a57
v_mfma_f32_16x16x32_bf16 a[100:103], a[240:243], v[80:83], a[100:103]
ds_read_b64_tr_b16 a[216:217], v234 offset:53248
v_accvgpr_read_b32 v118, a58
v_mfma_f32_16x16x32_bf16 a[104:107], a[240:243], v[84:87], a[104:107]
ds_read_b64_tr_b16 a[218:219], v234 offset:55296
v_accvgpr_read_b32 v119, a59
v_mfma_f32_16x16x32_bf16 a[108:111], a[244:247], v[76:79], a[108:111]
ds_read_b64_tr_b16 a[220:221], v235 offset:53248
v_accvgpr_read_b32 v120, a68
v_mfma_f32_16x16x32_bf16 a[112:115], a[244:247], v[80:83], a[112:115]
ds_read_b64_tr_b16 a[222:223], v235 offset:55296
v_accvgpr_read_b32 v121, a69
v_mfma_f32_16x16x32_bf16 a[116:119], a[244:247], v[84:87], a[116:119]
v_accvgpr_read_b32 v122, a70
v_accvgpr_read_b32 v123, a71
v_mfma_f32_16x16x32_bf16 a[120:123], a[248:251], v[76:79], a[120:123]
v_cvt_pk_bf16_f32 v116, v116, v117
v_cvt_pk_bf16_f32 v117, v118, v119
v_mfma_f32_16x16x32_bf16 a[124:127], a[248:251], v[80:83], a[124:127]
v_cvt_pk_bf16_f32 v118, v120, v121
v_cvt_pk_bf16_f32 v119, v122, v123
v_mfma_f32_16x16x32_bf16 a[128:131], a[248:251], v[84:87], a[128:131]
buffer_store_dwordx4 v[116:119], v253, s[40:43], s61 offen offset:2048 sc1
v_mfma_f32_16x16x32_bf16 a[132:135], a[252:255], v[76:79], a[132:135]
v_mfma_f32_16x16x32_bf16 a[136:139], a[252:255], v[80:83], a[136:139]
v_mfma_f32_16x16x32_bf16 a[140:143], a[252:255], v[84:87], a[140:143]
s_waitcnt vmcnt(25) lgkmcnt(0)
s_barrier
v_mfma_f32_16x16x32_bf16 a[96:99], a[192:195], v[16:19], a[96:99]
ds_read_b64_tr_b16 a[224:225], v224 offset:49152
v_mfma_f32_16x16x32_bf16 a[100:103], a[192:195], v[20:23], a[100:103]
ds_read_b64_tr_b16 a[226:227], v224 offset:51200
v_mfma_f32_16x16x32_bf16 a[104:107], a[192:195], v[24:27], a[104:107]
ds_read_b64_tr_b16 a[228:229], v225 offset:49152
v_mfma_f32_16x16x32_bf16 a[108:111], a[196:199], v[16:19], a[108:111]
ds_read_b64_tr_b16 a[230:231], v225 offset:51200
s_xor_b32 s61, s10, 3
v_mfma_f32_16x16x32_bf16 a[112:115], a[196:199], v[20:23], a[112:115]
ds_read_b64_tr_b16 a[232:233], v226 offset:49152
s_mul_i32 s61, s61, 24576
v_mfma_f32_16x16x32_bf16 a[116:119], a[196:199], v[24:27], a[116:119]
ds_read_b64_tr_b16 a[234:235], v226 offset:51200
s_add_u32 s61, s61, s63
v_mfma_f32_16x16x32_bf16 a[120:123], a[200:203], v[16:19], a[120:123]
ds_read_b64_tr_b16 a[236:237], v227 offset:49152
v_accvgpr_read_b32 v124, a72
v_mfma_f32_16x16x32_bf16 a[124:127], a[200:203], v[20:23], a[124:127]
ds_read_b64_tr_b16 a[238:239], v227 offset:51200
v_accvgpr_read_b32 v125, a73
v_mfma_f32_16x16x32_bf16 a[128:131], a[200:203], v[24:27], a[128:131]
ds_read_b64_tr_b16 a[240:241], v224 offset:53248
v_accvgpr_read_b32 v126, a74
v_mfma_f32_16x16x32_bf16 a[132:135], a[204:207], v[16:19], a[132:135]
ds_read_b64_tr_b16 a[242:243], v224 offset:55296
v_accvgpr_read_b32 v127, a75
v_mfma_f32_16x16x32_bf16 a[136:139], a[204:207], v[20:23], a[136:139]
ds_read_b64_tr_b16 a[244:245], v225 offset:53248
v_accvgpr_read_b32 v128, a84
v_mfma_f32_16x16x32_bf16 a[140:143], a[204:207], v[24:27], a[140:143]
ds_read_b64_tr_b16 a[246:247], v225 offset:55296
v_accvgpr_read_b32 v129, a85
v_mfma_f32_16x16x32_bf16 a[96:99], a[208:211], v[40:43], a[96:99]
ds_read_b64_tr_b16 a[248:249], v226 offset:53248
v_accvgpr_read_b32 v130, a86
v_mfma_f32_16x16x32_bf16 a[100:103], a[208:211], v[44:47], a[100:103]
ds_read_b64_tr_b16 a[250:251], v226 offset:55296
v_accvgpr_read_b32 v131, a87
v_mfma_f32_16x16x32_bf16 a[104:107], a[208:211], v[48:51], a[104:107]
ds_read_b64_tr_b16 a[252:253], v227 offset:53248
v_cvt_pk_bf16_f32 v124, v124, v125
v_mfma_f32_16x16x32_bf16 a[108:111], a[212:215], v[40:43], a[108:111]
ds_read_b64_tr_b16 a[254:255], v227 offset:55296
v_cvt_pk_bf16_f32 v125, v126, v127
v_mfma_f32_16x16x32_bf16 a[112:115], a[212:215], v[44:47], a[112:115]
v_cvt_pk_bf16_f32 v126, v128, v129
v_cvt_pk_bf16_f32 v127, v130, v131
v_mfma_f32_16x16x32_bf16 a[116:119], a[212:215], v[48:51], a[116:119]
buffer_store_dwordx4 v[124:127], v253, s[40:43], s61 offen sc1
v_mfma_f32_16x16x32_bf16 a[120:123], a[216:219], v[40:43], a[120:123]
v_accvgpr_read_b32 v132, a76
v_accvgpr_read_b32 v133, a77
v_mfma_f32_16x16x32_bf16 a[124:127], a[216:219], v[44:47], a[124:127]
v_accvgpr_read_b32 v134, a78
v_accvgpr_read_b32 v135, a79
v_mfma_f32_16x16x32_bf16 a[128:131], a[216:219], v[48:51], a[128:131]
v_accvgpr_read_b32 v136, a88
v_mfma_f32_16x16x32_bf16 a[132:135], a[220:223], v[40:43], a[132:135]
v_mfma_f32_16x16x32_bf16 a[136:139], a[220:223], v[44:47], a[136:139]
v_mfma_f32_16x16x32_bf16 a[140:143], a[220:223], v[48:51], a[140:143]
s_waitcnt vmcnt(17) lgkmcnt(0)
s_barrier
v_mfma_f32_16x16x32_bf16 a[96:99], a[224:227], v[64:67], a[96:99]
ds_read_b64_tr_b16 a[192:193], v224 offset:0
v_mfma_f32_16x16x32_bf16 a[100:103], a[224:227], v[68:71], a[100:103]
ds_read_b64_tr_b16 a[194:195], v224 offset:2048
v_mfma_f32_16x16x32_bf16 a[104:107], a[224:227], v[72:75], a[104:107]
ds_read_b64_tr_b16 a[196:197], v225 offset:0
v_mfma_f32_16x16x32_bf16 a[108:111], a[228:231], v[64:67], a[108:111]
ds_read_b64_tr_b16 a[198:199], v225 offset:2048
v_accvgpr_read_b32 v137, a89
v_mfma_f32_16x16x32_bf16 a[112:115], a[228:231], v[68:71], a[112:115]
ds_read_b64_tr_b16 a[200:201], v224 offset:4096
v_accvgpr_read_b32 v138, a90
v_mfma_f32_16x16x32_bf16 a[116:119], a[228:231], v[72:75], a[116:119]
ds_read_b64_tr_b16 a[202:203], v224 offset:6144
v_accvgpr_read_b32 v139, a91
v_mfma_f32_16x16x32_bf16 a[120:123], a[232:235], v[64:67], a[120:123]
ds_read_b64_tr_b16 a[204:205], v225 offset:4096
v_cvt_pk_bf16_f32 v132, v132, v133
v_mfma_f32_16x16x32_bf16 a[124:127], a[232:235], v[68:71], a[124:127]
ds_read_b64_tr_b16 a[206:207], v225 offset:6144
v_cvt_pk_bf16_f32 v133, v134, v135
v_mfma_f32_16x16x32_bf16 a[128:131], a[232:235], v[72:75], a[128:131]
ds_read_b64_tr_b16 a[208:209], v232 offset:0
v_cvt_pk_bf16_f32 v134, v136, v137
v_mfma_f32_16x16x32_bf16 a[132:135], a[236:239], v[64:67], a[132:135]
ds_read_b64_tr_b16 a[210:211], v232 offset:2048
v_cvt_pk_bf16_f32 v135, v138, v139
v_mfma_f32_16x16x32_bf16 a[136:139], a[236:239], v[68:71], a[136:139]
buffer_store_dwordx4 v[132:135], v253, s[40:43], s61 offen offset:1024 sc1
v_mfma_f32_16x16x32_bf16 a[140:143], a[236:239], v[72:75], a[140:143]
ds_read_b64_tr_b16 a[212:213], v233 offset:0
v_accvgpr_read_b32 v140, a80
v_mfma_f32_16x16x32_bf16 a[96:99], a[240:243], v[88:91], a[96:99]
ds_read_b64_tr_b16 a[214:215], v233 offset:2048
v_accvgpr_read_b32 v141, a81
v_mfma_f32_16x16x32_bf16 a[100:103], a[240:243], v[92:95], a[100:103]
ds_read_b64_tr_b16 a[216:217], v232 offset:4096
v_accvgpr_read_b32 v142, a82
v_mfma_f32_16x16x32_bf16 a[104:107], a[240:243], v[96:99], a[104:107]
ds_read_b64_tr_b16 a[218:219], v232 offset:6144
v_accvgpr_read_b32 v143, a83
v_mfma_f32_16x16x32_bf16 a[108:111], a[244:247], v[88:91], a[108:111]
ds_read_b64_tr_b16 a[220:221], v233 offset:4096
v_accvgpr_read_b32 v144, a92
v_mfma_f32_16x16x32_bf16 a[112:115], a[244:247], v[92:95], a[112:115]
ds_read_b64_tr_b16 a[222:223], v233 offset:6144
v_accvgpr_read_b32 v145, a93
v_mfma_f32_16x16x32_bf16 a[116:119], a[244:247], v[96:99], a[116:119]
v_accvgpr_read_b32 v146, a94
v_accvgpr_read_b32 v147, a95
v_mfma_f32_16x16x32_bf16 a[120:123], a[248:251], v[88:91], a[120:123]
v_cvt_pk_bf16_f32 v140, v140, v141
v_cvt_pk_bf16_f32 v141, v142, v143
v_mfma_f32_16x16x32_bf16 a[124:127], a[248:251], v[92:95], a[124:127]
v_cvt_pk_bf16_f32 v142, v144, v145
v_cvt_pk_bf16_f32 v143, v146, v147
v_mfma_f32_16x16x32_bf16 a[128:131], a[248:251], v[96:99], a[128:131]
buffer_store_dwordx4 v[140:143], v253, s[40:43], s61 offen offset:2048 sc1
v_mfma_f32_16x16x32_bf16 a[132:135], a[252:255], v[88:91], a[132:135]
v_mfma_f32_16x16x32_bf16 a[136:139], a[252:255], v[92:95], a[136:139]
v_mfma_f32_16x16x32_bf16 a[140:143], a[252:255], v[96:99], a[140:143]
s_waitcnt vmcnt(6) lgkmcnt(0)
s_barrier
v_mfma_f32_16x16x32_bf16 a[144:147], a[192:195], v[4:7], a[144:147]
ds_read_b64_tr_b16 a[224:225], v232 offset:16384
v_mfma_f32_16x16x32_bf16 a[148:151], a[192:195], v[8:11], a[148:151]
ds_read_b64_tr_b16 a[226:227], v232 offset:18432
v_mfma_f32_16x16x32_bf16 a[152:155], a[192:195], v[12:15], a[152:155]
ds_read_b64_tr_b16 a[228:229], v233 offset:16384
v_mfma_f32_16x16x32_bf16 a[156:159], a[196:199], v[4:7], a[156:159]
ds_read_b64_tr_b16 a[230:231], v233 offset:18432
s_xor_b32 s61, s10, 4
s_mul_i32 s61, s61, 24576
v_mfma_f32_16x16x32_bf16 a[160:163], a[196:199], v[8:11], a[160:163]
ds_read_b64_tr_b16 a[232:233], v232 offset:20480
s_add_u32 s61, s61, s63
v_accvgpr_read_b32 v100, a96
v_mfma_f32_16x16x32_bf16 a[164:167], a[196:199], v[12:15], a[164:167]
ds_read_b64_tr_b16 a[234:235], v232 offset:22528
v_accvgpr_read_b32 v101, a97
v_accvgpr_read_b32 v102, a98
v_mfma_f32_16x16x32_bf16 a[144:147], a[200:203], v[28:31], a[144:147]
ds_read_b64_tr_b16 a[236:237], v233 offset:20480
v_accvgpr_read_b32 v103, a99
v_accvgpr_read_b32 v104, a108
v_mfma_f32_16x16x32_bf16 a[148:151], a[200:203], v[32:35], a[148:151]
ds_read_b64_tr_b16 a[238:239], v233 offset:22528
v_accvgpr_read_b32 v105, a109
v_accvgpr_read_b32 v106, a110
v_mfma_f32_16x16x32_bf16 a[152:155], a[200:203], v[36:39], a[152:155]
ds_read_b64_tr_b16 a[240:241], v224 offset:16384
v_accvgpr_read_b32 v107, a111
v_cvt_pk_bf16_f32 v100, v100, v101
v_mfma_f32_16x16x32_bf16 a[156:159], a[204:207], v[28:31], a[156:159]
ds_read_b64_tr_b16 a[242:243], v224 offset:18432
v_cvt_pk_bf16_f32 v101, v102, v103
v_cvt_pk_bf16_f32 v102, v104, v105
v_mfma_f32_16x16x32_bf16 a[160:163], a[204:207], v[32:35], a[160:163]
ds_read_b64_tr_b16 a[244:245], v225 offset:16384
v_cvt_pk_bf16_f32 v103, v106, v107
v_mfma_f32_16x16x32_bf16 a[164:167], a[204:207], v[36:39], a[164:167]
buffer_store_dwordx4 v[100:103], v253, s[40:43], s61 offen sc1
v_mfma_f32_16x16x32_bf16 a[144:147], a[208:211], v[52:55], a[144:147]
ds_read_b64_tr_b16 a[246:247], v225 offset:18432
v_accvgpr_read_b32 v108, a100
v_accvgpr_read_b32 v109, a101
v_accvgpr_read_b32 v110, a102
v_mfma_f32_16x16x32_bf16 a[148:151], a[208:211], v[56:59], a[148:151]
ds_read_b64_tr_b16 a[248:249], v224 offset:20480
v_accvgpr_read_b32 v111, a103
v_accvgpr_read_b32 v112, a112
v_accvgpr_read_b32 v113, a113
v_mfma_f32_16x16x32_bf16 a[152:155], a[208:211], v[60:63], a[152:155]
ds_read_b64_tr_b16 a[250:251], v224 offset:22528
v_accvgpr_read_b32 v114, a114
v_accvgpr_read_b32 v115, a115
v_mfma_f32_16x16x32_bf16 a[156:159], a[212:215], v[52:55], a[156:159]
ds_read_b64_tr_b16 a[252:253], v225 offset:20480
v_cvt_pk_bf16_f32 v108, v108, v109
v_cvt_pk_bf16_f32 v109, v110, v111
v_mfma_f32_16x16x32_bf16 a[160:163], a[212:215], v[56:59], a[160:163]
ds_read_b64_tr_b16 a[254:255], v225 offset:22528
v_cvt_pk_bf16_f32 v110, v112, v113
v_cvt_pk_bf16_f32 v111, v114, v115
v_mfma_f32_16x16x32_bf16 a[164:167], a[212:215], v[60:63], a[164:167]
buffer_store_dwordx4 v[108:111], v253, s[40:43], s61 offen offset:1024 sc1
v_mfma_f32_16x16x32_bf16 a[144:147], a[216:219], v[76:79], a[144:147]
v_accvgpr_read_b32 v116, a104
v_accvgpr_read_b32 v117, a105
v_accvgpr_read_b32 v118, a106
v_mfma_f32_16x16x32_bf16 a[148:151], a[216:219], v[80:83], a[148:151]
v_accvgpr_read_b32 v119, a107
v_accvgpr_read_b32 v120, a116
v_mfma_f32_16x16x32_bf16 a[152:155], a[216:219], v[84:87], a[152:155]
v_accvgpr_read_b32 v121, a117
v_accvgpr_read_b32 v122, a118
v_mfma_f32_16x16x32_bf16 a[156:159], a[220:223], v[76:79], a[156:159]
v_accvgpr_read_b32 v123, a119
v_cvt_pk_bf16_f32 v116, v116, v117
v_mfma_f32_16x16x32_bf16 a[160:163], a[220:223], v[80:83], a[160:163]
v_cvt_pk_bf16_f32 v117, v118, v119
v_cvt_pk_bf16_f32 v118, v120, v121
v_mfma_f32_16x16x32_bf16 a[164:167], a[220:223], v[84:87], a[164:167]
v_cvt_pk_bf16_f32 v119, v122, v123
buffer_store_dwordx4 v[116:119], v253, s[40:43], s61 offen offset:2048 sc1
s_waitcnt lgkmcnt(0)
v_mfma_f32_16x16x32_bf16 a[144:147], a[224:227], v[16:19], a[144:147]
ds_read_b64_tr_b16 a[192:193], v226 offset:0
v_mfma_f32_16x16x32_bf16 a[148:151], a[224:227], v[20:23], a[148:151]
ds_read_b64_tr_b16 a[194:195], v226 offset:2048
v_mfma_f32_16x16x32_bf16 a[152:155], a[224:227], v[24:27], a[152:155]
ds_read_b64_tr_b16 a[196:197], v227 offset:0
v_mfma_f32_16x16x32_bf16 a[156:159], a[228:231], v[16:19], a[156:159]
ds_read_b64_tr_b16 a[198:199], v227 offset:2048
s_xor_b32 s61, s10, 5
s_mul_i32 s61, s61, 24576
v_mfma_f32_16x16x32_bf16 a[160:163], a[228:231], v[20:23], a[160:163]
ds_read_b64_tr_b16 a[200:201], v226 offset:4096
s_add_u32 s61, s61, s63
v_accvgpr_read_b32 v124, a120
v_mfma_f32_16x16x32_bf16 a[164:167], a[228:231], v[24:27], a[164:167]
ds_read_b64_tr_b16 a[202:203], v226 offset:6144
v_accvgpr_read_b32 v125, a121
v_accvgpr_read_b32 v126, a122
v_mfma_f32_16x16x32_bf16 a[144:147], a[232:235], v[40:43], a[144:147]
ds_read_b64_tr_b16 a[204:205], v227 offset:4096
v_accvgpr_read_b32 v127, a123
v_accvgpr_read_b32 v128, a132
v_mfma_f32_16x16x32_bf16 a[148:151], a[232:235], v[44:47], a[148:151]
ds_read_b64_tr_b16 a[206:207], v227 offset:6144
v_accvgpr_read_b32 v129, a133
v_accvgpr_read_b32 v130, a134
v_mfma_f32_16x16x32_bf16 a[152:155], a[232:235], v[48:51], a[152:155]
ds_read_b64_tr_b16 a[208:209], v234 offset:0
v_accvgpr_read_b32 v131, a135
v_cvt_pk_bf16_f32 v124, v124, v125
v_mfma_f32_16x16x32_bf16 a[156:159], a[236:239], v[40:43], a[156:159]
ds_read_b64_tr_b16 a[210:211], v234 offset:2048
v_cvt_pk_bf16_f32 v125, v126, v127
v_cvt_pk_bf16_f32 v126, v128, v129
v_mfma_f32_16x16x32_bf16 a[160:163], a[236:239], v[44:47], a[160:163]
ds_read_b64_tr_b16 a[212:213], v235 offset:0
v_cvt_pk_bf16_f32 v127, v130, v131
v_mfma_f32_16x16x32_bf16 a[164:167], a[236:239], v[48:51], a[164:167]
buffer_store_dwordx4 v[124:127], v253, s[40:43], s61 offen sc1
v_mfma_f32_16x16x32_bf16 a[144:147], a[240:243], v[64:67], a[144:147]
ds_read_b64_tr_b16 a[214:215], v235 offset:2048
v_accvgpr_read_b32 v132, a124
v_accvgpr_read_b32 v133, a125
v_accvgpr_read_b32 v134, a126
v_mfma_f32_16x16x32_bf16 a[148:151], a[240:243], v[68:71], a[148:151]
ds_read_b64_tr_b16 a[216:217], v234 offset:4096
v_accvgpr_read_b32 v135, a127
v_accvgpr_read_b32 v136, a136
v_accvgpr_read_b32 v137, a137
v_mfma_f32_16x16x32_bf16 a[152:155], a[240:243], v[72:75], a[152:155]
ds_read_b64_tr_b16 a[218:219], v234 offset:6144
v_accvgpr_read_b32 v138, a138
v_accvgpr_read_b32 v139, a139
v_mfma_f32_16x16x32_bf16 a[156:159], a[244:247], v[64:67], a[156:159]
ds_read_b64_tr_b16 a[220:221], v235 offset:4096
v_cvt_pk_bf16_f32 v132, v132, v133
v_cvt_pk_bf16_f32 v133, v134, v135
v_mfma_f32_16x16x32_bf16 a[160:163], a[244:247], v[68:71], a[160:163]
ds_read_b64_tr_b16 a[222:223], v235 offset:6144
v_cvt_pk_bf16_f32 v134, v136, v137
v_cvt_pk_bf16_f32 v135, v138, v139
v_mfma_f32_16x16x32_bf16 a[164:167], a[244:247], v[72:75], a[164:167]
buffer_store_dwordx4 v[132:135], v253, s[40:43], s61 offen offset:1024 sc1
v_mfma_f32_16x16x32_bf16 a[144:147], a[248:251], v[88:91], a[144:147]
v_accvgpr_read_b32 v140, a128
v_accvgpr_read_b32 v141, a129
v_accvgpr_read_b32 v142, a130
v_mfma_f32_16x16x32_bf16 a[148:151], a[248:251], v[92:95], a[148:151]
v_accvgpr_read_b32 v143, a131
v_accvgpr_read_b32 v144, a140
v_mfma_f32_16x16x32_bf16 a[152:155], a[248:251], v[96:99], a[152:155]
v_accvgpr_read_b32 v145, a141
v_accvgpr_read_b32 v146, a142
v_mfma_f32_16x16x32_bf16 a[156:159], a[252:255], v[88:91], a[156:159]
v_accvgpr_read_b32 v147, a143
v_cvt_pk_bf16_f32 v140, v140, v141
v_mfma_f32_16x16x32_bf16 a[160:163], a[252:255], v[92:95], a[160:163]
v_cvt_pk_bf16_f32 v141, v142, v143
v_cvt_pk_bf16_f32 v142, v144, v145
v_mfma_f32_16x16x32_bf16 a[164:167], a[252:255], v[96:99], a[164:167]
v_cvt_pk_bf16_f32 v143, v146, v147
buffer_store_dwordx4 v[140:143], v253, s[40:43], s61 offen offset:2048 sc1
s_waitcnt lgkmcnt(0)
s_add_u32 s24, s24, 8
s_add_u32 s55, s24, 1
v_mov_b32 v154, s55
s_waitcnt vmcnt(6)
s_mov_b64 exec, 1
buffer_store_dword v154, v155, s[40:43], s22 offen sc1
s_mov_b64 exec, -1
s_nop 3
v_mfma_f32_16x16x32_bf16 a[168:171], a[192:195], v[4:7], a[168:171]
ds_read_b64_tr_b16 a[224:225], v234 offset:16384
v_mfma_f32_16x16x32_bf16 a[172:175], a[192:195], v[8:11], a[172:175]
ds_read_b64_tr_b16 a[226:227], v234 offset:18432
v_mfma_f32_16x16x32_bf16 a[176:179], a[192:195], v[12:15], a[176:179]
ds_read_b64_tr_b16 a[228:229], v235 offset:16384
v_mfma_f32_16x16x32_bf16 a[180:183], a[196:199], v[4:7], a[180:183]
ds_read_b64_tr_b16 a[230:231], v235 offset:18432
s_xor_b32 s61, s10, 6
s_mul_i32 s61, s61, 24576
s_add_u32 s61, s61, s63
v_accvgpr_read_b32 v100, a144
v_mfma_f32_16x16x32_bf16 a[184:187], a[196:199], v[8:11], a[184:187]
ds_read_b64_tr_b16 a[232:233], v234 offset:20480
v_accvgpr_read_b32 v101, a145
v_accvgpr_read_b32 v102, a146
v_accvgpr_read_b32 v103, a147
v_accvgpr_read_b32 v104, a156
v_mfma_f32_16x16x32_bf16 a[188:191], a[196:199], v[12:15], a[188:191]
ds_read_b64_tr_b16 a[234:235], v234 offset:22528
v_accvgpr_read_b32 v105, a157
v_accvgpr_read_b32 v106, a158
v_accvgpr_read_b32 v107, a159
v_cvt_pk_bf16_f32 v100, v100, v101
v_mfma_f32_16x16x32_bf16 a[168:171], a[200:203], v[28:31], a[168:171]
ds_read_b64_tr_b16 a[236:237], v235 offset:20480
v_cvt_pk_bf16_f32 v101, v102, v103
v_cvt_pk_bf16_f32 v102, v104, v105
v_cvt_pk_bf16_f32 v103, v106, v107
v_mfma_f32_16x16x32_bf16 a[172:175], a[200:203], v[32:35], a[172:175]
buffer_store_dwordx4 v[100:103], v253, s[40:43], s61 offen sc1
v_mfma_f32_16x16x32_bf16 a[176:179], a[200:203], v[36:39], a[176:179]
ds_read_b64_tr_b16 a[238:239], v235 offset:22528
v_accvgpr_read_b32 v108, a148
v_accvgpr_read_b32 v109, a149
v_accvgpr_read_b32 v110, a150
v_accvgpr_read_b32 v111, a151
v_mfma_f32_16x16x32_bf16 a[180:183], a[204:207], v[28:31], a[180:183]
ds_read_b64_tr_b16 a[240:241], v226 offset:16384
v_accvgpr_read_b32 v112, a160
v_accvgpr_read_b32 v113, a161
v_accvgpr_read_b32 v114, a162
v_accvgpr_read_b32 v115, a163
v_mfma_f32_16x16x32_bf16 a[184:187], a[204:207], v[32:35], a[184:187]
ds_read_b64_tr_b16 a[242:243], v226 offset:18432
v_cvt_pk_bf16_f32 v108, v108, v109
v_cvt_pk_bf16_f32 v109, v110, v111
v_cvt_pk_bf16_f32 v110, v112, v113
v_mfma_f32_16x16x32_bf16 a[188:191], a[204:207], v[36:39], a[188:191]
ds_read_b64_tr_b16 a[244:245], v227 offset:16384
v_cvt_pk_bf16_f32 v111, v114, v115
v_mfma_f32_16x16x32_bf16 a[168:171], a[208:211], v[52:55], a[168:171]
buffer_store_dwordx4 v[108:111], v253, s[40:43], s61 offen offset:1024 sc1
v_mfma_f32_16x16x32_bf16 a[172:175], a[208:211], v[56:59], a[172:175]
ds_read_b64_tr_b16 a[246:247], v227 offset:18432
v_accvgpr_read_b32 v116, a152
v_accvgpr_read_b32 v117, a153
v_accvgpr_read_b32 v118, a154
v_accvgpr_read_b32 v119, a155
v_accvgpr_read_b32 v120, a164
v_mfma_f32_16x16x32_bf16 a[176:179], a[208:211], v[60:63], a[176:179]
ds_read_b64_tr_b16 a[248:249], v226 offset:20480
v_accvgpr_read_b32 v121, a165
v_accvgpr_read_b32 v122, a166
v_accvgpr_read_b32 v123, a167
v_cvt_pk_bf16_f32 v116, v116, v117
v_mfma_f32_16x16x32_bf16 a[180:183], a[212:215], v[52:55], a[180:183]
ds_read_b64_tr_b16 a[250:251], v226 offset:22528
v_cvt_pk_bf16_f32 v117, v118, v119
v_cvt_pk_bf16_f32 v118, v120, v121
v_cvt_pk_bf16_f32 v119, v122, v123
v_mfma_f32_16x16x32_bf16 a[184:187], a[212:215], v[56:59], a[184:187]
buffer_store_dwordx4 v[116:119], v253, s[40:43], s61 offen offset:2048 sc1
v_mfma_f32_16x16x32_bf16 a[188:191], a[212:215], v[60:63], a[188:191]
ds_read_b64_tr_b16 a[252:253], v227 offset:20480
v_mfma_f32_16x16x32_bf16 a[168:171], a[216:219], v[76:79], a[168:171]
ds_read_b64_tr_b16 a[254:255], v227 offset:22528
v_mfma_f32_16x16x32_bf16 a[172:175], a[216:219], v[80:83], a[172:175]
v_mfma_f32_16x16x32_bf16 a[176:179], a[216:219], v[84:87], a[176:179]
v_mfma_f32_16x16x32_bf16 a[180:183], a[220:223], v[76:79], a[180:183]
v_mfma_f32_16x16x32_bf16 a[184:187], a[220:223], v[80:83], a[184:187]
v_mfma_f32_16x16x32_bf16 a[188:191], a[220:223], v[84:87], a[188:191]
s_waitcnt lgkmcnt(0)
v_mfma_f32_16x16x32_bf16 a[168:171], a[224:227], v[16:19], a[168:171]
v_mfma_f32_16x16x32_bf16 a[172:175], a[224:227], v[20:23], a[172:175]
v_mfma_f32_16x16x32_bf16 a[176:179], a[224:227], v[24:27], a[176:179]
v_mfma_f32_16x16x32_bf16 a[180:183], a[228:231], v[16:19], a[180:183]
buffer_load_dword v153, v152, s[40:43], s23 offen sc1
v_mfma_f32_16x16x32_bf16 a[184:187], a[228:231], v[20:23], a[184:187]
v_mfma_f32_16x16x32_bf16 a[188:191], a[228:231], v[24:27], a[188:191]
v_mfma_f32_16x16x32_bf16 a[168:171], a[232:235], v[40:43], a[168:171]
v_mfma_f32_16x16x32_bf16 a[172:175], a[232:235], v[44:47], a[172:175]
v_mfma_f32_16x16x32_bf16 a[176:179], a[232:235], v[48:51], a[176:179]
v_mfma_f32_16x16x32_bf16 a[180:183], a[236:239], v[40:43], a[180:183]
v_mfma_f32_16x16x32_bf16 a[184:187], a[236:239], v[44:47], a[184:187]
v_mfma_f32_16x16x32_bf16 a[188:191], a[236:239], v[48:51], a[188:191]
v_mfma_f32_16x16x32_bf16 a[168:171], a[240:243], v[64:67], a[168:171]
v_mfma_f32_16x16x32_bf16 a[172:175], a[240:243], v[68:71], a[172:175]
v_mfma_f32_16x16x32_bf16 a[176:179], a[240:243], v[72:75], a[176:179]
v_mfma_f32_16x16x32_bf16 a[180:183], a[244:247], v[64:67], a[180:183]
v_mfma_f32_16x16x32_bf16 a[184:187], a[244:247], v[68:71], a[184:187]
v_mfma_f32_16x16x32_bf16 a[188:191], a[244:247], v[72:75], a[188:191]
v_mfma_f32_16x16x32_bf16 a[168:171], a[248:251], v[88:91], a[168:171]
v_mfma_f32_16x16x32_bf16 a[172:175], a[248:251], v[92:95], a[172:175]
v_mfma_f32_16x16x32_bf16 a[176:179], a[248:251], v[96:99], a[176:179]
v_mfma_f32_16x16x32_bf16 a[180:183], a[252:255], v[88:91], a[180:183]
v_mfma_f32_16x16x32_bf16 a[184:187], a[252:255], v[92:95], a[184:187]
v_mfma_f32_16x16x32_bf16 a[188:191], a[252:255], v[96:99], a[188:191]
s_add_u32 s24, s24, 8
s_add_u32 s55, s24, 2
v_mov_b32 v154, s55
s_waitcnt vmcnt(0)
s_mov_b64 exec, 1
buffer_store_dword v154, v155, s[40:43], s22 offen sc1
s_mov_b64 exec, -1
v_accvgpr_read_b32 v160, a168
v_accvgpr_read_b32 v161, a169
v_accvgpr_read_b32 v162, a170
v_accvgpr_read_b32 v163, a171
v_accvgpr_read_b32 v164, a180
v_accvgpr_read_b32 v165, a181
v_accvgpr_read_b32 v166, a182
v_accvgpr_read_b32 v167, a183
v_accvgpr_read_b32 v168, a172
v_accvgpr_read_b32 v169, a173
v_accvgpr_read_b32 v170, a174
v_accvgpr_read_b32 v171, a175
v_accvgpr_read_b32 v172, a184
v_accvgpr_read_b32 v173, a185
v_accvgpr_read_b32 v174, a186
v_accvgpr_read_b32 v175, a187
v_accvgpr_read_b32 v176, a176
v_accvgpr_read_b32 v177, a177
v_accvgpr_read_b32 v178, a178
v_accvgpr_read_b32 v179, a179
v_accvgpr_read_b32 v180, a188
v_accvgpr_read_b32 v181, a189
v_accvgpr_read_b32 v182, a190
v_accvgpr_read_b32 v183, a191
s_mov_b32 s25, 0
L_pt0:
v_and_b32 v157, 7, v153
v_cmp_eq_u32 s[68:69], v153, v255
v_cmp_gt_u32 vcc, 1, v157
s_nop 0
s_or_b32 s52, vcc_lo, s68
s_and_b32 s52, s52, 15
s_cbranch_scc0 L_pd0
buffer_load_dword v153, v152, s[40:43], s23 offen sc1
s_add_u32 s25, s25, 1
s_and_b32 s52, s25, 31
s_cbranch_scc0 L_pr0
L_pw0:
s_waitcnt vmcnt(0)
s_cmp_lt_u32 s25, 100000
s_cbranch_scc1 L_pt0
L_pd0:
s_mov_b32 s54, s26
s_xor_b32 s52, s10, 0
s_mul_i32 s52, s52, 3072
s_add_u32 s52, s52, s54
buffer_load_dwordx4 v[4:7], v253, s[40:43], s52 offen sc1
buffer_load_dwordx4 v[8:11], v253, s[40:43], s52 offen offset:1024 sc1
buffer_load_dwordx4 v[12:15], v253, s[40:43], s52 offen offset:2048 sc1
s_xor_b32 s52, s10, 1
s_mul_i32 s52, s52, 3072
s_add_u32 s52, s52, s54
buffer_load_dwordx4 v[16:19], v253, s[40:43], s52 offen sc1
buffer_load_dwordx4 v[20:23], v253, s[40:43], s52 offen offset:1024 sc1
buffer_load_dwordx4 v[24:27], v253, s[40:43], s52 offen offset:2048 sc1
s_xor_b32 s52, s10, 2
s_mul_i32 s52, s52, 3072
s_add_u32 s52, s52, s54
buffer_load_dwordx4 v[28:31], v253, s[40:43], s52 offen sc1
buffer_load_dwordx4 v[32:35], v253, s[40:43], s52 offen offset:1024 sc1
buffer_load_dwordx4 v[36:39], v253, s[40:43], s52 offen offset:2048 sc1
s_xor_b32 s52, s10, 3
s_mul_i32 s52, s52, 3072
s_add_u32 s52, s52, s54
buffer_load_dwordx4 v[40:43], v253, s[40:43], s52 offen sc1
buffer_load_dwordx4 v[44:47], v253, s[40:43], s52 offen offset:1024 sc1
buffer_load_dwordx4 v[48:51], v253, s[40:43], s52 offen offset:2048 sc1
v_and_b32 v157, 7, v153
v_cmp_eq_u32 s[68:69], v153, v255
v_cmp_gt_u32 vcc, 2, v157
s_nop 0
s_or_b32 s52, vcc_lo, s68
s_and_b32 s52, s52, 112
s_cselect_b32 s62, 1, 0
s_cselect_b32 s54, 2146435072, s26
s_xor_b32 s52, s10, 4
s_mul_i32 s52, s52, 3072
s_add_u32 s52, s52, s54
buffer_load_dwordx4 v[52:55], v253, s[40:43], s52 offen sc1
buffer_load_dwordx4 v[56:59], v253, s[40:43], s52 offen offset:1024 sc1
buffer_load_dwordx4 v[60:63], v253, s[40:43], s52 offen offset:2048 sc1
s_xor_b32 s52, s10, 5
s_mul_i32 s52, s52, 3072
s_add_u32 s52, s52, s54
buffer_load_dwordx4 v[64:67], v253, s[40:43], s52 offen sc1
buffer_load_dwordx4 v[68:71], v253, s[40:43], s52 offen offset:1024 sc1
buffer_load_dwordx4 v[72:75], v253, s[40:43], s52 offen offset:2048 sc1
s_xor_b32 s52, s10, 6
s_mul_i32 s52, s52, 3072
s_add_u32 s52, s52, s54
buffer_load_dwordx4 v[76:79], v253, s[40:43], s52 offen sc1
buffer_load_dwordx4 v[80:83], v253, s[40:43], s52 offen offset:1024 sc1
buffer_load_dwordx4 v[84:87], v253, s[40:43], s52 offen offset:2048 sc1
buffer_load_dword v153, v152, s[40:43], s23 offen sc1
s_cmp_eq_u32 s62, 0
s_cbranch_scc1 L_second
s_waitcnt vmcnt(0)
v_and_b32 v157, 7, v153
v_cmp_eq_u32 s[68:69], v153, v255
v_cmp_gt_u32 vcc, 2, v157
s_nop 0
s_or_b32 s52, vcc_lo, s68
s_and_b32 s52, s52, 112
s_cselect_b32 s62, 1, 0
s_cselect_b32 s54, 2146435072, s26
s_xor_b32 s52, s10, 4
s_mul_i32 s52, s52, 3072
s_add_u32 s52, s52, s54
buffer_load_dwordx4 v[52:55], v253, s[40:43], s52 offen sc1
buffer_load_dwordx4 v[56:59], v253, s[40:43], s52 offen offset:1024 sc1
buffer_load_dwordx4 v[60:63], v253, s[40:43], s52 offen offset:2048 sc1
s_xor_b32 s52, s10, 5
s_mul_i32 s52, s52, 3072
s_add_u32 s52, s52, s54
buffer_load_dwordx4 v[64:67], v253, s[40:43], s52 offen sc1
buffer_load_dwordx4 v[68:71], v253, s[40:43], s52 offen offset:1024 sc1
buffer_load_dwordx4 v[72:75], v253, s[40:43], s52 offen offset:2048 sc1
s_xor_b32 s52, s10, 6
s_mul_i32 s52, s52, 3072
s_add_u32 s52, s52, s54
buffer_load_dwordx4 v[76:79], v253, s[40:43], s52 offen sc1
buffer_load_dwordx4 v[80:83], v253, s[40:43], s52 offen offset:1024 sc1
buffer_load_dwordx4 v[84:87], v253, s[40:43], s52 offen offset:2048 sc1
buffer_load_dword v153, v152, s[40:43], s23 offen sc1
L_second:
s_waitcnt vmcnt(10)
v_dot2_f32_bf16 v160, v4, s96, v160
v_dot2_f32_bf16 v161, v4, s97, v161
v_dot2_f32_bf16 v162, v5, s96, v162
v_dot2_f32_bf16 v163, v5, s97, v163
v_dot2_f32_bf16 v164, v6, s96, v164
v_dot2_f32_bf16 v165, v6, s97, v165
v_dot2_f32_bf16 v166, v7, s96, v166
v_dot2_f32_bf16 v167, v7, s97, v167
v_dot2_f32_bf16 v160, v16, s96, v160
v_dot2_f32_bf16 v161, v16, s97, v161
v_dot2_f32_bf16 v162, v17, s96, v162
v_dot2_f32_bf16 v163, v17, s97, v163
v_dot2_f32_bf16 v164, v18, s96, v164
v_dot2_f32_bf16 v165, v18, s97, v165
v_dot2_f32_bf16 v166, v19, s96, v166
v_dot2_f32_bf16 v167, v19, s97, v167
v_dot2_f32_bf16 v160, v28, s96, v160
v_dot2_f32_bf16 v161, v28, s97, v161
v_dot2_f32_bf16 v162, v29, s96, v162
v_dot2_f32_bf16 v163, v29, s97, v163
v_dot2_f32_bf16 v164, v30, s96, v164
v_dot2_f32_bf16 v165, v30, s97, v165
v_dot2_f32_bf16 v166, v31, s96, v166
v_dot2_f32_bf16 v167, v31, s97, v167
v_dot2_f32_bf16 v160, v40, s96, v160
v_dot2_f32_bf16 v161, v40, s97, v161
v_dot2_f32_bf16 v162, v41, s96, v162
v_dot2_f32_bf16 v163, v41, s97, v163
v_dot2_f32_bf16 v164, v42, s96, v164
v_dot2_f32_bf16 v165, v42, s97, v165
v_dot2_f32_bf16 v166, v43, s96, v166
v_dot2_f32_bf16 v167, v43, s97, v167
v_dot2_f32_bf16 v168, v8, s96, v168
v_dot2_f32_bf16 v169, v8, s97, v169
v_dot2_f32_bf16 v170, v9, s96, v170
v_dot2_f32_bf16 v171, v9, s97, v171
v_dot2_f32_bf16 v172, v10, s96, v172
v_dot2_f32_bf16 v173, v10, s97, v173
v_dot2_f32_bf16 v174, v11, s96, v174
v_dot2_f32_bf16 v175, v11, s97, v175
v_dot2_f32_bf16 v168, v20, s96, v168
v_dot2_f32_bf16 v169, v20, s97, v169
v_dot2_f32_bf16 v170, v21, s96, v170
v_dot2_f32_bf16 v171, v21, s97, v171
v_dot2_f32_bf16 v172, v22, s96, v172
v_dot2_f32_bf16 v173, v22, s97, v173
v_dot2_f32_bf16 v174, v23, s96, v174
v_dot2_f32_bf16 v175, v23, s97, v175
v_dot2_f32_bf16 v168, v32, s96, v168
v_dot2_f32_bf16 v169, v32, s97, v169
v_dot2_f32_bf16 v170, v33, s96, v170
v_dot2_f32_bf16 v171, v33, s97, v171
v_dot2_f32_bf16 v172, v34, s96, v172
v_dot2_f32_bf16 v173, v34, s97, v173
v_dot2_f32_bf16 v174, v35, s96, v174
v_dot2_f32_bf16 v175, v35, s97, v175
v_dot2_f32_bf16 v168, v44, s96, v168
v_dot2_f32_bf16 v169, v44, s97, v169
v_dot2_f32_bf16 v170, v45, s96, v170
v_dot2_f32_bf16 v171, v45, s97, v171
v_dot2_f32_bf16 v172, v46, s96, v172
v_dot2_f32_bf16 v173, v46, s97, v173
v_dot2_f32_bf16 v174, v47, s96, v174
v_dot2_f32_bf16 v175, v47, s97, v175
v_dot2_f32_bf16 v176, v12, s96, v176
v_dot2_f32_bf16 v177, v12, s97, v177
v_dot2_f32_bf16 v178, v13, s96, v178
v_dot2_f32_bf16 v179, v13, s97, v179
v_dot2_f32_bf16 v180, v14, s96, v180
v_dot2_f32_bf16 v181, v14, s97, v181
v_dot2_f32_bf16 v182, v15, s96, v182
v_dot2_f32_bf16 v183, v15, s97, v183
v_dot2_f32_bf16 v176, v24, s96, v176
v_dot2_f32_bf16 v177, v24, s97, v177
v_dot2_f32_bf16 v178, v25, s96, v178
v_dot2_f32_bf16 v179, v25, s97, v179
v_dot2_f32_bf16 v180, v26, s96, v180
v_dot2_f32_bf16 v181, v26, s97, v181
v_dot2_f32_bf16 v182, v27, s96, v182
v_dot2_f32_bf16 v183, v27, s97, v183
v_dot2_f32_bf16 v176, v36, s96, v176
v_dot2_f32_bf16 v177, v36, s97, v177
v_dot2_f32_bf16 v178, v37, s96, v178
v_dot2_f32_bf16 v179, v37, s97, v179
v_dot2_f32_bf16 v180, v38, s96, v180
v_dot2_f32_bf16 v181, v38, s97, v181
v_dot2_f32_bf16 v182, v39, s96, v182
v_dot2_f32_bf16 v183, v39, s97, v183
v_dot2_f32_bf16 v176, v48, s96, v176
v_dot2_f32_bf16 v177, v48, s97, v177
v_dot2_f32_bf16 v178, v49, s96, v178
v_dot2_f32_bf16 v179, v49, s97, v179
v_dot2_f32_bf16 v180, v50, s96, v180
v_dot2_f32_bf16 v181, v50, s97, v181
v_dot2_f32_bf16 v182, v51, s96, v182
v_dot2_f32_bf16 v183, v51, s97, v183
s_cmp_eq_u32 s62, 0
s_cbranch_scc1 L_have
s_waitcnt vmcnt(0)
s_mov_b32 s25, 0
L_pt1:
v_and_b32 v157, 7, v153
v_cmp_eq_u32 s[68:69], v153, v255
v_cmp_gt_u32 vcc, 2, v157
s_nop 0
s_or_b32 s52, vcc_lo, s68
s_and_b32 s52, s52, 112
s_cbranch_scc0 L_pd1
buffer_load_dword v153, v152, s[40:43], s23 offen sc1
s_add_u32 s25, s25, 1
s_and_b32 s52, s25, 31
s_cbranch_scc0 L_pr1
L_pw1:
s_waitcnt vmcnt(0)
s_cmp_lt_u32 s25, 100000
s_cbranch_scc1 L_pt1
L_pd1:
s_mov_b32 s54, s26
s_xor_b32 s52, s10, 4
s_mul_i32 s52, s52, 3072
s_add_u32 s52, s52, s54
buffer_load_dwordx4 v[52:55], v253, s[40:43], s52 offen sc1
buffer_load_dwordx4 v[56:59], v253, s[40:43], s52 offen offset:1024 sc1
buffer_load_dwordx4 v[60:63], v253, s[40:43], s52 offen offset:2048 sc1
s_xor_b32 s52, s10, 5
s_mul_i32 s52, s52, 3072
s_add_u32 s52, s52, s54
buffer_load_dwordx4 v[64:67], v253, s[40:43], s52 offen sc1
buffer_load_dwordx4 v[68:71], v253, s[40:43], s52 offen offset:1024 sc1
buffer_load_dwordx4 v[72:75], v253, s[40:43], s52 offen offset:2048 sc1
s_xor_b32 s52, s10, 6
s_mul_i32 s52, s52, 3072
s_add_u32 s52, s52, s54
buffer_load_dwordx4 v[76:79], v253, s[40:43], s52 offen sc1
buffer_load_dwordx4 v[80:83], v253, s[40:43], s52 offen offset:1024 sc1
buffer_load_dwordx4 v[84:87], v253, s[40:43], s52 offen offset:2048 sc1
s_waitcnt vmcnt(0)
L_have:
s_waitcnt vmcnt(1)
v_dot2_f32_bf16 v160, v52, s96, v160
v_dot2_f32_bf16 v161, v52, s97, v161
v_dot2_f32_bf16 v162, v53, s96, v162
v_dot2_f32_bf16 v163, v53, s97, v163
v_dot2_f32_bf16 v164, v54, s96, v164
v_dot2_f32_bf16 v165, v54, s97, v165
v_dot2_f32_bf16 v166, v55, s96, v166
v_dot2_f32_bf16 v167, v55, s97, v167
v_dot2_f32_bf16 v160, v64, s96, v160
v_dot2_f32_bf16 v161, v64, s97, v161
v_dot2_f32_bf16 v162, v65, s96, v162
v_dot2_f32_bf16 v163, v65, s97, v163
v_dot2_f32_bf16 v164, v66, s96, v164
v_dot2_f32_bf16 v165, v66, s97, v165
v_dot2_f32_bf16 v166, v67, s96, v166
v_dot2_f32_bf16 v167, v67, s97, v167
v_dot2_f32_bf16 v160, v76, s96, v160
v_dot2_f32_bf16 v161, v76, s97, v161
v_dot2_f32_bf16 v162, v77, s96, v162
v_dot2_f32_bf16 v163, v77, s97, v163
v_dot2_f32_bf16 v164, v78, s96, v164
v_dot2_f32_bf16 v165, v78, s97, v165
v_dot2_f32_bf16 v166, v79, s96, v166
v_dot2_f32_bf16 v167, v79, s97, v167
s_nop 2
v_cvt_pk_bf16_f32 v160, v160, v161
v_cvt_pk_bf16_f32 v161, v162, v163
v_cvt_pk_bf16_f32 v162, v164, v165
v_cvt_pk_bf16_f32 v163, v166, v167
s_nop 1
v_permlane32_swap_b32 v160, v162
v_permlane32_swap_b32 v161, v163
s_nop 1
v_permlane16_swap_b32 v160, v162
v_permlane16_swap_b32 v161, v163
buffer_store_dwordx4 v[160:163], v156, s[12:15], s27 offen
s_add_u32 s27, s27, 32768
v_dot2_f32_bf16 v168, v56, s96, v168
v_dot2_f32_bf16 v169, v56, s97, v169
v_dot2_f32_bf16 v170, v57, s96, v170
v_dot2_f32_bf16 v171, v57, s97, v171
v_dot2_f32_bf16 v172, v58, s96, v172
v_dot2_f32_bf16 v173, v58, s97, v173
v_dot2_f32_bf16 v174, v59, s96, v174
v_dot2_f32_bf16 v175, v59, s97, v175
v_dot2_f32_bf16 v168, v68, s96, v168
v_dot2_f32_bf16 v169, v68, s97, v169
v_dot2_f32_bf16 v170, v69, s96, v170
v_dot2_f32_bf16 v171, v69, s97, v171
v_dot2_f32_bf16 v172, v70, s96, v172
v_dot2_f32_bf16 v173, v70, s97, v173
v_dot2_f32_bf16 v174, v71, s96, v174
v_dot2_f32_bf16 v175, v71, s97, v175
v_dot2_f32_bf16 v168, v80, s96, v168
v_dot2_f32_bf16 v169, v80, s97, v169
v_dot2_f32_bf16 v170, v81, s96, v170
v_dot2_f32_bf16 v171, v81, s97, v171
v_dot2_f32_bf16 v172, v82, s96, v172
v_dot2_f32_bf16 v173, v82, s97, v173
v_dot2_f32_bf16 v174, v83, s96, v174
v_dot2_f32_bf16 v175, v83, s97, v175
s_nop 2
v_cvt_pk_bf16_f32 v168, v168, v169
v_cvt_pk_bf16_f32 v169, v170, v171
v_cvt_pk_bf16_f32 v170, v172, v173
v_cvt_pk_bf16_f32 v171, v174, v175
s_nop 1
v_permlane32_swap_b32 v168, v170
v_permlane32_swap_b32 v169, v171
s_nop 1
v_permlane16_swap_b32 v168, v170
v_permlane16_swap_b32 v169, v171
buffer_store_dwordx4 v[168:171], v156, s[12:15], s27 offen
s_add_u32 s27, s27, 32768
v_dot2_f32_bf16 v176, v60, s96, v176
v_dot2_f32_bf16 v177, v60, s97, v177
v_dot2_f32_bf16 v178, v61, s96, v178
v_dot2_f32_bf16 v179, v61, s97, v179
v_dot2_f32_bf16 v180, v62, s96, v180
v_dot2_f32_bf16 v181, v62, s97, v181
v_dot2_f32_bf16 v182, v63, s96, v182
v_dot2_f32_bf16 v183, v63, s97, v183
v_dot2_f32_bf16 v176, v72, s96, v176
v_dot2_f32_bf16 v177, v72, s97, v177
v_dot2_f32_bf16 v178, v73, s96, v178
v_dot2_f32_bf16 v179, v73, s97, v179
v_dot2_f32_bf16 v180, v74, s96, v180
v_dot2_f32_bf16 v181, v74, s97, v181
v_dot2_f32_bf16 v182, v75, s96, v182
v_dot2_f32_bf16 v183, v75, s97, v183
v_dot2_f32_bf16 v176, v84, s96, v176
v_dot2_f32_bf16 v177, v84, s97, v177
v_dot2_f32_bf16 v178, v85, s96, v178
v_dot2_f32_bf16 v179, v85, s97, v179
v_dot2_f32_bf16 v180, v86, s96, v180
v_dot2_f32_bf16 v181, v86, s97, v181
v_dot2_f32_bf16 v182, v87, s96, v182
v_dot2_f32_bf16 v183, v87, s97, v183
s_nop 2
v_cvt_pk_bf16_f32 v176, v176, v177
v_cvt_pk_bf16_f32 v177, v178, v179
v_cvt_pk_bf16_f32 v178, v180, v181
v_cvt_pk_bf16_f32 v179, v182, v183
s_nop 1
v_permlane32_swap_b32 v176, v178
v_permlane32_swap_b32 v177, v179
s_nop 1
v_permlane16_swap_b32 v176, v178
v_permlane16_swap_b32 v177, v179
buffer_store_dwordx4 v[176:179], v156, s[12:15], s27 offen
L_end:
s_endpgm
L_rare:
v_mov_b32 v247, v244
v_mov_b32 v248, v245
v_mov_b32 v249, v246
s_nop 1
v_permlane32_swap_b32 v244, v247
v_permlane32_swap_b32 v245, v248
v_permlane32_swap_b32 v246, v249
v_max_f32 v244, v244, v247
v_max_f32 v245, v245, v248
v_max_f32 v246, v246, v249
v_mov_b32 v247, v244
v_mov_b32 v248, v245
v_mov_b32 v249, v246
s_nop 1
v_permlane16_swap_b32 v244, v247
v_permlane16_swap_b32 v245, v248
v_permlane16_swap_b32 v246, v249
v_max3_f32 v244, v244, v247, 0
v_max3_f32 v245, v245, v248, 0
v_max3_f32 v246, v246, v249, 0
v_exp_f32 v247, -v244
v_exp_f32 v248, -v245
v_exp_f32 v249, -v246
v_sub_f32 v124, v124, v244
v_sub_f32 v125, v125, v244
v_sub_f32 v126, v126, v244
v_sub_f32 v127, v127, v244
v_sub_f32 v136, v136, v244
v_sub_f32 v137, v137, v244
v_sub_f32 v138, v138, v244
v_sub_f32 v139, v139, v244
v_sub_f32 v112, v112, v244
v_sub_f32 v113, v113, v244
v_sub_f32 v114, v114, v244
v_sub_f32 v115, v115, v244
v_sub_f32 v128, v128, v245
v_sub_f32 v129, v129, v245
v_sub_f32 v130, v130, v245
v_sub_f32 v131, v131, v245
v_sub_f32 v140, v140, v245
v_sub_f32 v141, v141, v245
v_sub_f32 v142, v142, v245
v_sub_f32 v143, v143, v245
v_sub_f32 v116, v116, v245
v_sub_f32 v117, v117, v245
v_sub_f32 v118, v118, v245
v_sub_f32 v119, v119, v245
v_sub_f32 v132, v132, v246
v_sub_f32 v133, v133, v246
v_sub_f32 v134, v134, v246
v_sub_f32 v135, v135, v246
v_sub_f32 v144, v144, v246
v_sub_f32 v145, v145, v246
v_sub_f32 v146, v146, v246
v_sub_f32 v147, v147, v246
v_sub_f32 v120, v120, v246
v_sub_f32 v121, v121, v246
v_sub_f32 v122, v122, v246
v_sub_f32 v123, v123, v246
v_mul_f32 v4, v4, v247
v_mul_f32 v5, v5, v247
v_mul_f32 v6, v6, v247
v_mul_f32 v7, v7, v247
v_mul_f32 v16, v16, v247
v_mul_f32 v17, v17, v247
v_mul_f32 v18, v18, v247
v_mul_f32 v19, v19, v247
v_mul_f32 v28, v28, v247
v_mul_f32 v29, v29, v247
v_mul_f32 v30, v30, v247
v_mul_f32 v31, v31, v247
v_mul_f32 v40, v40, v247
v_mul_f32 v41, v41, v247
v_mul_f32 v42, v42, v247
v_mul_f32 v43, v43, v247
v_mul_f32 v52, v52, v247
v_mul_f32 v53, v53, v247
v_mul_f32 v54, v54, v247
v_mul_f32 v55, v55, v247
v_mul_f32 v64, v64, v247
v_mul_f32 v65, v65, v247
v_mul_f32 v66, v66, v247
v_mul_f32 v67, v67, v247
v_mul_f32 v76, v76, v247
v_mul_f32 v77, v77, v247
v_mul_f32 v78, v78, v247
v_mul_f32 v79, v79, v247
v_mul_f32 v88, v88, v247
v_mul_f32 v89, v89, v247
v_mul_f32 v90, v90, v247
v_mul_f32 v91, v91, v247
v_mul_f32 v100, v100, v247
v_mul_f32 v101, v101, v247
v_mul_f32 v102, v102, v247
v_mul_f32 v103, v103, v247
v_mul_f32 v8, v8, v248
v_mul_f32 v9, v9, v248
v_mul_f32 v10, v10, v248
v_mul_f32 v11, v11, v248
v_mul_f32 v20, v20, v248
v_mul_f32 v21, v21, v248
v_mul_f32 v22, v22, v248
v_mul_f32 v23, v23, v248
v_mul_f32 v32, v32, v248
v_mul_f32 v33, v33, v248
v_mul_f32 v34, v34, v248
v_mul_f32 v35, v35, v248
v_mul_f32 v44, v44, v248
v_mul_f32 v45, v45, v248
v_mul_f32 v46, v46, v248
v_mul_f32 v47, v47, v248
v_mul_f32 v56, v56, v248
v_mul_f32 v57, v57, v248
v_mul_f32 v58, v58, v248
v_mul_f32 v59, v59, v248
v_mul_f32 v68, v68, v248
v_mul_f32 v69, v69, v248
v_mul_f32 v70, v70, v248
v_mul_f32 v71, v71, v248
v_mul_f32 v80, v80, v248
v_mul_f32 v81, v81, v248
v_mul_f32 v82, v82, v248
v_mul_f32 v83, v83, v248
v_mul_f32 v92, v92, v248
v_mul_f32 v93, v93, v248
v_mul_f32 v94, v94, v248
v_mul_f32 v95, v95, v248
v_mul_f32 v104, v104, v248
v_mul_f32 v105, v105, v248
v_mul_f32 v106, v106, v248
v_mul_f32 v107, v107, v248
v_mul_f32 v12, v12, v249
v_mul_f32 v13, v13, v249
v_mul_f32 v14, v14, v249
v_mul_f32 v15, v15, v249
v_mul_f32 v24, v24, v249
v_mul_f32 v25, v25, v249
v_mul_f32 v26, v26, v249
v_mul_f32 v27, v27, v249
v_mul_f32 v36, v36, v249
v_mul_f32 v37, v37, v249
v_mul_f32 v38, v38, v249
v_mul_f32 v39, v39, v249
v_mul_f32 v48, v48, v249
v_mul_f32 v49, v49, v249
v_mul_f32 v50, v50, v249
v_mul_f32 v51, v51, v249
v_mul_f32 v60, v60, v249
v_mul_f32 v61, v61, v249
v_mul_f32 v62, v62, v249
v_mul_f32 v63, v63, v249
v_mul_f32 v72, v72, v249
v_mul_f32 v73, v73, v249
v_mul_f32 v74, v74, v249
v_mul_f32 v75, v75, v249
v_mul_f32 v84, v84, v249
v_mul_f32 v85, v85, v249
v_mul_f32 v86, v86, v249
v_mul_f32 v87, v87, v249
v_mul_f32 v96, v96, v249
v_mul_f32 v97, v97, v249
v_mul_f32 v98, v98, v249
v_mul_f32 v99, v99, v249
v_mul_f32 v108, v108, v249
v_mul_f32 v109, v109, v249
v_mul_f32 v110, v110, v249
v_mul_f32 v111, v111, v249
s_setpc_b64 s[68:69]
L_rs3:
s_call_b64 s[68:69], L_rare
s_branch L_rb3
L_rs4:
s_call_b64 s[68:69], L_rare
s_branch L_rb4
L_rs7:
s_call_b64 s[68:69], L_rare
s_branch L_rb7
L_rs8:
s_call_b64 s[68:69], L_rare
s_branch L_rb8
L_rs9:
s_call_b64 s[68:69], L_rare
s_branch L_rb9
L_rs10:
s_call_b64 s[68:69], L_rare
s_branch L_rb10
L_rs11:
s_call_b64 s[68:69], L_rare
s_branch L_rb11
L_rs12:
s_call_b64 s[68:69], L_rare
s_branch L_rb12
L_rs13:
s_call_b64 s[68:69], L_rare
s_branch L_rb13
L_rs14:
s_call_b64 s[68:69], L_rare
s_branch L_rb14
L_rs17:
s_call_b64 s[68:69], L_rare
s_branch L_rb17
L_rs18:
s_call_b64 s[68:69], L_rare
s_branch L_rb18
L_rs19:
s_call_b64 s[68:69], L_rare
s_branch L_rb19
L_rs20:
s_call_b64 s[68:69], L_rare
s_branch L_rb20
L_rs21:
s_call_b64 s[68:69], L_rare
s_branch L_rb21
L_rs22:
s_call_b64 s[68:69], L_rare
s_branch L_rb22
L_rs23:
s_call_b64 s[68:69], L_rare
s_branch L_rb23
L_rs26:
s_call_b64 s[68:69], L_rare
s_branch L_rb26
L_rs27:
s_call_b64 s[68:69], L_rare
s_branch L_rb27
L_rs28:
s_call_b64 s[68:69], L_rare
s_branch L_rb28
L_rs29:
s_call_b64 s[68:69], L_rare
s_branch L_rb29
L_rs30:
s_call_b64 s[68:69], L_rare
s_branch L_rb30
L_rs31:
s_call_b64 s[68:69], L_rare
s_branch L_rb31
L_rs32:
s_call_b64 s[68:69], L_rare
s_branch L_rb32
L_rs33:
s_call_b64 s[68:69], L_rare
s_branch L_rb33
L_rs36:
s_call_b64 s[68:69], L_rare
s_branch L_rb36
L_rs37:
s_call_b64 s[68:69], L_rare
s_branch L_rb37
L_rs38:
s_call_b64 s[68:69], L_rare
s_branch L_rb38
L_rs39:
s_call_b64 s[68:69], L_rare
s_branch L_rb39
L_rs40:
s_call_b64 s[68:69], L_rare
s_branch L_rb40
L_pr0:
s_add_u32 s24, s24, 8
s_add_u32 s55, s24, 2
v_mov_b32 v154, s55
s_waitcnt vmcnt(63)
s_mov_b64 exec, 1
buffer_store_dword v154, v155, s[40:43], s22 offen sc1
s_mov_b64 exec, -1
s_branch L_pw0
L_pr1:
s_add_u32 s24, s24, 8
s_add_u32 s55, s24, 2
v_mov_b32 v154, s55
s_waitcnt vmcnt(63)
s_mov_b64 exec, 1
buffer_store_dword v154, v155, s[40:43], s22 offen sc1
s_mov_b64 exec, -1
s_branch L_pw1
L_codeend:
.section .rodata,"a"
.p2align 6
.amdhsa_kernel concat_heads__mha_block_cached__mha_block_cached__near_ridge_kernel
  .amdhsa_next_free_vgpr 512
  .amdhsa_next_free_sgpr 100
  .amdhsa_accum_offset 256
  .amdhsa_group_segment_fixed_size 0
  .amdhsa_kernarg_size 104
  .amdhsa_user_sgpr_count 2
  .amdhsa_user_sgpr_kernarg_segment_ptr 1
  .amdhsa_system_sgpr_workgroup_id_x 1
.end_amdhsa_kernel
```
